```python
import torch

def _softmax(x, axis=-1):
    return torch.softmax(x, dim=axis)
def _gelu(x):
    return torch.nn.functional.gelu(x, approximate="tanh")
def _silu(x):
    return torch.nn.functional.silu(x)
def _sigmoid(x):
    return torch.sigmoid(x)
def _layernorm(x, axis=-1, eps=1e-5):
    m = x.mean(dim=axis, keepdim=True)
    v = x.var(dim=axis, keepdim=True, unbiased=False)
    return (x - m) / torch.sqrt(v + eps)
def _scatter_add(tgt, idx, src, axis=0):
    return tgt.clone().index_add_(axis, idx, src)
def _segment_sum(src, seg, n):
    out = torch.zeros((n,) + src.shape[1:], dtype=src.dtype)
    return out.index_add_(0, seg, src)
def _pad(x, pw):
    flat = tuple(v for pair in reversed(pw) for v in pair)
    return torch.nn.functional.pad(x, flat)

kernel_name = 'interleave_layers__sliding_local_dilated__moe_arch_mod__prompt'

def setup_inputs():

    _w = (lambda a: (lambda t: t.to(torch.bfloat16) if t.is_floating_point() else t)(torch.as_tensor(a)))
    def _A_setup():
        B, S, D = 1, 2048, 576
        return {
            "x": _w((lambda *s: torch.randn(*s, dtype=torch.bfloat16) * 0.05)(B, S, D)),
            "wqkv": _w((lambda *s: torch.randn(*s, dtype=torch.bfloat16) * 0.05)(D, 3 * D)),
            "wo": _w((lambda *s: torch.randn(*s, dtype=torch.bfloat16) * 0.05)(D, D)),
        }
    _A_in = _A_setup()

    def _B_setup():
        B, S, D, F, C = 1, 2048, 576, 4608, 1
        return {
            "x": _w((lambda *s: torch.randn(*s, dtype=torch.bfloat16) * 0.05)(B, S, D)),
            "w_r": _w((lambda *s: torch.randn(*s, dtype=torch.bfloat16) * 0.05)(D)),
            "w_gate": _w((lambda *s: torch.randn(*s, dtype=torch.bfloat16) * 0.05)(D, F)),
            "w_up": _w((lambda *s: torch.randn(*s, dtype=torch.bfloat16) * 0.05)(D, F)),
            "w_down": _w((lambda *s: torch.randn(*s, dtype=torch.bfloat16) * 0.05)(F, D)),
        }
    _B_in = _B_setup()

    return {
        "A_x": _A_in["x"],
        "A_wqkv": _A_in["wqkv"],
        "A_wo": _A_in["wo"],
        "B_x": _B_in["x"],
        "B_w_r": _B_in["w_r"],
        "B_w_gate": _B_in["w_gate"],
        "B_w_up": _B_in["w_up"],
        "B_w_down": _B_in["w_down"],
    }

def reference(A_x, A_wqkv, A_wo, B_x, B_w_r, B_w_gate, B_w_up, B_w_down):
    def _A_ref(x, wqkv, wo):
        B, S, D = x.shape
        H = 32; Dh = D // H
        W, dil = 8, 2
        qkv = (lambda x, *d: x.permute(*d))((x @ wqkv).reshape(B, S, 3, H, Dh), 2, 0, 3, 1, 4)
        q, k, v = qkv[0], qkv[1], qkv[2]
        scale = Dh ** -0.5
        pos = torch.arange(S)
        off = torch.arange(W) * dil
        idx = pos[:, None] - off[None, :]
        mask = idx >= 0
        idx_c = torch.where(mask, idx, 0).reshape(-1)
        kg = k[:, :, idx_c, :].reshape(B, H, S, W, Dh)
        vg = v[:, :, idx_c, :].reshape(B, H, S, W, Dh)
        logits = torch.einsum("bhsd,bhswd->bhsw", q, kg) * scale
        logits = torch.where(mask[None, None, :, :], logits, -1e9)
        attn = _softmax(logits, axis=-1)
        o = torch.einsum("bhsw,bhswd->bhsd", attn, vg)
        return (lambda x, *d: x.permute(*d))(o, 0, 2, 1, 3).reshape(B, S, D) @ wo

    def _B_ref(x, w_r, w_gate, w_up, w_down):
        B, S, D = x.shape
        C = 1
        r = x @ w_r
        idx = torch.argsort(-r, axis=-1)[:, :C]
        idx_e = (lambda x, n, axis: torch.repeat_interleave(x, n, dim=axis))(idx.reshape(B, C, 1), D, axis=2)
        x_sel = (lambda x, i, axis: torch.take_along_dim(x, i, dim=axis))(x, idx_e, axis=1)
        g = _silu(x_sel @ w_gate)
        u = x_sel @ w_up
        y = (g * u) @ w_down
        r_sel = _sigmoid((lambda x, i, axis: torch.take_along_dim(x, i, dim=axis))(r, idx, axis=1))
        y = y * r_sel.reshape(B, C, 1)
        b_off = (torch.arange(B) * S).reshape(B, 1)
        flat_idx = (idx + b_off).reshape(B * C)
        zero = (x * 0.0).reshape(B * S, D)
        upd = _scatter_add(zero, flat_idx, y.reshape(B * C, D), axis=0)
        return x + upd.reshape(B, S, D)

    x = A_x
    x = x + _A_ref(_layernorm(x, axis=-1), A_wqkv, A_wo)
    x = x + _B_ref(_layernorm(x, axis=-1), B_w_r, B_w_gate, B_w_up, B_w_down)
    x = x + _A_ref(_layernorm(x, axis=-1), A_wqkv, A_wo)
    x = x + _B_ref(_layernorm(x, axis=-1), B_w_r, B_w_gate, B_w_up, B_w_down)
    return x
```

```asm
; @launch grid=(256,1,1) block=(256,1,1) lds=163840
.amdgcn_target "amdgcn-amd-amdhsa--gfx950"
.text
.globl interleave_layers__sliding_local_dilated__moe_arch_mod__prompt_kernel
.p2align 8
.type interleave_layers__sliding_local_dilated__moe_arch_mod__prompt_kernel,@function
interleave_layers__sliding_local_dilated__moe_arch_mod__prompt_kernel:
s_cmp_ge_u32 s2, 256
s_cbranch_scc1 L_exit
s_load_dwordx2 s[12:13], s[0:1], 8
s_load_dwordx2 s[8:9], s[0:1], 0
s_load_dwordx2 s[16:17], s[0:1], 16
s_load_dwordx2 s[24:25], s[0:1], 80
s_getpc_b64 s[48:49]
L_pc:
s_lshr_b32 s75, s2, 3
s_mov_b32 s50, L_hotend-L_pc
s_mov_b32 s51, 0x20000
v_lshrrev_b32 v1, 4, v0
v_lshlrev_b32 v1, 7, v1
s_lshl_b32 s3, s75, 11
buffer_load_dword v18, v1, s[48:51], s3 offen
v_lshrrev_b32 v2, 6, v0
s_and_b32 s74, s2, 7
v_readfirstlane_b32 s77, v2
s_load_dwordx2 s[40:41], s[0:1], 56
s_load_dwordx2 s[32:33], s[0:1], 40
s_load_dwordx2 s[36:37], s[0:1], 48
s_load_dwordx2 s[20:21], s[0:1], 32
s_load_dwordx2 s[28:29], s[0:1], 64
v_and_b32 v0, 63, v0
s_and_b32 s76, s75, 7
s_lshr_b32 s3, s75, 3
s_lshl_b32 s78, s74, 2
s_add_u32 s78, s78, s3
s_lshr_b32 s63, s78, 4
s_and_b32 s79, s78, 15
v_lshlrev_b32 v5, 4, v0
s_mov_b32 s10, 2359296
s_mov_b32 s11, 0x20000
s_cmp_lg_u32 s77, 0
s_cbranch_scc1 L_1
v_mul_u32_u24 v22, 7282, v0
v_lshrrev_b32 v22, 16, v22
s_mov_b32 s18, 663552
s_mov_b32 s19, 0x20000
s_mov_b32 s14, 1990656
s_mov_b32 s15, 0x20000
s_mul_i32 s7, s76, 144
s_mov_b32 m0, 84352
v_mul_u32_u24 v67, 1008, v22
v_add_u32 v67, v67, v5
s_cmp_ge_u32 s78, 27
s_cbranch_scc1 L_2
s_mul_i32 s58, s78, 43
s_lshr_b32 s58, s58, 7
s_mul_i32 s57, s58, 3
s_sub_u32 s57, s78, s57
v_mul_u32_u24 v22, 3312, v22
v_add_u32 v22, v22, v5
s_mul_i32 s6, s58, 221184
s_add_u32 s6, s6, s7
s_mul_i32 s5, s57, 1152
s_add_u32 s6, s6, s5
s_waitcnt lgkmcnt(0)
buffer_load_dwordx4 v22, s[12:15], s6 offen lds
s_add_u32 m0, m0, 1008
s_add_u32 s6, s6, 24192
buffer_load_dwordx4 v22, s[12:15], s6 offen lds
s_add_u32 m0, m0, 1008
s_add_u32 s6, s6, 24192
buffer_load_dwordx4 v22, s[12:15], s6 offen lds
s_add_u32 m0, m0, 1008
s_add_u32 s6, s6, 24192
buffer_load_dwordx4 v22, s[12:15], s6 offen lds
s_add_u32 m0, m0, 1008
s_add_u32 s6, s6, 24192
buffer_load_dwordx4 v22, s[12:15], s6 offen lds
s_add_u32 m0, m0, 1008
s_add_u32 s6, s6, 24192
buffer_load_dwordx4 v22, s[12:15], s6 offen lds
s_add_u32 m0, m0, 1008
s_add_u32 s6, s6, 24192
buffer_load_dwordx4 v22, s[12:15], s6 offen lds
s_add_u32 m0, m0, 1008
s_add_u32 s6, s6, 24192
buffer_load_dwordx4 v22, s[12:15], s6 offen lds
s_add_u32 m0, m0, 1008
s_add_u32 s6, s6, 24192
buffer_load_dwordx4 v22, s[12:15], s6 offen lds
s_add_u32 m0, m0, 1008
s_add_u32 s6, s6, 24192
s_mov_b64 exec, 511
buffer_load_dwordx4 v22, s[12:15], s6 offen lds
L_3:
s_and_b32 s5, s78, 1
s_mul_i32 s6, s78, 9
s_add_u32 s6, s6, s5
s_mul_i32 s6, s6, 2304
s_add_u32 s6, s6, s7
s_mov_b32 exec_lo, 0xffffffff
s_mov_b32 exec_hi, 0xf
s_mov_b32 m0, 93568
s_nop 0
buffer_load_dwordx4 v67, s[16:19], s6 offen lds
s_mov_b32 m0, 94144
s_add_u32 s6, s6, 4608
buffer_load_dwordx4 v67, s[16:19], s6 offen lds
s_mov_b32 m0, 94720
s_add_u32 s6, s6, 4608
buffer_load_dwordx4 v67, s[16:19], s6 offen lds
s_mov_b32 m0, 95296
s_add_u32 s6, s6, 4608
buffer_load_dwordx4 v67, s[16:19], s6 offen lds
s_mov_b64 exec, -1
s_lshl_b32 s3, s79, 7
s_add_u32 s3, s3, s63
s_mul_i32 s4, s76, 18
s_add_u32 s3, s3, s4
s_sub_u32 s3, s3, 16
s_mul_i32 s3, s3, 1152
v_mul_u32_u24 v23, 7282, v0
v_lshrrev_b32 v23, 16, v23
v_mul_u32_u24 v23, 1152, v23
v_lshl_add_u32 v23, v0, 7, v23
v_add_u32 v23, s3, v23
v_add_u32 v24, 16128, v23
buffer_load_dword v18, v23, s[8:11], 0 offen
s_mov_b64 exec, 262142
buffer_load_dword v18, v24, s[8:11], 0 offen
s_mov_b64 exec, -1
s_branch L_4
L_2:
s_sub_u32 s58, s78, 27
s_min_u32 s58, s58, 3
s_mul_i32 s6, s58, 165888
s_add_u32 s6, s6, 18432
s_add_u32 s6, s6, s7
s_mov_b32 exec_lo, 0xffffffff
s_mov_b32 exec_hi, 0xf
s_mov_b32 m0, 84352
s_waitcnt lgkmcnt(0)
buffer_load_dwordx4 v67, s[16:19], s6 offen lds
s_mov_b32 m0, 84928
s_add_u32 s6, s6, 41472
buffer_load_dwordx4 v67, s[16:19], s6 offen lds
s_mov_b32 m0, 85504
s_add_u32 s6, s6, 41472
buffer_load_dwordx4 v67, s[16:19], s6 offen lds
s_mov_b32 m0, 86080
s_add_u32 s6, s6, 41472
buffer_load_dwordx4 v67, s[16:19], s6 offen lds
s_branch L_3
L_1:
s_mov_b32 s22, 1152
s_mov_b32 s23, 0x20000
s_lshl_b32 s3, s79, 7
s_add_u32 s3, s3, s63
s_mul_i32 s3, s3, 1152
v_min_u32 v23, 26, v0
s_mul_i32 s4, s76, 3
s_add_u32 s4, s4, s77
s_mul_i32 s4, s4, 6912
s_add_u32 s4, s4, s3
s_sub_u32 s4, s4, 25344
v_mul_u32_u24 v22, 7282, v23
v_lshrrev_b32 v22, 16, v22
v_mul_u32_u24 v22, 1152, v22
v_lshl_add_u32 v22, v23, 7, v22
v_add_u32 v67, s4, v22
s_mov_b32 s26, 16777216
s_mov_b32 s27, 0x20000
s_cmp_eq_u32 s77, 1
s_cbranch_scc0 L_8
s_lshl_b32 s4, s78, 3
s_add_u32 s4, s4, s76
s_lshl_b32 s4, s4, 9
s_add_u32 s4, s4, 65536
v_min_u32 v22, 3, v0
v_lshl_add_u32 v22, v22, 7, s4
s_and_b32 s4, s78, 1
s_lshl1_add_u32 s4, s76, s4
s_mul_i32 s4, s4, 256
s_mul_i32 s5, s74, 4096
s_add_u32 s4, s4, s5
s_add_u32 s4, s4, 4096
v_writelane_b32 v22, s4, 4
s_lshl3_add_u32 s4, s74, s76
s_lshl_b32 s4, s4, 8
s_add_u32 s4, s4, 36864
v_writelane_b32 v22, s4, 5
s_lshl_b32 s4, s78, 8
s_add_u32 s4, s4, 53248
v_writelane_b32 v22, s4, 6
s_mul_i32 s4, s78, 286720
s_add_u32 s4, s4, 4391936
v_writelane_b32 v22, s4, 62
s_waitcnt lgkmcnt(0)
buffer_load_dword v18, v22, s[24:27], 0 offen sc1
L_8:
s_cmp_lg_u32 s77, 1
s_cbranch_scc0 L_9
s_lshl_b32 s5, s77, 10
s_add_u32 m0, s5, 160512
s_and_b32 s5, s5, 1024
s_cselect_b64 exec, 0xff, -1
s_waitcnt lgkmcnt(0)
buffer_load_dwordx4 v5, s[20:23], s5 offen lds
s_mov_b64 exec, -1
L_9:
s_sub_u32 s7, s77, 1
s_mul_i32 s58, s7, 27648
s_lshl_b32 s56, s58, 1
s_add_u32 s56, s56, s3
s_cmp_eq_u32 s79, 0
s_cselect_b32 s5, 0, 18432
s_sub_u32 s5, s3, s5
s_add_u32 s59, s56, 36864
s_cmp_eq_u32 s77, 3
s_cselect_b32 s59, s5, s59
s_cselect_b32 s57, 144, 0
s_add_u32 s57, s57, 896
L_4:
v_and_b32 v6, 15, v0
v_lshrrev_b32 v7, 4, v0
s_waitcnt lgkmcnt(0)
s_load_dword s80, s[24:25], 0
s_mov_b32 s26, 16777216
s_mov_b32 s27, 0x20000
s_mov_b32 s30, 2359296
s_mov_b32 s31, 0x20000
s_mov_b32 s46, 16711680
s_mov_b32 s47, 0x20000
s_cmp_lt_u32 s75, 18
s_cselect_b32 s95, 5308416, 0
s_mov_b32 s42, s95
s_mov_b32 s43, 0x20000
s_mov_b32 s34, s95
s_mov_b32 s35, 0x20000
s_mov_b32 s38, s95
s_mov_b32 s39, 0x20000
s_add_u32 s44, s24, 65536
s_addc_u32 s45, s25, 0
s_mov_b32 s82, 20000
s_mov_b32 s93, 0
s_mul_i32 s81, s74, 18
s_add_u32 s81, s81, s75
s_sub_u32 s83, s75, 24
s_lshl_b32 s83, s83, 3
s_add_u32 s83, s83, s74
s_cmp_eq_u32 s77, 0
s_cselect_b32 s83, s83, 99
s_mul_i32 s84, s78, 286720
s_add_u32 s84, s84, 4194304
s_cmp_eq_u32 s79, 0
s_cselect_b32 s3, 0, 286720
s_cselect_b32 s72, 0xf149f2ca, 0
s_mov_b32 s73, s72
s_sub_u32 s85, s84, s3
s_lshl_b32 s3, s76, 2
s_add_u32 s3, s3, s77
s_mul_i32 s92, s3, 62208
s_add_u32 s92, s92, 196608
s_lshl_b32 s4, s3, 9
s_add_u32 s86, s4, s84
s_lshl_b32 s4, s3, 8
s_add_u32 s4, s4, s84
s_add_u32 s87, s4, 65536
s_add_u32 s88, s4, 73728
s_lshl_b32 s4, s3, 10
s_add_u32 s4, s4, s84
s_add_u32 s89, s4, 155648
s_lshr_b32 s4, s77, 1
s_mul_i32 s4, s4, 294912
s_and_b32 s5, s77, 1
s_mul_i32 s5, s5, 36864
s_add_u32 s4, s4, s5
s_lshl_b32 s5, s81, 6
s_add_u32 s90, s4, s5
s_lshl_b32 s91, s77, 10
s_mul_i32 s81, s81, 36864
s_add_u32 s81, s81, s91
s_lshl_b32 s3, s79, 2
s_add_u32 s3, s3, s77
s_lshl_b32 s3, s3, 5
s_add_u32 s3, s3, s63
s_lshl_b32 s3, s3, 3
s_add_u32 s3, s3, s76
s_mul_i32 s94, s3, 144
v_lshrrev_b32 v28, 3, v6
v_mul_u32_u24 v28, 9216, v28
v_and_b32 v29, 7, v6
v_and_b32 v31, 6, v29
v_xor_b32 v32, v31, v7
v_lshlrev_b32 v32, 4, v32
v_lshl_add_u32 v32, v29, 7, v32
v_add_u32 v1, v32, v28
v_xor_b32 v2, 64, v1
v_cmp_gt_u32 vcc, 8, v6
v_mov_b32 v33, 74752
v_add_u32 v34, 64512, v1
v_add_u32 v35, 64512, v2
v_cndmask_b32 v3, v34, v33, vcc
v_cndmask_b32 v4, v35, v33, vcc
s_mul_i32 s3, s76, 9
s_mul_i32 s4, s77, 18432
v_lshl_add_u32 v33, v29, 7, v28
v_add_u32 v33, s4, v33
s_add_u32 s5, s3, 0
v_add_u32 v34, s5, v7
v_lshrrev_b32 v35, 3, v34
v_and_b32 v34, 7, v34
v_xor_b32 v34, v34, v31
v_lshl_add_u32 v35, v35, 10, v33
v_lshl_add_u32 v19, v34, 4, v35
s_add_u32 s5, s3, 4
v_add_u32 v34, s5, v7
v_lshrrev_b32 v35, 3, v34
v_and_b32 v34, 7, v34
v_xor_b32 v34, v34, v31
v_lshl_add_u32 v35, v35, 10, v33
v_lshl_add_u32 v20, v34, 4, v35
s_add_u32 s5, s3, 8
v_mov_b32 v34, s5
v_lshrrev_b32 v35, 3, v34
v_and_b32 v34, 7, v34
v_xor_b32 v34, v34, v31
v_lshl_add_u32 v35, v35, 10, v33
v_lshl_add_u32 v21, v34, 4, v35
v_and_b32 v34, 1, v7
v_lshl_add_u32 v21, v34, 3, v21
v_bfe_u32 v35, v0, 2, 2
v_lshl_add_u32 v35, v7, 3, v35
v_mul_u32_u24 v35, 9216, v35
v_xor_b32 v36, v34, v0
v_and_b32 v36, 3, v36
v_lshl_add_u32 v24, v36, 4, v35
v_xor_b32 v25, 32, v24
v_lshlrev_b32 v27, 4, v7
v_lshl_add_u32 v27, v6, 6, v27
v_mov_b32 v35, 1073741824
v_cmp_gt_u32 vcc, 6, v6
s_lshl_b32 s4, s78, 12
s_add_u32 s4, s4, 65536
v_cndmask_b32 v27, v35, v27, vcc
v_min_u32 v37, 31, v0
v_lshl_add_u32 v26, v37, 7, s4
s_lshl_b32 s4, s78, 8
s_add_u32 s4, s4, 53248
v_min_u32 v37, 7, v0
v_lshl_add_u32 v26, v37, 2, s4
s_lshl3_add_u32 s4, s74, s76
s_lshl_b32 s4, s4, 8
s_add_u32 s4, s4, 36736
s_mov_b32 exec_lo, 0
v_lshl_add_u32 v26, v0, 2, s4
s_mov_b32 exec_lo, -1
v_lshlrev_b32 v34, 14, v34
v_lshrrev_b32 v35, 1, v7
v_lshl_add_u32 v34, v35, 8, v34
v_lshl_add_u32 v17, v6, 4, v34
v_mov_b32 v36, 0xf149f2ca
v_mov_b32 v37, 0xffff
v_mov_b32 v38, 0xffff0000
v_lshl_add_u32 v34, v7, 2, 0
v_cmp_le_u32 s[64:65], v34, v6
v_sub_u32 v35, v6, v34
v_and_b32 v35, 8, v35
v_cmp_eq_u32 vcc, 0, v35
v_cndmask_b32 v40, 0, v37, s[64:65]
s_nop 0
v_cndmask_b32 v8, v36, 0, vcc
v_lshl_add_u32 v34, v7, 2, 1
v_cmp_le_u32 s[66:67], v34, v6
v_sub_u32 v35, v6, v34
v_and_b32 v35, 8, v35
v_cmp_eq_u32 vcc, 0, v35
v_cndmask_b32 v41, 0, v38, s[66:67]
s_nop 0
v_cndmask_b32 v9, v36, 0, vcc
v_lshl_add_u32 v34, v7, 2, 2
v_cmp_le_u32 s[68:69], v34, v6
v_sub_u32 v35, v6, v34
v_and_b32 v35, 8, v35
v_cmp_eq_u32 vcc, 0, v35
v_cndmask_b32 v42, 0, v37, s[68:69]
s_nop 0
v_cndmask_b32 v10, v36, 0, vcc
v_lshl_add_u32 v34, v7, 2, 3
v_cmp_le_u32 s[70:71], v34, v6
v_sub_u32 v35, v6, v34
v_and_b32 v35, 8, v35
v_cmp_eq_u32 vcc, 0, v35
v_cndmask_b32 v43, 0, v38, s[70:71]
s_nop 0
v_cndmask_b32 v11, v36, 0, vcc
v_or_b32 v12, v40, v41
v_or_b32 v13, v42, v43
v_and_b32 v34, 0x33, v0
v_mov_b32 v35, 0x3f80
v_mov_b32 v36, 0x3f800000
v_cmp_eq_u32 vcc, 16, v34
s_nop 1
v_cndmask_b32 v14, 0, v35, vcc
v_cmp_eq_u32 vcc, 17, v34
s_nop 1
v_cndmask_b32 v14, v14, v36, vcc
v_cmp_eq_u32 vcc, 18, v34
s_nop 1
v_cndmask_b32 v15, 0, v35, vcc
s_cmp_lg_u32 s77, 0
s_cbranch_scc1 L_5
v_bfe_u32 v30, v0, 2, 2
v_and_b32 v31, 3, v0
v_lshrrev_b32 v28, 3, v0
v_mul_u32_u24 v28, 32640, v28
v_add_u32 v28, v28, v5
v_lshlrev_b32 v29, 7, v0
v_lshrrev_b32 v33, 1, v7
v_and_b32 v34, 1, v7
v_lshl_add_u32 v36, v34, 3, v30
v_mul_u32_u24 v36, 144, v36
v_add_u32 v36, 84352, v36
v_and_b32 v35, 1, v0
v_lshl_add_u32 v44, v31, 4, v36
v_lshl_add_u32 v44, v33, 3, v44
v_lshl_add_u32 v45, v35, 3, v36
v_lshlrev_b32 v38, 7, v7
v_lshl_add_u32 v38, v6, 4, v38
v_add_u32 v38, 4096, v38
v_lshl_add_u32 v39, v33, 9, v5
s_mul_i32 s59, s76, 82944
s_add_u32 s59, s59, 2228224
s_cmp_ge_u32 s78, 27
s_cbranch_scc1 L_6
v_lshl_add_u32 v32, v7, 3, v30
v_mul_u32_u24 v32, 144, v32
v_lshl_add_u32 v40, v31, 3, v32
v_add_u32 v40, 84352, v40
v_lshrrev_b32 v33, 1, v31
v_mul_u32_u24 v33, 4464, v33
v_mul_u32_u24 v34, 72, v31
v_add3_u32 v41, v32, v33, v34
v_add_u32 v41, 84384, v41
v_bfe_u32 v33, v0, 1, 2
v_mul_u32_u24 v33, 62208, v33
v_bfe_u32 v34, v0, 3, 1
v_mul_u32_u24 v34, 3456, v34
v_lshlrev_b32 v35, 6, v35
v_add3_u32 v42, v33, v34, v35
v_lshl_add_u32 v42, v7, 4, v42
s_mul_i32 s6, s58, 6912
s_add_u32 s6, s6, s92
s_lshl_b32 s7, s57, 10
s_add_u32 s4, s6, s7
s_lshl_b32 s7, s57, 7
s_add_u32 s5, s6, s7
s_waitcnt vmcnt(6)
ds_read_b64_tr_b16 v[108:109], v40 offset:0
ds_read_b64_tr_b16 v[110:111], v40 offset:576
ds_read_b64_tr_b16 v[112:113], v40 offset:4608
ds_read_b64_tr_b16 v[114:115], v40 offset:5184
ds_read_b64_tr_b16 v[116:117], v40 offset:40
ds_read_b64_tr_b16 v[118:119], v40 offset:616
ds_read_b64_tr_b16 v[120:121], v40 offset:4648
ds_read_b64_tr_b16 v[122:123], v40 offset:5224
ds_read_b64_tr_b16 v[124:125], v40 offset:72
ds_read_b64_tr_b16 v[126:127], v40 offset:648
ds_read_b64_tr_b16 v[128:129], v40 offset:4680
ds_read_b64_tr_b16 v[130:131], v40 offset:5256
ds_read_b64_tr_b16 v[132:133], v40 offset:112
ds_read_b64_tr_b16 v[134:135], v40 offset:688
ds_read_b64_tr_b16 v[136:137], v40 offset:4720
ds_read_b64_tr_b16 v[138:139], v40 offset:5296
ds_read_b64_tr_b16 v[140:141], v41 offset:0
ds_read_b64_tr_b16 v[142:143], v41 offset:576
s_waitcnt lgkmcnt(0)
buffer_store_dwordx4 v[108:111], v5, s[24:27], s4 offen offset:0 sc1
buffer_store_dwordx4 v[112:115], v5, s[24:27], s4 offen offset:3456 sc1
s_add_u32 s4, s4, 62208
buffer_store_dwordx4 v[116:119], v5, s[24:27], s4 offen offset:0 sc1
buffer_store_dwordx4 v[120:123], v5, s[24:27], s4 offen offset:3456 sc1
s_add_u32 s4, s4, 62208
buffer_store_dwordx4 v[124:127], v5, s[24:27], s4 offen offset:0 sc1
buffer_store_dwordx4 v[128:131], v5, s[24:27], s4 offen offset:3456 sc1
s_add_u32 s4, s4, 62208
buffer_store_dwordx4 v[132:135], v5, s[24:27], s4 offen offset:0 sc1
buffer_store_dwordx4 v[136:139], v5, s[24:27], s4 offen offset:3456 sc1
buffer_store_dwordx4 v[140:143], v42, s[24:27], s5 offen offset:3072 sc1
s_waitcnt vmcnt(11)
ds_read_b64_tr_b16 v[68:69], v44 offset:9216
ds_read_b64_tr_b16 v[70:71], v44 offset:9792
ds_read_b64_tr_b16 v[72:73], v44 offset:9280
ds_read_b64_tr_b16 v[74:75], v44 offset:9856
ds_read_b64_tr_b16 v[76:77], v45 offset:9344
ds_read_b64_tr_b16 v[78:79], v45 offset:9920
s_waitcnt lgkmcnt(0)
L_7:
s_lshr_b32 s3, s78, 1
s_mul_i32 s3, s3, 4608
s_add_u32 s60, s59, s3
s_and_b32 s3, s78, 1
s_lshl_b32 s3, s3, 8
s_add_u32 s60, s60, s3
s_add_u32 s56, s60, s3
buffer_store_dwordx4 v[68:71], v39, s[24:27], s56 offen offset:0 sc1
buffer_store_dwordx4 v[72:75], v39, s[24:27], s56 offen offset:2048 sc1
s_mov_b64 exec, 16711935
buffer_store_dwordx4 v[76:79], v38, s[24:27], s60 offen sc1
s_mov_b64 exec, -1
v_mov_b32 v40, -1
v_mov_b32 v41, -1
v_mov_b32 v42, -1
v_mov_b32 v43, -1
s_cmp_lt_u32 s83, 36
s_cselect_b32 s1, 0xff000000, 0
s_or_b32 exec_hi, s1, 0xffff00
s_mov_b32 exec_lo, 0
buffer_store_dwordx4 v[40:43], v5, s[24:27], s89 offen offset:0 sc1
buffer_store_dwordx4 v[40:43], v5, s[24:27], s89 offen offset:1024 sc1
buffer_store_dwordx4 v[40:43], v5, s[24:27], s89 offen offset:2048 sc1
buffer_store_dwordx4 v[40:43], v5, s[24:27], s89 offen offset:3072 sc1
s_mov_b64 exec, -1
s_lshl_b32 s1, s76, 2
s_add_u32 s1, s1, s77
s_mul_i32 s1, s1, 2560
v_add_u32 v44, s1, v5
buffer_store_dwordx4 v[40:43], v44, s[24:27], s84 offen offset:0
buffer_store_dwordx4 v[40:43], v44, s[24:27], s84 offen offset:1024
s_mov_b32 exec_hi, 0
buffer_store_dwordx4 v[40:43], v44, s[24:27], s84 offen offset:2048
s_mov_b64 exec, -1
s_barrier
s_mul_i32 s80, s80, 1664525
s_add_u32 s80, s80, 1013904223
s_and_b32 s80, s80, -16
s_mul_i32 s6, s76, 512
s_add_u32 s6, s6, 4096
s_lshr_b32 s7, s78, 4
s_mul_i32 s7, s7, 192
s_lshl2_add_u32 s7, s78, s7
s_add_u32 s7, s7, s6
s_mul_i32 s3, s74, 4096
s_add_u32 s6, s6, s3
s_mov_b32 s4, s80
s_mov_b32 s5, s80
s_waitcnt vmcnt(10)
s_atomic_swap s4, s[24:25], s7 offset:0
s_atomic_swap s4, s[24:25], s7 offset:4096
s_atomic_swap s4, s[24:25], s7 offset:8192
s_atomic_swap s4, s[24:25], s7 offset:12288
s_atomic_swap s4, s[24:25], s7 offset:16384
s_atomic_swap s4, s[24:25], s7 offset:20480
s_atomic_swap s4, s[24:25], s7 offset:24576
s_atomic_swap s4, s[24:25], s7 offset:28672
s_lshl_b32 s3, s76, 8
s_lshl2_add_u32 s3, s78, s3
s_waitcnt vmcnt(0)
s_atomic_swap s4, s[24:25], s3 offset:36864
s_atomic_swap s4, s[24:25], s3 offset:38912
s_atomic_swap s4, s[24:25], s3 offset:40960
s_atomic_swap s4, s[24:25], s3 offset:43008
s_atomic_swap s4, s[24:25], s3 offset:45056
s_atomic_swap s4, s[24:25], s3 offset:47104
s_atomic_swap s4, s[24:25], s3 offset:49152
s_atomic_swap s4, s[24:25], s3 offset:51200
P_10:
s_sub_u32 s82, s82, 1
s_cbranch_scc1 L_exit
s_load_dwordx16 s[8:23], s[24:25], s6 glc
s_load_dwordx16 s[48:63], s[24:25], s6 offset:256 glc
s_waitcnt lgkmcnt(0)
s_cmp_eq_u64 s[8:9], s[4:5]
s_cbranch_scc0 P_10
s_cmp_eq_u64 s[10:11], s[4:5]
s_cbranch_scc0 P_10
s_cmp_eq_u64 s[12:13], s[4:5]
s_cbranch_scc0 P_10
s_cmp_eq_u64 s[14:15], s[4:5]
s_cbranch_scc0 P_10
s_cmp_eq_u64 s[16:17], s[4:5]
s_cbranch_scc0 P_10
s_cmp_eq_u64 s[18:19], s[4:5]
s_cbranch_scc0 P_10
s_cmp_eq_u64 s[20:21], s[4:5]
s_cbranch_scc0 P_10
s_cmp_eq_u64 s[22:23], s[4:5]
s_cbranch_scc0 P_10
s_cmp_eq_u64 s[48:49], s[4:5]
s_cbranch_scc0 P_10
s_cmp_eq_u64 s[50:51], s[4:5]
s_cbranch_scc0 P_10
s_cmp_eq_u64 s[52:53], s[4:5]
s_cbranch_scc0 P_10
s_cmp_eq_u64 s[54:55], s[4:5]
s_cbranch_scc0 P_10
s_cmp_eq_u64 s[56:57], s[4:5]
s_cbranch_scc0 P_10
s_cmp_eq_u32 s58, s4
s_cbranch_scc0 P_10
s_waitcnt vmcnt(0)
s_branch L_main
L_6:
s_lshr_b32 s3, s58, 1
s_mul_i32 s3, s3, 4608
s_add_u32 s60, s59, s3
s_and_b32 s3, s58, 1
s_lshl_b32 s3, s3, 8
s_add_u32 s60, s60, 73728
s_add_u32 s60, s60, s3
s_add_u32 s56, s60, s3
s_waitcnt vmcnt(2)
ds_read_b64_tr_b16 v[108:109], v44 offset:0
ds_read_b64_tr_b16 v[110:111], v44 offset:576
ds_read_b64_tr_b16 v[112:113], v44 offset:64
ds_read_b64_tr_b16 v[114:115], v44 offset:640
ds_read_b64_tr_b16 v[116:117], v45 offset:128
ds_read_b64_tr_b16 v[118:119], v45 offset:704
ds_read_b64_tr_b16 v[68:69], v44 offset:9216
ds_read_b64_tr_b16 v[70:71], v44 offset:9792
ds_read_b64_tr_b16 v[72:73], v44 offset:9280
ds_read_b64_tr_b16 v[74:75], v44 offset:9856
ds_read_b64_tr_b16 v[76:77], v45 offset:9344
ds_read_b64_tr_b16 v[78:79], v45 offset:9920
s_waitcnt lgkmcnt(0)
buffer_store_dwordx4 v[108:111], v39, s[24:27], s56 offen offset:0 sc1
buffer_store_dwordx4 v[112:115], v39, s[24:27], s56 offen offset:2048 sc1
s_mov_b64 exec, 16711935
buffer_store_dwordx4 v[116:119], v38, s[24:27], s60 offen sc1
s_mov_b64 exec, -1
s_waitcnt lgkmcnt(0)
s_branch L_7
L_5:
s_cmp_eq_u32 s77, 2
s_cbranch_scc0 L_11
v_mul_u32_u24 v22, 1168, v0
v_add_u32 v22, 74752, v22
v_mov_b32 v68, 1065369472
v_mov_b32 v69, 1065369472
v_mov_b32 v70, 1065369472
v_mov_b32 v71, 1065369472
s_mov_b64 exec, 511
ds_write_b128 v22, v[68:71]
s_mov_b64 exec, -1
L_11:
s_cmp_eq_u32 s77, 1
s_cbranch_scc0 L_12
v_mov_b32 v36, 0
v_mov_b32 v37, 0
v_mov_b32 v38, 0
v_mov_b32 v39, 0
v_add_u32 v22, 158080, v5
ds_write_b128 v22, v[36:39]
L_12:
v_lshrrev_b32 v22, 3, v0
v_and_b32 v23, 7, v0
v_and_b32 v66, 6, v22
v_xor_b32 v66, v66, v23
v_mul_u32_u24 v23, 2304, v22
v_lshl_add_u32 v66, v66, 4, v23
s_mul_i32 s5, s77, 96
s_add_u32 s5, s5, 160096
v_lshl_add_u32 v64, v0, 2, s5
v_and_b32 v46, 6, v0
v_xor_b32 v46, v46, v22
v_and_b32 v23, 7, v0
v_lshl_add_u32 v23, v23, 7, s58
v_lshl_add_u32 v46, v46, 4, v23
v_lshlrev_b32 v55, 2, v7
v_sub_u32 v55, v6, v55
s_add_u32 s5, s57, 128
v_mov_b32 v188, 1065369472
v_mov_b32 v189, 1065369472
v_mov_b32 v190, 1065369472
v_mov_b32 v191, 1065369472
v_add_u32 v47, s5, v46
v_add_u32 v48, s5, v47
v_add_u32 v49, s5, v48
v_add_u32 v50, s5, v49
v_add_u32 v51, s5, v50
v_add_u32 v52, s5, v51
v_add_u32 v53, s5, v52
v_add_u32 v54, s5, v53
s_waitcnt vmcnt(1)
s_mov_b64 exec, 0
s_cmp_eq_u32 s77, 2
s_cbranch_scc1 L_pad1
s_cmp_eq_u32 s77, 3
s_cbranch_scc1 L_pad2
s_branch L_pad0
L_padret:
s_mov_b64 exec, -1
s_waitcnt lgkmcnt(0)
s_mul_i32 s80, s80, 1664525
s_add_u32 s80, s80, 1013904223
s_and_b32 s80, s80, -16
s_waitcnt vmcnt(0)
s_barrier
s_add_u32 m0, s58, 0
s_nop 0
buffer_load_dwordx4 v66, s[8:11], s56 offen offset:0 lds
s_add_u32 m0, s58, 896
s_nop 0
buffer_load_dwordx4 v66, s[8:11], s56 offen offset:128 lds
s_add_u32 m0, s58, 1792
s_nop 0
buffer_load_dwordx4 v66, s[8:11], s56 offen offset:256 lds
s_add_u32 m0, s58, 2688
s_nop 0
buffer_load_dwordx4 v66, s[8:11], s56 offen offset:384 lds
s_add_u32 m0, s58, 3584
s_nop 0
buffer_load_dwordx4 v66, s[8:11], s56 offen offset:512 lds
s_add_u32 m0, s58, 4480
s_nop 0
buffer_load_dwordx4 v66, s[8:11], s56 offen offset:640 lds
s_add_u32 m0, s58, 5376
s_nop 0
buffer_load_dwordx4 v66, s[8:11], s56 offen offset:768 lds
s_add_u32 m0, s58, 6272
s_nop 0
buffer_load_dwordx4 v66, s[8:11], s56 offen offset:896 lds
s_add_u32 m0, s58, 7168
s_nop 0
buffer_load_dwordx4 v66, s[8:11], s56 offen offset:1024 lds
s_cmp_eq_u32 s77, 2
s_cbranch_scc0 L_13
v_add_u32 v22, 162560, v5
ds_read_b128 v[56:59], v22
ds_read_b128 v[60:63], v22 offset:1024
s_mov_b32 s3, 1065369472
s_waitcnt lgkmcnt(1)
v_dot2_f32_bf16 v22, v56, s3, 0
v_dot2_f32_bf16 v22, v57, s3, v22
v_dot2_f32_bf16 v22, v58, s3, v22
v_dot2_f32_bf16 v22, v59, s3, v22
s_mov_b64 exec, 255
s_waitcnt lgkmcnt(0)
v_dot2_f32_bf16 v22, v60, s3, v22
v_dot2_f32_bf16 v22, v61, s3, v22
v_dot2_f32_bf16 v22, v62, s3, v22
v_dot2_f32_bf16 v22, v63, s3, v22
s_mov_b64 exec, -1
s_nop 1
v_add_f32_dpp v22, v22, v22 row_ror:8 row_mask:0xf bank_mask:0xf
s_nop 1
v_add_f32_dpp v22, v22, v22 row_ror:4 row_mask:0xf bank_mask:0xf
s_nop 1
v_add_f32_dpp v22, v22, v22 row_ror:2 row_mask:0xf bank_mask:0xf
s_nop 1
v_add_f32_dpp v22, v22, v22 row_ror:1 row_mask:0xf bank_mask:0xf
v_mov_b32 v23, v22
s_nop 1
v_permlane32_swap_b32 v22, v23
v_add_f32 v22, v22, v23
v_mov_b32 v23, v22
s_nop 1
v_permlane16_swap_b32 v22, v23
v_add_f32 v22, v22, v23
v_mov_b32 v56, 163792
v_mov_b32 v23, 0
ds_write_b64 v56, v[22:23]
L_13:
s_add_u32 s56, s56, 18432
s_add_u32 m0, s58, 9216
s_nop 0
buffer_load_dwordx4 v66, s[8:11], s56 offen offset:0 lds
s_add_u32 m0, s58, 10112
s_nop 0
buffer_load_dwordx4 v66, s[8:11], s56 offen offset:128 lds
s_add_u32 m0, s58, 11008
s_nop 0
buffer_load_dwordx4 v66, s[8:11], s56 offen offset:256 lds
s_add_u32 m0, s58, 11904
s_nop 0
buffer_load_dwordx4 v66, s[8:11], s56 offen offset:384 lds
s_add_u32 m0, s58, 12800
s_nop 0
buffer_load_dwordx4 v66, s[8:11], s56 offen offset:512 lds
s_add_u32 m0, s58, 13696
s_nop 0
buffer_load_dwordx4 v66, s[8:11], s56 offen offset:640 lds
s_add_u32 m0, s58, 14592
s_nop 0
buffer_load_dwordx4 v66, s[8:11], s56 offen offset:768 lds
s_add_u32 m0, s58, 15488
s_nop 0
buffer_load_dwordx4 v66, s[8:11], s56 offen offset:896 lds
s_add_u32 m0, s58, 16384
s_nop 0
buffer_load_dwordx4 v66, s[8:11], s56 offen offset:1024 lds
s_waitcnt vmcnt(9)
ds_read_b128 v[108:111], v46 offset:0
ds_read_b128 v[112:115], v46 offset:1024
ds_read_b128 v[116:119], v46 offset:2048
ds_read_b128 v[120:123], v46 offset:3072
ds_read_b128 v[124:127], v46 offset:4096
ds_read_b128 v[128:131], v46 offset:5120
ds_read_b128 v[132:135], v46 offset:6144
ds_read_b128 v[136:139], v46 offset:7168
ds_read_b128 v[140:143], v46 offset:8192
s_waitcnt lgkmcnt(8)
v_mfma_f32_16x16x32_bf16 v[192:195], v[188:191], v[108:111], 0
v_mfma_f32_16x16x32_bf16 v[196:199], v[108:111], v[108:111], 0
s_add_u32 m0, s58, 18432
s_nop 0
buffer_load_dwordx4 v66, s[8:11], s59 offen offset:0 lds
s_waitcnt lgkmcnt(7)
v_mfma_f32_16x16x32_bf16 v[192:195], v[188:191], v[112:115], v[192:195]
v_mfma_f32_16x16x32_bf16 v[196:199], v[112:115], v[112:115], v[196:199]
s_add_u32 m0, m0, s57
s_nop 0
buffer_load_dwordx4 v66, s[8:11], s59 offen offset:128 lds
s_waitcnt lgkmcnt(6)
v_mfma_f32_16x16x32_bf16 v[192:195], v[188:191], v[116:119], v[192:195]
v_mfma_f32_16x16x32_bf16 v[196:199], v[116:119], v[116:119], v[196:199]
s_add_u32 m0, m0, s57
s_nop 0
buffer_load_dwordx4 v66, s[8:11], s59 offen offset:256 lds
s_waitcnt lgkmcnt(5)
v_mfma_f32_16x16x32_bf16 v[192:195], v[188:191], v[120:123], v[192:195]
v_mfma_f32_16x16x32_bf16 v[196:199], v[120:123], v[120:123], v[196:199]
s_add_u32 m0, m0, s57
s_nop 0
buffer_load_dwordx4 v66, s[8:11], s59 offen offset:384 lds
s_waitcnt lgkmcnt(4)
v_mfma_f32_16x16x32_bf16 v[192:195], v[188:191], v[124:127], v[192:195]
v_mfma_f32_16x16x32_bf16 v[196:199], v[124:127], v[124:127], v[196:199]
s_add_u32 m0, m0, s57
s_nop 0
buffer_load_dwordx4 v66, s[8:11], s59 offen offset:512 lds
s_waitcnt lgkmcnt(3)
v_mfma_f32_16x16x32_bf16 v[192:195], v[188:191], v[128:131], v[192:195]
v_mfma_f32_16x16x32_bf16 v[196:199], v[128:131], v[128:131], v[196:199]
s_add_u32 m0, m0, s57
s_nop 0
buffer_load_dwordx4 v66, s[8:11], s59 offen offset:640 lds
s_waitcnt lgkmcnt(2)
v_mfma_f32_16x16x32_bf16 v[192:195], v[188:191], v[132:135], v[192:195]
v_mfma_f32_16x16x32_bf16 v[196:199], v[132:135], v[132:135], v[196:199]
s_add_u32 m0, m0, s57
s_nop 0
buffer_load_dwordx4 v66, s[8:11], s59 offen offset:768 lds
s_waitcnt lgkmcnt(1)
v_mfma_f32_16x16x32_bf16 v[192:195], v[188:191], v[136:139], v[192:195]
v_mfma_f32_16x16x32_bf16 v[196:199], v[136:139], v[136:139], v[196:199]
s_add_u32 m0, m0, s57
s_nop 0
buffer_load_dwordx4 v66, s[8:11], s59 offen offset:896 lds
s_waitcnt lgkmcnt(0)
v_mfma_f32_16x16x32_bf16 v[192:195], v[188:191], v[140:143], v[192:195]
v_mfma_f32_16x16x32_bf16 v[196:199], v[140:143], v[140:143], v[196:199]
s_add_u32 m0, m0, s57
s_nop 0
buffer_load_dwordx4 v66, s[8:11], s59 offen offset:1024 lds
s_waitcnt vmcnt(9)
ds_read_b128 v[144:147], v46 offset:9216
ds_read_b128 v[148:151], v46 offset:10240
ds_read_b128 v[152:155], v46 offset:11264
ds_read_b128 v[156:159], v46 offset:12288
ds_read_b128 v[160:163], v46 offset:13312
ds_read_b128 v[164:167], v46 offset:14336
ds_read_b128 v[168:171], v46 offset:15360
ds_read_b128 v[172:175], v46 offset:16384
ds_read_b128 v[176:179], v46 offset:17408
s_waitcnt lgkmcnt(8)
v_mfma_f32_16x16x32_bf16 v[200:203], v[188:191], v[144:147], 0
v_mov_b32 v40, -1
v_mov_b32 v41, -1
v_mov_b32 v42, -1
v_mov_b32 v43, -1
v_mfma_f32_16x16x32_bf16 v[204:207], v[144:147], v[144:147], 0
s_lshl_b32 s1, s76, 2
s_add_u32 s1, s1, s77
s_mul_i32 s1, s1, 2560
v_add_u32 v44, s1, v5
s_waitcnt lgkmcnt(7)
v_mfma_f32_16x16x32_bf16 v[200:203], v[188:191], v[148:151], v[200:203]
buffer_store_dwordx4 v[40:43], v44, s[24:27], s84 offen offset:0
v_mfma_f32_16x16x32_bf16 v[204:207], v[148:151], v[148:151], v[204:207]
buffer_store_dwordx4 v[40:43], v44, s[24:27], s84 offen offset:1024
s_waitcnt lgkmcnt(6)
v_mfma_f32_16x16x32_bf16 v[200:203], v[188:191], v[152:155], v[200:203]
s_mov_b32 exec_hi, 0
buffer_store_dwordx4 v[40:43], v44, s[24:27], s84 offen offset:2048
s_mov_b64 exec, -1
v_mfma_f32_16x16x32_bf16 v[204:207], v[152:155], v[152:155], v[204:207]
s_lshl_b32 s4, s75, 2
s_add_u32 s4, s4, s77
s_cmp_eq_u32 s4, 125
s_cbranch_scc0 L_14
v_lshrrev_b32 v38, 5, v0
v_mul_u32_u24 v38, 57344, v38
v_lshl_add_u32 v38, v0, 8, v38
s_lshl_b32 s3, s74, 13
s_add_u32 s3, s3, 2949120
buffer_load_dword v18, v38, s[24:27], s3 offen sc1
L_14:
s_waitcnt lgkmcnt(5)
v_mfma_f32_16x16x32_bf16 v[200:203], v[188:191], v[156:159], v[200:203]
s_add_u32 m0, s91, 120192
s_add_u32 s1, s81, 0xfffffc00
buffer_load_dwordx4 v5, s[40:43], s1 offen nt lds
v_mfma_f32_16x16x32_bf16 v[204:207], v[156:159], v[156:159], v[204:207]
s_add_u32 m0, s91, 123264
s_add_u32 s1, s81, 0x800
buffer_load_dwordx4 v5, s[40:43], s1 offen nt lds
s_waitcnt lgkmcnt(4)
v_mfma_f32_16x16x32_bf16 v[200:203], v[188:191], v[160:163], v[200:203]
s_add_u32 m0, s91, 126336
s_add_u32 s1, s81, 0x1400
buffer_load_dwordx4 v5, s[40:43], s1 offen nt lds
v_mfma_f32_16x16x32_bf16 v[204:207], v[160:163], v[160:163], v[204:207]
s_add_u32 m0, s91, 129408
s_add_u32 s1, s81, 0x2000
buffer_load_dwordx4 v5, s[40:43], s1 offen nt lds
s_waitcnt lgkmcnt(3)
v_mfma_f32_16x16x32_bf16 v[200:203], v[188:191], v[164:167], v[200:203]
s_add_u32 m0, s91, 132480
s_add_u32 s1, s81, 0x2c00
buffer_load_dwordx4 v5, s[40:43], s1 offen nt lds
v_mfma_f32_16x16x32_bf16 v[204:207], v[164:167], v[164:167], v[204:207]
s_add_u32 m0, s91, 135552
s_add_u32 s1, s81, 0x3800
buffer_load_dwordx4 v5, s[40:43], s1 offen nt lds
s_waitcnt lgkmcnt(2)
v_mfma_f32_16x16x32_bf16 v[200:203], v[188:191], v[168:171], v[200:203]
s_add_u32 m0, s91, 138624
s_add_u32 s1, s81, 0x4400
buffer_load_dwordx4 v5, s[40:43], s1 offen nt lds
v_mfma_f32_16x16x32_bf16 v[204:207], v[168:171], v[168:171], v[204:207]
s_add_u32 m0, s91, 141696
s_add_u32 s1, s81, 0x5000
buffer_load_dwordx4 v5, s[40:43], s1 offen nt lds
s_waitcnt lgkmcnt(1)
v_mfma_f32_16x16x32_bf16 v[200:203], v[188:191], v[172:175], v[200:203]
v_add_u32 v36, 0, v0
v_min_u32 v36, 125, v36
v_mfma_f32_16x16x32_bf16 v[204:207], v[172:175], v[172:175], v[204:207]
s_mul_i32 s1, s77, 126
s_sub_u32 s1, s1, 126
v_add_u32 v36, s1, v36
v_min_u32 v36, 377, v36
s_waitcnt lgkmcnt(0)
v_mfma_f32_16x16x32_bf16 v[200:203], v[188:191], v[176:179], v[200:203]
v_mul_u32_u24 v37, 7282, v36
v_lshrrev_b32 v37, 16, v37
v_mfma_f32_16x16x32_bf16 v[204:207], v[176:179], v[176:179], v[204:207]
v_mul_u32_u24 v37, 8064, v37
v_lshl_add_u32 v36, v36, 7, v37
s_mul_i32 s1, s75, 336
s_add_u32 s1, s1, s74
s_add_u32 s1, s1, 0xffffe860
s_mul_i32 s1, s1, 1152
s_xor_b32 s34, s95, 5308416
buffer_load_dword v18, v36, s[32:35], s1 offen
s_mov_b32 s34, s95
v_add_u32 v36, 64, v0
v_min_u32 v36, 125, v36
s_mul_i32 s1, s77, 126
s_sub_u32 s1, s1, 126
v_add_u32 v36, s1, v36
v_min_u32 v36, 377, v36
v_mul_u32_u24 v37, 7282, v36
v_lshrrev_b32 v37, 16, v37
v_mul_u32_u24 v37, 8064, v37
v_lshl_add_u32 v36, v36, 7, v37
s_mul_i32 s1, s75, 336
s_add_u32 s1, s1, s74
s_add_u32 s1, s1, 0xffffe860
s_mul_i32 s1, s1, 1152
s_xor_b32 s34, s95, 5308416
buffer_load_dword v18, v36, s[32:35], s1 offen
s_mov_b32 s34, s95
s_add_u32 m0, s91, 144768
s_add_u32 s1, s81, 0x5c00
buffer_load_dwordx4 v5, s[40:43], s1 offen nt lds
s_add_u32 m0, s91, 147840
s_add_u32 s1, s81, 0x6800
buffer_load_dwordx4 v5, s[40:43], s1 offen nt lds
s_add_u32 m0, s91, 150912
s_add_u32 s1, s81, 0x7400
buffer_load_dwordx4 v5, s[40:43], s1 offen nt lds
s_add_u32 m0, s91, 153984
s_add_u32 s1, s81, 0x8000
buffer_load_dwordx4 v5, s[40:43], s1 offen nt lds
s_waitcnt vmcnt(17)
ds_read_b128 v[108:111], v46 offset:18432
ds_read_b128 v[112:115], v47 offset:18432
ds_read_b128 v[116:119], v48 offset:18432
ds_read_b128 v[120:123], v49 offset:18432
ds_read_b128 v[124:127], v50 offset:18432
ds_read_b128 v[128:131], v51 offset:18432
ds_read_b128 v[132:135], v52 offset:18432
ds_read_b128 v[136:139], v53 offset:18432
ds_read_b128 v[140:143], v54 offset:18432
s_waitcnt lgkmcnt(8)
v_mfma_f32_16x16x32_bf16 v[208:211], v[188:191], v[108:111], 0
v_mfma_f32_16x16x32_bf16 v[212:215], v[108:111], v[108:111], 0
s_waitcnt lgkmcnt(7)
v_mfma_f32_16x16x32_bf16 v[208:211], v[188:191], v[112:115], v[208:211]
v_mfma_f32_16x16x32_bf16 v[212:215], v[112:115], v[112:115], v[212:215]
s_waitcnt lgkmcnt(6)
v_mfma_f32_16x16x32_bf16 v[208:211], v[188:191], v[116:119], v[208:211]
v_mfma_f32_16x16x32_bf16 v[212:215], v[116:119], v[116:119], v[212:215]
s_waitcnt lgkmcnt(5)
v_mfma_f32_16x16x32_bf16 v[208:211], v[188:191], v[120:123], v[208:211]
v_mfma_f32_16x16x32_bf16 v[212:215], v[120:123], v[120:123], v[212:215]
s_waitcnt lgkmcnt(4)
v_mfma_f32_16x16x32_bf16 v[208:211], v[188:191], v[124:127], v[208:211]
v_mfma_f32_16x16x32_bf16 v[212:215], v[124:127], v[124:127], v[212:215]
s_waitcnt lgkmcnt(3)
v_mfma_f32_16x16x32_bf16 v[208:211], v[188:191], v[128:131], v[208:211]
v_mfma_f32_16x16x32_bf16 v[212:215], v[128:131], v[128:131], v[212:215]
s_waitcnt lgkmcnt(2)
v_mfma_f32_16x16x32_bf16 v[208:211], v[188:191], v[132:135], v[208:211]
v_mfma_f32_16x16x32_bf16 v[212:215], v[132:135], v[132:135], v[212:215]
s_waitcnt lgkmcnt(1)
v_mfma_f32_16x16x32_bf16 v[208:211], v[188:191], v[136:139], v[208:211]
v_mfma_f32_16x16x32_bf16 v[212:215], v[136:139], v[136:139], v[212:215]
s_waitcnt lgkmcnt(0)
v_mfma_f32_16x16x32_bf16 v[208:211], v[188:191], v[140:143], v[208:211]
v_mfma_f32_16x16x32_bf16 v[212:215], v[140:143], v[140:143], v[212:215]
v_cmp_eq_u32 vcc, 0, v55
v_mov_b32 v28, v192
v_mov_b32 v30, v200
s_nop 3
v_mov_b32 v32, v208
v_cndmask_b32 v29, 0, v196, vcc
v_cndmask_b32 v31, 0, v204, vcc
v_cndmask_b32 v33, 0, v212, vcc
v_cmp_eq_u32 vcc, 1, v55
s_nop 1
v_cndmask_b32 v29, v29, v197, vcc
v_cndmask_b32 v31, v31, v205, vcc
v_cndmask_b32 v33, v33, v213, vcc
v_cmp_eq_u32 vcc, 2, v55
s_nop 1
v_cndmask_b32 v29, v29, v198, vcc
v_cndmask_b32 v31, v31, v206, vcc
v_cndmask_b32 v33, v33, v214, vcc
v_cmp_eq_u32 vcc, 3, v55
s_nop 1
v_cndmask_b32 v29, v29, v199, vcc
v_cndmask_b32 v31, v31, v207, vcc
v_cndmask_b32 v33, v33, v215, vcc
v_add_f32_dpp v28, v28, v28 row_ror:8 row_mask:0xf bank_mask:0xf
v_add_f32_dpp v29, v29, v29 row_ror:8 row_mask:0xf bank_mask:0xf
v_add_f32_dpp v30, v30, v30 row_ror:8 row_mask:0xf bank_mask:0xf
v_add_f32_dpp v31, v31, v31 row_ror:8 row_mask:0xf bank_mask:0xf
v_add_f32_dpp v32, v32, v32 row_ror:8 row_mask:0xf bank_mask:0xf
v_add_f32_dpp v33, v33, v33 row_ror:8 row_mask:0xf bank_mask:0xf
v_mov_b32 v34, v29
v_mov_b32 v35, v31
v_mov_b32 v36, v33
v_permlane32_swap_b32 v29, v34
v_permlane32_swap_b32 v31, v35
v_permlane32_swap_b32 v33, v36
v_add_f32 v29, v29, v34
v_add_f32 v31, v31, v35
v_add_f32 v33, v33, v36
v_mov_b32 v34, v29
v_mov_b32 v35, v31
v_mov_b32 v36, v33
v_permlane16_swap_b32 v29, v34
v_permlane16_swap_b32 v31, v35
v_permlane16_swap_b32 v33, v36
v_add_f32 v29, v29, v34
v_add_f32 v31, v31, v35
v_add_f32 v33, v33, v36
s_mov_b32 s3, 0x3ae38e39
v_mov_b32 v40, 0x3727c5ac
v_mul_f32 v28, 0xbae38e39, v28
v_mul_f32 v30, 0xbae38e39, v30
v_mul_f32 v32, 0xbae38e39, v32
v_fma_f32 v29, v29, s3, v40
v_fma_f32 v31, v31, s3, v40
v_fma_f32 v33, v33, s3, v40
v_fma_f32 v29, -v28, v28, v29
v_fma_f32 v31, -v30, v30, v31
v_fma_f32 v33, -v32, v32, v33
v_max_f32 v29, v40, v29
v_max_f32 v31, v40, v31
v_max_f32 v33, v40, v33
v_rsq_f32 v29, v29
v_rsq_f32 v31, v31
v_rsq_f32 v33, v33
s_cmp_eq_u32 s77, 3
s_cselect_b32 s5, 288, 0
s_cselect_b32 s7, 320, 0
v_subrev_u32 v41, s5, v64
v_subrev_u32 v42, s7, v64
s_cmp_lg_u32 s77, 0
s_cbranch_scc0 L_15
s_mov_b64 exec, 255
ds_write2_b32 v64, v28, v29 offset0:0 offset1:80
ds_write2_b32 v64, v30, v31 offset0:8 offset1:88
ds_write2_b32 v41, v32, v33 offset0:16 offset1:96
ds_write2_b32 v42, v32, v33 offset0:16 offset1:96
s_mov_b64 exec, -1
L_15:
s_waitcnt vmcnt(14)
s_branch L_main
L_startend:
.p2align 12
L_main:
L_pad0:
s_cbranch_execz L_pad3
s_waitcnt lgkmcnt(0)
s_barrier
ds_read_b128 v[68:71], v3 offset:0
ds_read_b128 v[72:75], v1 offset:0
ds_read_b128 v[76:79], v1 offset:18432
ds_read_b128 v[80:83], v1 offset:36864
ds_read_b128 v[84:87], v1 offset:55296
s_add_u32 s6, s92, 0
buffer_load_dwordx4 a[0:3], v5, s[24:27], s6 offen sc1
buffer_load_dwordx4 a[4:7], v5, s[24:27], s6 offen offset:1024 sc1
buffer_load_dwordx4 a[8:11], v5, s[24:27], s6 offen offset:2048 sc1
buffer_load_dwordx4 a[12:15], v27, s[24:27], s6 offen offset:3072 sc1
s_waitcnt lgkmcnt(0)
s_lshl_b32 s1, s78, 8
s_lshl2_add_u32 s1, s76, s1
s_getreg_b32 s0, hwreg(HW_REG_XCC_ID, 0, 4)
s_or_b32 s62, s0, s80
s_cmp_eq_u32 s77, 0
s_cbranch_scc0 L_16
s_atomic_swap s62, s[24:25], s1 offset:53248
L_16:
s_add_u32 s6, s92, 3456
buffer_load_dwordx4 a[16:19], v5, s[24:27], s6 offen sc1
buffer_load_dwordx4 a[20:23], v5, s[24:27], s6 offen offset:1024 sc1
buffer_load_dwordx4 a[24:27], v5, s[24:27], s6 offen offset:2048 sc1
buffer_load_dwordx4 a[28:31], v27, s[24:27], s6 offen offset:3072 sc1
s_add_u32 s6, s92, 6912
buffer_load_dwordx4 a[32:35], v5, s[24:27], s6 offen sc1
buffer_load_dwordx4 a[36:39], v5, s[24:27], s6 offen offset:1024 sc1
buffer_load_dwordx4 a[40:43], v5, s[24:27], s6 offen offset:2048 sc1
buffer_load_dwordx4 a[44:47], v27, s[24:27], s6 offen offset:3072 sc1
s_getreg_b32 s3, hwreg(HW_REG_XCC_ID, 0, 4)
s_or_b32 s3, s3, s80
v_mov_b32 v46, s3
s_mov_b32 exec_lo, 0
v_mov_b32 v46, s80
s_mov_b32 exec_lo, -1
s_waitcnt vmcnt(11)
v_mfma_f32_16x16x32_bf16 v[108:111], a[0:3], v[68:71], 0
s_waitcnt vmcnt(10)
v_mfma_f32_16x16x32_bf16 v[128:131], a[4:7], v[68:71], 0
ds_read_b128 v[88:91], v4 offset:0
s_waitcnt vmcnt(9)
v_mfma_f32_16x16x32_bf16 v[148:151], v[68:71], a[8:11], 0
s_waitcnt vmcnt(8)
v_mfma_f32_16x16x32_bf16 v[168:171], a[12:15], v[68:71], 0
ds_read_b128 v[92:95], v2 offset:0
v_mfma_f32_16x16x32_bf16 v[112:115], a[0:3], v[72:75], 0
v_mfma_f32_16x16x32_bf16 v[132:135], a[4:7], v[72:75], 0
ds_read_b128 v[96:99], v2 offset:18432
v_mfma_f32_16x16x32_bf16 v[152:155], v[72:75], a[8:11], 0
v_mfma_f32_16x16x32_bf16 v[172:175], a[12:15], v[72:75], 0
ds_read_b128 v[100:103], v2 offset:36864
v_mfma_f32_16x16x32_bf16 v[116:119], a[0:3], v[76:79], 0
v_mfma_f32_16x16x32_bf16 v[136:139], a[4:7], v[76:79], 0
ds_read_b128 v[104:107], v2 offset:55296
v_mfma_f32_16x16x32_bf16 v[156:159], v[76:79], a[8:11], 0
v_mfma_f32_16x16x32_bf16 v[176:179], a[12:15], v[76:79], 0
s_add_u32 s6, s92, 10368
buffer_load_dwordx4 a[48:51], v5, s[24:27], s6 offen sc1
v_mfma_f32_16x16x32_bf16 v[120:123], a[0:3], v[80:83], 0
v_mfma_f32_16x16x32_bf16 v[140:143], a[4:7], v[80:83], 0
buffer_load_dwordx4 a[52:55], v5, s[24:27], s6 offen offset:1024 sc1
v_mfma_f32_16x16x32_bf16 v[160:163], v[80:83], a[8:11], 0
v_mfma_f32_16x16x32_bf16 v[180:183], a[12:15], v[80:83], 0
buffer_load_dwordx4 a[56:59], v5, s[24:27], s6 offen offset:2048 sc1
v_mfma_f32_16x16x32_bf16 v[124:127], a[0:3], v[84:87], 0
v_mfma_f32_16x16x32_bf16 v[144:147], a[4:7], v[84:87], 0
buffer_load_dwordx4 a[60:63], v27, s[24:27], s6 offen offset:3072 sc1
v_mfma_f32_16x16x32_bf16 v[164:167], v[84:87], a[8:11], 0
v_mfma_f32_16x16x32_bf16 v[184:187], a[12:15], v[84:87], 0
s_waitcnt vmcnt(11) lgkmcnt(0)
v_mfma_f32_16x16x32_bf16 v[108:111], a[16:19], v[88:91], v[108:111]
s_waitcnt vmcnt(10)
v_mfma_f32_16x16x32_bf16 v[128:131], a[20:23], v[88:91], v[128:131]
ds_read_b128 v[68:71], v3 offset:1168
s_waitcnt vmcnt(9)
v_mfma_f32_16x16x32_bf16 v[148:151], v[88:91], a[24:27], v[148:151]
s_waitcnt vmcnt(8)
v_mfma_f32_16x16x32_bf16 v[168:171], a[28:31], v[88:91], v[168:171]
ds_read_b128 v[72:75], v1 offset:1024
v_mfma_f32_16x16x32_bf16 v[112:115], a[16:19], v[92:95], v[112:115]
v_mfma_f32_16x16x32_bf16 v[132:135], a[20:23], v[92:95], v[132:135]
ds_read_b128 v[76:79], v1 offset:19456
v_mfma_f32_16x16x32_bf16 v[152:155], v[92:95], a[24:27], v[152:155]
v_mfma_f32_16x16x32_bf16 v[172:175], a[28:31], v[92:95], v[172:175]
ds_read_b128 v[80:83], v1 offset:37888
v_mfma_f32_16x16x32_bf16 v[116:119], a[16:19], v[96:99], v[116:119]
v_mfma_f32_16x16x32_bf16 v[136:139], a[20:23], v[96:99], v[136:139]
ds_read_b128 v[84:87], v1 offset:56320
v_mfma_f32_16x16x32_bf16 v[156:159], v[96:99], a[24:27], v[156:159]
v_mfma_f32_16x16x32_bf16 v[176:179], a[28:31], v[96:99], v[176:179]
s_add_u32 s6, s92, 13824
buffer_load_dwordx4 a[64:67], v5, s[24:27], s6 offen sc1
v_mfma_f32_16x16x32_bf16 v[120:123], a[16:19], v[100:103], v[120:123]
v_mfma_f32_16x16x32_bf16 v[140:143], a[20:23], v[100:103], v[140:143]
buffer_load_dwordx4 a[68:71], v5, s[24:27], s6 offen offset:1024 sc1
v_mfma_f32_16x16x32_bf16 v[160:163], v[100:103], a[24:27], v[160:163]
v_mfma_f32_16x16x32_bf16 v[180:183], a[28:31], v[100:103], v[180:183]
buffer_load_dwordx4 a[72:75], v5, s[24:27], s6 offen offset:2048 sc1
v_mfma_f32_16x16x32_bf16 v[124:127], a[16:19], v[104:107], v[124:127]
v_mfma_f32_16x16x32_bf16 v[144:147], a[20:23], v[104:107], v[144:147]
buffer_load_dwordx4 a[76:79], v27, s[24:27], s6 offen offset:3072 sc1
v_mfma_f32_16x16x32_bf16 v[164:167], v[104:107], a[24:27], v[164:167]
v_mfma_f32_16x16x32_bf16 v[184:187], a[28:31], v[104:107], v[184:187]
s_waitcnt vmcnt(11) lgkmcnt(4)
v_mfma_f32_16x16x32_bf16 v[108:111], a[32:35], v[68:71], v[108:111]
s_waitcnt vmcnt(10)
v_mfma_f32_16x16x32_bf16 v[128:131], a[36:39], v[68:71], v[128:131]
ds_read_b128 v[88:91], v4 offset:1168
s_waitcnt vmcnt(9)
v_mfma_f32_16x16x32_bf16 v[148:151], v[68:71], a[40:43], v[148:151]
s_waitcnt vmcnt(8)
v_mfma_f32_16x16x32_bf16 v[168:171], a[44:47], v[68:71], v[168:171]
ds_read_b128 v[92:95], v2 offset:1024
s_waitcnt lgkmcnt(5)
v_mfma_f32_16x16x32_bf16 v[112:115], a[32:35], v[72:75], v[112:115]
v_mfma_f32_16x16x32_bf16 v[132:135], a[36:39], v[72:75], v[132:135]
ds_read_b128 v[96:99], v2 offset:19456
v_mfma_f32_16x16x32_bf16 v[152:155], v[72:75], a[40:43], v[152:155]
v_mfma_f32_16x16x32_bf16 v[172:175], a[44:47], v[72:75], v[172:175]
ds_read_b128 v[100:103], v2 offset:37888
s_waitcnt lgkmcnt(6)
v_mfma_f32_16x16x32_bf16 v[116:119], a[32:35], v[76:79], v[116:119]
v_mfma_f32_16x16x32_bf16 v[136:139], a[36:39], v[76:79], v[136:139]
ds_read_b128 v[104:107], v2 offset:56320
v_mfma_f32_16x16x32_bf16 v[156:159], v[76:79], a[40:43], v[156:159]
v_mfma_f32_16x16x32_bf16 v[176:179], a[44:47], v[76:79], v[176:179]
s_add_u32 s6, s92, 17280
buffer_load_dwordx4 a[80:83], v5, s[24:27], s6 offen sc1
s_waitcnt lgkmcnt(6)
v_mfma_f32_16x16x32_bf16 v[120:123], a[32:35], v[80:83], v[120:123]
v_mfma_f32_16x16x32_bf16 v[140:143], a[36:39], v[80:83], v[140:143]
buffer_load_dwordx4 a[84:87], v5, s[24:27], s6 offen offset:1024 sc1
v_mfma_f32_16x16x32_bf16 v[160:163], v[80:83], a[40:43], v[160:163]
v_mfma_f32_16x16x32_bf16 v[180:183], a[44:47], v[80:83], v[180:183]
buffer_load_dwordx4 a[88:91], v5, s[24:27], s6 offen offset:2048 sc1
s_waitcnt lgkmcnt(5)
v_mfma_f32_16x16x32_bf16 v[124:127], a[32:35], v[84:87], v[124:127]
v_mfma_f32_16x16x32_bf16 v[144:147], a[36:39], v[84:87], v[144:147]
buffer_load_dwordx4 a[92:95], v27, s[24:27], s6 offen offset:3072 sc1
v_mfma_f32_16x16x32_bf16 v[164:167], v[84:87], a[40:43], v[164:167]
v_mfma_f32_16x16x32_bf16 v[184:187], a[44:47], v[84:87], v[184:187]
s_waitcnt vmcnt(11) lgkmcnt(4)
v_mfma_f32_16x16x32_bf16 v[108:111], a[48:51], v[88:91], v[108:111]
s_waitcnt vmcnt(10)
v_mfma_f32_16x16x32_bf16 v[128:131], a[52:55], v[88:91], v[128:131]
ds_read_b128 v[68:71], v3 offset:2336
s_waitcnt vmcnt(9)
v_mfma_f32_16x16x32_bf16 v[148:151], v[88:91], a[56:59], v[148:151]
s_waitcnt vmcnt(8)
v_mfma_f32_16x16x32_bf16 v[168:171], a[60:63], v[88:91], v[168:171]
ds_read_b128 v[72:75], v1 offset:2048
s_waitcnt lgkmcnt(5)
v_mfma_f32_16x16x32_bf16 v[112:115], a[48:51], v[92:95], v[112:115]
v_mfma_f32_16x16x32_bf16 v[132:135], a[52:55], v[92:95], v[132:135]
ds_read_b128 v[76:79], v1 offset:20480
v_mfma_f32_16x16x32_bf16 v[152:155], v[92:95], a[56:59], v[152:155]
v_mfma_f32_16x16x32_bf16 v[172:175], a[60:63], v[92:95], v[172:175]
ds_read_b128 v[80:83], v1 offset:38912
s_waitcnt lgkmcnt(6)
v_mfma_f32_16x16x32_bf16 v[116:119], a[48:51], v[96:99], v[116:119]
v_mfma_f32_16x16x32_bf16 v[136:139], a[52:55], v[96:99], v[136:139]
ds_read_b128 v[84:87], v1 offset:57344
v_mfma_f32_16x16x32_bf16 v[156:159], v[96:99], a[56:59], v[156:159]
v_mfma_f32_16x16x32_bf16 v[176:179], a[60:63], v[96:99], v[176:179]
s_add_u32 s6, s92, 20736
buffer_load_dwordx4 a[96:99], v5, s[24:27], s6 offen sc1
s_waitcnt lgkmcnt(6)
v_mfma_f32_16x16x32_bf16 v[120:123], a[48:51], v[100:103], v[120:123]
v_mfma_f32_16x16x32_bf16 v[140:143], a[52:55], v[100:103], v[140:143]
buffer_load_dwordx4 a[100:103], v5, s[24:27], s6 offen offset:1024 sc1
v_mfma_f32_16x16x32_bf16 v[160:163], v[100:103], a[56:59], v[160:163]
v_mfma_f32_16x16x32_bf16 v[180:183], a[60:63], v[100:103], v[180:183]
buffer_load_dwordx4 a[104:107], v5, s[24:27], s6 offen offset:2048 sc1
s_waitcnt lgkmcnt(5)
v_mfma_f32_16x16x32_bf16 v[124:127], a[48:51], v[104:107], v[124:127]
v_mfma_f32_16x16x32_bf16 v[144:147], a[52:55], v[104:107], v[144:147]
buffer_load_dwordx4 a[108:111], v27, s[24:27], s6 offen offset:3072 sc1
v_mfma_f32_16x16x32_bf16 v[164:167], v[104:107], a[56:59], v[164:167]
v_mfma_f32_16x16x32_bf16 v[184:187], a[60:63], v[104:107], v[184:187]
s_waitcnt vmcnt(11) lgkmcnt(4)
v_mfma_f32_16x16x32_bf16 v[108:111], a[64:67], v[68:71], v[108:111]
s_waitcnt vmcnt(10)
v_mfma_f32_16x16x32_bf16 v[128:131], a[68:71], v[68:71], v[128:131]
ds_read_b128 v[88:91], v4 offset:2336
s_waitcnt vmcnt(9)
v_mfma_f32_16x16x32_bf16 v[148:151], v[68:71], a[72:75], v[148:151]
s_waitcnt vmcnt(8)
v_mfma_f32_16x16x32_bf16 v[168:171], a[76:79], v[68:71], v[168:171]
ds_read_b128 v[92:95], v2 offset:2048
s_waitcnt lgkmcnt(5)
v_mfma_f32_16x16x32_bf16 v[112:115], a[64:67], v[72:75], v[112:115]
v_mfma_f32_16x16x32_bf16 v[132:135], a[68:71], v[72:75], v[132:135]
ds_read_b128 v[96:99], v2 offset:20480
v_mfma_f32_16x16x32_bf16 v[152:155], v[72:75], a[72:75], v[152:155]
v_mfma_f32_16x16x32_bf16 v[172:175], a[76:79], v[72:75], v[172:175]
ds_read_b128 v[100:103], v2 offset:38912
s_waitcnt lgkmcnt(6)
v_mfma_f32_16x16x32_bf16 v[116:119], a[64:67], v[76:79], v[116:119]
v_mfma_f32_16x16x32_bf16 v[136:139], a[68:71], v[76:79], v[136:139]
ds_read_b128 v[104:107], v2 offset:57344
v_mfma_f32_16x16x32_bf16 v[156:159], v[76:79], a[72:75], v[156:159]
v_mfma_f32_16x16x32_bf16 v[176:179], a[76:79], v[76:79], v[176:179]
s_add_u32 s6, s92, 24192
buffer_load_dwordx4 a[112:115], v5, s[24:27], s6 offen sc1
s_waitcnt lgkmcnt(6)
v_mfma_f32_16x16x32_bf16 v[120:123], a[64:67], v[80:83], v[120:123]
v_mfma_f32_16x16x32_bf16 v[140:143], a[68:71], v[80:83], v[140:143]
buffer_load_dwordx4 a[116:119], v5, s[24:27], s6 offen offset:1024 sc1
v_mfma_f32_16x16x32_bf16 v[160:163], v[80:83], a[72:75], v[160:163]
v_mfma_f32_16x16x32_bf16 v[180:183], a[76:79], v[80:83], v[180:183]
buffer_load_dwordx4 a[120:123], v5, s[24:27], s6 offen offset:2048 sc1
s_waitcnt lgkmcnt(5)
v_mfma_f32_16x16x32_bf16 v[124:127], a[64:67], v[84:87], v[124:127]
v_mfma_f32_16x16x32_bf16 v[144:147], a[68:71], v[84:87], v[144:147]
buffer_load_dwordx4 a[124:127], v27, s[24:27], s6 offen offset:3072 sc1
v_mfma_f32_16x16x32_bf16 v[164:167], v[84:87], a[72:75], v[164:167]
v_mfma_f32_16x16x32_bf16 v[184:187], a[76:79], v[84:87], v[184:187]
s_waitcnt vmcnt(11) lgkmcnt(4)
v_mfma_f32_16x16x32_bf16 v[108:111], a[80:83], v[88:91], v[108:111]
s_waitcnt vmcnt(10)
v_mfma_f32_16x16x32_bf16 v[128:131], a[84:87], v[88:91], v[128:131]
ds_read_b128 v[68:71], v3 offset:3504
s_waitcnt vmcnt(9)
v_mfma_f32_16x16x32_bf16 v[148:151], v[88:91], a[88:91], v[148:151]
s_waitcnt vmcnt(8)
v_mfma_f32_16x16x32_bf16 v[168:171], a[92:95], v[88:91], v[168:171]
ds_read_b128 v[72:75], v1 offset:3072
s_waitcnt lgkmcnt(5)
v_mfma_f32_16x16x32_bf16 v[112:115], a[80:83], v[92:95], v[112:115]
v_mfma_f32_16x16x32_bf16 v[132:135], a[84:87], v[92:95], v[132:135]
ds_read_b128 v[76:79], v1 offset:21504
v_mfma_f32_16x16x32_bf16 v[152:155], v[92:95], a[88:91], v[152:155]
v_mfma_f32_16x16x32_bf16 v[172:175], a[92:95], v[92:95], v[172:175]
ds_read_b128 v[80:83], v1 offset:39936
s_waitcnt lgkmcnt(6)
v_mfma_f32_16x16x32_bf16 v[116:119], a[80:83], v[96:99], v[116:119]
v_mfma_f32_16x16x32_bf16 v[136:139], a[84:87], v[96:99], v[136:139]
ds_read_b128 v[84:87], v1 offset:58368
v_mfma_f32_16x16x32_bf16 v[156:159], v[96:99], a[88:91], v[156:159]
v_mfma_f32_16x16x32_bf16 v[176:179], a[92:95], v[96:99], v[176:179]
s_add_u32 s6, s92, 27648
buffer_load_dwordx4 a[128:131], v5, s[24:27], s6 offen sc1
s_waitcnt lgkmcnt(6)
v_mfma_f32_16x16x32_bf16 v[120:123], a[80:83], v[100:103], v[120:123]
v_mfma_f32_16x16x32_bf16 v[140:143], a[84:87], v[100:103], v[140:143]
buffer_load_dwordx4 a[132:135], v5, s[24:27], s6 offen offset:1024 sc1
v_mfma_f32_16x16x32_bf16 v[160:163], v[100:103], a[88:91], v[160:163]
v_mfma_f32_16x16x32_bf16 v[180:183], a[92:95], v[100:103], v[180:183]
buffer_load_dwordx4 a[136:139], v5, s[24:27], s6 offen offset:2048 sc1
s_waitcnt lgkmcnt(5)
v_mfma_f32_16x16x32_bf16 v[124:127], a[80:83], v[104:107], v[124:127]
v_mfma_f32_16x16x32_bf16 v[144:147], a[84:87], v[104:107], v[144:147]
buffer_load_dwordx4 a[140:143], v27, s[24:27], s6 offen offset:3072 sc1
v_mfma_f32_16x16x32_bf16 v[164:167], v[104:107], a[88:91], v[164:167]
v_mfma_f32_16x16x32_bf16 v[184:187], a[92:95], v[104:107], v[184:187]
s_waitcnt vmcnt(11) lgkmcnt(4)
v_mfma_f32_16x16x32_bf16 v[108:111], a[96:99], v[68:71], v[108:111]
s_waitcnt vmcnt(10)
v_mfma_f32_16x16x32_bf16 v[128:131], a[100:103], v[68:71], v[128:131]
ds_read_b128 v[88:91], v4 offset:3504
s_waitcnt vmcnt(9)
v_mfma_f32_16x16x32_bf16 v[148:151], v[68:71], a[104:107], v[148:151]
s_waitcnt vmcnt(8)
v_mfma_f32_16x16x32_bf16 v[168:171], a[108:111], v[68:71], v[168:171]
ds_read_b128 v[92:95], v2 offset:3072
s_waitcnt lgkmcnt(5)
v_mfma_f32_16x16x32_bf16 v[112:115], a[96:99], v[72:75], v[112:115]
v_mfma_f32_16x16x32_bf16 v[132:135], a[100:103], v[72:75], v[132:135]
ds_read_b128 v[96:99], v2 offset:21504
v_mfma_f32_16x16x32_bf16 v[152:155], v[72:75], a[104:107], v[152:155]
v_mfma_f32_16x16x32_bf16 v[172:175], a[108:111], v[72:75], v[172:175]
ds_read_b128 v[100:103], v2 offset:39936
s_waitcnt lgkmcnt(6)
v_mfma_f32_16x16x32_bf16 v[116:119], a[96:99], v[76:79], v[116:119]
v_mfma_f32_16x16x32_bf16 v[136:139], a[100:103], v[76:79], v[136:139]
ds_read_b128 v[104:107], v2 offset:58368
v_mfma_f32_16x16x32_bf16 v[156:159], v[76:79], a[104:107], v[156:159]
v_mfma_f32_16x16x32_bf16 v[176:179], a[108:111], v[76:79], v[176:179]
s_add_u32 s6, s92, 31104
buffer_load_dwordx4 a[144:147], v5, s[24:27], s6 offen sc1
s_waitcnt lgkmcnt(6)
v_mfma_f32_16x16x32_bf16 v[120:123], a[96:99], v[80:83], v[120:123]
v_mfma_f32_16x16x32_bf16 v[140:143], a[100:103], v[80:83], v[140:143]
buffer_load_dwordx4 a[148:151], v5, s[24:27], s6 offen offset:1024 sc1
v_mfma_f32_16x16x32_bf16 v[160:163], v[80:83], a[104:107], v[160:163]
v_mfma_f32_16x16x32_bf16 v[180:183], a[108:111], v[80:83], v[180:183]
buffer_load_dwordx4 a[152:155], v5, s[24:27], s6 offen offset:2048 sc1
s_waitcnt lgkmcnt(5)
v_mfma_f32_16x16x32_bf16 v[124:127], a[96:99], v[84:87], v[124:127]
v_mfma_f32_16x16x32_bf16 v[144:147], a[100:103], v[84:87], v[144:147]
buffer_load_dwordx4 a[156:159], v27, s[24:27], s6 offen offset:3072 sc1
v_mfma_f32_16x16x32_bf16 v[164:167], v[84:87], a[104:107], v[164:167]
v_mfma_f32_16x16x32_bf16 v[184:187], a[108:111], v[84:87], v[184:187]
s_waitcnt vmcnt(11) lgkmcnt(4)
v_mfma_f32_16x16x32_bf16 v[108:111], a[112:115], v[88:91], v[108:111]
s_waitcnt vmcnt(10)
v_mfma_f32_16x16x32_bf16 v[128:131], a[116:119], v[88:91], v[128:131]
ds_read_b128 v[68:71], v3 offset:4672
s_waitcnt vmcnt(9)
v_mfma_f32_16x16x32_bf16 v[148:151], v[88:91], a[120:123], v[148:151]
s_waitcnt vmcnt(8)
v_mfma_f32_16x16x32_bf16 v[168:171], a[124:127], v[88:91], v[168:171]
ds_read_b128 v[72:75], v1 offset:4096
s_waitcnt lgkmcnt(5)
v_mfma_f32_16x16x32_bf16 v[112:115], a[112:115], v[92:95], v[112:115]
v_mfma_f32_16x16x32_bf16 v[132:135], a[116:119], v[92:95], v[132:135]
ds_read_b128 v[76:79], v1 offset:22528
v_mfma_f32_16x16x32_bf16 v[152:155], v[92:95], a[120:123], v[152:155]
v_mfma_f32_16x16x32_bf16 v[172:175], a[124:127], v[92:95], v[172:175]
ds_read_b128 v[80:83], v1 offset:40960
s_waitcnt lgkmcnt(6)
v_mfma_f32_16x16x32_bf16 v[116:119], a[112:115], v[96:99], v[116:119]
v_mfma_f32_16x16x32_bf16 v[136:139], a[116:119], v[96:99], v[136:139]
ds_read_b128 v[84:87], v1 offset:59392
v_mfma_f32_16x16x32_bf16 v[156:159], v[96:99], a[120:123], v[156:159]
v_mfma_f32_16x16x32_bf16 v[176:179], a[124:127], v[96:99], v[176:179]
s_add_u32 s6, s92, 34560
buffer_load_dwordx4 a[160:163], v5, s[24:27], s6 offen sc1
s_waitcnt lgkmcnt(6)
v_mfma_f32_16x16x32_bf16 v[120:123], a[112:115], v[100:103], v[120:123]
v_mfma_f32_16x16x32_bf16 v[140:143], a[116:119], v[100:103], v[140:143]
buffer_load_dwordx4 a[164:167], v5, s[24:27], s6 offen offset:1024 sc1
v_mfma_f32_16x16x32_bf16 v[160:163], v[100:103], a[120:123], v[160:163]
v_mfma_f32_16x16x32_bf16 v[180:183], a[124:127], v[100:103], v[180:183]
buffer_load_dwordx4 a[168:171], v5, s[24:27], s6 offen offset:2048 sc1
s_waitcnt lgkmcnt(5)
v_mfma_f32_16x16x32_bf16 v[124:127], a[112:115], v[104:107], v[124:127]
v_mfma_f32_16x16x32_bf16 v[144:147], a[116:119], v[104:107], v[144:147]
buffer_load_dwordx4 a[172:175], v27, s[24:27], s6 offen offset:3072 sc1
v_mfma_f32_16x16x32_bf16 v[164:167], v[104:107], a[120:123], v[164:167]
v_mfma_f32_16x16x32_bf16 v[184:187], a[124:127], v[104:107], v[184:187]
s_waitcnt vmcnt(11) lgkmcnt(4)
v_mfma_f32_16x16x32_bf16 v[108:111], a[128:131], v[68:71], v[108:111]
s_waitcnt vmcnt(10)
v_mfma_f32_16x16x32_bf16 v[128:131], a[132:135], v[68:71], v[128:131]
ds_read_b128 v[88:91], v4 offset:4672
s_waitcnt vmcnt(9)
v_mfma_f32_16x16x32_bf16 v[148:151], v[68:71], a[136:139], v[148:151]
s_waitcnt vmcnt(8)
v_mfma_f32_16x16x32_bf16 v[168:171], a[140:143], v[68:71], v[168:171]
ds_read_b128 v[92:95], v2 offset:4096
s_waitcnt lgkmcnt(5)
v_mfma_f32_16x16x32_bf16 v[112:115], a[128:131], v[72:75], v[112:115]
v_mfma_f32_16x16x32_bf16 v[132:135], a[132:135], v[72:75], v[132:135]
ds_read_b128 v[96:99], v2 offset:22528
v_mfma_f32_16x16x32_bf16 v[152:155], v[72:75], a[136:139], v[152:155]
v_mfma_f32_16x16x32_bf16 v[172:175], a[140:143], v[72:75], v[172:175]
ds_read_b128 v[100:103], v2 offset:40960
s_waitcnt lgkmcnt(6)
v_mfma_f32_16x16x32_bf16 v[116:119], a[128:131], v[76:79], v[116:119]
v_mfma_f32_16x16x32_bf16 v[136:139], a[132:135], v[76:79], v[136:139]
ds_read_b128 v[104:107], v2 offset:59392
v_mfma_f32_16x16x32_bf16 v[156:159], v[76:79], a[136:139], v[156:159]
v_mfma_f32_16x16x32_bf16 v[176:179], a[140:143], v[76:79], v[176:179]
s_add_u32 s6, s92, 38016
buffer_load_dwordx4 a[176:179], v5, s[24:27], s6 offen sc1
s_waitcnt lgkmcnt(6)
v_mfma_f32_16x16x32_bf16 v[120:123], a[128:131], v[80:83], v[120:123]
v_mfma_f32_16x16x32_bf16 v[140:143], a[132:135], v[80:83], v[140:143]
buffer_load_dwordx4 a[180:183], v5, s[24:27], s6 offen offset:1024 sc1
v_mfma_f32_16x16x32_bf16 v[160:163], v[80:83], a[136:139], v[160:163]
v_mfma_f32_16x16x32_bf16 v[180:183], a[140:143], v[80:83], v[180:183]
buffer_load_dwordx4 a[184:187], v5, s[24:27], s6 offen offset:2048 sc1
s_waitcnt lgkmcnt(5)
v_mfma_f32_16x16x32_bf16 v[124:127], a[128:131], v[84:87], v[124:127]
v_mfma_f32_16x16x32_bf16 v[144:147], a[132:135], v[84:87], v[144:147]
buffer_load_dwordx4 a[188:191], v27, s[24:27], s6 offen offset:3072 sc1
v_mfma_f32_16x16x32_bf16 v[164:167], v[84:87], a[136:139], v[164:167]
v_mfma_f32_16x16x32_bf16 v[184:187], a[140:143], v[84:87], v[184:187]
s_waitcnt vmcnt(11) lgkmcnt(4)
v_mfma_f32_16x16x32_bf16 v[108:111], a[144:147], v[88:91], v[108:111]
s_waitcnt vmcnt(10)
v_mfma_f32_16x16x32_bf16 v[128:131], a[148:151], v[88:91], v[128:131]
ds_read_b128 v[68:71], v3 offset:5840
s_waitcnt vmcnt(9)
v_mfma_f32_16x16x32_bf16 v[148:151], v[88:91], a[152:155], v[148:151]
s_waitcnt vmcnt(8)
v_mfma_f32_16x16x32_bf16 v[168:171], a[156:159], v[88:91], v[168:171]
ds_read_b128 v[72:75], v1 offset:5120
s_waitcnt lgkmcnt(5)
v_mfma_f32_16x16x32_bf16 v[112:115], a[144:147], v[92:95], v[112:115]
v_mfma_f32_16x16x32_bf16 v[132:135], a[148:151], v[92:95], v[132:135]
ds_read_b128 v[76:79], v1 offset:23552
v_mfma_f32_16x16x32_bf16 v[152:155], v[92:95], a[152:155], v[152:155]
v_mfma_f32_16x16x32_bf16 v[172:175], a[156:159], v[92:95], v[172:175]
ds_read_b128 v[80:83], v1 offset:41984
s_waitcnt lgkmcnt(6)
v_mfma_f32_16x16x32_bf16 v[116:119], a[144:147], v[96:99], v[116:119]
v_mfma_f32_16x16x32_bf16 v[136:139], a[148:151], v[96:99], v[136:139]
ds_read_b128 v[84:87], v1 offset:60416
v_mfma_f32_16x16x32_bf16 v[156:159], v[96:99], a[152:155], v[156:159]
v_mfma_f32_16x16x32_bf16 v[176:179], a[156:159], v[96:99], v[176:179]
s_add_u32 s6, s92, 41472
buffer_load_dwordx4 a[192:195], v5, s[24:27], s6 offen sc1
s_waitcnt lgkmcnt(6)
v_mfma_f32_16x16x32_bf16 v[120:123], a[144:147], v[100:103], v[120:123]
v_mfma_f32_16x16x32_bf16 v[140:143], a[148:151], v[100:103], v[140:143]
buffer_load_dwordx4 a[196:199], v5, s[24:27], s6 offen offset:1024 sc1
v_mfma_f32_16x16x32_bf16 v[160:163], v[100:103], a[152:155], v[160:163]
v_mfma_f32_16x16x32_bf16 v[180:183], a[156:159], v[100:103], v[180:183]
buffer_load_dwordx4 a[200:203], v5, s[24:27], s6 offen offset:2048 sc1
s_waitcnt lgkmcnt(5)
v_mfma_f32_16x16x32_bf16 v[124:127], a[144:147], v[104:107], v[124:127]
v_mfma_f32_16x16x32_bf16 v[144:147], a[148:151], v[104:107], v[144:147]
buffer_load_dwordx4 a[204:207], v27, s[24:27], s6 offen offset:3072 sc1
v_mfma_f32_16x16x32_bf16 v[164:167], v[104:107], a[152:155], v[164:167]
v_mfma_f32_16x16x32_bf16 v[184:187], a[156:159], v[104:107], v[184:187]
s_waitcnt vmcnt(11) lgkmcnt(4)
v_mfma_f32_16x16x32_bf16 v[108:111], a[160:163], v[68:71], v[108:111]
s_waitcnt vmcnt(10)
v_mfma_f32_16x16x32_bf16 v[128:131], a[164:167], v[68:71], v[128:131]
ds_read_b128 v[88:91], v4 offset:5840
s_waitcnt vmcnt(9)
v_mfma_f32_16x16x32_bf16 v[148:151], v[68:71], a[168:171], v[148:151]
s_waitcnt vmcnt(8)
v_mfma_f32_16x16x32_bf16 v[168:171], a[172:175], v[68:71], v[168:171]
ds_read_b128 v[92:95], v2 offset:5120
s_waitcnt lgkmcnt(5)
v_mfma_f32_16x16x32_bf16 v[112:115], a[160:163], v[72:75], v[112:115]
v_mfma_f32_16x16x32_bf16 v[132:135], a[164:167], v[72:75], v[132:135]
ds_read_b128 v[96:99], v2 offset:23552
v_mfma_f32_16x16x32_bf16 v[152:155], v[72:75], a[168:171], v[152:155]
v_mfma_f32_16x16x32_bf16 v[172:175], a[172:175], v[72:75], v[172:175]
ds_read_b128 v[100:103], v2 offset:41984
s_waitcnt lgkmcnt(6)
v_mfma_f32_16x16x32_bf16 v[116:119], a[160:163], v[76:79], v[116:119]
v_mfma_f32_16x16x32_bf16 v[136:139], a[164:167], v[76:79], v[136:139]
ds_read_b128 v[104:107], v2 offset:60416
v_mfma_f32_16x16x32_bf16 v[156:159], v[76:79], a[168:171], v[156:159]
v_mfma_f32_16x16x32_bf16 v[176:179], a[172:175], v[76:79], v[176:179]
s_add_u32 s6, s92, 44928
buffer_load_dwordx4 a[208:211], v5, s[24:27], s6 offen sc1
s_waitcnt lgkmcnt(6)
v_mfma_f32_16x16x32_bf16 v[120:123], a[160:163], v[80:83], v[120:123]
v_mfma_f32_16x16x32_bf16 v[140:143], a[164:167], v[80:83], v[140:143]
buffer_load_dwordx4 a[212:215], v5, s[24:27], s6 offen offset:1024 sc1
v_mfma_f32_16x16x32_bf16 v[160:163], v[80:83], a[168:171], v[160:163]
v_mfma_f32_16x16x32_bf16 v[180:183], a[172:175], v[80:83], v[180:183]
buffer_load_dwordx4 a[216:219], v5, s[24:27], s6 offen offset:2048 sc1
s_waitcnt lgkmcnt(5)
v_mfma_f32_16x16x32_bf16 v[124:127], a[160:163], v[84:87], v[124:127]
v_mfma_f32_16x16x32_bf16 v[144:147], a[164:167], v[84:87], v[144:147]
buffer_load_dwordx4 a[220:223], v27, s[24:27], s6 offen offset:3072 sc1
v_mfma_f32_16x16x32_bf16 v[164:167], v[84:87], a[168:171], v[164:167]
v_mfma_f32_16x16x32_bf16 v[184:187], a[172:175], v[84:87], v[184:187]
s_waitcnt vmcnt(11) lgkmcnt(4)
v_mfma_f32_16x16x32_bf16 v[108:111], a[176:179], v[88:91], v[108:111]
s_waitcnt vmcnt(10)
v_mfma_f32_16x16x32_bf16 v[128:131], a[180:183], v[88:91], v[128:131]
ds_read_b128 v[68:71], v3 offset:7008
s_waitcnt vmcnt(9)
v_mfma_f32_16x16x32_bf16 v[148:151], v[88:91], a[184:187], v[148:151]
s_waitcnt vmcnt(8)
v_mfma_f32_16x16x32_bf16 v[168:171], a[188:191], v[88:91], v[168:171]
ds_read_b128 v[72:75], v1 offset:6144
s_waitcnt lgkmcnt(5)
v_mfma_f32_16x16x32_bf16 v[112:115], a[176:179], v[92:95], v[112:115]
v_mfma_f32_16x16x32_bf16 v[132:135], a[180:183], v[92:95], v[132:135]
ds_read_b128 v[76:79], v1 offset:24576
v_mfma_f32_16x16x32_bf16 v[152:155], v[92:95], a[184:187], v[152:155]
v_mfma_f32_16x16x32_bf16 v[172:175], a[188:191], v[92:95], v[172:175]
ds_read_b128 v[80:83], v1 offset:43008
s_waitcnt lgkmcnt(6)
v_mfma_f32_16x16x32_bf16 v[116:119], a[176:179], v[96:99], v[116:119]
v_mfma_f32_16x16x32_bf16 v[136:139], a[180:183], v[96:99], v[136:139]
ds_read_b128 v[84:87], v1 offset:61440
v_mfma_f32_16x16x32_bf16 v[156:159], v[96:99], a[184:187], v[156:159]
v_mfma_f32_16x16x32_bf16 v[176:179], a[188:191], v[96:99], v[176:179]
s_add_u32 s6, s92, 48384
buffer_load_dwordx4 a[224:227], v5, s[24:27], s6 offen sc1
s_waitcnt lgkmcnt(6)
v_mfma_f32_16x16x32_bf16 v[120:123], a[176:179], v[100:103], v[120:123]
v_mfma_f32_16x16x32_bf16 v[140:143], a[180:183], v[100:103], v[140:143]
buffer_load_dwordx4 a[228:231], v5, s[24:27], s6 offen offset:1024 sc1
v_mfma_f32_16x16x32_bf16 v[160:163], v[100:103], a[184:187], v[160:163]
v_mfma_f32_16x16x32_bf16 v[180:183], a[188:191], v[100:103], v[180:183]
buffer_load_dwordx4 a[232:235], v5, s[24:27], s6 offen offset:2048 sc1
s_waitcnt lgkmcnt(5)
v_mfma_f32_16x16x32_bf16 v[124:127], a[176:179], v[104:107], v[124:127]
v_mfma_f32_16x16x32_bf16 v[144:147], a[180:183], v[104:107], v[144:147]
buffer_load_dwordx4 a[236:239], v27, s[24:27], s6 offen offset:3072 sc1
v_mfma_f32_16x16x32_bf16 v[164:167], v[104:107], a[184:187], v[164:167]
v_mfma_f32_16x16x32_bf16 v[184:187], a[188:191], v[104:107], v[184:187]
s_waitcnt vmcnt(11) lgkmcnt(4)
v_mfma_f32_16x16x32_bf16 v[108:111], a[192:195], v[68:71], v[108:111]
s_waitcnt vmcnt(10)
v_mfma_f32_16x16x32_bf16 v[128:131], a[196:199], v[68:71], v[128:131]
ds_read_b128 v[88:91], v4 offset:7008
s_waitcnt vmcnt(9)
v_mfma_f32_16x16x32_bf16 v[148:151], v[68:71], a[200:203], v[148:151]
s_waitcnt vmcnt(8)
v_mfma_f32_16x16x32_bf16 v[168:171], a[204:207], v[68:71], v[168:171]
ds_read_b128 v[92:95], v2 offset:6144
s_waitcnt lgkmcnt(5)
v_mfma_f32_16x16x32_bf16 v[112:115], a[192:195], v[72:75], v[112:115]
v_mfma_f32_16x16x32_bf16 v[132:135], a[196:199], v[72:75], v[132:135]
ds_read_b128 v[96:99], v2 offset:24576
v_mfma_f32_16x16x32_bf16 v[152:155], v[72:75], a[200:203], v[152:155]
v_mfma_f32_16x16x32_bf16 v[172:175], a[204:207], v[72:75], v[172:175]
ds_read_b128 v[100:103], v2 offset:43008
s_waitcnt lgkmcnt(6)
v_mfma_f32_16x16x32_bf16 v[116:119], a[192:195], v[76:79], v[116:119]
v_mfma_f32_16x16x32_bf16 v[136:139], a[196:199], v[76:79], v[136:139]
ds_read_b128 v[104:107], v2 offset:61440
v_mfma_f32_16x16x32_bf16 v[156:159], v[76:79], a[200:203], v[156:159]
v_mfma_f32_16x16x32_bf16 v[176:179], a[204:207], v[76:79], v[176:179]
s_add_u32 s6, s92, 51840
buffer_load_dwordx4 a[240:243], v5, s[24:27], s6 offen sc1
s_waitcnt lgkmcnt(6)
v_mfma_f32_16x16x32_bf16 v[120:123], a[192:195], v[80:83], v[120:123]
v_mfma_f32_16x16x32_bf16 v[140:143], a[196:199], v[80:83], v[140:143]
buffer_load_dwordx4 a[244:247], v5, s[24:27], s6 offen offset:1024 sc1
v_mfma_f32_16x16x32_bf16 v[160:163], v[80:83], a[200:203], v[160:163]
v_mfma_f32_16x16x32_bf16 v[180:183], a[204:207], v[80:83], v[180:183]
buffer_load_dwordx4 a[248:251], v5, s[24:27], s6 offen offset:2048 sc1
s_waitcnt lgkmcnt(5)
v_mfma_f32_16x16x32_bf16 v[124:127], a[192:195], v[84:87], v[124:127]
v_mfma_f32_16x16x32_bf16 v[144:147], a[196:199], v[84:87], v[144:147]
buffer_load_dwordx4 a[252:255], v27, s[24:27], s6 offen offset:3072 sc1
v_mfma_f32_16x16x32_bf16 v[164:167], v[84:87], a[200:203], v[164:167]
v_mfma_f32_16x16x32_bf16 v[184:187], a[204:207], v[84:87], v[184:187]
s_waitcnt vmcnt(11) lgkmcnt(4)
v_mfma_f32_16x16x32_bf16 v[108:111], a[208:211], v[88:91], v[108:111]
ds_read_b128 v[68:71], v3 offset:8176
s_waitcnt vmcnt(10)
v_mfma_f32_16x16x32_bf16 v[128:131], a[212:215], v[88:91], v[128:131]
ds_read_b128 v[72:75], v1 offset:7168
s_waitcnt vmcnt(9)
v_mfma_f32_16x16x32_bf16 v[148:151], v[88:91], a[216:219], v[148:151]
ds_read_b128 v[76:79], v1 offset:25600
s_waitcnt vmcnt(8)
v_mfma_f32_16x16x32_bf16 v[168:171], a[220:223], v[88:91], v[168:171]
ds_read_b128 v[80:83], v1 offset:44032
s_waitcnt lgkmcnt(7)
v_mfma_f32_16x16x32_bf16 v[112:115], a[208:211], v[92:95], v[112:115]
ds_read_b128 v[84:87], v1 offset:62464
v_mfma_f32_16x16x32_bf16 v[132:135], a[212:215], v[92:95], v[132:135]
s_add_u32 s6, s92, 55296
buffer_load_dwordx4 v[224:227], v5, s[24:27], s6 offen sc1
v_mfma_f32_16x16x32_bf16 v[152:155], v[92:95], a[216:219], v[152:155]
v_mfma_f32_16x16x32_bf16 v[172:175], a[220:223], v[92:95], v[172:175]
buffer_load_dwordx4 v[228:231], v5, s[24:27], s6 offen offset:1024 sc1
s_waitcnt lgkmcnt(7)
v_mfma_f32_16x16x32_bf16 v[116:119], a[208:211], v[96:99], v[116:119]
v_mfma_f32_16x16x32_bf16 v[136:139], a[212:215], v[96:99], v[136:139]
buffer_load_dwordx4 v[232:235], v5, s[24:27], s6 offen offset:2048 sc1
v_mfma_f32_16x16x32_bf16 v[156:159], v[96:99], a[216:219], v[156:159]
v_mfma_f32_16x16x32_bf16 v[176:179], a[220:223], v[96:99], v[176:179]
buffer_load_dwordx4 v[236:239], v27, s[24:27], s6 offen offset:3072 sc1
s_waitcnt lgkmcnt(6)
v_mfma_f32_16x16x32_bf16 v[120:123], a[208:211], v[100:103], v[120:123]
v_mfma_f32_16x16x32_bf16 v[140:143], a[212:215], v[100:103], v[140:143]
s_lshr_b32 s13, s75, 1
s_mul_i32 s13, s13, 14
s_add_u32 s13, s13, s75
v_mfma_f32_16x16x32_bf16 v[160:163], v[100:103], a[216:219], v[160:163]
v_mfma_f32_16x16x32_bf16 v[180:183], a[220:223], v[100:103], v[180:183]
s_lshl1_add_u32 s13, s74, s13
s_lshl_b32 s13, s13, 6
s_mul_i32 s1, s77, 82944
s_add_u32 s13, s13, s1
s_waitcnt lgkmcnt(5)
v_mfma_f32_16x16x32_bf16 v[124:127], a[208:211], v[104:107], v[124:127]
v_mfma_f32_16x16x32_bf16 v[144:147], a[212:215], v[104:107], v[144:147]
s_add_u32 s13, s13, 3145728
v_mfma_f32_16x16x32_bf16 v[164:167], v[104:107], a[216:219], v[164:167]
v_mfma_f32_16x16x32_bf16 v[184:187], a[220:223], v[104:107], v[184:187]
v_lshrrev_b32 v44, 2, v0
v_mul_u32_u24 v44, 9152, v44
v_add_u32 v44, v44, v5
s_waitcnt vmcnt(11) lgkmcnt(4)
v_mfma_f32_16x16x32_bf16 v[108:111], a[224:227], v[68:71], v[108:111]
ds_read_b128 v[88:91], v4 offset:8176
s_waitcnt vmcnt(10)
v_mfma_f32_16x16x32_bf16 v[128:131], a[228:231], v[68:71], v[128:131]
ds_read_b128 v[92:95], v2 offset:7168
L_pad1:
s_cbranch_execz L_pad4
s_waitcnt vmcnt(9)
v_mfma_f32_16x16x32_bf16 v[148:151], v[68:71], a[232:235], v[148:151]
ds_read_b128 v[96:99], v2 offset:25600
s_waitcnt vmcnt(8)
v_mfma_f32_16x16x32_bf16 v[168:171], a[236:239], v[68:71], v[168:171]
ds_read_b128 v[100:103], v2 offset:44032
s_waitcnt lgkmcnt(7)
v_mfma_f32_16x16x32_bf16 v[112:115], a[224:227], v[72:75], v[112:115]
v_mfma_f32_16x16x32_bf16 v[132:135], a[228:231], v[72:75], v[132:135]
ds_read_b128 v[104:107], v2 offset:62464
v_mfma_f32_16x16x32_bf16 v[152:155], v[72:75], a[232:235], v[152:155]
v_mfma_f32_16x16x32_bf16 v[172:175], a[236:239], v[72:75], v[172:175]
s_add_u32 s6, s92, 58752
buffer_load_dwordx4 v[240:243], v5, s[24:27], s6 offen sc1
s_waitcnt lgkmcnt(7)
v_mfma_f32_16x16x32_bf16 v[116:119], a[224:227], v[76:79], v[116:119]
v_mfma_f32_16x16x32_bf16 v[136:139], a[228:231], v[76:79], v[136:139]
buffer_load_dwordx4 v[244:247], v5, s[24:27], s6 offen offset:1024 sc1
v_mfma_f32_16x16x32_bf16 v[156:159], v[76:79], a[232:235], v[156:159]
v_mfma_f32_16x16x32_bf16 v[176:179], a[236:239], v[76:79], v[176:179]
buffer_load_dwordx4 v[248:251], v5, s[24:27], s6 offen offset:2048 sc1
s_waitcnt lgkmcnt(6)
v_mfma_f32_16x16x32_bf16 v[120:123], a[224:227], v[80:83], v[120:123]
v_mfma_f32_16x16x32_bf16 v[140:143], a[228:231], v[80:83], v[140:143]
buffer_load_dwordx4 v[252:255], v27, s[24:27], s6 offen offset:3072 sc1
v_mfma_f32_16x16x32_bf16 v[160:163], v[80:83], a[232:235], v[160:163]
v_mfma_f32_16x16x32_bf16 v[180:183], a[236:239], v[80:83], v[180:183]
buffer_load_dword v54, v26, s[24:27], 0 offen sc1
s_waitcnt lgkmcnt(5)
v_mfma_f32_16x16x32_bf16 v[124:127], a[224:227], v[84:87], v[124:127]
v_mfma_f32_16x16x32_bf16 v[144:147], a[228:231], v[84:87], v[144:147]
s_lshl_b32 s1, s76, 2
s_add_u32 s1, s1, s77
s_mul_i32 s1, s1, 4
s_add_u32 s1, s1, 512
v_min_u32 v55, 3, v0
v_add_lshl_u32 v55, v55, s1, 7
v_mfma_f32_16x16x32_bf16 v[164:167], v[84:87], a[232:235], v[164:167]
v_mfma_f32_16x16x32_bf16 v[184:187], a[236:239], v[84:87], v[184:187]
v_mov_b32 v40, -1
v_mov_b32 v41, -1
v_mov_b32 v42, -1
v_mov_b32 v43, -1
s_waitcnt vmcnt(12) lgkmcnt(4)
v_mfma_f32_16x16x32_bf16 v[108:111], a[240:243], v[88:91], v[108:111]
ds_read_b128 v[68:71], v3 offset:9344
s_waitcnt vmcnt(11)
v_mfma_f32_16x16x32_bf16 v[128:131], a[244:247], v[88:91], v[128:131]
ds_read_b128 v[72:75], v1 offset:8192
s_waitcnt vmcnt(10)
v_mfma_f32_16x16x32_bf16 v[148:151], v[88:91], a[248:251], v[148:151]
ds_read_b128 v[76:79], v1 offset:26624
s_waitcnt vmcnt(9)
v_mfma_f32_16x16x32_bf16 v[168:171], a[252:255], v[88:91], v[168:171]
ds_read_b128 v[80:83], v1 offset:45056
s_waitcnt lgkmcnt(7)
v_mfma_f32_16x16x32_bf16 v[112:115], a[240:243], v[92:95], v[112:115]
v_mfma_f32_16x16x32_bf16 v[132:135], a[244:247], v[92:95], v[132:135]
ds_read_b128 v[84:87], v1 offset:63488
v_mfma_f32_16x16x32_bf16 v[152:155], v[92:95], a[248:251], v[152:155]
v_mfma_f32_16x16x32_bf16 v[172:175], a[252:255], v[92:95], v[172:175]
v_min_u32 v53, 41, v0
v_lshlrev_b32 v53, 7, v53
s_waitcnt lgkmcnt(7)
v_mfma_f32_16x16x32_bf16 v[116:119], a[240:243], v[96:99], v[116:119]
v_mfma_f32_16x16x32_bf16 v[136:139], a[244:247], v[96:99], v[136:139]
s_add_u32 s1, s13, 0
s_cmp_lt_u32 s75, 18
s_cselect_b32 exec_lo, -1, 0
s_cselect_b32 exec_hi, 15, 0
buffer_store_dwordx4 v[40:43], v44, s[24:27], s1 offen sc1
s_mov_b64 exec, -1
v_mfma_f32_16x16x32_bf16 v[156:159], v[96:99], a[248:251], v[156:159]
v_mfma_f32_16x16x32_bf16 v[176:179], a[252:255], v[96:99], v[176:179]
v_add_u32 v50, 0, v0
v_min_u32 v50, 40, v50
s_waitcnt lgkmcnt(6)
v_mfma_f32_16x16x32_bf16 v[120:123], a[240:243], v[100:103], v[120:123]
v_mfma_f32_16x16x32_bf16 v[140:143], a[244:247], v[100:103], v[140:143]
s_mul_i32 s1, s77, 41
s_sub_u32 s1, s1, 0
v_add_u32 v50, s1, v50
v_min_u32 v50, 161, v50
v_mfma_f32_16x16x32_bf16 v[160:163], v[100:103], a[248:251], v[160:163]
v_mfma_f32_16x16x32_bf16 v[180:183], a[252:255], v[100:103], v[180:183]
v_mul_u32_u24 v51, 7282, v50
v_lshrrev_b32 v51, 16, v51
s_waitcnt lgkmcnt(5)
v_mfma_f32_16x16x32_bf16 v[124:127], a[240:243], v[104:107], v[124:127]
v_mfma_f32_16x16x32_bf16 v[144:147], a[244:247], v[104:107], v[144:147]
v_mul_u32_u24 v51, 8064, v51
v_lshl_add_u32 v50, v50, 7, v51
v_mfma_f32_16x16x32_bf16 v[164:167], v[104:107], a[248:251], v[164:167]
v_mfma_f32_16x16x32_bf16 v[184:187], a[252:255], v[104:107], v[184:187]
s_mul_i32 s1, s75, 144
s_add_u32 s1, s1, s74
s_mul_i32 s1, s1, 1152
s_mov_b32 s38, 5308416
buffer_load_dword v18, v50, s[36:39], s1 offen
s_mov_b32 s38, s95
s_waitcnt vmcnt(10) lgkmcnt(4)
v_mfma_f32_16x16x32_bf16 v[108:111], v[224:227], v[68:71], v[108:111]
s_waitcnt vmcnt(9)
v_mfma_f32_16x16x32_bf16 v[128:131], v[228:231], v[68:71], v[128:131]
ds_read_b128 v[88:91], v4 offset:9344
s_waitcnt vmcnt(8)
v_mfma_f32_16x16x32_bf16 v[148:151], v[68:71], v[232:235], v[148:151]
s_waitcnt vmcnt(7)
v_mfma_f32_16x16x32_bf16 v[168:171], v[236:239], v[68:71], v[168:171]
ds_read_b128 v[92:95], v2 offset:8192
s_waitcnt lgkmcnt(5)
v_mfma_f32_16x16x32_bf16 v[112:115], v[224:227], v[72:75], v[112:115]
v_mfma_f32_16x16x32_bf16 v[132:135], v[228:231], v[72:75], v[132:135]
ds_read_b128 v[96:99], v2 offset:26624
v_mfma_f32_16x16x32_bf16 v[152:155], v[72:75], v[232:235], v[152:155]
v_mfma_f32_16x16x32_bf16 v[172:175], v[236:239], v[72:75], v[172:175]
ds_read_b128 v[100:103], v2 offset:45056
s_waitcnt lgkmcnt(6)
v_mfma_f32_16x16x32_bf16 v[116:119], v[224:227], v[76:79], v[116:119]
v_mfma_f32_16x16x32_bf16 v[136:139], v[228:231], v[76:79], v[136:139]
ds_read_b128 v[104:107], v2 offset:63488
v_mfma_f32_16x16x32_bf16 v[156:159], v[76:79], v[232:235], v[156:159]
v_mfma_f32_16x16x32_bf16 v[176:179], v[236:239], v[76:79], v[176:179]
s_and_b32 s1, s78, 3
s_lshl_b32 s7, s76, 2
s_add_u32 s1, s1, s7
s_mul_i32 s1, s1, 20736
s_mul_i32 s7, s77, 5120
s_add_u32 s1, s1, s7
s_add_u32 s1, s1, 2228224
buffer_load_dword v18, v53, s[24:27], s1 offen sc1
s_waitcnt lgkmcnt(6)
v_mfma_f32_16x16x32_bf16 v[120:123], v[224:227], v[80:83], v[120:123]
v_mfma_f32_16x16x32_bf16 v[140:143], v[228:231], v[80:83], v[140:143]
v_mfma_f32_16x16x32_bf16 v[160:163], v[80:83], v[232:235], v[160:163]
v_mfma_f32_16x16x32_bf16 v[180:183], v[236:239], v[80:83], v[180:183]
s_waitcnt lgkmcnt(5)
v_mfma_f32_16x16x32_bf16 v[124:127], v[224:227], v[84:87], v[124:127]
v_mfma_f32_16x16x32_bf16 v[144:147], v[228:231], v[84:87], v[144:147]
v_mfma_f32_16x16x32_bf16 v[164:167], v[84:87], v[232:235], v[164:167]
v_mfma_f32_16x16x32_bf16 v[184:187], v[236:239], v[84:87], v[184:187]
s_waitcnt vmcnt(3)
v_cmp_ne_u32 vcc, v54, v46
s_cbranch_vccnz R_17
C_18:
s_waitcnt lgkmcnt(4)
v_mfma_f32_16x16x32_bf16 v[108:111], v[240:243], v[88:91], v[108:111]
buffer_load_dword v18, v55, s[24:27], s84 offen sc1
v_mfma_f32_16x16x32_bf16 v[128:131], v[244:247], v[88:91], v[128:131]
v_lshlrev_b32 v22, 2, v6
v_mfma_f32_16x16x32_bf16 v[148:151], v[88:91], v[248:251], v[148:151]
v_add_u32 v22, 160128, v22
v_mfma_f32_16x16x32_bf16 v[168:171], v[252:255], v[88:91], v[168:171]
v_lshlrev_b32 v23, 4, v7
s_waitcnt lgkmcnt(3)
v_mfma_f32_16x16x32_bf16 v[112:115], v[240:243], v[92:95], v[112:115]
v_add_u32 v23, 160128, v23
v_mfma_f32_16x16x32_bf16 v[132:135], v[244:247], v[92:95], v[132:135]
ds_read_b128 v[58:61], v19
v_mfma_f32_16x16x32_bf16 v[152:155], v[92:95], v[248:251], v[152:155]
ds_read_b128 v[62:65], v20
v_mfma_f32_16x16x32_bf16 v[172:175], v[252:255], v[92:95], v[172:175]
ds_read_b64 v[66:67], v21
s_waitcnt lgkmcnt(5)
v_mfma_f32_16x16x32_bf16 v[116:119], v[240:243], v[96:99], v[116:119]
ds_read2_b32 v[28:29], v22 offset0:0 offset1:80
v_mfma_f32_16x16x32_bf16 v[136:139], v[244:247], v[96:99], v[136:139]
ds_read2_b32 v[30:31], v22 offset0:16 offset1:96
v_mfma_f32_16x16x32_bf16 v[156:159], v[96:99], v[248:251], v[156:159]
ds_read2_b32 v[32:33], v22 offset0:32 offset1:112
v_mfma_f32_16x16x32_bf16 v[176:179], v[252:255], v[96:99], v[176:179]
ds_read2_b32 v[34:35], v22 offset0:48 offset1:128
s_waitcnt lgkmcnt(8)
v_mfma_f32_16x16x32_bf16 v[120:123], v[240:243], v[100:103], v[120:123]
ds_read2_b32 v[36:37], v22 offset0:64 offset1:144
v_mfma_f32_16x16x32_bf16 v[140:143], v[244:247], v[100:103], v[140:143]
ds_read_b128 v[68:71], v23 offset:0
v_mfma_f32_16x16x32_bf16 v[160:163], v[100:103], v[248:251], v[160:163]
v_mfma_f32_16x16x32_bf16 v[180:183], v[252:255], v[100:103], v[180:183]
ds_read_b128 v[72:75], v23 offset:320
s_waitcnt lgkmcnt(10)
v_mfma_f32_16x16x32_bf16 v[124:127], v[240:243], v[104:107], v[124:127]
v_mfma_f32_16x16x32_bf16 v[144:147], v[244:247], v[104:107], v[144:147]
ds_read_b128 v[76:79], v23 offset:64
v_mfma_f32_16x16x32_bf16 v[164:167], v[104:107], v[248:251], v[164:167]
v_mfma_f32_16x16x32_bf16 v[184:187], v[252:255], v[104:107], v[184:187]
ds_read_b128 v[80:83], v23 offset:384
s_cmp_lg_u32 s93, 0
s_cbranch_scc1 L_slow
s_waitcnt lgkmcnt(0)
s_barrier
s_mul_i32 s3, s77, 20480
s_mul_i32 s4, s76, 82944
s_add_u32 s4, s4, s3
v_mul_f32 v38, 0x3eae1a93, v29
v_mul_f32 v39, 0x3eae1a93, v31
v_mul_f32 v40, 0x3eae1a93, v33
v_mul_f32 v41, 0x3eae1a93, v35
v_mul_f32 v42, 0x3eae1a93, v37
v_mov_b32 v56, v148
v_mov_b32 v57, v148
v_mov_b32_dpp v52, v168 row_newbcast:0 row_mask:0xf bank_mask:0xf
v_mov_b32_dpp v53, v169 row_newbcast:0 row_mask:0xf bank_mask:0xf
v_mov_b32_dpp v54, v170 row_newbcast:0 row_mask:0xf bank_mask:0xf
v_mov_b32_dpp v55, v171 row_newbcast:0 row_mask:0xf bank_mask:0xf
v_mov_b32_dpp v48, v128 row_newbcast:0 row_mask:0xf bank_mask:0xf
s_add_u32 m0, s3, 0
s_add_u32 s5, s4, 2228224
buffer_load_dwordx4 v5, s[24:27], s5 offen offset:0 sc1 lds
v_mov_b32_dpp v49, v129 row_newbcast:0 row_mask:0xf bank_mask:0xf
v_mov_b32_dpp v50, v130 row_newbcast:0 row_mask:0xf bank_mask:0xf
v_mov_b32_dpp v51, v131 row_newbcast:0 row_mask:0xf bank_mask:0xf
v_mov_b32_dpp v44, v108 row_newbcast:0 row_mask:0xf bank_mask:0xf
v_mov_b32_dpp v45, v109 row_newbcast:0 row_mask:0xf bank_mask:0xf
v_mov_b32_dpp v46, v110 row_newbcast:0 row_mask:0xf bank_mask:0xf
v_mov_b32_dpp v47, v111 row_newbcast:0 row_mask:0xf bank_mask:0xf
v_permlane32_swap_b32 v56, v57
s_lshl_b32 s1, s77, 8
s_add_u32 s1, s1, 159104
v_lshl_add_u32 v26, v7, 4, s1
v_lshl_add_u32 v27, v6, 2, s1
ds_write_b128 v26, v[44:47] offset:0
ds_write_b128 v26, v[48:51] offset:64
ds_write_b128 v26, v[52:55] offset:128
ds_write_b32 v27, v56 offset:192
v_pk_fma_f32 v[168:169], v[52:53], v[28:29], v[168:169] op_sel_hi:[1,0,1]
v_pk_fma_f32 v[170:171], v[54:55], v[28:29], v[170:171] op_sel_hi:[1,0,1]
v_pk_fma_f32 v[128:129], v[48:49], v[28:29], v[128:129] op_sel_hi:[1,0,1]
v_pk_fma_f32 v[130:131], v[50:51], v[28:29], v[130:131] op_sel_hi:[1,0,1]
buffer_load_dwordx4 v5, s[24:27], s5 offen offset:1024 sc1 lds
v_pk_mul_f32 v[168:169], v[168:169], v[28:29] op_sel:[0,1] op_sel_hi:[1,1]
v_pk_mul_f32 v[170:171], v[170:171], v[38:39] op_sel:[0,0] op_sel_hi:[1,0]
v_pk_mul_f32 v[128:129], v[128:129], v[38:39] op_sel:[0,0] op_sel_hi:[1,0]
v_pk_mul_f32 v[130:131], v[130:131], v[38:39] op_sel:[0,0] op_sel_hi:[1,0]
v_pk_fma_f32 v[148:149], v[68:69], v[56:57], v[148:149] op_sel_hi:[1,0,1]
v_pk_fma_f32 v[150:151], v[70:71], v[56:57], v[150:151] op_sel_hi:[1,0,1]
v_pk_mul_f32 v[148:149], v[148:149], v[72:73]
v_pk_mul_f32 v[150:151], v[150:151], v[74:75]
v_cvt_pk_bf16_f32 v110, v168, v169
v_mov_b32 v111, 0x3f80
v_cvt_pk_bf16_f32 v128, v128, v129
v_cvt_pk_bf16_f32 v129, v130, v131
buffer_load_dwordx4 v5, s[24:27], s5 offen offset:2048 sc1 lds
v_cvt_pk_bf16_f32 v130, v170, v171
v_mov_b32 v131, 0
v_mfma_f32_16x16x16_bf16 v[168:171], v[110:111], v[14:15], 0
v_cvt_pk_bf16_f32 v151, v150, v151
v_cvt_pk_bf16_f32 v150, v148, v149
ds_read_b128 v[68:71], v23 offset:128
ds_read_b128 v[72:75], v23 offset:448
v_pk_fma_f32 v[172:173], v[52:53], v[30:31], v[172:173] op_sel_hi:[1,0,1]
v_pk_fma_f32 v[174:175], v[54:55], v[30:31], v[174:175] op_sel_hi:[1,0,1]
v_pk_fma_f32 v[132:133], v[48:49], v[30:31], v[132:133] op_sel_hi:[1,0,1]
v_pk_fma_f32 v[134:135], v[50:51], v[30:31], v[134:135] op_sel_hi:[1,0,1]
v_pk_fma_f32 v[112:113], v[44:45], v[30:31], v[112:113] op_sel_hi:[1,0,1]
buffer_load_dwordx4 v5, s[24:27], s5 offen offset:3072 sc1 lds
v_pk_fma_f32 v[114:115], v[46:47], v[30:31], v[114:115] op_sel_hi:[1,0,1]
v_pk_mul_f32 v[172:173], v[172:173], v[30:31] op_sel:[0,1] op_sel_hi:[1,1]
v_pk_mul_f32 v[174:175], v[174:175], v[38:39] op_sel:[0,1] op_sel_hi:[1,1]
v_pk_mul_f32 v[132:133], v[132:133], v[38:39] op_sel:[0,1] op_sel_hi:[1,1]
v_pk_mul_f32 v[134:135], v[134:135], v[38:39] op_sel:[0,1] op_sel_hi:[1,1]
v_pk_mul_f32 v[112:113], v[112:113], v[30:31] op_sel:[0,1] op_sel_hi:[1,1]
v_pk_mul_f32 v[114:115], v[114:115], v[30:31] op_sel:[0,1] op_sel_hi:[1,1]
v_pk_fma_f32 v[152:153], v[76:77], v[56:57], v[152:153] op_sel_hi:[1,0,1]
v_pk_fma_f32 v[154:155], v[78:79], v[56:57], v[154:155] op_sel_hi:[1,0,1]
v_pk_mul_f32 v[152:153], v[152:153], v[80:81]
v_pk_mul_f32 v[154:155], v[154:155], v[82:83]
v_cvt_pk_bf16_f32 v112, v112, v113
s_add_u32 m0, s3, 4096
s_add_u32 s5, s4, 2232320
buffer_load_dwordx4 v5, s[24:27], s5 offen offset:0 sc1 lds
v_cvt_pk_bf16_f32 v113, v114, v115
v_cvt_pk_bf16_f32 v114, v172, v173
v_mov_b32 v115, 0x3f80
v_cvt_pk_bf16_f32 v132, v132, v133
v_cvt_pk_bf16_f32 v133, v134, v135
v_mfma_f32_16x16x32_bf16 v[108:111], v[128:131], v[112:115], v[8:11]
v_cvt_pk_bf16_f32 v134, v174, v175
v_mov_b32 v135, 0
v_mfma_f32_16x16x16_bf16 v[172:175], v[114:115], v[14:15], 0
v_cvt_pk_bf16_f32 v152, v152, v153
v_cvt_pk_bf16_f32 v153, v154, v155
v_mfma_f32_16x16x32_bf16 v[88:91], v[132:135], v[112:115], v[8:11]
buffer_load_dwordx4 v5, s[24:27], s5 offen offset:1024 sc1 lds
ds_read_b128 v[76:79], v23 offset:192
ds_read_b128 v[80:83], v23 offset:512
v_pk_fma_f32 v[176:177], v[52:53], v[32:33], v[176:177] op_sel_hi:[1,0,1]
v_pk_fma_f32 v[178:179], v[54:55], v[32:33], v[178:179] op_sel_hi:[1,0,1]
v_pk_fma_f32 v[136:137], v[48:49], v[32:33], v[136:137] op_sel_hi:[1,0,1]
v_pk_fma_f32 v[138:139], v[50:51], v[32:33], v[138:139] op_sel_hi:[1,0,1]
v_pk_fma_f32 v[116:117], v[44:45], v[32:33], v[116:117] op_sel_hi:[1,0,1]
v_pk_fma_f32 v[118:119], v[46:47], v[32:33], v[118:119] op_sel_hi:[1,0,1]
v_pk_mul_f32 v[176:177], v[176:177], v[32:33] op_sel:[0,1] op_sel_hi:[1,1]
v_pk_mul_f32 v[178:179], v[178:179], v[40:41] op_sel:[0,0] op_sel_hi:[1,0]
v_pk_mul_f32 v[136:137], v[136:137], v[40:41] op_sel:[0,0] op_sel_hi:[1,0]
v_pk_mul_f32 v[138:139], v[138:139], v[40:41] op_sel:[0,0] op_sel_hi:[1,0]
buffer_load_dwordx4 v5, s[24:27], s5 offen offset:2048 sc1 lds
v_pk_mul_f32 v[116:117], v[116:117], v[32:33] op_sel:[0,1] op_sel_hi:[1,1]
v_pk_mul_f32 v[118:119], v[118:119], v[32:33] op_sel:[0,1] op_sel_hi:[1,1]
s_waitcnt lgkmcnt(3)
v_pk_fma_f32 v[156:157], v[68:69], v[56:57], v[156:157] op_sel_hi:[1,0,1]
v_pk_fma_f32 v[158:159], v[70:71], v[56:57], v[158:159] op_sel_hi:[1,0,1]
s_waitcnt lgkmcnt(2)
v_pk_mul_f32 v[156:157], v[156:157], v[72:73]
v_pk_mul_f32 v[158:159], v[158:159], v[74:75]
v_cvt_pk_bf16_f32 v116, v116, v117
v_cvt_pk_bf16_f32 v117, v118, v119
v_cvt_pk_bf16_f32 v118, v176, v177
v_mov_b32 v119, 0x3f80
v_cvt_pk_bf16_f32 v136, v136, v137
v_cvt_pk_bf16_f32 v137, v138, v139
buffer_load_dwordx4 v5, s[24:27], s5 offen offset:3072 sc1 lds
v_mfma_f32_16x16x32_bf16 v[112:115], v[132:135], v[116:119], v[8:11]
v_cvt_pk_bf16_f32 v138, v178, v179
v_mov_b32 v139, 0
v_mfma_f32_16x16x16_bf16 v[176:179], v[118:119], v[14:15], 0
v_cvt_pk_bf16_f32 v154, v156, v157
v_cvt_pk_bf16_f32 v155, v158, v159
v_mfma_f32_16x16x32_bf16 v[92:95], v[136:139], v[116:119], v[8:11]
ds_read_b128 v[68:71], v23 offset:256
ds_read_b128 v[72:75], v23 offset:576
v_pk_fma_f32 v[180:181], v[52:53], v[34:35], v[180:181] op_sel_hi:[1,0,1]
v_pk_fma_f32 v[182:183], v[54:55], v[34:35], v[182:183] op_sel_hi:[1,0,1]
v_pk_fma_f32 v[140:141], v[48:49], v[34:35], v[140:141] op_sel_hi:[1,0,1]
s_add_u32 m0, s3, 8192
s_add_u32 s5, s4, 2236416
buffer_load_dwordx4 v5, s[24:27], s5 offen offset:0 sc1 lds
v_pk_fma_f32 v[142:143], v[50:51], v[34:35], v[142:143] op_sel_hi:[1,0,1]
v_pk_fma_f32 v[120:121], v[44:45], v[34:35], v[120:121] op_sel_hi:[1,0,1]
v_pk_fma_f32 v[122:123], v[46:47], v[34:35], v[122:123] op_sel_hi:[1,0,1]
v_pk_mul_f32 v[180:181], v[180:181], v[34:35] op_sel:[0,1] op_sel_hi:[1,1]
v_pk_mul_f32 v[182:183], v[182:183], v[40:41] op_sel:[0,1] op_sel_hi:[1,1]
v_pk_mul_f32 v[140:141], v[140:141], v[40:41] op_sel:[0,1] op_sel_hi:[1,1]
v_pk_mul_f32 v[142:143], v[142:143], v[40:41] op_sel:[0,1] op_sel_hi:[1,1]
v_pk_mul_f32 v[120:121], v[120:121], v[34:35] op_sel:[0,1] op_sel_hi:[1,1]
v_pk_mul_f32 v[122:123], v[122:123], v[34:35] op_sel:[0,1] op_sel_hi:[1,1]
s_waitcnt lgkmcnt(3)
v_pk_fma_f32 v[160:161], v[76:77], v[56:57], v[160:161] op_sel_hi:[1,0,1]
v_pk_fma_f32 v[162:163], v[78:79], v[56:57], v[162:163] op_sel_hi:[1,0,1]
s_waitcnt lgkmcnt(2)
v_pk_mul_f32 v[160:161], v[160:161], v[80:81]
buffer_load_dwordx4 v5, s[24:27], s5 offen offset:1024 sc1 lds
v_pk_mul_f32 v[162:163], v[162:163], v[82:83]
v_cvt_pk_bf16_f32 v120, v120, v121
v_cvt_pk_bf16_f32 v121, v122, v123
v_cvt_pk_bf16_f32 v122, v180, v181
v_mov_b32 v123, 0x3f80
v_cvt_pk_bf16_f32 v140, v140, v141
v_cvt_pk_bf16_f32 v141, v142, v143
v_mfma_f32_16x16x32_bf16 v[116:119], v[136:139], v[120:123], v[8:11]
v_cvt_pk_bf16_f32 v142, v182, v183
v_mov_b32 v143, 0
v_mfma_f32_16x16x16_bf16 v[180:183], v[122:123], v[14:15], 0
v_cvt_pk_bf16_f32 v156, v160, v161
buffer_load_dwordx4 v5, s[24:27], s5 offen offset:2048 sc1 lds
v_cvt_pk_bf16_f32 v157, v162, v163
v_mfma_f32_16x16x32_bf16 v[96:99], v[140:143], v[120:123], v[8:11]
v_pk_fma_f32 v[184:185], v[52:53], v[36:37], v[184:185] op_sel_hi:[1,0,1]
v_pk_fma_f32 v[186:187], v[54:55], v[36:37], v[186:187] op_sel_hi:[1,0,1]
v_pk_fma_f32 v[144:145], v[48:49], v[36:37], v[144:145] op_sel_hi:[1,0,1]
v_pk_fma_f32 v[146:147], v[50:51], v[36:37], v[146:147] op_sel_hi:[1,0,1]
v_pk_fma_f32 v[124:125], v[44:45], v[36:37], v[124:125] op_sel_hi:[1,0,1]
v_pk_fma_f32 v[126:127], v[46:47], v[36:37], v[126:127] op_sel_hi:[1,0,1]
v_pk_mul_f32 v[184:185], v[184:185], v[36:37] op_sel:[0,1] op_sel_hi:[1,1]
v_pk_mul_f32 v[186:187], v[186:187], v[42:43] op_sel:[0,0] op_sel_hi:[1,0]
v_pk_mul_f32 v[144:145], v[144:145], v[42:43] op_sel:[0,0] op_sel_hi:[1,0]
v_pk_mul_f32 v[146:147], v[146:147], v[42:43] op_sel:[0,0] op_sel_hi:[1,0]
buffer_load_dwordx4 v5, s[24:27], s5 offen offset:3072 sc1 lds
v_pk_mul_f32 v[124:125], v[124:125], v[36:37] op_sel:[0,1] op_sel_hi:[1,1]
v_pk_mul_f32 v[126:127], v[126:127], v[36:37] op_sel:[0,1] op_sel_hi:[1,1]
s_waitcnt lgkmcnt(1)
v_pk_fma_f32 v[164:165], v[68:69], v[56:57], v[164:165] op_sel_hi:[1,0,1]
v_pk_fma_f32 v[166:167], v[70:71], v[56:57], v[166:167] op_sel_hi:[1,0,1]
s_waitcnt lgkmcnt(0)
v_pk_mul_f32 v[164:165], v[164:165], v[72:73]
v_pk_mul_f32 v[166:167], v[166:167], v[74:75]
v_cvt_pk_bf16_f32 v124, v124, v125
v_cvt_pk_bf16_f32 v125, v126, v127
v_cvt_pk_bf16_f32 v126, v184, v185
v_mov_b32 v127, 0x3f80
v_cvt_pk_bf16_f32 v144, v144, v145
v_cvt_pk_bf16_f32 v145, v146, v147
s_add_u32 m0, s3, 12288
s_add_u32 s5, s4, 2240512
buffer_load_dwordx4 v5, s[24:27], s5 offen offset:0 sc1 lds
v_mfma_f32_16x16x32_bf16 v[120:123], v[140:143], v[124:127], v[8:11]
v_cvt_pk_bf16_f32 v146, v186, v187
v_mov_b32 v147, 0
v_mfma_f32_16x16x16_bf16 v[184:187], v[126:127], v[14:15], 0
v_cvt_pk_bf16_f32 v158, v164, v165
v_cvt_pk_bf16_f32 v159, v166, v167
v_mfma_f32_16x16x32_bf16 v[100:103], v[144:147], v[124:127], v[8:11]
v_pk_add_f32 v[108:109], v[108:109], s[72:73]
v_pk_add_f32 v[110:111], v[110:111], s[72:73]
v_cndmask_b32 v88, v108, v88, s[64:65]
v_cndmask_b32 v89, v109, v89, s[66:67]
v_cndmask_b32 v90, v110, v90, s[68:69]
buffer_load_dwordx4 v5, s[24:27], s5 offen offset:1024 sc1 lds
v_cndmask_b32 v91, v111, v91, s[70:71]
v_max3_f32 v84, v88, v89, v90
v_max_f32 v84, v84, v91
v_cndmask_b32 v92, v112, v92, s[64:65]
v_cndmask_b32 v93, v113, v93, s[66:67]
v_cndmask_b32 v94, v114, v94, s[68:69]
v_cndmask_b32 v95, v115, v95, s[70:71]
v_max3_f32 v85, v92, v93, v94
v_max_f32 v85, v85, v95
v_cndmask_b32 v96, v116, v96, s[64:65]
v_cndmask_b32 v97, v117, v97, s[66:67]
v_cndmask_b32 v98, v118, v98, s[68:69]
buffer_load_dwordx4 v5, s[24:27], s5 offen offset:2048 sc1 lds
v_cndmask_b32 v99, v119, v99, s[70:71]
v_max3_f32 v86, v96, v97, v98
v_max_f32 v86, v86, v99
v_cndmask_b32 v100, v120, v100, s[64:65]
v_cndmask_b32 v101, v121, v101, s[66:67]
v_cndmask_b32 v102, v122, v102, s[68:69]
v_cndmask_b32 v103, v123, v103, s[70:71]
v_max3_f32 v87, v100, v101, v102
v_max_f32 v87, v87, v103
v_permlane32_swap_b32 v84, v85
v_cvt_pk_bf16_f32 v168, v168, v169
v_permlane32_swap_b32 v86, v87
buffer_load_dwordx4 v5, s[24:27], s5 offen offset:3072 sc1 lds
v_max_f32 v84, v84, v85
v_max_f32 v86, v86, v87
v_cvt_pk_bf16_f32 v169, v170, v171
v_cvt_pk_bf16_f32 v170, v172, v173
v_permlane16_swap_b32 v84, v86
v_max_f32 v84, v84, v86
v_mov_b32 v86, v84
v_cvt_pk_bf16_f32 v171, v174, v175
v_cvt_pk_bf16_f32 v172, v176, v177
v_permlane16_swap_b32 v84, v86
v_mov_b32 v85, v84
v_mov_b32 v87, v86
s_add_u32 m0, s3, 16384
s_add_u32 s5, s4, 2244608
buffer_load_dwordx4 v5, s[24:27], s5 offen offset:0 sc1 lds
v_cvt_pk_bf16_f32 v173, v178, v179
v_permlane32_swap_b32 v84, v85
v_permlane32_swap_b32 v86, v87
v_cvt_pk_bf16_f32 v174, v180, v181
v_cvt_pk_bf16_f32 v175, v182, v183
v_cvt_pk_bf16_f32 v176, v184, v185
v_cvt_pk_bf16_f32 v177, v186, v187
v_pk_add_f32 v[88:89], v[88:89], v[84:85] op_sel:[0,0] op_sel_hi:[1,0] neg_lo:[0,1] neg_hi:[0,1]
v_pk_add_f32 v[90:91], v[90:91], v[84:85] op_sel:[0,0] op_sel_hi:[1,0] neg_lo:[0,1] neg_hi:[0,1]
v_pk_add_f32 v[92:93], v[92:93], v[84:85] op_sel:[0,1] op_sel_hi:[1,1] neg_lo:[0,1] neg_hi:[0,1]
v_pk_add_f32 v[94:95], v[94:95], v[84:85] op_sel:[0,1] op_sel_hi:[1,1] neg_lo:[0,1] neg_hi:[0,1]
v_pk_add_f32 v[96:97], v[96:97], v[86:87] op_sel:[0,0] op_sel_hi:[1,0] neg_lo:[0,1] neg_hi:[0,1]
buffer_load_dwordx4 v5, s[24:27], s5 offen offset:1024 sc1 lds
v_pk_add_f32 v[98:99], v[98:99], v[86:87] op_sel:[0,0] op_sel_hi:[1,0] neg_lo:[0,1] neg_hi:[0,1]
v_pk_add_f32 v[100:101], v[100:101], v[86:87] op_sel:[0,1] op_sel_hi:[1,1] neg_lo:[0,1] neg_hi:[0,1]
v_pk_add_f32 v[102:103], v[102:103], v[86:87] op_sel:[0,1] op_sel_hi:[1,1] neg_lo:[0,1] neg_hi:[0,1]
v_exp_f32 v88, v88
v_exp_f32 v89, v89
v_exp_f32 v90, v90
v_exp_f32 v91, v91
v_cvt_pk_bf16_f32 v130, v88, v89
v_cvt_pk_bf16_f32 v131, v90, v91
v_bfi_b32 v128, v12, 0, v130
v_bfi_b32 v129, v13, 0, v131
v_and_b32 v130, v12, v130
buffer_load_dwordx4 v5, s[24:27], s5 offen offset:2048 sc1 lds
v_and_b32 v131, v13, v131
v_exp_f32 v92, v92
v_exp_f32 v93, v93
v_mfma_f32_16x16x32_bf16 v[68:71], v[168:171], v[128:131], 0
v_exp_f32 v94, v94
v_mfma_f32_16x16x32_bf16 v[88:91], v[150:153], v[128:131], 0
v_exp_f32 v95, v95
v_cvt_pk_bf16_f32 v134, v92, v93
v_cvt_pk_bf16_f32 v135, v94, v95
v_bfi_b32 v132, v12, 0, v134
v_bfi_b32 v133, v13, 0, v135
v_and_b32 v134, v12, v134
buffer_load_dwordx4 v5, s[24:27], s5 offen offset:3072 sc1 lds
v_and_b32 v135, v13, v135
v_exp_f32 v96, v96
v_exp_f32 v97, v97
v_mfma_f32_16x16x32_bf16 v[72:75], v[170:173], v[132:135], 0
v_exp_f32 v98, v98
v_mfma_f32_16x16x32_bf16 v[92:95], v[152:155], v[132:135], 0
v_exp_f32 v99, v99
v_cvt_pk_bf16_f32 v138, v96, v97
v_cvt_pk_bf16_f32 v139, v98, v99
v_bfi_b32 v136, v12, 0, v138
v_bfi_b32 v137, v13, 0, v139
v_and_b32 v138, v12, v138
s_add_u32 m0, s3, 20480
s_add_u32 s5, s4, 2248704
buffer_load_dwordx4 v5, s[24:27], s5 offen offset:0 sc1 lds
v_and_b32 v139, v13, v139
v_exp_f32 v100, v100
v_exp_f32 v101, v101
v_mfma_f32_16x16x32_bf16 v[76:79], v[172:175], v[136:139], 0
v_exp_f32 v102, v102
v_mfma_f32_16x16x32_bf16 v[96:99], v[154:157], v[136:139], 0
v_exp_f32 v103, v103
v_cvt_pk_bf16_f32 v142, v100, v101
v_cvt_pk_bf16_f32 v143, v102, v103
v_bfi_b32 v140, v12, 0, v142
v_bfi_b32 v141, v13, 0, v143
v_and_b32 v142, v12, v142
v_and_b32 v143, v13, v143
v_rcp_f32 v70, v70
v_rcp_f32 v74, v74
v_mfma_f32_16x16x32_bf16 v[80:83], v[174:177], v[140:143], 0
v_rcp_f32 v78, v78
v_mfma_f32_16x16x32_bf16 v[100:103], v[156:159], v[140:143], 0
s_mul_i32 s7, s77, 252
s_sub_u32 s7, s87, s7
s_add_u32 s6, s86, 32768
v_pk_mul_f32 v[88:89], v[88:89], v[70:71] op_sel_hi:[1,0]
v_pk_mul_f32 v[90:91], v[90:91], v[70:71] op_sel_hi:[1,0]
v_pk_mul_f32 v[68:69], v[68:69], v[70:71] op_sel_hi:[1,0]
v_cvt_pk_bf16_f32 v108, v88, v89
v_cvt_pk_bf16_f32 v109, v90, v91
v_cvt_pk_bf16_f32 v116, v68, v69
v_pk_mul_f32 v[92:93], v[92:93], v[74:75] op_sel_hi:[1,0]
v_pk_mul_f32 v[94:95], v[94:95], v[74:75] op_sel_hi:[1,0]
v_pk_mul_f32 v[72:73], v[72:73], v[74:75] op_sel_hi:[1,0]
v_cvt_pk_bf16_f32 v110, v92, v93
v_cvt_pk_bf16_f32 v111, v94, v95
v_cvt_pk_bf16_f32 v117, v72, v73
v_rcp_f32 v82, v82
v_pk_mul_f32 v[96:97], v[96:97], v[78:79] op_sel_hi:[1,0]
v_pk_mul_f32 v[98:99], v[98:99], v[78:79] op_sel_hi:[1,0]
v_pk_mul_f32 v[76:77], v[76:77], v[78:79] op_sel_hi:[1,0]
v_cvt_pk_bf16_f32 v112, v96, v97
v_cvt_pk_bf16_f32 v113, v98, v99
v_cvt_pk_bf16_f32 v118, v76, v77
v_permlane16_swap_b32 v108, v110
v_permlane16_swap_b32 v109, v111
buffer_store_dwordx4 v[108:111], v17, s[24:27], s86 offen
v_pk_mul_f32 v[100:101], v[100:101], v[82:83] op_sel_hi:[1,0]
v_pk_mul_f32 v[102:103], v[102:103], v[82:83] op_sel_hi:[1,0]
v_pk_mul_f32 v[80:81], v[80:81], v[82:83] op_sel_hi:[1,0]
v_cvt_pk_bf16_f32 v114, v100, v101
v_cvt_pk_bf16_f32 v115, v102, v103
v_cvt_pk_bf16_f32 v119, v80, v81
v_mov_b32_dpp v116, v117 quad_perm:[0,1,2,3] row_mask:2 bank_mask:0xf
s_nop 1
v_mov_b32_dpp v116, v118 quad_perm:[0,1,2,3] row_mask:4 bank_mask:0xf
v_permlane16_swap_b32 v112, v114
v_permlane16_swap_b32 v113, v115
v_mov_b32_dpp v116, v119 quad_perm:[0,1,2,3] row_mask:8 bank_mask:0xf
buffer_store_dwordx4 v[112:115], v17, s[24:27], s6 offen
buffer_store_dword v116, v5, s[24:27], s7 offen
s_add_u32 s63, s80, 0
v_lshlrev_b32 v26, 10, v7
v_lshl_add_u32 v26, v6, 4, v26
s_lshl_b32 s3, s77, 14
s_add_u32 s3, s3, s84
s_lshl_b32 s5, s77, 8
s_add_u32 s5, s5, s84
s_add_u32 s5, s5, 65536
s_add_u32 s6, s5, 4096
v_add_u32 v180, 41472, v5
v_and_b32 v181, 7, v0
v_lshlrev_b32 v181, 4, v181
v_lshl_add_u32 v181, v7, 7, v181
v_add_u32 v182, 41472, v181
v_lshlrev_b32 v28, 16, v58
v_and_b32 v29, 0xffff0000, v58
v_lshlrev_b32 v30, 16, v59
v_and_b32 v31, 0xffff0000, v59
v_lshlrev_b32 v32, 16, v60
v_and_b32 v33, 0xffff0000, v60
v_lshlrev_b32 v34, 16, v61
v_and_b32 v35, 0xffff0000, v61
v_lshlrev_b32 v36, 16, v62
v_and_b32 v37, 0xffff0000, v62
v_lshlrev_b32 v38, 16, v63
v_and_b32 v39, 0xffff0000, v63
v_lshlrev_b32 v40, 16, v64
v_and_b32 v41, 0xffff0000, v64
v_lshlrev_b32 v42, 16, v65
v_and_b32 v43, 0xffff0000, v65
v_lshlrev_b32 v44, 16, v66
v_and_b32 v45, 0xffff0000, v66
v_lshlrev_b32 v46, 16, v67
v_and_b32 v47, 0xffff0000, v67
s_waitcnt vmcnt(3)
s_barrier
ds_read_b128 v[68:71], v180 offset:32256
L_pad2:
s_cbranch_execz L_pad5
ds_read_b128 v[72:75], v180 offset:33280
ds_read_b128 v[76:79], v180 offset:34304
ds_read_b128 v[80:83], v180 offset:35328
ds_read_b128 v[84:87], v182 offset:36352
ds_read_b128 v[88:91], v180 offset:36864
ds_read_b128 v[92:95], v180 offset:37888
ds_read_b128 v[96:99], v180 offset:38912
s_waitcnt vmcnt(0)
buffer_load_dwordx4 v[172:175], v26, s[24:27], s5 offen sc1
buffer_load_dwordx4 v[176:179], v26, s[24:27], s6 offen sc1
s_add_u32 s4, s3, 0
buffer_load_dwordx4 v[108:111], v5, s[24:27], s4 offen offset:0 sc1
buffer_load_dwordx4 v[112:115], v5, s[24:27], s4 offen offset:1024 sc1
ds_read_b128 v[100:103], v180 offset:39936
ds_read_b128 v[104:107], v182 offset:40960
ds_read_b128 v[188:191], v5 offset:0
ds_read_b128 v[192:195], v5 offset:1024
ds_read_b128 v[196:199], v5 offset:2048
ds_read_b128 v[200:203], v5 offset:3072
ds_read_b128 v[204:207], v181 offset:4096
ds_read_b128 v[208:211], v5 offset:4608
ds_read_b128 v[212:215], v5 offset:5632
ds_read_b128 v[216:219], v5 offset:6656
L_19:
s_waitcnt vmcnt(3)
v_max_u32 v183, v172, v173
v_max3_u32 v183, v183, v174, v175
s_waitcnt vmcnt(2)
v_max3_u32 v183, v183, v176, v177
v_max3_u32 v183, v183, v178, v179
v_cmp_eq_u32 vcc, -1, v183
s_cbranch_vccz L_22
L_21:
s_sub_u32 s82, s82, 1
s_cbranch_scc1 L_exit
s_waitcnt vmcnt(0)
buffer_load_dwordx4 v[172:175], v26, s[24:27], s5 offen sc1
buffer_load_dwordx4 v[176:179], v26, s[24:27], s6 offen sc1
s_add_u32 s4, s3, 0
buffer_load_dwordx4 v[108:111], v5, s[24:27], s4 offen offset:0 sc1
buffer_load_dwordx4 v[112:115], v5, s[24:27], s4 offen offset:1024 sc1
s_waitcnt vmcnt(0)
s_branch L_19
L_22:
buffer_load_dwordx4 v[116:119], v5, s[24:27], s4 offen offset:2048 sc1
buffer_load_dwordx4 v[120:123], v5, s[24:27], s4 offen offset:3072 sc1
s_add_u32 s4, s3, 4096
buffer_load_dwordx4 v[124:127], v5, s[24:27], s4 offen offset:0 sc1
buffer_load_dwordx4 v[128:131], v5, s[24:27], s4 offen offset:1024 sc1
ds_read_b128 v[220:223], v5 offset:7680
s_waitcnt lgkmcnt(15)
v_mfma_f32_16x16x32_bf16 v[28:31], v[68:71], v[172:175], v[28:31]
buffer_load_dwordx4 v[132:135], v5, s[24:27], s4 offen offset:2048 sc1
ds_read_b128 v[68:71], v181 offset:8704
v_mfma_f32_16x16x32_bf16 v[32:35], v[72:75], v[172:175], v[32:35]
s_mul_i32 s7, s76, 144
s_add_u32 s7, s7, 162560
v_lshl_add_u32 v22, v7, 4, s7
ds_read_b128 v[72:75], v5 offset:9216
v_mfma_f32_16x16x32_bf16 v[36:39], v[76:79], v[172:175], v[36:39]
v_and_b32 v23, 1, v7
v_lshl_add_u32 v23, v23, 3, s7
ds_read_b128 v[76:79], v5 offset:10240
v_mfma_f32_16x16x32_bf16 v[40:43], v[80:83], v[172:175], v[40:43]
ds_read_b128 v[48:51], v22
ds_read_b128 v[80:83], v5 offset:11264
s_waitcnt lgkmcnt(15)
v_mfma_f32_16x16x32_bf16 v[44:47], v[84:87], v[172:175], v[44:47]
ds_read_b128 v[52:55], v22 offset:64
ds_read_b128 v[84:87], v5 offset:12288
v_mfma_f32_16x16x32_bf16 v[28:31], v[88:91], v[176:179], v[28:31]
buffer_load_dwordx4 v[136:139], v5, s[24:27], s4 offen offset:3072 sc1
ds_read_b128 v[88:91], v181 offset:13312
v_mfma_f32_16x16x32_bf16 v[32:35], v[92:95], v[176:179], v[32:35]
ds_read_b64 v[56:57], v23 offset:128
ds_read_b128 v[92:95], v5 offset:13824
v_mfma_f32_16x16x32_bf16 v[36:39], v[96:99], v[176:179], v[36:39]
v_lshrrev_b32 v22, 3, v6
ds_read_b128 v[96:99], v5 offset:14848
v_mfma_f32_16x16x32_bf16 v[40:43], v[100:103], v[176:179], v[40:43]
v_mul_u32_u24 v22, 9216, v22
ds_read_b128 v[100:103], v5 offset:15872
s_waitcnt lgkmcnt(15)
v_mfma_f32_16x16x32_bf16 v[44:47], v[104:107], v[176:179], v[44:47]
v_add_u32 v1, v22, v181
ds_read_b128 v[104:107], v5 offset:16896
s_waitcnt vmcnt(7)
v_mfma_f32_16x16x32_bf16 v[28:31], v[188:191], v[108:111], v[28:31]
s_add_u32 s4, s3, 8192
buffer_load_dwordx4 v[140:143], v5, s[24:27], s4 offen offset:0 sc1
ds_read_b128 v[188:191], v181 offset:17920
v_mfma_f32_16x16x32_bf16 v[32:35], v[192:195], v[108:111], v[32:35]
v_add_u32 v2, 512, v1
ds_read_b128 v[192:195], v5 offset:18432
v_mfma_f32_16x16x32_bf16 v[36:39], v[196:199], v[108:111], v[36:39]
v_max3_u32 v183, v183, v108, v109
ds_read_b128 v[196:199], v5 offset:19456
v_mfma_f32_16x16x32_bf16 v[40:43], v[200:203], v[108:111], v[40:43]
v_max3_u32 v183, v183, v110, v111
ds_read_b128 v[200:203], v5 offset:20480
v_mfma_f32_16x16x32_bf16 v[44:47], v[204:207], v[108:111], v[44:47]
v_cmp_gt_u32 vcc, 8, v6
ds_read_b128 v[204:207], v5 offset:21504
s_waitcnt vmcnt(7)
v_mfma_f32_16x16x32_bf16 v[28:31], v[208:211], v[112:115], v[28:31]
buffer_load_dwordx4 v[144:147], v5, s[24:27], s4 offen offset:1024 sc1
ds_read_b128 v[208:211], v181 offset:22528
s_waitcnt lgkmcnt(15)
v_mfma_f32_16x16x32_bf16 v[32:35], v[212:215], v[112:115], v[32:35]
v_mov_b32 v22, 74752
ds_read_b128 v[212:215], v5 offset:23040
v_mfma_f32_16x16x32_bf16 v[36:39], v[216:219], v[112:115], v[36:39]
v_max3_u32 v183, v183, v112, v113
ds_read_b128 v[216:219], v5 offset:24064
v_mfma_f32_16x16x32_bf16 v[40:43], v[220:223], v[112:115], v[40:43]
v_max3_u32 v183, v183, v114, v115
ds_read_b128 v[220:223], v5 offset:25088
v_mfma_f32_16x16x32_bf16 v[44:47], v[68:71], v[112:115], v[44:47]
v_add_u32 v3, 64512, v1
ds_read_b128 v[68:71], v5 offset:26112
s_waitcnt vmcnt(7)
v_mfma_f32_16x16x32_bf16 v[28:31], v[72:75], v[116:119], v[28:31]
buffer_load_dwordx4 v[148:151], v5, s[24:27], s4 offen offset:2048 sc1
ds_read_b128 v[72:75], v181 offset:27136
v_mfma_f32_16x16x32_bf16 v[32:35], v[76:79], v[116:119], v[32:35]
v_add_u32 v4, 64512, v2
ds_read_b128 v[76:79], v5 offset:27648
s_waitcnt lgkmcnt(15)
v_mfma_f32_16x16x32_bf16 v[36:39], v[80:83], v[116:119], v[36:39]
v_max3_u32 v183, v183, v116, v117
ds_read_b128 v[80:83], v5 offset:28672
v_mfma_f32_16x16x32_bf16 v[40:43], v[84:87], v[116:119], v[40:43]
v_max3_u32 v183, v183, v118, v119
ds_read_b128 v[84:87], v5 offset:29696
v_mfma_f32_16x16x32_bf16 v[44:47], v[88:91], v[116:119], v[44:47]
v_cndmask_b32 v3, v3, v22, vcc
ds_read_b128 v[88:91], v5 offset:30720
s_waitcnt vmcnt(7)
v_mfma_f32_16x16x32_bf16 v[28:31], v[92:95], v[120:123], v[28:31]
buffer_load_dwordx4 v[152:155], v5, s[24:27], s4 offen offset:3072 sc1
ds_read_b128 v[92:95], v181 offset:31744
s_waitcnt lgkmcnt(15)
v_mfma_f32_16x16x32_bf16 v[32:35], v[96:99], v[120:123], v[32:35]
v_cndmask_b32 v4, v4, v22, vcc
ds_read_b128 v[96:99], v5 offset:32256
v_mfma_f32_16x16x32_bf16 v[36:39], v[100:103], v[120:123], v[36:39]
v_max3_u32 v183, v183, v120, v121
ds_read_b128 v[100:103], v5 offset:33280
v_mfma_f32_16x16x32_bf16 v[40:43], v[104:107], v[120:123], v[40:43]
v_max3_u32 v183, v183, v122, v123
ds_read_b128 v[104:107], v5 offset:34304
v_mfma_f32_16x16x32_bf16 v[44:47], v[188:191], v[120:123], v[44:47]
s_lshl_b32 s7, s77, 4
ds_read_b128 v[188:191], v5 offset:35328
s_waitcnt vmcnt(7) lgkmcnt(15)
v_mfma_f32_16x16x32_bf16 v[28:31], v[192:195], v[124:127], v[28:31]
s_add_u32 s4, s3, 12288
buffer_load_dwordx4 v[156:159], v5, s[24:27], s4 offen offset:0 sc1
ds_read_b128 v[192:195], v181 offset:36352
v_mfma_f32_16x16x32_bf16 v[32:35], v[196:199], v[124:127], v[32:35]
s_add_u32 s7, s7, s76
ds_read_b128 v[196:199], v5 offset:36864
v_mfma_f32_16x16x32_bf16 v[36:39], v[200:203], v[124:127], v[36:39]
v_max3_u32 v183, v183, v124, v125
ds_read_b128 v[200:203], v5 offset:37888
v_mfma_f32_16x16x32_bf16 v[40:43], v[204:207], v[124:127], v[40:43]
v_max3_u32 v183, v183, v126, v127
ds_read_b128 v[204:207], v5 offset:38912
s_waitcnt lgkmcnt(15)
v_mfma_f32_16x16x32_bf16 v[44:47], v[208:211], v[124:127], v[44:47]
s_mul_i32 s7, s7, 1152
ds_read_b128 v[208:211], v5 offset:39936
s_waitcnt vmcnt(7)
v_mfma_f32_16x16x32_bf16 v[28:31], v[212:215], v[128:131], v[28:31]
buffer_load_dwordx4 v[160:163], v5, s[24:27], s4 offen offset:1024 sc1
ds_read_b128 v[212:215], v181 offset:40960
v_mfma_f32_16x16x32_bf16 v[32:35], v[216:219], v[128:131], v[32:35]
v_add_u32 v19, s7, v1
ds_read_b128 v[216:219], v180 offset:0
v_mfma_f32_16x16x32_bf16 v[36:39], v[220:223], v[128:131], v[36:39]
v_max3_u32 v183, v183, v128, v129
ds_read_b128 v[220:223], v180 offset:1024
s_waitcnt lgkmcnt(15)
v_mfma_f32_16x16x32_bf16 v[40:43], v[68:71], v[128:131], v[40:43]
v_max3_u32 v183, v183, v130, v131
ds_read_b128 v[68:71], v180 offset:2048
v_mfma_f32_16x16x32_bf16 v[44:47], v[72:75], v[128:131], v[44:47]
v_add_u32 v20, 512, v19
ds_read_b128 v[72:75], v180 offset:3072
s_waitcnt vmcnt(7)
v_mfma_f32_16x16x32_bf16 v[28:31], v[76:79], v[132:135], v[28:31]
buffer_load_dwordx4 v[164:167], v5, s[24:27], s4 offen offset:2048 sc1
ds_read_b128 v[76:79], v182 offset:4096
v_mfma_f32_16x16x32_bf16 v[32:35], v[80:83], v[132:135], v[32:35]
v_lshlrev_b32 v22, 7, v7
ds_read_b128 v[80:83], v180 offset:4608
s_waitcnt lgkmcnt(15)
v_mfma_f32_16x16x32_bf16 v[36:39], v[84:87], v[132:135], v[36:39]
v_max3_u32 v183, v183, v132, v133
ds_read_b128 v[84:87], v180 offset:5632
v_mfma_f32_16x16x32_bf16 v[40:43], v[88:91], v[132:135], v[40:43]
v_max3_u32 v183, v183, v134, v135
ds_read_b128 v[88:91], v180 offset:6656
v_mfma_f32_16x16x32_bf16 v[44:47], v[92:95], v[132:135], v[44:47]
v_sub_u32 v22, v19, v22
ds_read_b128 v[92:95], v180 offset:7680
s_waitcnt vmcnt(7)
v_mfma_f32_16x16x32_bf16 v[28:31], v[96:99], v[136:139], v[28:31]
buffer_load_dwordx4 v[168:171], v5, s[24:27], s4 offen offset:3072 sc1
ds_read_b128 v[96:99], v182 offset:8704
s_waitcnt lgkmcnt(15)
v_mfma_f32_16x16x32_bf16 v[32:35], v[100:103], v[136:139], v[32:35]
v_and_b32 v23, 1, v7
ds_read_b128 v[100:103], v180 offset:9216
v_mfma_f32_16x16x32_bf16 v[36:39], v[104:107], v[136:139], v[36:39]
v_max3_u32 v183, v183, v136, v137
ds_read_b128 v[104:107], v180 offset:10240
v_mfma_f32_16x16x32_bf16 v[40:43], v[188:191], v[136:139], v[40:43]
v_max3_u32 v183, v183, v138, v139
ds_read_b128 v[188:191], v180 offset:11264
v_mfma_f32_16x16x32_bf16 v[44:47], v[192:195], v[136:139], v[44:47]
v_lshl_add_u32 v22, v23, 3, v22
ds_read_b128 v[192:195], v180 offset:12288
s_waitcnt vmcnt(7) lgkmcnt(15)
v_mfma_f32_16x16x32_bf16 v[28:31], v[196:199], v[140:143], v[28:31]
v_add_u32 v21, 1024, v22
ds_read_b128 v[196:199], v182 offset:13312
v_mfma_f32_16x16x32_bf16 v[32:35], v[200:203], v[140:143], v[32:35]
v_add_u32 v22, 0, v0
v_min_u32 v22, 40, v22
ds_read_b128 v[200:203], v180 offset:13824
v_mfma_f32_16x16x32_bf16 v[36:39], v[204:207], v[140:143], v[36:39]
v_max3_u32 v183, v183, v140, v141
ds_read_b128 v[204:207], v180 offset:14848
v_mfma_f32_16x16x32_bf16 v[40:43], v[208:211], v[140:143], v[40:43]
v_max3_u32 v183, v183, v142, v143
ds_read_b128 v[208:211], v180 offset:15872
s_waitcnt lgkmcnt(15)
v_mfma_f32_16x16x32_bf16 v[44:47], v[212:215], v[140:143], v[44:47]
s_mul_i32 s1, s77, 41
s_sub_u32 s1, s1, 0
v_add_u32 v22, s1, v22
v_min_u32 v22, 161, v22
ds_read_b128 v[212:215], v180 offset:16896
s_waitcnt vmcnt(6)
v_mfma_f32_16x16x32_bf16 v[28:31], v[216:219], v[144:147], v[28:31]
v_mul_u32_u24 v23, 7282, v22
v_lshrrev_b32 v23, 16, v23
ds_read_b128 v[216:219], v182 offset:17920
v_mfma_f32_16x16x32_bf16 v[32:35], v[220:223], v[144:147], v[32:35]
v_mul_u32_u24 v23, 8064, v23
v_lshl_add_u32 v22, v22, 7, v23
ds_read_b128 v[220:223], v180 offset:18432
v_mfma_f32_16x16x32_bf16 v[36:39], v[68:71], v[144:147], v[36:39]
v_max3_u32 v183, v183, v144, v145
ds_read_b128 v[68:71], v180 offset:19456
s_waitcnt lgkmcnt(15)
v_mfma_f32_16x16x32_bf16 v[40:43], v[72:75], v[144:147], v[40:43]
v_max3_u32 v183, v183, v146, v147
ds_read_b128 v[72:75], v180 offset:20480
v_mfma_f32_16x16x32_bf16 v[44:47], v[76:79], v[144:147], v[44:47]
s_mul_i32 s1, s75, 144
s_add_u32 s1, s1, s74
s_mul_i32 s1, s1, 1152
s_mov_b32 s34, 5308416
buffer_load_dword v18, v22, s[32:35], s1 offen
s_mov_b32 s34, s95
ds_read_b128 v[76:79], v180 offset:21504
s_waitcnt vmcnt(6)
v_mfma_f32_16x16x32_bf16 v[28:31], v[80:83], v[148:151], v[28:31]
v_add_u32 v22, 0, v0
v_min_u32 v22, 40, v22
ds_read_b128 v[80:83], v182 offset:22528
v_mfma_f32_16x16x32_bf16 v[32:35], v[84:87], v[148:151], v[32:35]
s_mul_i32 s1, s77, 41
s_sub_u32 s1, s1, 0
v_add_u32 v22, s1, v22
v_min_u32 v22, 161, v22
ds_read_b128 v[84:87], v180 offset:23040
s_waitcnt lgkmcnt(15)
v_mfma_f32_16x16x32_bf16 v[36:39], v[88:91], v[148:151], v[36:39]
v_max3_u32 v183, v183, v148, v149
ds_read_b128 v[88:91], v180 offset:24064
v_mfma_f32_16x16x32_bf16 v[40:43], v[92:95], v[148:151], v[40:43]
v_max3_u32 v183, v183, v150, v151
ds_read_b128 v[92:95], v180 offset:25088
v_mfma_f32_16x16x32_bf16 v[44:47], v[96:99], v[148:151], v[44:47]
v_mul_u32_u24 v23, 7282, v22
v_lshrrev_b32 v23, 16, v23
ds_read_b128 v[96:99], v180 offset:26112
s_waitcnt vmcnt(5)
v_mfma_f32_16x16x32_bf16 v[28:31], v[100:103], v[152:155], v[28:31]
v_mul_u32_u24 v23, 8064, v23
v_lshl_add_u32 v22, v22, 7, v23
ds_read_b128 v[100:103], v182 offset:27136
s_waitcnt lgkmcnt(15)
v_mfma_f32_16x16x32_bf16 v[32:35], v[104:107], v[152:155], v[32:35]
s_mul_i32 s1, s75, 144
s_add_u32 s1, s1, s74
s_mul_i32 s1, s1, 1152
s_mov_b32 s38, 5308416
buffer_load_dword v18, v22, s[36:39], s1 offen
s_mov_b32 s38, s95
ds_read_b128 v[104:107], v180 offset:27648
v_mfma_f32_16x16x32_bf16 v[36:39], v[188:191], v[152:155], v[36:39]
v_max3_u32 v183, v183, v152, v153
ds_read_b128 v[188:191], v180 offset:28672
v_mfma_f32_16x16x32_bf16 v[40:43], v[192:195], v[152:155], v[40:43]
v_max3_u32 v183, v183, v154, v155
ds_read_b128 v[192:195], v180 offset:29696
v_mfma_f32_16x16x32_bf16 v[44:47], v[196:199], v[152:155], v[44:47]
ds_read_b128 v[196:199], v180 offset:30720
s_waitcnt vmcnt(5) lgkmcnt(15)
v_mfma_f32_16x16x32_bf16 v[28:31], v[200:203], v[156:159], v[28:31]
ds_read_b128 v[200:203], v182 offset:31744
v_mfma_f32_16x16x32_bf16 v[32:35], v[204:207], v[156:159], v[32:35]
v_mfma_f32_16x16x32_bf16 v[36:39], v[208:211], v[156:159], v[36:39]
v_max3_u32 v183, v183, v156, v157
v_mfma_f32_16x16x32_bf16 v[40:43], v[212:215], v[156:159], v[40:43]
v_max3_u32 v183, v183, v158, v159
s_waitcnt lgkmcnt(15)
v_mfma_f32_16x16x32_bf16 v[44:47], v[216:219], v[156:159], v[44:47]
s_waitcnt vmcnt(4) lgkmcnt(14)
v_mfma_f32_16x16x32_bf16 v[28:31], v[220:223], v[160:163], v[28:31]
s_waitcnt lgkmcnt(13)
v_mfma_f32_16x16x32_bf16 v[32:35], v[68:71], v[160:163], v[32:35]
s_waitcnt lgkmcnt(12)
v_mfma_f32_16x16x32_bf16 v[36:39], v[72:75], v[160:163], v[36:39]
v_max3_u32 v183, v183, v160, v161
s_waitcnt lgkmcnt(11)
v_mfma_f32_16x16x32_bf16 v[40:43], v[76:79], v[160:163], v[40:43]
v_max3_u32 v183, v183, v162, v163
s_waitcnt lgkmcnt(10)
v_mfma_f32_16x16x32_bf16 v[44:47], v[80:83], v[160:163], v[44:47]
s_waitcnt vmcnt(3) lgkmcnt(9)
v_mfma_f32_16x16x32_bf16 v[28:31], v[84:87], v[164:167], v[28:31]
s_waitcnt lgkmcnt(8)
v_mfma_f32_16x16x32_bf16 v[32:35], v[88:91], v[164:167], v[32:35]
s_waitcnt lgkmcnt(7)
v_mfma_f32_16x16x32_bf16 v[36:39], v[92:95], v[164:167], v[36:39]
v_max3_u32 v183, v183, v164, v165
s_waitcnt lgkmcnt(6)
v_mfma_f32_16x16x32_bf16 v[40:43], v[96:99], v[164:167], v[40:43]
v_max3_u32 v183, v183, v166, v167
s_waitcnt lgkmcnt(5)
v_mfma_f32_16x16x32_bf16 v[44:47], v[100:103], v[164:167], v[44:47]
s_waitcnt vmcnt(2) lgkmcnt(4)
v_mfma_f32_16x16x32_bf16 v[28:31], v[104:107], v[168:171], v[28:31]
s_waitcnt lgkmcnt(3)
v_mfma_f32_16x16x32_bf16 v[32:35], v[188:191], v[168:171], v[32:35]
s_waitcnt lgkmcnt(2)
v_mfma_f32_16x16x32_bf16 v[36:39], v[192:195], v[168:171], v[36:39]
v_max3_u32 v183, v183, v168, v169
s_waitcnt lgkmcnt(1)
v_mfma_f32_16x16x32_bf16 v[40:43], v[196:199], v[168:171], v[40:43]
v_max3_u32 v183, v183, v170, v171
s_waitcnt lgkmcnt(0)
v_mfma_f32_16x16x32_bf16 v[44:47], v[200:203], v[168:171], v[44:47]
v_cmp_eq_u32 vcc, -1, v183
s_cbranch_vccnz L_20
s_mov_b32 s3, 1065369472
s_add_u32 s4, s84, 81920
v_cvt_pk_bf16_f32 v108, v28, v29
v_cvt_pk_bf16_f32 v109, v30, v31
v_cvt_pk_bf16_f32 v110, v32, v33
v_cvt_pk_bf16_f32 v111, v34, v35
buffer_store_dwordx4 v[108:111], v19, s[24:27], s4 offen offset:0 sc1
v_cvt_pk_bf16_f32 v112, v36, v37
v_cvt_pk_bf16_f32 v113, v38, v39
v_cvt_pk_bf16_f32 v114, v40, v41
v_cvt_pk_bf16_f32 v115, v42, v43
buffer_store_dwordx4 v[112:115], v19, s[24:27], s4 offen offset:512 sc1
v_cvt_pk_bf16_f32 v116, v44, v45
v_cvt_pk_bf16_f32 v117, v46, v47
v_dot2_f32_bf16 v120, v108, s3, 0
v_dot2_f32_bf16 v121, v108, v108, 0
v_dot2_f32_bf16 v122, v108, v48, 0
s_mov_b32 exec_hi, 0
v_dot2_f32_bf16 v120, v116, s3, v120
v_dot2_f32_bf16 v121, v116, v116, v121
v_dot2_f32_bf16 v122, v116, v56, v122
v_dot2_f32_bf16 v120, v117, s3, v120
v_dot2_f32_bf16 v121, v117, v117, v121
v_dot2_f32_bf16 v122, v117, v57, v122
s_mov_b64 exec, -1
v_permlane16_swap_b32 v116, v118
v_permlane16_swap_b32 v117, v119
s_mov_b64 exec, 65535
buffer_store_dwordx4 v[116:119], v19, s[24:27], s4 offen offset:1024 sc1
s_mov_b64 exec, -1
v_dot2_f32_bf16 v120, v109, s3, v120
v_dot2_f32_bf16 v121, v109, v109, v121
v_dot2_f32_bf16 v122, v109, v49, v122
v_dot2_f32_bf16 v120, v110, s3, v120
v_dot2_f32_bf16 v121, v110, v110, v121
v_dot2_f32_bf16 v122, v110, v50, v122
v_dot2_f32_bf16 v120, v111, s3, v120
v_dot2_f32_bf16 v121, v111, v111, v121
v_dot2_f32_bf16 v122, v111, v51, v122
v_dot2_f32_bf16 v120, v112, s3, v120
v_dot2_f32_bf16 v121, v112, v112, v121
v_dot2_f32_bf16 v122, v112, v52, v122
v_dot2_f32_bf16 v120, v113, s3, v120
v_dot2_f32_bf16 v121, v113, v113, v121
v_dot2_f32_bf16 v122, v113, v53, v122
v_dot2_f32_bf16 v120, v114, s3, v120
v_dot2_f32_bf16 v121, v114, v114, v121
v_dot2_f32_bf16 v122, v114, v54, v122
v_dot2_f32_bf16 v120, v115, s3, v120
v_dot2_f32_bf16 v121, v115, v115, v121
v_dot2_f32_bf16 v122, v115, v55, v122
v_mov_b32 v123, s63
v_permlane32_swap_b32 v120, v124
v_permlane32_swap_b32 v121, v125
v_permlane32_swap_b32 v122, v126
v_add_f32 v120, v120, v124
v_add_f32 v121, v121, v125
v_add_f32 v122, v122, v126
v_permlane16_swap_b32 v120, v124
v_permlane16_swap_b32 v121, v125
v_permlane16_swap_b32 v122, v126
v_add_f32 v120, v120, v124
v_add_f32 v121, v121, v125
v_add_f32 v122, v122, v126
s_lshl_b32 s4, s77, 8
s_add_u32 s4, s4, s84
s_add_u32 s4, s4, 73728
s_add_u32 s5, s4, 4096
s_barrier
s_cmp_eq_u32 s77, 2
s_cbranch_scc0 L_23
v_mul_u32_u24 v22, 1168, v0
v_add_u32 v22, 74752, v22
v_mov_b32 v68, 1065369472
v_mov_b32 v69, 1065369472
v_mov_b32 v70, 1065369472
v_mov_b32 v71, 1065369472
s_mov_b64 exec, 511
ds_write_b128 v22, v[68:71]
s_mov_b64 exec, -1
L_23:
s_mul_i32 s62, s77, 18432
s_add_u32 s92, s84, 81920
s_add_u32 s92, s92, s62
v_bfe_u32 v22, v0, 2, 2
v_lshl_add_u32 v22, v7, 3, v22
v_mul_u32_u24 v22, 1152, v22
v_and_b32 v23, 3, v0
v_lshl_add_u32 v22, v23, 3, v22
s_mul_i32 s3, s77, 288
s_add_u32 s3, s3, 121216
v_add_u32 v22, s3, v22
ds_read_b64_tr_b16 v[188:189], v22 offset:0
ds_read_b64_tr_b16 v[190:191], v22 offset:4608
ds_read_b64_tr_b16 v[192:193], v22 offset:32
ds_read_b64_tr_b16 v[194:195], v22 offset:4640
ds_read_b64_tr_b16 v[196:197], v22 offset:64
ds_read_b64_tr_b16 v[198:199], v22 offset:4672
ds_read_b64_tr_b16 v[200:201], v22 offset:96
ds_read_b64_tr_b16 v[202:203], v22 offset:4704
ds_read_b64_tr_b16 v[204:205], v22 offset:128
ds_read_b64_tr_b16 v[206:207], v22 offset:4736
ds_read_b64_tr_b16 v[208:209], v22 offset:160
ds_read_b64_tr_b16 v[210:211], v22 offset:4768
ds_read_b64_tr_b16 v[212:213], v22 offset:192
ds_read_b64_tr_b16 v[214:215], v22 offset:4800
ds_read_b64_tr_b16 v[216:217], v22 offset:224
ds_read_b64_tr_b16 v[218:219], v22 offset:4832
ds_read_b64_tr_b16 v[220:221], v22 offset:256
ds_read_b64_tr_b16 v[222:223], v22 offset:4864
v_mul_u32_u24 v55, 9216, v7
v_lshl_add_u32 v55, v6, 2, v55
s_lshl_b32 s1, s77, 4
s_add_u32 s1, s1, 158080
v_lshl_add_u32 v53, v0, 1, s1
v_lshlrev_b32 v54, 4, v7
v_add_u32 v54, 158080, v54
v_bfe_u32 v56, v0, 1, 1
v_lshlrev_b32 v57, 1, v56
v_and_or_b32 v57, v7, 1, v57
v_xor_b32 v57, s77, v57
v_mul_u32_u24 v56, 36864, v56
v_lshl_add_u32 v56, v57, 4, v56
v_lshrrev_b32 v57, 2, v0
v_lshl_add_u32 v56, v57, 6, v56
v_and_b32 v57, 1, v0
v_lshl_add_u32 v56, v57, 3, v56
v_add_u32 v56, 84352, v56
v_and_b32 v57, 3, v0
v_lshl_add_u32 v57, v57, 2, v7
v_lshlrev_b32 v57, 4, v57
v_add_u32 v57, 161408, v57
v_mul_u32_u24 v50, 7282, v0
v_lshrrev_b32 v50, 16, v50
v_mul_u32_u24 v50, 3952, v50
v_add_u32 v50, v50, v5
s_waitcnt vmcnt(0)
s_mov_b64 exec, 65535
buffer_store_dwordx4 v[120:123], v5, s[24:27], s88 offen
s_mov_b64 exec, -1
s_waitcnt vmcnt(0)
buffer_load_dwordx4 v[128:131], v26, s[24:27], s4 offen sc1
buffer_load_dwordx4 v[132:135], v26, s[24:27], s5 offen sc1
v_mov_b32 v175, 163792
ds_read_b32 v175, v175
v_lshlrev_b32 v22, 4, v7
v_mov_b32 v139, s80
s_lshl_b32 s3, s77, 4
v_or_b32 v141, s3, v6
s_add_u32 s3, s3, 163728
v_mov_b32 v23, s3
v_and_b32 v173, 3, v0
v_lshlrev_b32 v173, 4, v173
v_add_u32 v173, 163728, v173
v_lshrrev_b32 v174, 2, v0
v_lshlrev_b32 v174, 13, v174
s_lshl_b32 s3, s78, 8
s_add_u32 s3, s3, 2949120
s_mov_b32 s7, -64
v_mov_b32 v176, 163796
v_mov_b32 v177, 1
s_branch C_24
R_25:
s_sub_u32 s82, s82, 1
s_cbranch_scc1 L_exit
s_waitcnt vmcnt(0)
buffer_load_dwordx4 v[128:131], v26, s[24:27], s4 offen sc1
buffer_load_dwordx4 v[132:135], v26, s[24:27], s5 offen sc1
s_waitcnt vmcnt(0)
C_24:
s_waitcnt vmcnt(1)
v_cmp_ne_u32 s[52:53], s63, v131
s_waitcnt vmcnt(0)
v_cmp_ne_u32 vcc, s63, v135
s_or_b64 vcc, vcc, s[52:53]
s_cbranch_vccnz R_25
s_add_u32 m0, s62, 0
s_add_u32 s1, s92, 0
buffer_load_dwordx4 v5, s[24:27], s1 offen sc1 lds
s_add_u32 m0, s62, 9216
s_add_u32 s1, s92, 9216
buffer_load_dwordx4 v5, s[24:27], s1 offen sc1 lds
s_add_u32 m0, s62, 1024
s_add_u32 s1, s92, 1024
buffer_load_dwordx4 v5, s[24:27], s1 offen sc1 lds
s_add_u32 m0, s62, 10240
s_add_u32 s1, s92, 10240
buffer_load_dwordx4 v5, s[24:27], s1 offen sc1 lds
v_add_f32 v128, v128, v132
v_add_f32 v129, v129, v133
v_add_f32 v130, v130, v134
v_mov_b32 v132, v128
v_mov_b32 v133, v129
v_mov_b32 v134, v130
v_permlane32_swap_b32 v128, v132
v_permlane32_swap_b32 v129, v133
v_permlane32_swap_b32 v130, v134
v_add_f32 v128, v128, v132
v_add_f32 v129, v129, v133
v_add_f32 v130, v130, v134
v_mov_b32 v132, v128
v_mov_b32 v133, v129
v_mov_b32 v134, v130
v_permlane16_swap_b32 v128, v132
v_permlane16_swap_b32 v129, v133
v_permlane16_swap_b32 v130, v134
v_add_f32 v128, v128, v132
v_add_f32 v129, v129, v133
v_add_f32 v130, v130, v134
v_mul_f32 v128, 0xbae38e39, v128
v_mul_f32 v129, 0x3ae38e39, v129
v_fma_f32 v129, -v128, v128, v129
v_max_f32 v129, 0, v129
v_add_f32 v132, 0x3727c5ac, v129
v_rsq_f32 v131, v132
s_waitcnt lgkmcnt(0)
v_fma_f32 v136, v128, v175, v130
v_mul_f32 v136, v136, v131
v_ashrrev_i32 v140, 31, v136
v_lshrrev_b32 v140, 1, v140
v_xor_b32 v136, v136, v140
v_and_or_b32 v136, v136, s7, v141
v_mov_b32 v142, v131
v_mul_f32 v143, v128, v131
v_max_i32_dpp v140, v136, v136 row_ror:8 row_mask:0xf bank_mask:0xf
v_mul_f32 v138, v132, v131
v_sub_f32 v137, 0, v128
v_max_i32_dpp v140, v140, v140 row_ror:4 row_mask:0xf bank_mask:0xf
v_pk_fma_f32 v[164:165], v[44:45], v[142:143], v[142:143] op_sel:[0,0,1] op_sel_hi:[1,0,1]
v_pk_fma_f32 v[166:167], v[46:47], v[142:143], v[142:143] op_sel:[0,0,1] op_sel_hi:[1,0,1]
v_max_i32_dpp v140, v140, v140 row_ror:2 row_mask:0xf bank_mask:0xf
v_pk_fma_f32 v[148:149], v[28:29], v[142:143], v[142:143] op_sel:[0,0,1] op_sel_hi:[1,0,1]
v_pk_fma_f32 v[150:151], v[30:31], v[142:143], v[142:143] op_sel:[0,0,1] op_sel_hi:[1,0,1]
v_max_i32_dpp v140, v140, v140 row_ror:1 row_mask:0xf bank_mask:0xf
v_cmp_eq_u32 s[54:55], v136, v140
v_pk_fma_f32 v[152:153], v[32:33], v[142:143], v[142:143] op_sel:[0,0,1] op_sel_hi:[1,0,1]
v_pk_fma_f32 v[154:155], v[34:35], v[142:143], v[142:143] op_sel:[0,0,1] op_sel_hi:[1,0,1]
s_and_b64 exec, s[54:55], 0xffff
ds_write_b128 v23, v[136:139]
ds_add_rtn_u32 v176, v176, v177
s_mov_b64 exec, -1
ds_read_b128 v[168:171], v173
v_pk_fma_f32 v[156:157], v[36:37], v[142:143], v[142:143] op_sel:[0,0,1] op_sel_hi:[1,0,1]
v_pk_fma_f32 v[158:159], v[38:39], v[142:143], v[142:143] op_sel:[0,0,1] op_sel_hi:[1,0,1]
v_pk_fma_f32 v[160:161], v[40:41], v[142:143], v[142:143] op_sel:[0,0,1] op_sel_hi:[1,0,1]
v_pk_fma_f32 v[162:163], v[42:43], v[142:143], v[142:143] op_sel:[0,0,1] op_sel_hi:[1,0,1]
s_cmp_eq_u32 s76, 0
s_cbranch_scc0 L_26
s_waitcnt lgkmcnt(1)
v_cmp_eq_u32 vcc, 3, v176
s_cbranch_vccz L_27
L_pad3:
s_cbranch_execz L_pad6
s_waitcnt lgkmcnt(0)
v_max_i32_dpp v172, v168, v168 quad_perm:[1,0,3,2] row_mask:0xf bank_mask:0xf
s_nop 1
v_max_i32_dpp v172, v172, v172 quad_perm:[2,3,0,1] row_mask:0xf bank_mask:0xf
v_cmp_eq_u32 vcc, v168, v172
s_mov_b32 exec_hi, 0
s_mov_b32 exec_lo, vcc_lo
buffer_store_dwordx4 v[168:171], v174, s[24:27], s3 offen sc1
s_mov_b64 exec, -1
L_27:
L_26:
v_cvt_pk_bf16_f32 v116, v164, v165
v_cvt_pk_bf16_f32 v117, v166, v167
v_cvt_pk_bf16_f32 v108, v148, v149
v_cvt_pk_bf16_f32 v109, v150, v151
v_cvt_pk_bf16_f32 v110, v152, v153
v_cvt_pk_bf16_f32 v111, v154, v155
v_cvt_pk_bf16_f32 v112, v156, v157
v_cvt_pk_bf16_f32 v113, v158, v159
v_cvt_pk_bf16_f32 v114, v160, v161
v_cvt_pk_bf16_f32 v115, v162, v163
v_permlane16_swap_b32 v116, v118
v_permlane16_swap_b32 v117, v119
s_mov_b64 exec, s[54:55]
buffer_store_dwordx4 v[108:111], v22, s[24:27], s89 offen offset:640 sc1
buffer_store_dwordx4 v[112:115], v22, s[24:27], s89 offen offset:704 sc1
s_and_b64 exec, s[54:55], 0xffff
buffer_store_dwordx4 v[116:119], v22, s[24:27], s89 offen offset:768 sc1
s_mov_b64 exec, -1
s_add_u32 m0, s62, 2048
s_add_u32 s1, s92, 2048
buffer_load_dwordx4 v5, s[24:27], s1 offen sc1 lds
s_add_u32 m0, s62, 11264
s_add_u32 s1, s92, 11264
buffer_load_dwordx4 v5, s[24:27], s1 offen sc1 lds
s_add_u32 m0, s62, 3072
s_add_u32 s1, s92, 3072
buffer_load_dwordx4 v5, s[24:27], s1 offen sc1 lds
s_add_u32 m0, s62, 12288
s_add_u32 s1, s92, 12288
buffer_load_dwordx4 v5, s[24:27], s1 offen sc1 lds
s_add_u32 m0, s62, 4096
s_add_u32 s1, s92, 4096
buffer_load_dwordx4 v5, s[24:27], s1 offen sc1 lds
s_add_u32 m0, s62, 13312
s_add_u32 s1, s92, 13312
buffer_load_dwordx4 v5, s[24:27], s1 offen sc1 lds
v_add_f32 v133, 1.0, v131
v_mul_f32 v134, v133, v133
v_mul_f32 v134, v134, v129
v_add_f32 v134, 0x3727c5ac, v134
v_rsq_f32 v134, v134
s_nop 0
v_mul_f32 v134, v134, v133
s_lshl_b32 s3, s77, 6
s_add_u32 s3, s3, 160192
v_lshl_add_u32 v23, v6, 2, s3
v_mov_b32 v60, v128
v_mov_b32 v61, v134
v_mov_b32 v62, 0
v_mov_b32 v63, s80
s_mov_b64 exec, 65535
ds_write2_b32 v23, v128, v134 offset0:0 offset1:80
ds_write2_b32 v23, v133, v143 offset0:160 offset1:240
s_mov_b64 exec, -1
v_lshlrev_b32 v38, 8, v0
v_mov_b32 v44, 0
v_mov_b32 v45, 0
v_mov_b32 v46, 0
v_mov_b32 v47, 0
v_mov_b32 v37, 163712
s_waitcnt vmcnt(9)
s_waitcnt lgkmcnt(0)
s_barrier
ds_read_b128 v[84:87], v1 offset:0
ds_read_b128 v[88:91], v1 offset:18432
ds_read_b128 v[92:95], v1 offset:36864
ds_read_b128 v[96:99], v1 offset:55296
s_waitcnt lgkmcnt(3)
v_mfma_f32_16x16x32_bf16 v[112:115], a[0:3], v[84:87], 0
v_mfma_f32_16x16x32_bf16 v[132:135], a[4:7], v[84:87], 0
ds_read_b128 v[68:71], v2 offset:0
v_mfma_f32_16x16x32_bf16 v[152:155], v[84:87], a[8:11], 0
v_mfma_f32_16x16x32_bf16 v[172:175], a[12:15], v[84:87], 0
ds_read_b128 v[72:75], v2 offset:18432
s_waitcnt lgkmcnt(4)
v_mfma_f32_16x16x32_bf16 v[116:119], a[0:3], v[88:91], 0
v_mfma_f32_16x16x32_bf16 v[136:139], a[4:7], v[88:91], 0
ds_read_b128 v[76:79], v2 offset:36864
v_mfma_f32_16x16x32_bf16 v[156:159], v[88:91], a[8:11], 0
v_mfma_f32_16x16x32_bf16 v[176:179], a[12:15], v[88:91], 0
ds_read_b128 v[80:83], v2 offset:55296
s_waitcnt lgkmcnt(5)
v_mfma_f32_16x16x32_bf16 v[120:123], a[0:3], v[92:95], 0
v_mfma_f32_16x16x32_bf16 v[140:143], a[4:7], v[92:95], 0
s_add_u32 m0, s62, 5120
s_add_u32 s1, s92, 5120
buffer_load_dwordx4 v5, s[24:27], s1 offen sc1 lds
v_mfma_f32_16x16x32_bf16 v[160:163], v[92:95], a[8:11], 0
v_mfma_f32_16x16x32_bf16 v[180:183], a[12:15], v[92:95], 0
s_add_u32 m0, s62, 14336
s_add_u32 s1, s92, 14336
buffer_load_dwordx4 v5, s[24:27], s1 offen sc1 lds
s_waitcnt lgkmcnt(4)
v_mfma_f32_16x16x32_bf16 v[124:127], a[0:3], v[96:99], 0
v_mfma_f32_16x16x32_bf16 v[144:147], a[4:7], v[96:99], 0
s_add_u32 m0, s62, 6144
s_add_u32 s1, s92, 6144
buffer_load_dwordx4 v5, s[24:27], s1 offen sc1 lds
v_mfma_f32_16x16x32_bf16 v[164:167], v[96:99], a[8:11], 0
v_mfma_f32_16x16x32_bf16 v[184:187], a[12:15], v[96:99], 0
s_waitcnt lgkmcnt(3)
v_mfma_f32_16x16x32_bf16 v[112:115], a[16:19], v[68:71], v[112:115]
v_mfma_f32_16x16x32_bf16 v[132:135], a[20:23], v[68:71], v[132:135]
ds_read_b128 v[84:87], v1 offset:1024
v_mfma_f32_16x16x32_bf16 v[152:155], v[68:71], a[24:27], v[152:155]
v_mfma_f32_16x16x32_bf16 v[172:175], a[28:31], v[68:71], v[172:175]
ds_read_b128 v[88:91], v1 offset:19456
s_waitcnt lgkmcnt(4)
v_mfma_f32_16x16x32_bf16 v[116:119], a[16:19], v[72:75], v[116:119]
v_mfma_f32_16x16x32_bf16 v[136:139], a[20:23], v[72:75], v[136:139]
ds_read_b128 v[92:95], v1 offset:37888
v_mfma_f32_16x16x32_bf16 v[156:159], v[72:75], a[24:27], v[156:159]
v_mfma_f32_16x16x32_bf16 v[176:179], a[28:31], v[72:75], v[176:179]
ds_read_b128 v[96:99], v1 offset:56320
s_waitcnt lgkmcnt(5)
v_mfma_f32_16x16x32_bf16 v[120:123], a[16:19], v[76:79], v[120:123]
v_mfma_f32_16x16x32_bf16 v[140:143], a[20:23], v[76:79], v[140:143]
s_add_u32 m0, s62, 15360
s_add_u32 s1, s92, 15360
buffer_load_dwordx4 v5, s[24:27], s1 offen sc1 lds
v_mfma_f32_16x16x32_bf16 v[160:163], v[76:79], a[24:27], v[160:163]
v_mfma_f32_16x16x32_bf16 v[180:183], a[28:31], v[76:79], v[180:183]
s_add_u32 m0, s91, 84352
s_add_u32 s1, s90, 0
buffer_load_dwordx4 v24, s[32:35], s1 offen lds
s_waitcnt lgkmcnt(4)
v_mfma_f32_16x16x32_bf16 v[124:127], a[16:19], v[80:83], v[124:127]
v_mfma_f32_16x16x32_bf16 v[144:147], a[20:23], v[80:83], v[144:147]
s_add_u32 m0, s91, 88448
s_add_u32 s1, s90, 589824
buffer_load_dwordx4 v24, s[32:35], s1 offen lds
v_mfma_f32_16x16x32_bf16 v[164:167], v[80:83], a[24:27], v[164:167]
v_mfma_f32_16x16x32_bf16 v[184:187], a[28:31], v[80:83], v[184:187]
s_cmp_eq_u32 s77, 0
s_cbranch_scc0 L_28
s_lshl_b32 s1, s74, 13
s_add_u32 s1, s1, 2949120
s_mov_b32 exec_hi, 0
buffer_load_dwordx4 v[28:31], v38, s[24:27], s1 offen sc1
s_mov_b64 exec, -1
L_28:
s_waitcnt lgkmcnt(3)
v_mfma_f32_16x16x32_bf16 v[112:115], a[32:35], v[84:87], v[112:115]
v_mfma_f32_16x16x32_bf16 v[132:135], a[36:39], v[84:87], v[132:135]
ds_read_b128 v[68:71], v2 offset:1024
v_mfma_f32_16x16x32_bf16 v[152:155], v[84:87], a[40:43], v[152:155]
v_mfma_f32_16x16x32_bf16 v[172:175], a[44:47], v[84:87], v[172:175]
ds_read_b128 v[72:75], v2 offset:19456
s_waitcnt lgkmcnt(4)
v_mfma_f32_16x16x32_bf16 v[116:119], a[32:35], v[88:91], v[116:119]
v_mfma_f32_16x16x32_bf16 v[136:139], a[36:39], v[88:91], v[136:139]
ds_read_b128 v[76:79], v2 offset:37888
v_mfma_f32_16x16x32_bf16 v[156:159], v[88:91], a[40:43], v[156:159]
v_mfma_f32_16x16x32_bf16 v[176:179], a[44:47], v[88:91], v[176:179]
ds_read_b128 v[80:83], v2 offset:56320
s_waitcnt lgkmcnt(5)
v_mfma_f32_16x16x32_bf16 v[120:123], a[32:35], v[92:95], v[120:123]
v_mfma_f32_16x16x32_bf16 v[140:143], a[36:39], v[92:95], v[140:143]
s_add_u32 m0, s91, 92544
s_add_u32 s1, s90, 1179648
buffer_load_dwordx4 v24, s[32:35], s1 offen lds
v_mfma_f32_16x16x32_bf16 v[160:163], v[92:95], a[40:43], v[160:163]
v_mfma_f32_16x16x32_bf16 v[180:183], a[44:47], v[92:95], v[180:183]
s_add_u32 m0, s91, 96640
s_add_u32 s1, s90, 1769472
buffer_load_dwordx4 v24, s[32:35], s1 offen lds
s_waitcnt lgkmcnt(4)
v_mfma_f32_16x16x32_bf16 v[124:127], a[32:35], v[96:99], v[124:127]
v_mfma_f32_16x16x32_bf16 v[144:147], a[36:39], v[96:99], v[144:147]
s_add_u32 m0, s91, 100736
s_add_u32 s1, s90, 2359296
buffer_load_dwordx4 v24, s[32:35], s1 offen lds
v_mfma_f32_16x16x32_bf16 v[164:167], v[96:99], a[40:43], v[164:167]
v_mfma_f32_16x16x32_bf16 v[184:187], a[44:47], v[96:99], v[184:187]
v_mov_b32 v22, v53
v_mov_b32 v23, v54
v_mov_b32 v26, v55
s_waitcnt vmcnt(5)
s_cmp_eq_u32 s77, 3
s_cbranch_scc0 L_29
s_lshl_b32 s3, s76, 7
s_add_u32 s3, s3, s84
s_add_u32 s3, s3, 197504
s_mov_b64 exec, 65280
buffer_store_dwordx4 v[60:63], v5, s[24:27], s3 offen sc1
s_mov_b64 exec, -1
L_29:
s_barrier
s_waitcnt lgkmcnt(3)
v_mfma_f32_16x16x32_bf16 v[112:115], a[48:51], v[68:71], v[112:115]
v_mfma_f32_16x16x32_bf16 v[132:135], a[52:55], v[68:71], v[132:135]
ds_read_b128 v[84:87], v1 offset:2048
v_mfma_f32_16x16x32_bf16 v[152:155], v[68:71], a[56:59], v[152:155]
v_mfma_f32_16x16x32_bf16 v[172:175], a[60:63], v[68:71], v[172:175]
ds_read_b128 v[88:91], v1 offset:20480
s_waitcnt lgkmcnt(4)
v_mfma_f32_16x16x32_bf16 v[116:119], a[48:51], v[72:75], v[116:119]
v_mfma_f32_16x16x32_bf16 v[136:139], a[52:55], v[72:75], v[136:139]
ds_read_b128 v[92:95], v1 offset:38912
v_mfma_f32_16x16x32_bf16 v[156:159], v[72:75], a[56:59], v[156:159]
v_mfma_f32_16x16x32_bf16 v[176:179], a[60:63], v[72:75], v[176:179]
ds_read_b128 v[96:99], v1 offset:57344
s_waitcnt lgkmcnt(5)
v_mfma_f32_16x16x32_bf16 v[120:123], a[48:51], v[76:79], v[120:123]
v_mfma_f32_16x16x32_bf16 v[140:143], a[52:55], v[76:79], v[140:143]
s_add_u32 m0, s91, 104832
s_add_u32 s1, s90, 2949120
buffer_load_dwordx4 v24, s[32:35], s1 offen lds
v_mfma_f32_16x16x32_bf16 v[160:163], v[76:79], a[56:59], v[160:163]
v_mfma_f32_16x16x32_bf16 v[180:183], a[60:63], v[76:79], v[180:183]
s_add_u32 m0, s91, 108928
s_add_u32 s1, s90, 3538944
buffer_load_dwordx4 v24, s[32:35], s1 offen lds
s_waitcnt lgkmcnt(4)
v_mfma_f32_16x16x32_bf16 v[124:127], a[48:51], v[80:83], v[124:127]
v_mfma_f32_16x16x32_bf16 v[144:147], a[52:55], v[80:83], v[144:147]
s_add_u32 m0, s91, 113024
s_add_u32 s1, s90, 4128768
buffer_load_dwordx4 v24, s[32:35], s1 offen lds
v_mfma_f32_16x16x32_bf16 v[164:167], v[80:83], a[56:59], v[164:167]
v_mfma_f32_16x16x32_bf16 v[184:187], a[60:63], v[80:83], v[184:187]
s_waitcnt lgkmcnt(3)
v_mfma_f32_16x16x32_bf16 v[112:115], a[64:67], v[84:87], v[112:115]
v_mfma_f32_16x16x32_bf16 v[132:135], a[68:71], v[84:87], v[132:135]
ds_read_b128 v[68:71], v2 offset:2048
v_mfma_f32_16x16x32_bf16 v[152:155], v[84:87], a[72:75], v[152:155]
v_mfma_f32_16x16x32_bf16 v[172:175], a[76:79], v[84:87], v[172:175]
ds_read_b128 v[72:75], v2 offset:20480
s_waitcnt lgkmcnt(4)
v_mfma_f32_16x16x32_bf16 v[116:119], a[64:67], v[88:91], v[116:119]
v_mfma_f32_16x16x32_bf16 v[136:139], a[68:71], v[88:91], v[136:139]
ds_read_b128 v[76:79], v2 offset:38912
v_mfma_f32_16x16x32_bf16 v[156:159], v[88:91], a[72:75], v[156:159]
v_mfma_f32_16x16x32_bf16 v[176:179], a[76:79], v[88:91], v[176:179]
ds_read_b128 v[80:83], v2 offset:57344
s_waitcnt lgkmcnt(5)
v_mfma_f32_16x16x32_bf16 v[120:123], a[64:67], v[92:95], v[120:123]
v_mfma_f32_16x16x32_bf16 v[140:143], a[68:71], v[92:95], v[140:143]
s_add_u32 m0, s91, 117120
s_add_u32 s1, s90, 4718592
buffer_load_dwordx4 v24, s[32:35], s1 offen lds
v_mfma_f32_16x16x32_bf16 v[160:163], v[92:95], a[72:75], v[160:163]
v_mfma_f32_16x16x32_bf16 v[180:183], a[76:79], v[92:95], v[180:183]
s_add_u32 m0, s91, 121216
s_add_u32 s1, s90, 0
buffer_load_dwordx4 v25, s[36:39], s1 offen lds
s_waitcnt lgkmcnt(4)
v_mfma_f32_16x16x32_bf16 v[124:127], a[64:67], v[96:99], v[124:127]
v_mfma_f32_16x16x32_bf16 v[144:147], a[68:71], v[96:99], v[144:147]
s_add_u32 m0, s91, 125312
s_add_u32 s1, s90, 589824
buffer_load_dwordx4 v25, s[36:39], s1 offen lds
v_mfma_f32_16x16x32_bf16 v[164:167], v[96:99], a[72:75], v[164:167]
v_mfma_f32_16x16x32_bf16 v[184:187], a[76:79], v[96:99], v[184:187]
s_lshl_b32 s3, s77, 5
s_add_u32 s3, s3, s75
s_cmp_lt_u32 s3, 18
s_cbranch_scc0 L_30
s_waitcnt vmcnt(9)
v_cmp_ne_u32 vcc, s80, v31
v_bfrev_b32 v36, 1
s_mov_b32 s52, vcc_lo
v_cndmask_b32 v28, v28, v36, vcc
s_nop 1
v_max_i32_dpp v36, v28, v28 row_ror:8 row_mask:0xf bank_mask:0xf
v_mov_b32 v31, v0
s_nop 0
v_max_i32_dpp v36, v36, v36 row_ror:4 row_mask:0xf bank_mask:0xf
s_nop 1
v_max_i32_dpp v36, v36, v36 row_ror:2 row_mask:0xf bank_mask:0xf
s_nop 1
v_max_i32_dpp v36, v36, v36 row_ror:1 row_mask:0xf bank_mask:0xf
s_nop 0
v_readlane_b32 s3, v36, 0
v_readlane_b32 s4, v36, 16
s_max_i32 s57, s3, s4
v_cmp_eq_u32 vcc, s57, v28
s_bfe_u32 s5, s57, 0x20004
s_lshl_b32 s5, s5, 10
s_add_u32 s5, s5, 4350592
s_ff1_i32_b32 s3, vcc_lo
s_mul_i32 s4, s3, 286720
s_add_u32 s4, s4, s5
s_lshl_b32 s1, s74, 13
s_add_u32 s1, s1, 2949120
s_mov_b32 exec_lo, s52
s_mov_b32 exec_hi, 0
buffer_load_dwordx4 v[28:31], v38, s[24:27], s1 offen sc1
s_mov_b64 exec, -1
buffer_load_dwordx4 v[40:43], v50, s[24:27], s4 offen sc1
s_add_u32 s1, s4, 28688
s_mov_b64 exec, 255
buffer_load_dwordx4 v[44:47], v5, s[24:27], s1 offen sc1
s_mov_b64 exec, -1
L_30:
s_waitcnt lgkmcnt(3)
v_mfma_f32_16x16x32_bf16 v[112:115], a[80:83], v[68:71], v[112:115]
v_mfma_f32_16x16x32_bf16 v[132:135], a[84:87], v[68:71], v[132:135]
ds_read_b128 v[84:87], v1 offset:3072
v_mfma_f32_16x16x32_bf16 v[152:155], v[68:71], a[88:91], v[152:155]
v_mfma_f32_16x16x32_bf16 v[172:175], a[92:95], v[68:71], v[172:175]
ds_read_b128 v[88:91], v1 offset:21504
s_waitcnt lgkmcnt(4)
v_mfma_f32_16x16x32_bf16 v[116:119], a[80:83], v[72:75], v[116:119]
v_mfma_f32_16x16x32_bf16 v[136:139], a[84:87], v[72:75], v[136:139]
ds_read_b128 v[92:95], v1 offset:39936
v_mfma_f32_16x16x32_bf16 v[156:159], v[72:75], a[88:91], v[156:159]
v_mfma_f32_16x16x32_bf16 v[176:179], a[92:95], v[72:75], v[176:179]
ds_read_b128 v[96:99], v1 offset:58368
s_waitcnt lgkmcnt(5)
v_mfma_f32_16x16x32_bf16 v[120:123], a[80:83], v[76:79], v[120:123]
v_mfma_f32_16x16x32_bf16 v[140:143], a[84:87], v[76:79], v[140:143]
s_add_u32 m0, s91, 129408
s_add_u32 s1, s90, 1179648
buffer_load_dwordx4 v25, s[36:39], s1 offen lds
v_mfma_f32_16x16x32_bf16 v[160:163], v[76:79], a[88:91], v[160:163]
v_mfma_f32_16x16x32_bf16 v[180:183], a[92:95], v[76:79], v[180:183]
s_add_u32 m0, s91, 133504
s_add_u32 s1, s90, 1769472
buffer_load_dwordx4 v25, s[36:39], s1 offen lds
s_waitcnt lgkmcnt(4)
v_mfma_f32_16x16x32_bf16 v[124:127], a[80:83], v[80:83], v[124:127]
v_mfma_f32_16x16x32_bf16 v[144:147], a[84:87], v[80:83], v[144:147]
s_add_u32 m0, s91, 137600
s_add_u32 s1, s90, 2359296
buffer_load_dwordx4 v25, s[36:39], s1 offen lds
v_mfma_f32_16x16x32_bf16 v[164:167], v[80:83], a[88:91], v[164:167]
v_mfma_f32_16x16x32_bf16 v[184:187], a[92:95], v[80:83], v[184:187]
s_waitcnt lgkmcnt(3)
v_mfma_f32_16x16x32_bf16 v[112:115], a[96:99], v[84:87], v[112:115]
ds_read_b128 v[68:71], v2 offset:3072
v_mfma_f32_16x16x32_bf16 v[132:135], a[100:103], v[84:87], v[132:135]
ds_read_b128 v[72:75], v2 offset:21504
v_mfma_f32_16x16x32_bf16 v[152:155], v[84:87], a[104:107], v[152:155]
v_mfma_f32_16x16x32_bf16 v[172:175], a[108:111], v[84:87], v[172:175]
ds_read_b128 v[76:79], v2 offset:39936
s_waitcnt lgkmcnt(5)
v_mfma_f32_16x16x32_bf16 v[116:119], a[96:99], v[88:91], v[116:119]
v_mfma_f32_16x16x32_bf16 v[136:139], a[100:103], v[88:91], v[136:139]
ds_read_b128 v[80:83], v2 offset:58368
v_mfma_f32_16x16x32_bf16 v[156:159], v[88:91], a[104:107], v[156:159]
v_mfma_f32_16x16x32_bf16 v[176:179], a[108:111], v[88:91], v[176:179]
s_add_u32 m0, s91, 141696
s_add_u32 s1, s90, 2949120
buffer_load_dwordx4 v25, s[36:39], s1 offen lds
s_waitcnt lgkmcnt(5)
v_mfma_f32_16x16x32_bf16 v[120:123], a[96:99], v[92:95], v[120:123]
v_mfma_f32_16x16x32_bf16 v[140:143], a[100:103], v[92:95], v[140:143]
s_add_u32 m0, s91, 145792
s_add_u32 s1, s90, 3538944
buffer_load_dwordx4 v25, s[36:39], s1 offen lds
v_mfma_f32_16x16x32_bf16 v[160:163], v[92:95], a[104:107], v[160:163]
v_mfma_f32_16x16x32_bf16 v[180:183], a[108:111], v[92:95], v[180:183]
s_add_u32 m0, s91, 149888
s_add_u32 s1, s90, 4128768
buffer_load_dwordx4 v25, s[36:39], s1 offen lds
s_waitcnt lgkmcnt(4)
v_mfma_f32_16x16x32_bf16 v[124:127], a[96:99], v[96:99], v[124:127]
v_mfma_f32_16x16x32_bf16 v[144:147], a[100:103], v[96:99], v[144:147]
v_mov_b32 v100, -1
v_mov_b32 v101, -1
v_mov_b32 v102, -1
v_mov_b32 v103, -1
v_mfma_f32_16x16x32_bf16 v[164:167], v[96:99], a[104:107], v[164:167]
v_mfma_f32_16x16x32_bf16 v[184:187], a[108:111], v[96:99], v[184:187]
buffer_store_dwordx4 v[100:103], v17, s[24:27], s86 offen
s_waitcnt lgkmcnt(3)
v_mfma_f32_16x16x32_bf16 v[112:115], a[112:115], v[68:71], v[112:115]
v_mfma_f32_16x16x32_bf16 v[132:135], a[116:119], v[68:71], v[132:135]
ds_read_b128 v[84:87], v1 offset:4096
v_mfma_f32_16x16x32_bf16 v[152:155], v[68:71], a[120:123], v[152:155]
v_mfma_f32_16x16x32_bf16 v[172:175], a[124:127], v[68:71], v[172:175]
ds_read_b128 v[88:91], v1 offset:22528
s_waitcnt lgkmcnt(4)
v_mfma_f32_16x16x32_bf16 v[116:119], a[112:115], v[72:75], v[116:119]
v_mfma_f32_16x16x32_bf16 v[136:139], a[116:119], v[72:75], v[136:139]
ds_read_b128 v[92:95], v1 offset:40960
v_mfma_f32_16x16x32_bf16 v[156:159], v[72:75], a[120:123], v[156:159]
v_mfma_f32_16x16x32_bf16 v[176:179], a[124:127], v[72:75], v[176:179]
ds_read_b128 v[96:99], v1 offset:59392
s_waitcnt lgkmcnt(5)
v_mfma_f32_16x16x32_bf16 v[120:123], a[112:115], v[76:79], v[120:123]
v_mfma_f32_16x16x32_bf16 v[140:143], a[116:119], v[76:79], v[140:143]
s_add_u32 m0, s91, 153984
s_add_u32 s1, s90, 4718592
buffer_load_dwordx4 v25, s[36:39], s1 offen lds
v_mfma_f32_16x16x32_bf16 v[160:163], v[76:79], a[120:123], v[160:163]
v_mfma_f32_16x16x32_bf16 v[180:183], a[124:127], v[76:79], v[180:183]
s_add_u32 s1, s86, 32768
buffer_store_dwordx4 v[100:103], v17, s[24:27], s1 offen
s_waitcnt lgkmcnt(4)
v_mfma_f32_16x16x32_bf16 v[124:127], a[112:115], v[80:83], v[124:127]
v_mfma_f32_16x16x32_bf16 v[144:147], a[116:119], v[80:83], v[144:147]
s_mov_b64 exec, 65535
buffer_store_dwordx4 v[100:103], v5, s[24:27], s87 offen
s_mov_b64 exec, -1
v_mfma_f32_16x16x32_bf16 v[164:167], v[80:83], a[120:123], v[164:167]
v_mfma_f32_16x16x32_bf16 v[184:187], a[124:127], v[80:83], v[184:187]
v_mov_b32 v24, v56
v_mov_b32 v25, v57
s_cmp_lt_u32 s75, 18
s_cbranch_scc0 L_31
s_cmp_eq_u32 s77, 0
s_cbranch_scc0 L_33
s_waitcnt vmcnt(12)
v_cmp_ne_u32 vcc, s80, v31
s_mov_b32 s9, vcc_lo
v_cmp_le_i32 vcc, s57, v28
s_or_b32 s9, s9, vcc_lo
s_and_b32 s9, s9, s52
s_waitcnt vmcnt(11)
v_max_u32 v48, v40, v41
v_max3_u32 v48, v48, v42, v43
s_waitcnt vmcnt(10)
v_max3_u32 v48, v48, v44, v45
v_max3_u32 v48, v48, v46, v47
v_cmp_eq_u32 vcc, -1, v48
v_add_u32 v48, 161408, v5
ds_write_b128 v48, v[40:43]
s_mov_b64 exec, 255
ds_write_b128 v48, v[44:47] offset:1024
s_mov_b64 exec, -1
s_lshl_b64 exec, 1, s3
ds_write_b128 v37, v[28:31]
s_mov_b64 exec, -1
s_or_b32 s9, s9, vcc_lo
s_or_b32 s9, s9, vcc_hi
s_cbranch_scc1 L_38
L_37:
L_33:
s_waitcnt vmcnt(2)
s_waitcnt lgkmcnt(0)
s_barrier
ds_read_b128 v[108:111], v25 offset:0
ds_read_b64_tr_b16 v[40:41], v24 offset:0
ds_read_b64_tr_b16 v[42:43], v24 offset:1024
ds_read_b64_tr_b16 v[44:45], v24 offset:2048
ds_read_b64_tr_b16 v[46:47], v24 offset:3072
ds_read_b64_tr_b16 v[48:49], v24 offset:4096
ds_read_b64_tr_b16 v[50:51], v24 offset:5120
ds_read_b128 v[128:131], v25 offset:192
ds_read_b64_tr_b16 v[52:53], v24 offset:6144
ds_read_b64_tr_b16 v[54:55], v24 offset:7168
ds_read_b64_tr_b16 v[56:57], v24 offset:8192
ds_read_b64_tr_b16 v[58:59], v24 offset:9216
ds_read_b64_tr_b16 v[60:61], v24 offset:10240
ds_read_b64_tr_b16 v[62:63], v24 offset:11264
ds_read_b128 v[148:151], v25 offset:384
ds_read_b64_tr_b16 v[64:65], v24 offset:12288
ds_read_b64_tr_b16 v[66:67], v24 offset:13312
s_waitcnt lgkmcnt(14)
v_mfma_f32_16x16x32_bf16 v[28:31], v[108:111], v[40:43], 0
ds_read_b64_tr_b16 v[40:41], v24 offset:14336
ds_read_b64_tr_b16 v[42:43], v24 offset:15360
s_waitcnt lgkmcnt(14)
v_mfma_f32_16x16x32_bf16 v[32:35], v[108:111], v[44:47], 0
ds_read_b64_tr_b16 v[44:45], v24 offset:16384
ds_read_b64_tr_b16 v[46:47], v24 offset:17408
s_waitcnt lgkmcnt(14)
v_mfma_f32_16x16x32_bf16 v[36:39], v[108:111], v[48:51], 0
ds_read_b128 v[168:171], v25 offset:576
ds_read_b64_tr_b16 v[48:49], v24 offset:18432
ds_read_b64_tr_b16 v[50:51], v24 offset:19456
s_waitcnt lgkmcnt(14)
v_mfma_f32_16x16x32_bf16 v[28:31], v[128:131], v[52:55], v[28:31]
ds_read_b64_tr_b16 v[52:53], v24 offset:20480
ds_read_b64_tr_b16 v[54:55], v24 offset:21504
s_waitcnt lgkmcnt(14)
v_mfma_f32_16x16x32_bf16 v[32:35], v[128:131], v[56:59], v[32:35]
ds_read_b64_tr_b16 v[56:57], v24 offset:22528
ds_read_b64_tr_b16 v[58:59], v24 offset:23552
s_waitcnt lgkmcnt(14)
v_mfma_f32_16x16x32_bf16 v[36:39], v[128:131], v[60:63], v[36:39]
ds_read_b128 v[108:111], v25 offset:768
ds_read_b64_tr_b16 v[60:61], v24 offset:24576
ds_read_b64_tr_b16 v[62:63], v24 offset:25600
s_waitcnt lgkmcnt(14)
v_mfma_f32_16x16x32_bf16 v[28:31], v[148:151], v[64:67], v[28:31]
ds_read_b64_tr_b16 v[64:65], v24 offset:26624
ds_read_b64_tr_b16 v[66:67], v24 offset:27648
s_waitcnt lgkmcnt(14)
v_mfma_f32_16x16x32_bf16 v[32:35], v[148:151], v[40:43], v[32:35]
ds_read_b64_tr_b16 v[40:41], v24 offset:28672
ds_read_b64_tr_b16 v[42:43], v24 offset:29696
s_waitcnt lgkmcnt(14)
v_mfma_f32_16x16x32_bf16 v[36:39], v[148:151], v[44:47], v[36:39]
ds_read_b128 v[128:131], v25 offset:960
ds_read_b64_tr_b16 v[44:45], v24 offset:30720
ds_read_b64_tr_b16 v[46:47], v24 offset:31744
s_waitcnt lgkmcnt(14)
v_mfma_f32_16x16x32_bf16 v[28:31], v[168:171], v[48:51], v[28:31]
ds_read_b64_tr_b16 v[48:49], v24 offset:32768
ds_read_b64_tr_b16 v[50:51], v24 offset:33792
s_waitcnt lgkmcnt(14)
v_mfma_f32_16x16x32_bf16 v[32:35], v[168:171], v[52:55], v[32:35]
ds_read_b64_tr_b16 v[52:53], v24 offset:34816
ds_read_b64_tr_b16 v[54:55], v24 offset:35840
s_waitcnt lgkmcnt(14)
v_mfma_f32_16x16x32_bf16 v[36:39], v[168:171], v[56:59], v[36:39]
s_waitcnt lgkmcnt(11)
v_mfma_f32_16x16x32_bf16 v[28:31], v[108:111], v[60:63], v[28:31]
s_waitcnt lgkmcnt(9)
v_mfma_f32_16x16x32_bf16 v[32:35], v[108:111], v[64:67], v[32:35]
s_waitcnt lgkmcnt(7)
v_mfma_f32_16x16x32_bf16 v[36:39], v[108:111], v[40:43], v[36:39]
s_waitcnt lgkmcnt(4)
v_mfma_f32_16x16x32_bf16 v[28:31], v[128:131], v[44:47], v[28:31]
s_waitcnt lgkmcnt(2)
v_mfma_f32_16x16x32_bf16 v[32:35], v[128:131], v[48:51], v[32:35]
s_waitcnt lgkmcnt(0)
v_mfma_f32_16x16x32_bf16 v[36:39], v[128:131], v[52:55], v[36:39]
s_nop 5
v_add_f32 v28, v28, v33
s_nop 0
v_add_f32 v28, v28, v38
v_mul_f32 v29, 0xbfb8aa3b, v28
v_exp_f32 v29, v29
v_mul_f32_dpp v28, v28, v28 row_ror:8 row_mask:0xf bank_mask:0xf
v_add_f32 v29, 1.0, v29
v_rcp_f32 v29, v29
s_mov_b64 exec, 0xff
v_mul_f32 v28, v28, v29
v_cvt_pk_bf16_f32 v28, v28, v28
ds_write_b16 v22, v28
s_mov_b64 exec, -1
s_waitcnt lgkmcnt(0)
s_barrier
ds_read_b128 v[28:31], v23
s_waitcnt lgkmcnt(0)
v_mfma_f32_16x16x32_bf16 v[32:35], v[28:31], v[188:191], 0
v_mfma_f32_16x16x32_bf16 v[36:39], v[28:31], v[192:195], 0
v_mfma_f32_16x16x32_bf16 v[40:43], v[28:31], v[196:199], 0
v_mfma_f32_16x16x32_bf16 v[44:47], v[28:31], v[200:203], 0
v_mfma_f32_16x16x32_bf16 v[48:51], v[28:31], v[204:207], 0
s_nop 4
v_mov_b32_dpp v32, v36 quad_perm:[0,1,2,3] row_mask:2 bank_mask:0xf
v_mfma_f32_16x16x32_bf16 v[52:55], v[28:31], v[208:211], 0
s_nop 0
v_mov_b32_dpp v32, v40 quad_perm:[0,1,2,3] row_mask:4 bank_mask:0xf
v_mfma_f32_16x16x32_bf16 v[56:59], v[28:31], v[212:215], 0
s_nop 0
v_mov_b32_dpp v32, v44 quad_perm:[0,1,2,3] row_mask:8 bank_mask:0xf
buffer_store_dword v32, v26, s[24:27], s13 offen sc1
s_add_u32 s1, s13, 36864
v_mfma_f32_16x16x32_bf16 v[60:63], v[28:31], v[216:219], 0
v_mfma_f32_16x16x32_bf16 v[64:67], v[28:31], v[220:223], 0
v_mov_b32_dpp v48, v52 quad_perm:[0,1,2,3] row_mask:2 bank_mask:0xf
s_nop 1
v_mov_b32_dpp v48, v56 quad_perm:[0,1,2,3] row_mask:4 bank_mask:0xf
s_nop 2
v_mov_b32_dpp v48, v60 quad_perm:[0,1,2,3] row_mask:8 bank_mask:0xf
buffer_store_dword v48, v26, s[24:27], s1 offen sc1
s_add_u32 s1, s13, 73728
s_mov_b64 exec, 0xffff
buffer_store_dword v64, v26, s[24:27], s1 offen sc1
s_mov_b64 exec, -1
L_32:
v_mfma_f32_16x16x32_bf16 v[112:115], a[128:131], v[84:87], v[112:115]
v_mfma_f32_16x16x32_bf16 v[132:135], a[132:135], v[84:87], v[132:135]
ds_read_b128 v[68:71], v2 offset:4096
v_mfma_f32_16x16x32_bf16 v[152:155], v[84:87], a[136:139], v[152:155]
v_mfma_f32_16x16x32_bf16 v[172:175], a[140:143], v[84:87], v[172:175]
ds_read_b128 v[72:75], v2 offset:22528
v_mfma_f32_16x16x32_bf16 v[116:119], a[128:131], v[88:91], v[116:119]
v_mfma_f32_16x16x32_bf16 v[136:139], a[132:135], v[88:91], v[136:139]
ds_read_b128 v[76:79], v2 offset:40960
v_mfma_f32_16x16x32_bf16 v[156:159], v[88:91], a[136:139], v[156:159]
v_mfma_f32_16x16x32_bf16 v[176:179], a[140:143], v[88:91], v[176:179]
ds_read_b128 v[80:83], v2 offset:59392
v_mfma_f32_16x16x32_bf16 v[120:123], a[128:131], v[92:95], v[120:123]
v_mfma_f32_16x16x32_bf16 v[140:143], a[132:135], v[92:95], v[140:143]
s_add_u32 m0, s62, 7168
s_add_u32 s1, s92, 7168
buffer_load_dwordx4 v5, s[24:27], s1 offen sc1 lds
v_mfma_f32_16x16x32_bf16 v[160:163], v[92:95], a[136:139], v[160:163]
v_mfma_f32_16x16x32_bf16 v[180:183], a[140:143], v[92:95], v[180:183]
s_add_u32 m0, s62, 16384
s_add_u32 s1, s92, 16384
buffer_load_dwordx4 v5, s[24:27], s1 offen sc1 lds
v_mfma_f32_16x16x32_bf16 v[124:127], a[128:131], v[96:99], v[124:127]
v_mfma_f32_16x16x32_bf16 v[144:147], a[132:135], v[96:99], v[144:147]
s_add_u32 m0, s62, 8192
s_add_u32 s1, s92, 8192
buffer_load_dwordx4 v5, s[24:27], s1 offen sc1 lds
v_mfma_f32_16x16x32_bf16 v[164:167], v[96:99], a[136:139], v[164:167]
v_mfma_f32_16x16x32_bf16 v[184:187], a[140:143], v[96:99], v[184:187]
s_add_u32 m0, s62, 17408
s_add_u32 s1, s92, 17408
buffer_load_dwordx4 v5, s[24:27], s1 offen sc1 lds
s_waitcnt lgkmcnt(3)
v_mfma_f32_16x16x32_bf16 v[112:115], a[144:147], v[68:71], v[112:115]
v_mfma_f32_16x16x32_bf16 v[132:135], a[148:151], v[68:71], v[132:135]
ds_read_b128 v[84:87], v1 offset:5120
v_mfma_f32_16x16x32_bf16 v[152:155], v[68:71], a[152:155], v[152:155]
L_pad4:
s_cbranch_execz L_pad7
v_mfma_f32_16x16x32_bf16 v[172:175], a[156:159], v[68:71], v[172:175]
ds_read_b128 v[88:91], v1 offset:23552
s_waitcnt lgkmcnt(4)
v_mfma_f32_16x16x32_bf16 v[116:119], a[144:147], v[72:75], v[116:119]
v_mfma_f32_16x16x32_bf16 v[136:139], a[148:151], v[72:75], v[136:139]
ds_read_b128 v[92:95], v1 offset:41984
v_mfma_f32_16x16x32_bf16 v[156:159], v[72:75], a[152:155], v[156:159]
v_mfma_f32_16x16x32_bf16 v[176:179], a[156:159], v[72:75], v[176:179]
ds_read_b128 v[96:99], v1 offset:60416
s_waitcnt lgkmcnt(5)
v_mfma_f32_16x16x32_bf16 v[120:123], a[144:147], v[76:79], v[120:123]
v_mfma_f32_16x16x32_bf16 v[140:143], a[148:151], v[76:79], v[140:143]
v_lshlrev_b32 v107, 2, v0
v_mov_b32 v106, s80
s_waitcnt vmcnt(7)
s_lshl_b32 s1, s78, 3
s_add_u32 s1, s1, s76
s_lshl_b32 s1, s1, 2
s_add_u32 s1, s1, s77
s_lshl_b32 s1, s1, 7
s_add_u32 s1, s1, 65536
s_mov_b32 exec_hi, 0
buffer_store_dword v106, v107, s[24:27], s1 offen
s_mov_b64 exec, -1
v_mfma_f32_16x16x32_bf16 v[160:163], v[76:79], a[152:155], v[160:163]
v_mfma_f32_16x16x32_bf16 v[180:183], a[156:159], v[76:79], v[180:183]
s_add_u32 s1, s85, 197632
buffer_load_dwordx4 v[60:63], v5, s[24:27], s1 offen sc1
s_waitcnt lgkmcnt(4)
v_mfma_f32_16x16x32_bf16 v[124:127], a[144:147], v[80:83], v[124:127]
v_mfma_f32_16x16x32_bf16 v[144:147], a[148:151], v[80:83], v[144:147]
v_mfma_f32_16x16x32_bf16 v[164:167], v[80:83], a[152:155], v[164:167]
v_mfma_f32_16x16x32_bf16 v[184:187], a[156:159], v[80:83], v[184:187]
s_waitcnt lgkmcnt(3)
v_mfma_f32_16x16x32_bf16 v[112:115], a[160:163], v[84:87], v[112:115]
v_mfma_f32_16x16x32_bf16 v[132:135], a[164:167], v[84:87], v[132:135]
ds_read_b128 v[68:71], v2 offset:5120
v_mfma_f32_16x16x32_bf16 v[152:155], v[84:87], a[168:171], v[152:155]
v_mfma_f32_16x16x32_bf16 v[172:175], a[172:175], v[84:87], v[172:175]
ds_read_b128 v[72:75], v2 offset:23552
s_waitcnt lgkmcnt(4)
v_mfma_f32_16x16x32_bf16 v[116:119], a[160:163], v[88:91], v[116:119]
v_mfma_f32_16x16x32_bf16 v[136:139], a[164:167], v[88:91], v[136:139]
ds_read_b128 v[76:79], v2 offset:41984
v_mfma_f32_16x16x32_bf16 v[156:159], v[88:91], a[168:171], v[156:159]
v_mfma_f32_16x16x32_bf16 v[176:179], a[172:175], v[88:91], v[176:179]
ds_read_b128 v[80:83], v2 offset:60416
s_waitcnt lgkmcnt(5)
v_mfma_f32_16x16x32_bf16 v[120:123], a[160:163], v[92:95], v[120:123]
v_mfma_f32_16x16x32_bf16 v[140:143], a[164:167], v[92:95], v[140:143]
s_mov_b32 exec_hi, 0xffff00
s_mov_b32 exec_lo, 0
buffer_store_dwordx4 v[100:103], v5, s[44:47], s89 offen offset:0 sc1
s_mov_b64 exec, -1
v_mfma_f32_16x16x32_bf16 v[160:163], v[92:95], a[168:171], v[160:163]
v_mfma_f32_16x16x32_bf16 v[180:183], a[172:175], v[92:95], v[180:183]
s_waitcnt lgkmcnt(4)
v_mfma_f32_16x16x32_bf16 v[124:127], a[160:163], v[96:99], v[124:127]
v_mfma_f32_16x16x32_bf16 v[144:147], a[164:167], v[96:99], v[144:147]
v_mfma_f32_16x16x32_bf16 v[164:167], v[96:99], a[168:171], v[164:167]
v_mfma_f32_16x16x32_bf16 v[184:187], a[172:175], v[96:99], v[184:187]
s_waitcnt lgkmcnt(3)
v_mfma_f32_16x16x32_bf16 v[112:115], a[176:179], v[68:71], v[112:115]
ds_read_b128 v[84:87], v1 offset:6144
v_mfma_f32_16x16x32_bf16 v[132:135], a[180:183], v[68:71], v[132:135]
ds_read_b128 v[88:91], v1 offset:24576
v_mfma_f32_16x16x32_bf16 v[152:155], v[68:71], a[184:187], v[152:155]
v_mfma_f32_16x16x32_bf16 v[172:175], a[188:191], v[68:71], v[172:175]
ds_read_b128 v[92:95], v1 offset:43008
s_waitcnt lgkmcnt(5)
v_mfma_f32_16x16x32_bf16 v[116:119], a[176:179], v[72:75], v[116:119]
v_mfma_f32_16x16x32_bf16 v[136:139], a[180:183], v[72:75], v[136:139]
ds_read_b128 v[96:99], v1 offset:61440
v_mfma_f32_16x16x32_bf16 v[156:159], v[72:75], a[184:187], v[156:159]
v_mfma_f32_16x16x32_bf16 v[176:179], a[188:191], v[72:75], v[176:179]
v_lshrrev_b32 v105, 2, v0
v_mul_u32_u24 v105, 9152, v105
v_add_u32 v105, v105, v5
s_waitcnt lgkmcnt(5)
v_mfma_f32_16x16x32_bf16 v[120:123], a[176:179], v[76:79], v[120:123]
v_mfma_f32_16x16x32_bf16 v[140:143], a[180:183], v[76:79], v[140:143]
s_add_u32 s1, s13, 331776
s_cmp_lt_u32 s75, 18
s_cselect_b32 exec_lo, -1, 0
s_cselect_b32 exec_hi, 15, 0
buffer_store_dwordx4 v[100:103], v105, s[24:27], s1 offen sc1
s_mov_b64 exec, -1
v_mfma_f32_16x16x32_bf16 v[160:163], v[76:79], a[184:187], v[160:163]
v_mfma_f32_16x16x32_bf16 v[180:183], a[188:191], v[76:79], v[180:183]
s_add_u32 s1, s13, 663552
s_cmp_lt_u32 s75, 18
s_cselect_b32 exec_lo, -1, 0
s_cselect_b32 exec_hi, 15, 0
buffer_store_dwordx4 v[100:103], v105, s[24:27], s1 offen sc1
s_mov_b64 exec, -1
s_waitcnt lgkmcnt(4)
v_mfma_f32_16x16x32_bf16 v[124:127], a[176:179], v[80:83], v[124:127]
v_mfma_f32_16x16x32_bf16 v[144:147], a[180:183], v[80:83], v[144:147]
s_mul_i32 s14, s77, 1168
s_lshl_b32 s15, s77, 10
s_add_u32 s15, s15, s85
v_mfma_f32_16x16x32_bf16 v[164:167], v[80:83], a[184:187], v[164:167]
v_mfma_f32_16x16x32_bf16 v[184:187], a[188:191], v[80:83], v[184:187]
v_lshlrev_b32 v64, 2, v0
v_add_u32 v64, 160128, v64
C_39:
s_waitcnt vmcnt(3)
v_cmp_ne_u32 vcc, s80, v63
s_cbranch_vccnz R_40
s_waitcnt lgkmcnt(3)
v_mfma_f32_16x16x32_bf16 v[112:115], a[192:195], v[84:87], v[112:115]
v_mfma_f32_16x16x32_bf16 v[132:135], a[196:199], v[84:87], v[132:135]
ds_read_b128 v[68:71], v2 offset:6144
v_mfma_f32_16x16x32_bf16 v[152:155], v[84:87], a[200:203], v[152:155]
v_mfma_f32_16x16x32_bf16 v[172:175], a[204:207], v[84:87], v[172:175]
ds_read_b128 v[72:75], v2 offset:24576
s_waitcnt lgkmcnt(4)
v_mfma_f32_16x16x32_bf16 v[116:119], a[192:195], v[88:91], v[116:119]
v_mfma_f32_16x16x32_bf16 v[136:139], a[196:199], v[88:91], v[136:139]
ds_read_b128 v[76:79], v2 offset:43008
v_mfma_f32_16x16x32_bf16 v[156:159], v[88:91], a[200:203], v[156:159]
v_mfma_f32_16x16x32_bf16 v[176:179], a[204:207], v[88:91], v[176:179]
ds_read_b128 v[80:83], v2 offset:61440
s_waitcnt lgkmcnt(5)
v_mfma_f32_16x16x32_bf16 v[120:123], a[192:195], v[92:95], v[120:123]
v_mfma_f32_16x16x32_bf16 v[140:143], a[196:199], v[92:95], v[140:143]
s_add_u32 m0, s14, 73728
s_add_u32 s1, s15, 146432
buffer_load_dwordx4 v5, s[24:27], s1 offen sc1 lds
v_mfma_f32_16x16x32_bf16 v[160:163], v[92:95], a[200:203], v[160:163]
v_mfma_f32_16x16x32_bf16 v[180:183], a[204:207], v[92:95], v[180:183]
s_mov_b64 exec, 0xffff
ds_write2_b32 v64, v60, v61 offset0:0 offset1:80
s_mov_b64 exec, -1
s_waitcnt lgkmcnt(5)
v_mfma_f32_16x16x32_bf16 v[124:127], a[192:195], v[96:99], v[124:127]
v_mfma_f32_16x16x32_bf16 v[144:147], a[196:199], v[96:99], v[144:147]
v_mfma_f32_16x16x32_bf16 v[164:167], v[96:99], a[200:203], v[164:167]
v_mfma_f32_16x16x32_bf16 v[184:187], a[204:207], v[96:99], v[184:187]
s_cmp_ge_u32 s75, 18
s_cbranch_scc1 L_41
L_42:
s_barrier
s_waitcnt lgkmcnt(4)
v_mfma_f32_16x16x32_bf16 v[112:115], a[208:211], v[68:71], v[112:115]
ds_read_b128 v[84:87], v1 offset:7168
v_mfma_f32_16x16x32_bf16 v[132:135], a[212:215], v[68:71], v[132:135]
ds_read_b128 v[88:91], v1 offset:25600
v_mfma_f32_16x16x32_bf16 v[152:155], v[68:71], a[216:219], v[152:155]
ds_read_b128 v[92:95], v1 offset:44032
v_mfma_f32_16x16x32_bf16 v[172:175], a[220:223], v[68:71], v[172:175]
ds_read_b128 v[96:99], v1 offset:62464
s_waitcnt lgkmcnt(7)
v_mfma_f32_16x16x32_bf16 v[116:119], a[208:211], v[72:75], v[116:119]
v_mfma_f32_16x16x32_bf16 v[136:139], a[212:215], v[72:75], v[136:139]
v_mov_b32 v32, 163712
ds_read_b128 v[28:31], v32
v_mfma_f32_16x16x32_bf16 v[156:159], v[72:75], a[216:219], v[156:159]
v_mfma_f32_16x16x32_bf16 v[176:179], a[220:223], v[72:75], v[176:179]
s_lshl_b32 s1, s78, 12
s_add_u32 s1, s1, 65536
v_min_u32 v104, 31, v0
v_lshl_add_u32 v104, v104, 7, s1
s_waitcnt lgkmcnt(7)
v_mfma_f32_16x16x32_bf16 v[120:123], a[208:211], v[76:79], v[120:123]
v_mfma_f32_16x16x32_bf16 v[140:143], a[212:215], v[76:79], v[140:143]
buffer_load_dword v105, v104, s[24:27], 0 offen sc1
v_mfma_f32_16x16x32_bf16 v[160:163], v[76:79], a[216:219], v[160:163]
v_mfma_f32_16x16x32_bf16 v[180:183], a[220:223], v[76:79], v[180:183]
s_add_u32 m0, s14, 78400
s_add_u32 s1, s15, 150528
buffer_load_dwordx4 v5, s[24:27], s1 offen sc1 lds
s_waitcnt lgkmcnt(6)
v_mfma_f32_16x16x32_bf16 v[124:127], a[208:211], v[80:83], v[124:127]
v_mfma_f32_16x16x32_bf16 v[144:147], a[212:215], v[80:83], v[144:147]
s_waitcnt lgkmcnt(0)
v_readfirstlane_b32 s57, v28
v_readfirstlane_b32 s58, v29
v_mfma_f32_16x16x32_bf16 v[164:167], v[80:83], a[216:219], v[164:167]
v_mfma_f32_16x16x32_bf16 v[184:187], a[220:223], v[80:83], v[184:187]
v_readfirstlane_b32 s59, v30
v_readfirstlane_b32 s56, v31
v_mfma_f32_16x16x32_bf16 v[112:115], a[224:227], v[84:87], v[112:115]
v_mfma_f32_16x16x32_bf16 v[132:135], a[228:231], v[84:87], v[132:135]
ds_read_b128 v[68:71], v2 offset:7168
v_mfma_f32_16x16x32_bf16 v[152:155], v[84:87], a[232:235], v[152:155]
v_mfma_f32_16x16x32_bf16 v[172:175], a[236:239], v[84:87], v[172:175]
ds_read_b128 v[72:75], v2 offset:25600
v_mfma_f32_16x16x32_bf16 v[116:119], a[224:227], v[88:91], v[116:119]
v_mfma_f32_16x16x32_bf16 v[136:139], a[228:231], v[88:91], v[136:139]
ds_read_b128 v[76:79], v2 offset:44032
v_mfma_f32_16x16x32_bf16 v[156:159], v[88:91], a[232:235], v[156:159]
v_mfma_f32_16x16x32_bf16 v[176:179], a[236:239], v[88:91], v[176:179]
ds_read_b128 v[80:83], v2 offset:62464
v_mfma_f32_16x16x32_bf16 v[120:123], a[224:227], v[92:95], v[120:123]
v_mfma_f32_16x16x32_bf16 v[140:143], a[228:231], v[92:95], v[140:143]
s_mov_b32 m0, 83072
s_add_u32 s1, s85, 154624
buffer_load_dwordx4 v5, s[24:27], s1 offen sc1 lds
v_mfma_f32_16x16x32_bf16 v[160:163], v[92:95], a[232:235], v[160:163]
v_mfma_f32_16x16x32_bf16 v[180:183], a[236:239], v[92:95], v[180:183]
v_mfma_f32_16x16x32_bf16 v[124:127], a[224:227], v[96:99], v[124:127]
v_mfma_f32_16x16x32_bf16 v[144:147], a[228:231], v[96:99], v[144:147]
v_mfma_f32_16x16x32_bf16 v[164:167], v[96:99], a[232:235], v[164:167]
v_mfma_f32_16x16x32_bf16 v[184:187], a[236:239], v[96:99], v[184:187]
s_cmp_lt_u32 s83, 36
s_cbranch_scc0 L_43
s_mul_i32 s5, s83, 9216
v_and_b32 v23, 3, v0
v_lshrrev_b32 v22, 5, v0
v_lshl_add_u32 v23, v23, 1, v22
v_mov_b32 v22, s59
v_add_f32 v22, 1.0, v22
v_lshlrev_b32 v23, 2, v23
s_lshl_b32 s6, s83, 5
v_add_u32 v26, s6, v23
v_lshrrev_b32 v27, 4, v26
v_mul_u32_u24 v27, 7282, v27
v_lshrrev_b32 v27, 16, v27
v_mul_u32_u24 v27, 3952, v27
v_add_u32 v27, v27, v26
s_ashr_i32 s3, s57, 31
s_lshr_b32 s3, s3, 1
s_xor_b32 s3, s3, s57
v_mov_b32 v26, 0xbfb8aa3b
v_mul_f32 v26, s3, v26
v_exp_f32 v26, v26
s_nop 0
v_add_f32 v26, 1.0, v26
v_rcp_f32 v26, v26
buffer_load_dword v64, v27, s[24:27], s4 offen sc1
s_add_u32 s1, s5, 3145728
buffer_load_dwordx4 v[28:31], v5, s[24:27], s1 offen offset:0 sc1
buffer_load_dwordx4 v[32:35], v5, s[24:27], s1 offen offset:1024 sc1
buffer_load_dwordx4 v[36:39], v5, s[24:27], s1 offen offset:2048 sc1
buffer_load_dwordx4 v[40:43], v5, s[24:27], s1 offen offset:3072 sc1
s_add_u32 s1, s5, 3149824
buffer_load_dwordx4 v[44:47], v5, s[24:27], s1 offen offset:0 sc1
buffer_load_dwordx4 v[48:51], v5, s[24:27], s1 offen offset:1024 sc1
buffer_load_dwordx4 v[52:55], v5, s[24:27], s1 offen offset:2048 sc1
buffer_load_dwordx4 v[56:59], v5, s[24:27], s1 offen offset:3072 sc1
s_add_u32 s1, s5, 3153920
buffer_load_dwordx4 v[60:63], v5, s[24:27], s1 offen offset:0 sc1
L_43:
s_waitcnt lgkmcnt(3)
v_mfma_f32_16x16x32_bf16 v[112:115], a[240:243], v[68:71], v[112:115]
ds_read_b128 v[84:87], v1 offset:8192
v_mfma_f32_16x16x32_bf16 v[132:135], a[244:247], v[68:71], v[132:135]
ds_read_b128 v[88:91], v1 offset:26624
v_mfma_f32_16x16x32_bf16 v[152:155], v[68:71], a[248:251], v[152:155]
ds_read_b128 v[92:95], v1 offset:45056
v_mfma_f32_16x16x32_bf16 v[172:175], a[252:255], v[68:71], v[172:175]
ds_read_b128 v[96:99], v1 offset:63488
s_waitcnt lgkmcnt(6)
v_mfma_f32_16x16x32_bf16 v[116:119], a[240:243], v[72:75], v[116:119]
s_sub_u32 s16, s56, s78
s_lshl_b32 s16, s16, 6
s_and_b32 s17, s57, 63
v_mfma_f32_16x16x32_bf16 v[136:139], a[244:247], v[72:75], v[136:139]
s_add_u32 s16, s16, 16
s_add_u32 s60, s16, s17
v_mfma_f32_16x16x32_bf16 v[156:159], v[72:75], a[248:251], v[156:159]
v_mfma_f32_16x16x32_bf16 v[176:179], a[252:255], v[72:75], v[176:179]
s_cmp_eq_u32 s79, 0
s_cselect_b32 s16, 16, 8
s_sub_u32 s17, s60, s16
s_waitcnt lgkmcnt(5)
v_mfma_f32_16x16x32_bf16 v[120:123], a[240:243], v[76:79], v[120:123]
v_mfma_f32_16x16x32_bf16 v[140:143], a[244:247], v[76:79], v[140:143]
s_sub_u32 s16, 80, s16
s_cmp_lt_u32 s17, s16
s_cselect_b32 s61, 1, 0
v_mfma_f32_16x16x32_bf16 v[160:163], v[76:79], a[248:251], v[160:163]
v_mfma_f32_16x16x32_bf16 v[180:183], a[252:255], v[76:79], v[180:183]
s_and_b32 s16, s57, 56
s_cmp_eq_u32 s16, 56
s_cselect_b32 s16, 3, 1
s_waitcnt lgkmcnt(4)
v_mfma_f32_16x16x32_bf16 v[124:127], a[240:243], v[80:83], v[124:127]
v_mfma_f32_16x16x32_bf16 v[144:147], a[244:247], v[80:83], v[144:147]
s_and_b32 s17, s56, 15
s_cmp_eq_u32 s17, 15
s_cselect_b32 s16, 1, s16
v_mfma_f32_16x16x32_bf16 v[164:167], v[80:83], a[248:251], v[164:167]
v_mfma_f32_16x16x32_bf16 v[184:187], a[252:255], v[80:83], v[184:187]
s_lshl_b32 s8, s16, s56
s_waitcnt lgkmcnt(3)
v_mfma_f32_16x16x32_bf16 v[112:115], v[224:227], v[84:87], v[112:115]
v_mfma_f32_16x16x32_bf16 v[132:135], v[228:231], v[84:87], v[132:135]
ds_read_b128 v[68:71], v2 offset:8192
v_mfma_f32_16x16x32_bf16 v[152:155], v[84:87], v[232:235], v[152:155]
v_mfma_f32_16x16x32_bf16 v[172:175], v[236:239], v[84:87], v[172:175]
ds_read_b128 v[72:75], v2 offset:26624
s_waitcnt lgkmcnt(4)
v_mfma_f32_16x16x32_bf16 v[116:119], v[224:227], v[88:91], v[116:119]
v_mfma_f32_16x16x32_bf16 v[136:139], v[228:231], v[88:91], v[136:139]
ds_read_b128 v[76:79], v2 offset:45056
v_mfma_f32_16x16x32_bf16 v[156:159], v[88:91], v[232:235], v[156:159]
v_mfma_f32_16x16x32_bf16 v[176:179], v[236:239], v[88:91], v[176:179]
ds_read_b128 v[80:83], v2 offset:63488
s_waitcnt lgkmcnt(5)
v_mfma_f32_16x16x32_bf16 v[120:123], v[224:227], v[92:95], v[120:123]
v_mfma_f32_16x16x32_bf16 v[140:143], v[228:231], v[92:95], v[140:143]
v_mfma_f32_16x16x32_bf16 v[160:163], v[92:95], v[232:235], v[160:163]
v_mfma_f32_16x16x32_bf16 v[180:183], v[236:239], v[92:95], v[180:183]
s_waitcnt lgkmcnt(4)
v_mfma_f32_16x16x32_bf16 v[124:127], v[224:227], v[96:99], v[124:127]
v_mfma_f32_16x16x32_bf16 v[144:147], v[228:231], v[96:99], v[144:147]
v_mfma_f32_16x16x32_bf16 v[164:167], v[96:99], v[232:235], v[164:167]
v_mfma_f32_16x16x32_bf16 v[184:187], v[236:239], v[96:99], v[184:187]
s_waitcnt vmcnt(0)
s_barrier
C_44:
v_cmp_ne_u32 vcc, s80, v105
s_cbranch_vccnz R_45
s_cmp_lt_u32 s83, 36
s_cbranch_scc1 L_46
L_47:
s_waitcnt lgkmcnt(3)
v_mfma_f32_16x16x32_bf16 v[112:115], v[240:243], v[68:71], v[112:115]
ds_read_b128 v[84:87], v3 offset:0
v_mfma_f32_16x16x32_bf16 v[132:135], v[244:247], v[68:71], v[132:135]
ds_read_b128 v[88:91], v4 offset:0
v_mfma_f32_16x16x32_bf16 v[152:155], v[68:71], v[248:251], v[152:155]
ds_read_b128 v[92:95], v3 offset:1168
v_mfma_f32_16x16x32_bf16 v[172:175], v[252:255], v[68:71], v[172:175]
ds_read_b128 v[96:99], v4 offset:1168
s_waitcnt lgkmcnt(6)
v_mfma_f32_16x16x32_bf16 v[116:119], v[240:243], v[72:75], v[116:119]
ds_read_b128 v[100:103], v3 offset:2336
v_mfma_f32_16x16x32_bf16 v[136:139], v[244:247], v[72:75], v[136:139]
v_lshlrev_b32 v22, 2, v6
v_add_u32 v22, 160128, v22
v_mfma_f32_16x16x32_bf16 v[156:159], v[72:75], v[248:251], v[156:159]
v_lshlrev_b32 v23, 4, v7
v_add_u32 v23, 160128, v23
v_mfma_f32_16x16x32_bf16 v[176:179], v[252:255], v[72:75], v[176:179]
ds_read_b128 v[58:61], v19
ds_read_b128 v[62:65], v20
s_waitcnt lgkmcnt(8)
v_mfma_f32_16x16x32_bf16 v[120:123], v[240:243], v[76:79], v[120:123]
ds_read_b64 v[66:67], v21
v_mfma_f32_16x16x32_bf16 v[140:143], v[244:247], v[76:79], v[140:143]
ds_read2_b32 v[28:29], v22 offset0:0 offset1:80
ds_read2_b32 v[30:31], v22 offset0:16 offset1:96
v_mfma_f32_16x16x32_bf16 v[160:163], v[76:79], v[248:251], v[160:163]
ds_read2_b32 v[32:33], v22 offset0:32 offset1:112
ds_read2_b32 v[34:35], v22 offset0:48 offset1:128
ds_read2_b32 v[36:37], v22 offset0:64 offset1:144
v_mfma_f32_16x16x32_bf16 v[180:183], v[252:255], v[76:79], v[180:183]
s_lshl_b32 s1, s77, 8
s_add_u32 s1, s1, 159104
v_lshl_add_u32 v26, v7, 4, s1
v_lshl_add_u32 v27, v6, 2, s1
s_waitcnt lgkmcnt(13)
v_mfma_f32_16x16x32_bf16 v[124:127], v[240:243], v[80:83], v[124:127]
v_mfma_f32_16x16x32_bf16 v[144:147], v[244:247], v[80:83], v[144:147]
ds_read_b128 v[52:55], v26 offset:128
ds_read_b128 v[48:51], v26 offset:64
v_mfma_f32_16x16x32_bf16 v[164:167], v[80:83], v[248:251], v[164:167]
v_mfma_f32_16x16x32_bf16 v[184:187], v[252:255], v[80:83], v[184:187]
ds_read_b128 v[44:47], v26 offset:0
ds_read_b32 v56, v27 offset:192
s_cmp_lg_u32 s61, 0
s_cbranch_scc1 L_patch
s_waitcnt lgkmcnt(15)
v_mfma_f32_16x16x32_bf16 v[168:171], a[12:15], v[84:87], 0
ds_read_b128 v[104:107], v4 offset:2336
ds_read_b128 v[76:79], v23 offset:64
ds_read_b128 v[80:83], v23 offset:384
ds_read_b128 v[68:71], v23 offset:128
ds_read_b128 v[72:75], v23 offset:448
v_mfma_f32_16x16x32_bf16 v[128:131], a[4:7], v[84:87], 0
s_waitcnt lgkmcnt(12)
v_mul_f32 v39, 0x3eae1a93, v31
s_waitcnt lgkmcnt(11)
v_mul_f32 v40, 0x3eae1a93, v33
s_waitcnt lgkmcnt(10)
v_mul_f32 v41, 0x3eae1a93, v35
s_waitcnt lgkmcnt(9)
v_mul_f32 v42, 0x3eae1a93, v37
s_waitcnt lgkmcnt(8)
v_fmac_f32 v172, v52, v30
v_mfma_f32_16x16x32_bf16 v[148:151], v[84:87], a[8:11], 0
v_fmac_f32 v173, v53, v30
v_fmac_f32 v174, v54, v30
v_fmac_f32 v175, v55, v30
s_waitcnt lgkmcnt(7)
v_fmac_f32 v132, v48, v30
v_fmac_f32 v133, v49, v30
v_mfma_f32_16x16x32_bf16 v[168:171], a[28:31], v[88:91], v[168:171]
ds_read_b128 v[84:87], v3 offset:3504
s_barrier
v_fmac_f32 v134, v50, v30
v_fmac_f32 v135, v51, v30
v_mul_f32 v174, v174, v39
v_mfma_f32_16x16x32_bf16 v[128:131], a[20:23], v[88:91], v[128:131]
s_mul_i32 s18, s76, 82944
s_add_u32 s18, s18, s62
s_add_u32 m0, s62, 0
s_add_u32 s19, s18, 2228224
buffer_load_dwordx4 v5, s[24:27], s19 offen offset:0 sc1 lds
v_mfma_f32_16x16x32_bf16 v[148:151], v[88:91], a[24:27], v[148:151]
v_mul_f32 v175, v175, v39
v_mul_f32 v132, v132, v39
v_mul_f32 v133, v133, v39
v_mul_f32 v134, v134, v39
v_mul_f32 v135, v135, v39
v_mfma_f32_16x16x32_bf16 v[168:171], a[44:47], v[92:95], v[168:171]
ds_read_b128 v[88:91], v4 offset:3504
buffer_load_dwordx4 v5, s[24:27], s19 offen offset:1024 sc1 lds
v_mul_f32 v172, v172, v31
v_mul_f32 v173, v173, v31
v_cvt_pk_bf16_f32 v132, v132, v133
v_mfma_f32_16x16x32_bf16 v[128:131], a[36:39], v[92:95], v[128:131]
v_cvt_pk_bf16_f32 v133, v134, v135
v_cvt_pk_bf16_f32 v134, v174, v175
v_mov_b32 v135, 0
s_waitcnt lgkmcnt(8)
v_fmac_f32 v112, v44, v30
v_fmac_f32 v113, v45, v30
v_mfma_f32_16x16x32_bf16 v[148:151], v[92:95], a[40:43], v[148:151]
v_fmac_f32 v114, v46, v30
v_fmac_f32 v115, v47, v30
v_mul_f32 v112, v112, v31
v_mul_f32 v113, v113, v31
v_mul_f32 v114, v114, v31
v_mfma_f32_16x16x32_bf16 v[168:171], a[60:63], v[96:99], v[168:171]
ds_read_b128 v[92:95], v3 offset:4672
buffer_load_dwordx4 v5, s[24:27], s19 offen offset:2048 sc1 lds
v_mul_f32 v115, v115, v31
v_cvt_pk_bf16_f32 v112, v112, v113
v_cvt_pk_bf16_f32 v113, v114, v115
v_mfma_f32_16x16x32_bf16 v[128:131], a[52:55], v[96:99], v[128:131]
v_cvt_pk_bf16_f32 v114, v172, v173
v_mov_b32 v115, 0x3f80
s_waitcnt lgkmcnt(6)
v_fmac_f32 v152, v76, v56
v_fmac_f32 v153, v77, v56
v_fmac_f32 v154, v78, v56
v_mfma_f32_16x16x32_bf16 v[148:151], v[96:99], a[56:59], v[148:151]
buffer_load_dwordx4 v5, s[24:27], s19 offen offset:3072 sc1 lds
v_fmac_f32 v155, v79, v56
s_waitcnt lgkmcnt(5)
v_mul_f32 v152, v152, v80
v_mul_f32 v153, v153, v81
v_mfma_f32_16x16x32_bf16 v[168:171], a[76:79], v[100:103], v[168:171]
ds_read_b128 v[96:99], v4 offset:4672
v_mul_f32 v154, v154, v82
v_mul_f32 v155, v155, v83
v_cvt_pk_bf16_f32 v152, v152, v153
v_mfma_f32_16x16x32_bf16 v[128:131], a[68:71], v[100:103], v[128:131]
s_add_u32 m0, s62, 4096
s_add_u32 s19, s18, 2232320
buffer_load_dwordx4 v5, s[24:27], s19 offen offset:0 sc1 lds
v_cvt_pk_bf16_f32 v153, v154, v155
v_mfma_f32_16x16x32_bf16 v[148:151], v[100:103], a[72:75], v[148:151]
ds_read_b128 v[76:79], v23 offset:192
ds_read_b128 v[80:83], v23 offset:512
v_fmac_f32 v176, v52, v32
v_fmac_f32 v177, v53, v32
v_mfma_f32_16x16x32_bf16 v[168:171], a[92:95], v[104:107], v[168:171]
ds_read_b128 v[100:103], v3 offset:5840
buffer_load_dwordx4 v5, s[24:27], s19 offen offset:1024 sc1 lds
v_fmac_f32 v178, v54, v32
v_fmac_f32 v179, v55, v32
v_mfma_f32_16x16x32_bf16 v[128:131], a[84:87], v[104:107], v[128:131]
v_fmac_f32 v136, v48, v32
v_fmac_f32 v137, v49, v32
v_fmac_f32 v138, v50, v32
v_fmac_f32 v139, v51, v32
v_mfma_f32_16x16x32_bf16 v[148:151], v[104:107], a[88:91], v[148:151]
v_mul_f32 v178, v178, v40
v_mul_f32 v179, v179, v40
v_mul_f32 v136, v136, v40
v_mul_f32 v137, v137, v40
s_waitcnt lgkmcnt(6)
v_mfma_f32_16x16x32_bf16 v[168:171], a[108:111], v[84:87], v[168:171]
ds_read_b128 v[104:107], v4 offset:5840
buffer_load_dwordx4 v5, s[24:27], s19 offen offset:2048 sc1 lds
v_mul_f32 v138, v138, v40
v_mul_f32 v139, v139, v40
v_mfma_f32_16x16x32_bf16 v[128:131], a[100:103], v[84:87], v[128:131]
v_mul_f32 v176, v176, v33
v_mul_f32 v177, v177, v33
v_cvt_pk_bf16_f32 v136, v136, v137
v_cvt_pk_bf16_f32 v137, v138, v139
v_mfma_f32_16x16x32_bf16 v[148:151], v[84:87], a[104:107], v[148:151]
buffer_load_dwordx4 v5, s[24:27], s19 offen offset:3072 sc1 lds
v_cvt_pk_bf16_f32 v138, v178, v179
v_mov_b32 v139, 0
v_fmac_f32 v116, v44, v32
s_waitcnt lgkmcnt(6)
v_mfma_f32_16x16x32_bf16 v[168:171], a[124:127], v[88:91], v[168:171]
ds_read_b128 v[84:87], v3 offset:7008
v_fmac_f32 v117, v45, v32
v_fmac_f32 v118, v46, v32
v_fmac_f32 v119, v47, v32
v_mfma_f32_16x16x32_bf16 v[128:131], a[116:119], v[88:91], v[128:131]
s_add_u32 m0, s62, 8192
s_add_u32 s19, s18, 2236416
buffer_load_dwordx4 v5, s[24:27], s19 offen offset:0 sc1 lds
v_mul_f32 v116, v116, v33
v_mfma_f32_16x16x32_bf16 v[148:151], v[88:91], a[120:123], v[148:151]
v_mul_f32 v117, v117, v33
v_mul_f32 v118, v118, v33
v_mul_f32 v119, v119, v33
v_cvt_pk_bf16_f32 v116, v116, v117
s_waitcnt lgkmcnt(6)
v_mfma_f32_16x16x32_bf16 v[168:171], a[140:143], v[92:95], v[168:171]
ds_read_b128 v[88:91], v4 offset:7008
buffer_load_dwordx4 v5, s[24:27], s19 offen offset:1024 sc1 lds
v_cvt_pk_bf16_f32 v117, v118, v119
v_cvt_pk_bf16_f32 v118, v176, v177
v_mfma_f32_16x16x32_bf16 v[128:131], a[132:135], v[92:95], v[128:131]
v_mov_b32 v119, 0x3f80
v_fmac_f32 v156, v68, v56
v_fmac_f32 v157, v69, v56
v_fmac_f32 v158, v70, v56
v_mfma_f32_16x16x32_bf16 v[148:151], v[92:95], a[136:139], v[148:151]
v_fmac_f32 v159, v71, v56
v_mul_f32 v156, v156, v72
v_mul_f32 v157, v157, v73
v_mul_f32 v158, v158, v74
s_waitcnt lgkmcnt(6)
v_mfma_f32_16x16x32_bf16 v[168:171], a[156:159], v[96:99], v[168:171]
ds_read_b128 v[92:95], v3 offset:8176
buffer_load_dwordx4 v5, s[24:27], s19 offen offset:2048 sc1 lds
v_mul_f32 v159, v159, v75
v_cvt_pk_bf16_f32 v154, v156, v157
v_mfma_f32_16x16x32_bf16 v[128:131], a[148:151], v[96:99], v[128:131]
v_cvt_pk_bf16_f32 v155, v158, v159
ds_read_b128 v[68:71], v23 offset:256
ds_read_b128 v[72:75], v23 offset:576
v_fmac_f32 v180, v52, v34
v_mfma_f32_16x16x32_bf16 v[148:151], v[96:99], a[152:155], v[148:151]
buffer_load_dwordx4 v5, s[24:27], s19 offen offset:3072 sc1 lds
v_fmac_f32 v181, v53, v34
v_fmac_f32 v182, v54, v34
v_fmac_f32 v183, v55, v34
s_waitcnt lgkmcnt(6)
v_mfma_f32_16x16x32_bf16 v[168:171], a[172:175], v[100:103], v[168:171]
ds_read_b128 v[96:99], v4 offset:8176
v_fmac_f32 v140, v48, v34
v_fmac_f32 v141, v49, v34
v_fmac_f32 v142, v50, v34
v_mfma_f32_16x16x32_bf16 v[128:131], a[164:167], v[100:103], v[128:131]
s_add_u32 m0, s62, 12288
s_add_u32 s19, s18, 2240512
buffer_load_dwordx4 v5, s[24:27], s19 offen offset:0 sc1 lds
v_fmac_f32 v143, v51, v34
v_mfma_f32_16x16x32_bf16 v[148:151], v[100:103], a[168:171], v[148:151]
v_mul_f32 v182, v182, v41
v_mul_f32 v183, v183, v41
v_mul_f32 v140, v140, v41
v_mul_f32 v141, v141, v41
s_waitcnt lgkmcnt(6)
v_mfma_f32_16x16x32_bf16 v[168:171], a[188:191], v[104:107], v[168:171]
ds_read_b128 v[100:103], v3 offset:9344
buffer_load_dwordx4 v5, s[24:27], s19 offen offset:1024 sc1 lds
v_mul_f32 v142, v142, v41
v_mul_f32 v143, v143, v41
v_mfma_f32_16x16x32_bf16 v[128:131], a[180:183], v[104:107], v[128:131]
v_mul_f32 v180, v180, v35
v_mul_f32 v181, v181, v35
v_cvt_pk_bf16_f32 v140, v140, v141
v_cvt_pk_bf16_f32 v141, v142, v143
v_mfma_f32_16x16x32_bf16 v[148:151], v[104:107], a[184:187], v[148:151]
v_cvt_pk_bf16_f32 v142, v182, v183
v_mov_b32 v143, 0
v_fmac_f32 v120, v44, v34
v_fmac_f32 v121, v45, v34
s_waitcnt lgkmcnt(6)
v_mfma_f32_16x16x32_bf16 v[168:171], a[204:207], v[84:87], v[168:171]
ds_read_b128 v[104:107], v4 offset:9344
buffer_load_dwordx4 v5, s[24:27], s19 offen offset:2048 sc1 lds
v_fmac_f32 v122, v46, v34
v_fmac_f32 v123, v47, v34
v_mfma_f32_16x16x32_bf16 v[128:131], a[196:199], v[84:87], v[128:131]
v_mul_f32 v120, v120, v35
v_mul_f32 v121, v121, v35
v_mul_f32 v122, v122, v35
v_mul_f32 v123, v123, v35
v_mfma_f32_16x16x32_bf16 v[148:151], v[84:87], a[200:203], v[148:151]
buffer_load_dwordx4 v5, s[24:27], s19 offen offset:3072 sc1 lds
v_cvt_pk_bf16_f32 v120, v120, v121
v_cvt_pk_bf16_f32 v121, v122, v123
v_cvt_pk_bf16_f32 v122, v180, v181
s_waitcnt lgkmcnt(6)
v_mfma_f32_16x16x32_bf16 v[168:171], a[220:223], v[88:91], v[168:171]
v_mov_b32 v123, 0x3f80
v_fmac_f32 v160, v76, v56
v_fmac_f32 v161, v77, v56
v_fmac_f32 v162, v78, v56
v_mfma_f32_16x16x32_bf16 v[128:131], a[212:215], v[88:91], v[128:131]
s_add_u32 m0, s62, 16384
s_add_u32 s19, s18, 2244608
buffer_load_dwordx4 v5, s[24:27], s19 offen offset:0 sc1 lds
v_fmac_f32 v163, v79, v56
v_mfma_f32_16x16x32_bf16 v[148:151], v[88:91], a[216:219], v[148:151]
v_mul_f32 v160, v160, v80
v_mul_f32 v161, v161, v81
v_mul_f32 v162, v162, v82
v_mul_f32 v163, v163, v83
s_waitcnt lgkmcnt(5)
v_mfma_f32_16x16x32_bf16 v[168:171], a[236:239], v[92:95], v[168:171]
buffer_load_dwordx4 v5, s[24:27], s19 offen offset:1024 sc1 lds
v_cvt_pk_bf16_f32 v156, v160, v161
v_cvt_pk_bf16_f32 v157, v162, v163
ds_read_b128 v[76:79], v23 offset:0
v_mfma_f32_16x16x32_bf16 v[128:131], a[228:231], v[92:95], v[128:131]
ds_read_b128 v[80:83], v23 offset:320
v_fmac_f32 v184, v52, v36
v_fmac_f32 v185, v53, v36
v_fmac_f32 v186, v54, v36
v_mfma_f32_16x16x32_bf16 v[148:151], v[92:95], a[232:235], v[148:151]
v_fmac_f32 v187, v55, v36
v_fmac_f32 v144, v48, v36
v_fmac_f32 v145, v49, v36
v_fmac_f32 v146, v50, v36
s_waitcnt lgkmcnt(4)
v_mfma_f32_16x16x32_bf16 v[168:171], a[252:255], v[96:99], v[168:171]
v_fmac_f32 v147, v51, v36
v_mul_f32 v186, v186, v42
v_mul_f32 v187, v187, v42
v_mul_f32 v144, v144, v42
v_mfma_f32_16x16x32_bf16 v[128:131], a[244:247], v[96:99], v[128:131]
v_mul_f32 v145, v145, v42
v_mul_f32 v146, v146, v42
v_mul_f32 v147, v147, v42
v_mul_f32 v184, v184, v37
v_mfma_f32_16x16x32_bf16 v[148:151], v[96:99], a[248:251], v[148:151]
v_mul_f32 v185, v185, v37
v_cvt_pk_bf16_f32 v144, v144, v145
v_cvt_pk_bf16_f32 v145, v146, v147
v_cvt_pk_bf16_f32 v146, v186, v187
s_waitcnt lgkmcnt(3)
v_mfma_f32_16x16x32_bf16 v[168:171], v[236:239], v[100:103], v[168:171]
v_mov_b32 v147, 0
v_fmac_f32 v124, v44, v36
v_fmac_f32 v125, v45, v36
v_fmac_f32 v126, v46, v36
v_mfma_f32_16x16x32_bf16 v[128:131], v[228:231], v[100:103], v[128:131]
v_fmac_f32 v127, v47, v36
v_mul_f32 v124, v124, v37
v_mul_f32 v125, v125, v37
v_mul_f32 v126, v126, v37
v_mfma_f32_16x16x32_bf16 v[148:151], v[100:103], v[232:235], v[148:151]
v_mul_f32 v127, v127, v37
v_cvt_pk_bf16_f32 v124, v124, v125
L_pad5:
s_cbranch_execz L_pad8
v_cvt_pk_bf16_f32 v125, v126, v127
v_cvt_pk_bf16_f32 v126, v184, v185
s_waitcnt lgkmcnt(2)
v_mfma_f32_16x16x32_bf16 v[168:171], v[252:255], v[104:107], v[168:171]
v_mov_b32 v127, 0x3f80
v_fmac_f32 v164, v68, v56
v_fmac_f32 v165, v69, v56
v_fmac_f32 v166, v70, v56
v_mfma_f32_16x16x32_bf16 v[128:131], v[244:247], v[104:107], v[128:131]
v_fmac_f32 v167, v71, v56
v_mul_f32 v164, v164, v72
v_mul_f32 v165, v165, v73
v_mul_f32 v166, v166, v74
v_mfma_f32_16x16x32_bf16 v[148:151], v[104:107], v[248:251], v[148:151]
v_mul_f32 v167, v167, v75
v_cvt_pk_bf16_f32 v158, v164, v165
v_cvt_pk_bf16_f32 v159, v166, v167
v_mul_f32 v38, 0x3eae1a93, v29
s_waitcnt lgkmcnt(0)
s_barrier
v_mfma_f32_16x16x32_bf16 v[88:91], v[132:135], v[112:115], v[8:11]
s_lshl_b32 s0, s77, 11
s_add_u32 m0, s0, 73728
s_sub_u32 s18, s18, s62
s_add_u32 s18, s18, s0
s_add_u32 s19, s18, 2301952
buffer_load_dwordx4 v5, s[24:27], s19 offen offset:0 sc1 lds
v_mfma_f32_16x16x32_bf16 v[92:95], v[136:139], v[116:119], v[8:11]
buffer_load_dwordx4 v5, s[24:27], s19 offen offset:1024 sc1 lds
buffer_load_dwordx4 v5, s[24:27], s19 offen offset:2048 sc1 lds
v_fmac_f32 v168, v52, v28
v_fmac_f32 v169, v53, v28
v_mfma_f32_16x16x32_bf16 v[96:99], v[140:143], v[120:123], v[8:11]
v_fmac_f32 v170, v54, v28
v_fmac_f32 v171, v55, v28
v_fmac_f32 v128, v48, v28
v_fmac_f32 v129, v49, v28
v_mfma_f32_16x16x32_bf16 v[100:103], v[144:147], v[124:127], v[8:11]
v_fmac_f32 v130, v50, v28
v_fmac_f32 v131, v51, v28
v_mul_f32 v170, v170, v38
v_mul_f32 v171, v171, v38
v_mfma_f32_16x16x16_bf16 v[172:175], v[114:115], v[14:15], 0
v_mul_f32 v128, v128, v38
v_mul_f32 v129, v129, v38
v_mul_f32 v130, v130, v38
v_mfma_f32_16x16x16_bf16 v[176:179], v[118:119], v[14:15], 0
v_mul_f32 v131, v131, v38
v_mul_f32 v168, v168, v29
v_mul_f32 v169, v169, v29
v_mfma_f32_16x16x16_bf16 v[180:183], v[122:123], v[14:15], 0
v_cvt_pk_bf16_f32 v128, v128, v129
v_cvt_pk_bf16_f32 v129, v130, v131
v_cvt_pk_bf16_f32 v130, v170, v171
v_mfma_f32_16x16x16_bf16 v[184:187], v[126:127], v[14:15], 0
v_mov_b32 v131, 0
v_cvt_pk_bf16_f32 v110, v168, v169
v_mov_b32 v111, 0x3f80
s_nop 1
v_mfma_f32_16x16x16_bf16 v[168:171], v[110:111], v[14:15], 0
v_fmac_f32 v148, v76, v56
v_fmac_f32 v149, v77, v56
v_mfma_f32_16x16x32_bf16 v[108:111], v[128:131], v[112:115], v[8:11]
v_fmac_f32 v150, v78, v56
v_fmac_f32 v151, v79, v56
v_mfma_f32_16x16x32_bf16 v[112:115], v[132:135], v[116:119], v[8:11]
v_mul_f32 v148, v148, v80
v_mul_f32 v149, v149, v81
v_mfma_f32_16x16x32_bf16 v[116:119], v[136:139], v[120:123], v[8:11]
v_mul_f32 v150, v150, v82
v_mul_f32 v151, v151, v83
v_mfma_f32_16x16x32_bf16 v[120:123], v[140:143], v[124:127], v[8:11]
v_cvt_pk_bf16_f32 v151, v150, v151
v_cvt_pk_bf16_f32 v150, v148, v149
L_patched:
s_cbranch_execz L_pw
v_pk_add_f32 v[108:109], v[108:109], s[72:73]
v_pk_add_f32 v[110:111], v[110:111], s[72:73]
v_cndmask_b32 v88, v108, v88, s[64:65]
v_cndmask_b32 v89, v109, v89, s[66:67]
v_cndmask_b32 v90, v110, v90, s[68:69]
v_cndmask_b32 v91, v111, v91, s[70:71]
v_max3_f32 v84, v88, v89, v90
v_max_f32 v84, v84, v91
v_cndmask_b32 v92, v112, v92, s[64:65]
v_cndmask_b32 v93, v113, v93, s[66:67]
v_cndmask_b32 v94, v114, v94, s[68:69]
v_cndmask_b32 v95, v115, v95, s[70:71]
v_max3_f32 v85, v92, v93, v94
v_max_f32 v85, v85, v95
v_cndmask_b32 v96, v116, v96, s[64:65]
v_cndmask_b32 v97, v117, v97, s[66:67]
v_cndmask_b32 v98, v118, v98, s[68:69]
v_cndmask_b32 v99, v119, v99, s[70:71]
v_max3_f32 v86, v96, v97, v98
v_max_f32 v86, v86, v99
v_cndmask_b32 v100, v120, v100, s[64:65]
v_cndmask_b32 v101, v121, v101, s[66:67]
v_cndmask_b32 v102, v122, v102, s[68:69]
v_cndmask_b32 v103, v123, v103, s[70:71]
v_max3_f32 v87, v100, v101, v102
v_max_f32 v87, v87, v103
v_permlane32_swap_b32 v84, v85
v_cvt_pk_bf16_f32 v168, v168, v169
v_permlane32_swap_b32 v86, v87
v_max_f32 v84, v84, v85
v_max_f32 v86, v86, v87
v_cvt_pk_bf16_f32 v169, v170, v171
v_cvt_pk_bf16_f32 v170, v172, v173
v_permlane16_swap_b32 v84, v86
v_max_f32 v84, v84, v86
v_mov_b32 v86, v84
v_cvt_pk_bf16_f32 v171, v174, v175
v_cvt_pk_bf16_f32 v172, v176, v177
v_permlane16_swap_b32 v84, v86
v_mov_b32 v85, v84
v_mov_b32 v87, v86
v_cvt_pk_bf16_f32 v173, v178, v179
v_permlane32_swap_b32 v84, v85
v_permlane32_swap_b32 v86, v87
v_cvt_pk_bf16_f32 v174, v180, v181
v_cvt_pk_bf16_f32 v175, v182, v183
v_cvt_pk_bf16_f32 v176, v184, v185
v_cvt_pk_bf16_f32 v177, v186, v187
v_pk_add_f32 v[88:89], v[88:89], v[84:85] op_sel:[0,0] op_sel_hi:[1,0] neg_lo:[0,1] neg_hi:[0,1]
v_pk_add_f32 v[90:91], v[90:91], v[84:85] op_sel:[0,0] op_sel_hi:[1,0] neg_lo:[0,1] neg_hi:[0,1]
v_pk_add_f32 v[92:93], v[92:93], v[84:85] op_sel:[0,1] op_sel_hi:[1,1] neg_lo:[0,1] neg_hi:[0,1]
v_pk_add_f32 v[94:95], v[94:95], v[84:85] op_sel:[0,1] op_sel_hi:[1,1] neg_lo:[0,1] neg_hi:[0,1]
v_pk_add_f32 v[96:97], v[96:97], v[86:87] op_sel:[0,0] op_sel_hi:[1,0] neg_lo:[0,1] neg_hi:[0,1]
v_pk_add_f32 v[98:99], v[98:99], v[86:87] op_sel:[0,0] op_sel_hi:[1,0] neg_lo:[0,1] neg_hi:[0,1]
v_pk_add_f32 v[100:101], v[100:101], v[86:87] op_sel:[0,1] op_sel_hi:[1,1] neg_lo:[0,1] neg_hi:[0,1]
v_pk_add_f32 v[102:103], v[102:103], v[86:87] op_sel:[0,1] op_sel_hi:[1,1] neg_lo:[0,1] neg_hi:[0,1]
v_exp_f32 v88, v88
v_exp_f32 v89, v89
v_exp_f32 v90, v90
v_exp_f32 v91, v91
v_cvt_pk_bf16_f32 v130, v88, v89
v_cvt_pk_bf16_f32 v131, v90, v91
v_bfi_b32 v128, v12, 0, v130
v_bfi_b32 v129, v13, 0, v131
v_and_b32 v130, v12, v130
v_and_b32 v131, v13, v131
v_exp_f32 v92, v92
v_exp_f32 v93, v93
v_mfma_f32_16x16x32_bf16 v[68:71], v[168:171], v[128:131], 0
v_exp_f32 v94, v94
v_mfma_f32_16x16x32_bf16 v[88:91], v[150:153], v[128:131], 0
v_exp_f32 v95, v95
v_cvt_pk_bf16_f32 v134, v92, v93
v_cvt_pk_bf16_f32 v135, v94, v95
v_bfi_b32 v132, v12, 0, v134
v_bfi_b32 v133, v13, 0, v135
v_and_b32 v134, v12, v134
v_and_b32 v135, v13, v135
v_exp_f32 v96, v96
v_exp_f32 v97, v97
v_mfma_f32_16x16x32_bf16 v[72:75], v[170:173], v[132:135], 0
v_exp_f32 v98, v98
v_mfma_f32_16x16x32_bf16 v[92:95], v[152:155], v[132:135], 0
v_exp_f32 v99, v99
v_cvt_pk_bf16_f32 v138, v96, v97
v_cvt_pk_bf16_f32 v139, v98, v99
v_bfi_b32 v136, v12, 0, v138
v_bfi_b32 v137, v13, 0, v139
v_and_b32 v138, v12, v138
v_and_b32 v139, v13, v139
v_exp_f32 v100, v100
v_exp_f32 v101, v101
v_mfma_f32_16x16x32_bf16 v[76:79], v[172:175], v[136:139], 0
v_exp_f32 v102, v102
v_mfma_f32_16x16x32_bf16 v[96:99], v[154:157], v[136:139], 0
v_exp_f32 v103, v103
v_cvt_pk_bf16_f32 v142, v100, v101
v_cvt_pk_bf16_f32 v143, v102, v103
v_bfi_b32 v140, v12, 0, v142
v_bfi_b32 v141, v13, 0, v143
v_and_b32 v142, v12, v142
v_and_b32 v143, v13, v143
v_rcp_f32 v70, v70
v_rcp_f32 v74, v74
v_mfma_f32_16x16x32_bf16 v[80:83], v[174:177], v[140:143], 0
v_rcp_f32 v78, v78
v_mfma_f32_16x16x32_bf16 v[100:103], v[156:159], v[140:143], 0
s_mul_i32 s7, s77, 252
s_sub_u32 s7, s87, s7
s_add_u32 s6, s86, 32768
v_pk_mul_f32 v[88:89], v[88:89], v[70:71] op_sel_hi:[1,0]
v_pk_mul_f32 v[90:91], v[90:91], v[70:71] op_sel_hi:[1,0]
v_pk_mul_f32 v[68:69], v[68:69], v[70:71] op_sel_hi:[1,0]
v_cvt_pk_bf16_f32 v108, v88, v89
v_cvt_pk_bf16_f32 v109, v90, v91
v_cvt_pk_bf16_f32 v116, v68, v69
v_pk_mul_f32 v[92:93], v[92:93], v[74:75] op_sel_hi:[1,0]
v_pk_mul_f32 v[94:95], v[94:95], v[74:75] op_sel_hi:[1,0]
v_pk_mul_f32 v[72:73], v[72:73], v[74:75] op_sel_hi:[1,0]
v_cvt_pk_bf16_f32 v110, v92, v93
v_cvt_pk_bf16_f32 v111, v94, v95
v_cvt_pk_bf16_f32 v117, v72, v73
v_rcp_f32 v82, v82
v_pk_mul_f32 v[96:97], v[96:97], v[78:79] op_sel_hi:[1,0]
v_pk_mul_f32 v[98:99], v[98:99], v[78:79] op_sel_hi:[1,0]
v_pk_mul_f32 v[76:77], v[76:77], v[78:79] op_sel_hi:[1,0]
v_cvt_pk_bf16_f32 v112, v96, v97
v_cvt_pk_bf16_f32 v113, v98, v99
v_cvt_pk_bf16_f32 v118, v76, v77
v_permlane16_swap_b32 v108, v110
v_permlane16_swap_b32 v109, v111
buffer_store_dwordx4 v[108:111], v17, s[24:27], s86 offen
v_pk_mul_f32 v[100:101], v[100:101], v[82:83] op_sel_hi:[1,0]
v_pk_mul_f32 v[102:103], v[102:103], v[82:83] op_sel_hi:[1,0]
v_pk_mul_f32 v[80:81], v[80:81], v[82:83] op_sel_hi:[1,0]
v_cvt_pk_bf16_f32 v114, v100, v101
v_cvt_pk_bf16_f32 v115, v102, v103
v_cvt_pk_bf16_f32 v119, v80, v81
v_mov_b32_dpp v116, v117 quad_perm:[0,1,2,3] row_mask:2 bank_mask:0xf
s_nop 1
v_mov_b32_dpp v116, v118 quad_perm:[0,1,2,3] row_mask:4 bank_mask:0xf
v_permlane16_swap_b32 v112, v114
v_permlane16_swap_b32 v113, v115
v_mov_b32_dpp v116, v119 quad_perm:[0,1,2,3] row_mask:8 bank_mask:0xf
buffer_store_dwordx4 v[112:115], v17, s[24:27], s6 offen
buffer_store_dword v116, v5, s[24:27], s7 offen
s_add_u32 s63, s80, 1
s_lshl_b32 s3, s77, 6
s_add_u32 s3, s3, 160832
v_lshl_add_u32 v22, v6, 2, s3
ds_read2_b32 v[184:185], v22 offset0:0 offset1:80
v_lshlrev_b32 v26, 10, v7
v_lshl_add_u32 v26, v6, 4, v26
s_lshl_b32 s3, s77, 14
s_add_u32 s3, s3, s84
s_lshl_b32 s5, s77, 8
s_add_u32 s5, s5, s84
s_add_u32 s5, s5, 65536
s_add_u32 s6, s5, 4096
v_add_u32 v180, 41472, v5
v_and_b32 v181, 7, v0
v_lshlrev_b32 v181, 4, v181
v_lshl_add_u32 v181, v7, 7, v181
v_add_u32 v182, 41472, v181
v_lshlrev_b32 v28, 16, v58
v_and_b32 v29, 0xffff0000, v58
s_waitcnt lgkmcnt(0)
v_pk_fma_f32 v[28:29], v[28:29], v[184:185], v[184:185] op_sel:[0,0,1] op_sel_hi:[1,0,1]
v_lshlrev_b32 v30, 16, v59
v_and_b32 v31, 0xffff0000, v59
v_pk_fma_f32 v[30:31], v[30:31], v[184:185], v[184:185] op_sel:[0,0,1] op_sel_hi:[1,0,1]
v_lshlrev_b32 v32, 16, v60
v_and_b32 v33, 0xffff0000, v60
v_pk_fma_f32 v[32:33], v[32:33], v[184:185], v[184:185] op_sel:[0,0,1] op_sel_hi:[1,0,1]
v_lshlrev_b32 v34, 16, v61
v_and_b32 v35, 0xffff0000, v61
v_pk_fma_f32 v[34:35], v[34:35], v[184:185], v[184:185] op_sel:[0,0,1] op_sel_hi:[1,0,1]
v_lshlrev_b32 v36, 16, v62
v_and_b32 v37, 0xffff0000, v62
v_pk_fma_f32 v[36:37], v[36:37], v[184:185], v[184:185] op_sel:[0,0,1] op_sel_hi:[1,0,1]
v_lshlrev_b32 v38, 16, v63
v_and_b32 v39, 0xffff0000, v63
v_pk_fma_f32 v[38:39], v[38:39], v[184:185], v[184:185] op_sel:[0,0,1] op_sel_hi:[1,0,1]
v_lshlrev_b32 v40, 16, v64
v_and_b32 v41, 0xffff0000, v64
v_pk_fma_f32 v[40:41], v[40:41], v[184:185], v[184:185] op_sel:[0,0,1] op_sel_hi:[1,0,1]
v_lshlrev_b32 v42, 16, v65
v_and_b32 v43, 0xffff0000, v65
v_pk_fma_f32 v[42:43], v[42:43], v[184:185], v[184:185] op_sel:[0,0,1] op_sel_hi:[1,0,1]
v_lshlrev_b32 v44, 16, v66
v_and_b32 v45, 0xffff0000, v66
v_pk_fma_f32 v[44:45], v[44:45], v[184:185], v[184:185] op_sel:[0,0,1] op_sel_hi:[1,0,1]
v_lshlrev_b32 v46, 16, v67
v_and_b32 v47, 0xffff0000, v67
v_pk_fma_f32 v[46:47], v[46:47], v[184:185], v[184:185] op_sel:[0,0,1] op_sel_hi:[1,0,1]
s_waitcnt vmcnt(3)
s_barrier
ds_read_b128 v[68:71], v180 offset:32256
ds_read_b128 v[72:75], v180 offset:33280
ds_read_b128 v[76:79], v180 offset:34304
ds_read_b128 v[80:83], v180 offset:35328
ds_read_b128 v[84:87], v182 offset:36352
ds_read_b128 v[88:91], v180 offset:36864
ds_read_b128 v[92:95], v180 offset:37888
ds_read_b128 v[96:99], v180 offset:38912
s_waitcnt vmcnt(0)
buffer_load_dwordx4 v[172:175], v26, s[24:27], s5 offen sc1
buffer_load_dwordx4 v[176:179], v26, s[24:27], s6 offen sc1
s_add_u32 s4, s3, 0
buffer_load_dwordx4 v[108:111], v5, s[24:27], s4 offen offset:0 sc1
buffer_load_dwordx4 v[112:115], v5, s[24:27], s4 offen offset:1024 sc1
ds_read_b128 v[100:103], v180 offset:39936
ds_read_b128 v[104:107], v182 offset:40960
ds_read_b128 v[224:227], v5 offset:0
ds_read_b128 v[228:231], v5 offset:1024
ds_read_b128 v[232:235], v5 offset:2048
ds_read_b128 v[236:239], v5 offset:3072
ds_read_b128 v[240:243], v181 offset:4096
ds_read_b128 v[244:247], v5 offset:4608
ds_read_b128 v[248:251], v5 offset:5632
ds_read_b128 v[252:255], v5 offset:6656
ds_read_b128 a[0:3], v5 offset:7680
ds_read_b128 a[4:7], v181 offset:8704
ds_read_b128 a[8:11], v5 offset:9216
ds_read_b128 a[12:15], v5 offset:10240
ds_read_b128 a[16:19], v5 offset:11264
ds_read_b128 a[20:23], v5 offset:12288
ds_read_b128 a[24:27], v181 offset:13312
L_48:
s_waitcnt vmcnt(3)
v_max_u32 v183, v172, v173
v_max3_u32 v183, v183, v174, v175
s_waitcnt vmcnt(2)
v_max3_u32 v183, v183, v176, v177
v_max3_u32 v183, v183, v178, v179
v_cmp_eq_u32 vcc, -1, v183
s_cbranch_vccz L_51
L_50:
s_sub_u32 s82, s82, 1
s_cbranch_scc1 L_exit
s_waitcnt vmcnt(0)
buffer_load_dwordx4 v[172:175], v26, s[24:27], s5 offen sc1
buffer_load_dwordx4 v[176:179], v26, s[24:27], s6 offen sc1
s_add_u32 s4, s3, 0
buffer_load_dwordx4 v[108:111], v5, s[24:27], s4 offen offset:0 sc1
buffer_load_dwordx4 v[112:115], v5, s[24:27], s4 offen offset:1024 sc1
s_waitcnt vmcnt(0)
s_branch L_48
L_51:
buffer_load_dwordx4 v[116:119], v5, s[24:27], s4 offen offset:2048 sc1
buffer_load_dwordx4 v[120:123], v5, s[24:27], s4 offen offset:3072 sc1
s_add_u32 s4, s3, 4096
buffer_load_dwordx4 v[124:127], v5, s[24:27], s4 offen offset:0 sc1
buffer_load_dwordx4 v[128:131], v5, s[24:27], s4 offen offset:1024 sc1
ds_read_b128 a[28:31], v5 offset:13824
s_waitcnt lgkmcnt(15)
v_mfma_f32_16x16x32_bf16 v[28:31], v[68:71], v[172:175], v[28:31]
buffer_load_dwordx4 v[132:135], v5, s[24:27], s4 offen offset:2048 sc1
ds_read_b128 v[68:71], v5 offset:14848
v_mfma_f32_16x16x32_bf16 v[32:35], v[72:75], v[172:175], v[32:35]
s_mul_i32 s7, s76, 144
s_add_u32 s7, s7, 162560
v_lshl_add_u32 v22, v7, 4, s7
ds_read_b128 v[72:75], v5 offset:15872
v_mfma_f32_16x16x32_bf16 v[36:39], v[76:79], v[172:175], v[36:39]
v_and_b32 v23, 1, v7
v_lshl_add_u32 v23, v23, 3, s7
ds_read_b128 v[76:79], v5 offset:16896
v_mfma_f32_16x16x32_bf16 v[40:43], v[80:83], v[172:175], v[40:43]
ds_read_b128 v[48:51], v22
ds_read_b128 v[80:83], v181 offset:17920
v_mfma_f32_16x16x32_bf16 v[44:47], v[84:87], v[172:175], v[44:47]
ds_read_b128 v[52:55], v22 offset:64
ds_read_b128 v[84:87], v5 offset:18432
v_mfma_f32_16x16x32_bf16 v[28:31], v[88:91], v[176:179], v[28:31]
buffer_load_dwordx4 v[136:139], v5, s[24:27], s4 offen offset:3072 sc1
ds_read_b128 v[88:91], v5 offset:19456
v_mfma_f32_16x16x32_bf16 v[32:35], v[92:95], v[176:179], v[32:35]
ds_read_b64 v[56:57], v23 offset:128
ds_read_b128 v[92:95], v5 offset:20480
v_mfma_f32_16x16x32_bf16 v[36:39], v[96:99], v[176:179], v[36:39]
v_mul_u32_u24 v1, 2304, v6
ds_read_b128 v[96:99], v5 offset:21504
v_mfma_f32_16x16x32_bf16 v[40:43], v[100:103], v[176:179], v[40:43]
v_lshl_add_u32 v1, v7, 4, v1
ds_read_b128 v[100:103], v181 offset:22528
v_mfma_f32_16x16x32_bf16 v[44:47], v[104:107], v[176:179], v[44:47]
ds_read_b128 v[104:107], v5 offset:23040
s_waitcnt vmcnt(7)
v_mfma_f32_16x16x32_bf16 v[28:31], v[224:227], v[108:111], v[28:31]
s_add_u32 s4, s3, 8192
buffer_load_dwordx4 v[140:143], v5, s[24:27], s4 offen offset:0 sc1
ds_read_b128 v[224:227], v5 offset:24064
s_waitcnt lgkmcnt(15)
v_mfma_f32_16x16x32_bf16 v[32:35], v[228:231], v[108:111], v[32:35]
ds_read_b128 v[228:231], v5 offset:25088
v_mfma_f32_16x16x32_bf16 v[36:39], v[232:235], v[108:111], v[36:39]
v_max3_u32 v183, v183, v108, v109
ds_read_b128 v[232:235], v5 offset:26112
v_mfma_f32_16x16x32_bf16 v[40:43], v[236:239], v[108:111], v[40:43]
v_max3_u32 v183, v183, v110, v111
ds_read_b128 v[236:239], v181 offset:27136
v_mfma_f32_16x16x32_bf16 v[44:47], v[240:243], v[108:111], v[44:47]
ds_read_b128 v[240:243], v5 offset:27648
s_waitcnt vmcnt(7)
v_mfma_f32_16x16x32_bf16 v[28:31], v[244:247], v[112:115], v[28:31]
buffer_load_dwordx4 v[144:147], v5, s[24:27], s4 offen offset:1024 sc1
ds_read_b128 v[244:247], v5 offset:28672
v_mfma_f32_16x16x32_bf16 v[32:35], v[248:251], v[112:115], v[32:35]
ds_read_b128 v[248:251], v5 offset:29696
v_mfma_f32_16x16x32_bf16 v[36:39], v[252:255], v[112:115], v[36:39]
v_max3_u32 v183, v183, v112, v113
ds_read_b128 v[252:255], v5 offset:30720
v_mfma_f32_16x16x32_bf16 v[40:43], a[0:3], v[112:115], v[40:43]
v_max3_u32 v183, v183, v114, v115
ds_read_b128 a[0:3], v181 offset:31744
v_mfma_f32_16x16x32_bf16 v[44:47], a[4:7], v[112:115], v[44:47]
ds_read_b128 a[4:7], v5 offset:32256
s_waitcnt vmcnt(7)
v_mfma_f32_16x16x32_bf16 v[28:31], a[8:11], v[116:119], v[28:31]
buffer_load_dwordx4 v[148:151], v5, s[24:27], s4 offen offset:2048 sc1
ds_read_b128 a[8:11], v5 offset:33280
v_mfma_f32_16x16x32_bf16 v[32:35], a[12:15], v[116:119], v[32:35]
ds_read_b128 a[12:15], v5 offset:34304
v_mfma_f32_16x16x32_bf16 v[36:39], a[16:19], v[116:119], v[36:39]
v_max3_u32 v183, v183, v116, v117
ds_read_b128 a[16:19], v5 offset:35328
v_mfma_f32_16x16x32_bf16 v[40:43], a[20:23], v[116:119], v[40:43]
v_max3_u32 v183, v183, v118, v119
ds_read_b128 a[20:23], v181 offset:36352
v_mfma_f32_16x16x32_bf16 v[44:47], a[24:27], v[116:119], v[44:47]
ds_read_b128 a[24:27], v5 offset:36864
s_waitcnt vmcnt(7) lgkmcnt(15)
v_mfma_f32_16x16x32_bf16 v[28:31], a[28:31], v[120:123], v[28:31]
buffer_load_dwordx4 v[152:155], v5, s[24:27], s4 offen offset:3072 sc1
ds_read_b128 a[28:31], v5 offset:37888
v_mfma_f32_16x16x32_bf16 v[32:35], v[68:71], v[120:123], v[32:35]
ds_read_b128 v[68:71], v5 offset:38912
v_mfma_f32_16x16x32_bf16 v[36:39], v[72:75], v[120:123], v[36:39]
v_max3_u32 v183, v183, v120, v121
ds_read_b128 v[72:75], v5 offset:39936
v_mfma_f32_16x16x32_bf16 v[40:43], v[76:79], v[120:123], v[40:43]
v_max3_u32 v183, v183, v122, v123
ds_read_b128 v[76:79], v181 offset:40960
v_mfma_f32_16x16x32_bf16 v[44:47], v[80:83], v[120:123], v[44:47]
ds_read_b128 v[80:83], v180 offset:0
s_waitcnt vmcnt(7)
v_mfma_f32_16x16x32_bf16 v[28:31], v[84:87], v[124:127], v[28:31]
s_add_u32 s4, s3, 12288
buffer_load_dwordx4 v[156:159], v5, s[24:27], s4 offen offset:0 sc1
ds_read_b128 v[84:87], v180 offset:1024
v_mfma_f32_16x16x32_bf16 v[32:35], v[88:91], v[124:127], v[32:35]
ds_read_b128 v[88:91], v180 offset:2048
v_mfma_f32_16x16x32_bf16 v[36:39], v[92:95], v[124:127], v[36:39]
v_max3_u32 v183, v183, v124, v125
ds_read_b128 v[92:95], v180 offset:3072
v_mfma_f32_16x16x32_bf16 v[40:43], v[96:99], v[124:127], v[40:43]
v_max3_u32 v183, v183, v126, v127
ds_read_b128 v[96:99], v182 offset:4096
v_mfma_f32_16x16x32_bf16 v[44:47], v[100:103], v[124:127], v[44:47]
ds_read_b128 v[100:103], v180 offset:4608
s_waitcnt vmcnt(7)
v_mfma_f32_16x16x32_bf16 v[28:31], v[104:107], v[128:131], v[28:31]
buffer_load_dwordx4 v[160:163], v5, s[24:27], s4 offen offset:1024 sc1
ds_read_b128 v[104:107], v180 offset:5632
s_waitcnt lgkmcnt(15)
v_mfma_f32_16x16x32_bf16 v[32:35], v[224:227], v[128:131], v[32:35]
ds_read_b128 v[224:227], v180 offset:6656
v_mfma_f32_16x16x32_bf16 v[36:39], v[228:231], v[128:131], v[36:39]
v_max3_u32 v183, v183, v128, v129
ds_read_b128 v[228:231], v180 offset:7680
v_mfma_f32_16x16x32_bf16 v[40:43], v[232:235], v[128:131], v[40:43]
v_max3_u32 v183, v183, v130, v131
ds_read_b128 v[232:235], v182 offset:8704
v_mfma_f32_16x16x32_bf16 v[44:47], v[236:239], v[128:131], v[44:47]
ds_read_b128 v[236:239], v180 offset:9216
s_waitcnt vmcnt(7)
v_mfma_f32_16x16x32_bf16 v[28:31], v[240:243], v[132:135], v[28:31]
buffer_load_dwordx4 v[164:167], v5, s[24:27], s4 offen offset:2048 sc1
ds_read_b128 v[240:243], v180 offset:10240
v_mfma_f32_16x16x32_bf16 v[32:35], v[244:247], v[132:135], v[32:35]
ds_read_b128 v[244:247], v180 offset:11264
v_mfma_f32_16x16x32_bf16 v[36:39], v[248:251], v[132:135], v[36:39]
v_max3_u32 v183, v183, v132, v133
ds_read_b128 v[248:251], v180 offset:12288
v_mfma_f32_16x16x32_bf16 v[40:43], v[252:255], v[132:135], v[40:43]
v_max3_u32 v183, v183, v134, v135
ds_read_b128 v[252:255], v182 offset:13312
v_mfma_f32_16x16x32_bf16 v[44:47], a[0:3], v[132:135], v[44:47]
ds_read_b128 a[0:3], v180 offset:13824
s_waitcnt vmcnt(7)
v_mfma_f32_16x16x32_bf16 v[28:31], a[4:7], v[136:139], v[28:31]
buffer_load_dwordx4 v[168:171], v5, s[24:27], s4 offen offset:3072 sc1
ds_read_b128 a[4:7], v180 offset:14848
v_mfma_f32_16x16x32_bf16 v[32:35], a[8:11], v[136:139], v[32:35]
ds_read_b128 a[8:11], v180 offset:15872
s_waitcnt lgkmcnt(15)
v_mfma_f32_16x16x32_bf16 v[36:39], a[12:15], v[136:139], v[36:39]
v_max3_u32 v183, v183, v136, v137
ds_read_b128 a[12:15], v180 offset:16896
v_mfma_f32_16x16x32_bf16 v[40:43], a[16:19], v[136:139], v[40:43]
v_max3_u32 v183, v183, v138, v139
ds_read_b128 a[16:19], v182 offset:17920
v_mfma_f32_16x16x32_bf16 v[44:47], a[20:23], v[136:139], v[44:47]
ds_read_b128 a[20:23], v180 offset:18432
s_waitcnt vmcnt(7)
v_mfma_f32_16x16x32_bf16 v[28:31], a[24:27], v[140:143], v[28:31]
ds_read_b128 a[24:27], v180 offset:19456
v_mfma_f32_16x16x32_bf16 v[32:35], a[28:31], v[140:143], v[32:35]
ds_read_b128 a[28:31], v180 offset:20480
v_mfma_f32_16x16x32_bf16 v[36:39], v[68:71], v[140:143], v[36:39]
v_max3_u32 v183, v183, v140, v141
ds_read_b128 v[68:71], v180 offset:21504
v_mfma_f32_16x16x32_bf16 v[40:43], v[72:75], v[140:143], v[40:43]
v_max3_u32 v183, v183, v142, v143
ds_read_b128 v[72:75], v182 offset:22528
v_mfma_f32_16x16x32_bf16 v[44:47], v[76:79], v[140:143], v[44:47]
ds_read_b128 v[76:79], v180 offset:23040
s_waitcnt vmcnt(6)
v_mfma_f32_16x16x32_bf16 v[28:31], v[80:83], v[144:147], v[28:31]
ds_read_b128 v[80:83], v180 offset:24064
v_mfma_f32_16x16x32_bf16 v[32:35], v[84:87], v[144:147], v[32:35]
ds_read_b128 v[84:87], v180 offset:25088
v_mfma_f32_16x16x32_bf16 v[36:39], v[88:91], v[144:147], v[36:39]
v_max3_u32 v183, v183, v144, v145
ds_read_b128 v[88:91], v180 offset:26112
s_waitcnt lgkmcnt(15)
v_mfma_f32_16x16x32_bf16 v[40:43], v[92:95], v[144:147], v[40:43]
v_max3_u32 v183, v183, v146, v147
ds_read_b128 v[92:95], v182 offset:27136
v_mfma_f32_16x16x32_bf16 v[44:47], v[96:99], v[144:147], v[44:47]
ds_read_b128 v[96:99], v180 offset:27648
s_waitcnt vmcnt(5)
v_mfma_f32_16x16x32_bf16 v[28:31], v[100:103], v[148:151], v[28:31]
ds_read_b128 v[100:103], v180 offset:28672
v_mfma_f32_16x16x32_bf16 v[32:35], v[104:107], v[148:151], v[32:35]
ds_read_b128 v[104:107], v180 offset:29696
v_mfma_f32_16x16x32_bf16 v[36:39], v[224:227], v[148:151], v[36:39]
v_max3_u32 v183, v183, v148, v149
ds_read_b128 v[224:227], v180 offset:30720
v_mfma_f32_16x16x32_bf16 v[40:43], v[228:231], v[148:151], v[40:43]
v_max3_u32 v183, v183, v150, v151
ds_read_b128 v[228:231], v182 offset:31744
v_mfma_f32_16x16x32_bf16 v[44:47], v[232:235], v[148:151], v[44:47]
s_waitcnt vmcnt(4)
v_mfma_f32_16x16x32_bf16 v[28:31], v[236:239], v[152:155], v[28:31]
v_mfma_f32_16x16x32_bf16 v[32:35], v[240:243], v[152:155], v[32:35]
v_mfma_f32_16x16x32_bf16 v[36:39], v[244:247], v[152:155], v[36:39]
v_max3_u32 v183, v183, v152, v153
v_mfma_f32_16x16x32_bf16 v[40:43], v[248:251], v[152:155], v[40:43]
v_max3_u32 v183, v183, v154, v155
s_waitcnt lgkmcnt(15)
v_mfma_f32_16x16x32_bf16 v[44:47], v[252:255], v[152:155], v[44:47]
s_waitcnt vmcnt(3)
v_mfma_f32_16x16x32_bf16 v[28:31], a[0:3], v[156:159], v[28:31]
v_mfma_f32_16x16x32_bf16 v[32:35], a[4:7], v[156:159], v[32:35]
v_mfma_f32_16x16x32_bf16 v[36:39], a[8:11], v[156:159], v[36:39]
v_max3_u32 v183, v183, v156, v157
v_mfma_f32_16x16x32_bf16 v[40:43], a[12:15], v[156:159], v[40:43]
v_max3_u32 v183, v183, v158, v159
v_mfma_f32_16x16x32_bf16 v[44:47], a[16:19], v[156:159], v[44:47]
s_waitcnt vmcnt(2) lgkmcnt(14)
v_mfma_f32_16x16x32_bf16 v[28:31], a[20:23], v[160:163], v[28:31]
s_waitcnt lgkmcnt(13)
v_mfma_f32_16x16x32_bf16 v[32:35], a[24:27], v[160:163], v[32:35]
s_waitcnt lgkmcnt(12)
v_mfma_f32_16x16x32_bf16 v[36:39], a[28:31], v[160:163], v[36:39]
v_max3_u32 v183, v183, v160, v161
s_waitcnt lgkmcnt(11)
v_mfma_f32_16x16x32_bf16 v[40:43], v[68:71], v[160:163], v[40:43]
v_max3_u32 v183, v183, v162, v163
s_waitcnt lgkmcnt(10)
v_mfma_f32_16x16x32_bf16 v[44:47], v[72:75], v[160:163], v[44:47]
s_waitcnt vmcnt(1) lgkmcnt(9)
v_mfma_f32_16x16x32_bf16 v[28:31], v[76:79], v[164:167], v[28:31]
s_waitcnt lgkmcnt(8)
v_mfma_f32_16x16x32_bf16 v[32:35], v[80:83], v[164:167], v[32:35]
s_waitcnt lgkmcnt(7)
v_mfma_f32_16x16x32_bf16 v[36:39], v[84:87], v[164:167], v[36:39]
v_max3_u32 v183, v183, v164, v165
s_waitcnt lgkmcnt(6)
v_mfma_f32_16x16x32_bf16 v[40:43], v[88:91], v[164:167], v[40:43]
v_max3_u32 v183, v183, v166, v167
s_waitcnt lgkmcnt(5)
v_mfma_f32_16x16x32_bf16 v[44:47], v[92:95], v[164:167], v[44:47]
s_waitcnt vmcnt(0) lgkmcnt(4)
v_mfma_f32_16x16x32_bf16 v[28:31], v[96:99], v[168:171], v[28:31]
s_waitcnt lgkmcnt(3)
v_mfma_f32_16x16x32_bf16 v[32:35], v[100:103], v[168:171], v[32:35]
s_waitcnt lgkmcnt(2)
v_mfma_f32_16x16x32_bf16 v[36:39], v[104:107], v[168:171], v[36:39]
v_max3_u32 v183, v183, v168, v169
s_waitcnt lgkmcnt(1)
v_mfma_f32_16x16x32_bf16 v[40:43], v[224:227], v[168:171], v[40:43]
v_max3_u32 v183, v183, v170, v171
s_waitcnt lgkmcnt(0)
v_mfma_f32_16x16x32_bf16 v[44:47], v[228:231], v[168:171], v[44:47]
v_cmp_eq_u32 vcc, -1, v183
s_cbranch_vccnz L_49
s_mov_b32 s3, 1065369472
v_cvt_pk_bf16_f32 v108, v28, v29
v_cvt_pk_bf16_f32 v109, v30, v31
v_cvt_pk_bf16_f32 v110, v32, v33
v_cvt_pk_bf16_f32 v111, v34, v35
v_cvt_pk_bf16_f32 v112, v36, v37
v_cvt_pk_bf16_f32 v113, v38, v39
v_cvt_pk_bf16_f32 v114, v40, v41
v_cvt_pk_bf16_f32 v115, v42, v43
v_cvt_pk_bf16_f32 v116, v44, v45
v_cvt_pk_bf16_f32 v117, v46, v47
v_dot2_f32_bf16 v120, v108, s3, 0
v_dot2_f32_bf16 v121, v108, v108, 0
v_dot2_f32_bf16 v122, v108, v48, 0
s_mov_b32 exec_hi, 0
v_dot2_f32_bf16 v120, v116, s3, v120
v_dot2_f32_bf16 v121, v116, v116, v121
v_dot2_f32_bf16 v122, v116, v56, v122
v_dot2_f32_bf16 v120, v117, s3, v120
v_dot2_f32_bf16 v121, v117, v117, v121
v_dot2_f32_bf16 v122, v117, v57, v122
s_mov_b64 exec, -1
v_dot2_f32_bf16 v120, v109, s3, v120
L_pad6:
s_cbranch_execz L_pad9
v_dot2_f32_bf16 v121, v109, v109, v121
v_dot2_f32_bf16 v122, v109, v49, v122
v_dot2_f32_bf16 v120, v110, s3, v120
v_dot2_f32_bf16 v121, v110, v110, v121
v_dot2_f32_bf16 v122, v110, v50, v122
v_dot2_f32_bf16 v120, v111, s3, v120
v_dot2_f32_bf16 v121, v111, v111, v121
v_dot2_f32_bf16 v122, v111, v51, v122
v_dot2_f32_bf16 v120, v112, s3, v120
v_dot2_f32_bf16 v121, v112, v112, v121
v_dot2_f32_bf16 v122, v112, v52, v122
v_dot2_f32_bf16 v120, v113, s3, v120
v_dot2_f32_bf16 v121, v113, v113, v121
v_dot2_f32_bf16 v122, v113, v53, v122
v_dot2_f32_bf16 v120, v114, s3, v120
v_dot2_f32_bf16 v121, v114, v114, v121
v_dot2_f32_bf16 v122, v114, v54, v122
v_dot2_f32_bf16 v120, v115, s3, v120
v_dot2_f32_bf16 v121, v115, v115, v121
v_dot2_f32_bf16 v122, v115, v55, v122
v_mov_b32 v123, s63
v_permlane32_swap_b32 v120, v124
v_permlane32_swap_b32 v121, v125
v_permlane32_swap_b32 v122, v126
v_add_f32 v120, v120, v124
v_add_f32 v121, v121, v125
v_add_f32 v122, v122, v126
v_permlane16_swap_b32 v120, v124
v_permlane16_swap_b32 v121, v125
v_permlane16_swap_b32 v122, v126
v_add_f32 v120, v120, v124
v_add_f32 v121, v121, v125
v_add_f32 v122, v122, v126
s_mov_b64 exec, 65535
buffer_store_dwordx4 v[120:123], v5, s[24:27], s88 offen
s_mov_b64 exec, -1
s_lshl_b32 s4, s77, 8
s_add_u32 s4, s4, s84
s_add_u32 s4, s4, 73728
s_add_u32 s5, s4, 4096
s_waitcnt vmcnt(0)
buffer_load_dwordx4 v[128:131], v26, s[24:27], s4 offen sc1
buffer_load_dwordx4 v[132:135], v26, s[24:27], s5 offen sc1
v_and_b32 v78, 31, v0
v_lshlrev_b32 v78, 8, v78
v_mov_b32 v175, 163792
ds_read_b32 v175, v175
v_lshlrev_b32 v22, 4, v7
v_mov_b32 v139, s80
s_lshl_b32 s3, s77, 4
v_or_b32 v141, s3, v6
s_add_u32 s3, s3, 163728
v_mov_b32 v23, s3
v_and_b32 v173, 3, v0
v_lshlrev_b32 v173, 4, v173
v_add_u32 v173, 163728, v173
v_lshrrev_b32 v174, 2, v0
v_lshlrev_b32 v174, 13, v174
s_lshl_b32 s3, s78, 8
s_add_u32 s3, s3, 2949120
s_mov_b32 s7, -64
v_mov_b32 v176, 163796
v_mov_b32 v177, 1
s_branch C_52
R_53:
s_sub_u32 s82, s82, 1
s_cbranch_scc1 L_exit
s_waitcnt vmcnt(0)
buffer_load_dwordx4 v[128:131], v26, s[24:27], s4 offen sc1
buffer_load_dwordx4 v[132:135], v26, s[24:27], s5 offen sc1
s_waitcnt vmcnt(0)
C_52:
s_waitcnt vmcnt(1)
v_cmp_ne_u32 s[52:53], s63, v131
s_waitcnt vmcnt(0)
v_cmp_ne_u32 vcc, s63, v135
s_or_b64 vcc, vcc, s[52:53]
s_cbranch_vccnz R_53
s_lshl_b32 s0, s77, 5
s_add_u32 s0, s0, s75
s_cmp_lt_u32 s0, 18
s_cbranch_scc0 L_54
s_lshl_b32 s1, s74, 13
s_add_u32 s1, s1, 2949120
s_not_b32 exec_lo, s8
s_mov_b32 exec_hi, 0
buffer_load_dwordx4 v[68:71], v78, s[44:47], s1 offen sc1
s_mov_b64 exec, -1
L_54:
v_add_f32 v128, v128, v132
v_add_f32 v129, v129, v133
v_add_f32 v130, v130, v134
v_mov_b32 v132, v128
v_mov_b32 v133, v129
v_mov_b32 v134, v130
v_permlane32_swap_b32 v128, v132
v_permlane32_swap_b32 v129, v133
v_permlane32_swap_b32 v130, v134
v_add_f32 v128, v128, v132
v_add_f32 v129, v129, v133
v_add_f32 v130, v130, v134
v_mov_b32 v132, v128
v_mov_b32 v133, v129
v_mov_b32 v134, v130
v_permlane16_swap_b32 v128, v132
v_permlane16_swap_b32 v129, v133
v_permlane16_swap_b32 v130, v134
v_add_f32 v128, v128, v132
v_add_f32 v129, v129, v133
v_add_f32 v130, v130, v134
v_mul_f32 v128, 0xbae38e39, v128
v_mul_f32 v129, 0x3ae38e39, v129
v_fma_f32 v129, -v128, v128, v129
v_max_f32 v129, 0, v129
v_add_f32 v132, 0x3727c5ac, v129
v_rsq_f32 v131, v132
s_waitcnt lgkmcnt(0)
v_fma_f32 v136, v128, v175, v130
v_mul_f32 v136, v136, v131
v_ashrrev_i32 v140, 31, v136
v_lshrrev_b32 v140, 1, v140
v_xor_b32 v136, v136, v140
v_and_or_b32 v136, v136, s7, v141
v_mov_b32 v142, v131
v_mul_f32 v143, v128, v131
v_max_i32_dpp v140, v136, v136 row_ror:8 row_mask:0xf bank_mask:0xf
v_mul_f32 v138, v132, v131
v_sub_f32 v137, 0, v128
v_max_i32_dpp v140, v140, v140 row_ror:4 row_mask:0xf bank_mask:0xf
v_pk_fma_f32 v[164:165], v[44:45], v[142:143], v[142:143] op_sel:[0,0,1] op_sel_hi:[1,0,1]
v_pk_fma_f32 v[166:167], v[46:47], v[142:143], v[142:143] op_sel:[0,0,1] op_sel_hi:[1,0,1]
v_max_i32_dpp v140, v140, v140 row_ror:2 row_mask:0xf bank_mask:0xf
v_pk_fma_f32 v[148:149], v[28:29], v[142:143], v[142:143] op_sel:[0,0,1] op_sel_hi:[1,0,1]
v_pk_fma_f32 v[150:151], v[30:31], v[142:143], v[142:143] op_sel:[0,0,1] op_sel_hi:[1,0,1]
v_max_i32_dpp v140, v140, v140 row_ror:1 row_mask:0xf bank_mask:0xf
v_cmp_eq_u32 s[54:55], v136, v140
v_pk_fma_f32 v[152:153], v[32:33], v[142:143], v[142:143] op_sel:[0,0,1] op_sel_hi:[1,0,1]
v_pk_fma_f32 v[154:155], v[34:35], v[142:143], v[142:143] op_sel:[0,0,1] op_sel_hi:[1,0,1]
s_and_b64 exec, s[54:55], 0xffff
ds_write_b128 v23, v[136:139]
ds_add_rtn_u32 v176, v176, v177
s_mov_b64 exec, -1
ds_read_b128 v[168:171], v173
v_pk_fma_f32 v[156:157], v[36:37], v[142:143], v[142:143] op_sel:[0,0,1] op_sel_hi:[1,0,1]
v_pk_fma_f32 v[158:159], v[38:39], v[142:143], v[142:143] op_sel:[0,0,1] op_sel_hi:[1,0,1]
v_pk_fma_f32 v[160:161], v[40:41], v[142:143], v[142:143] op_sel:[0,0,1] op_sel_hi:[1,0,1]
v_pk_fma_f32 v[162:163], v[42:43], v[142:143], v[142:143] op_sel:[0,0,1] op_sel_hi:[1,0,1]
s_cmp_eq_u32 s76, 0
s_cbranch_scc0 L_55
s_waitcnt lgkmcnt(1)
v_cmp_eq_u32 vcc, 7, v176
s_cbranch_vccz L_56
s_waitcnt lgkmcnt(0)
v_max_i32_dpp v172, v168, v168 quad_perm:[1,0,3,2] row_mask:0xf bank_mask:0xf
s_nop 1
v_max_i32_dpp v172, v172, v172 quad_perm:[2,3,0,1] row_mask:0xf bank_mask:0xf
v_cmp_eq_u32 vcc, v168, v172
s_mov_b32 exec_hi, 0
s_mov_b32 exec_lo, vcc_lo
buffer_store_dwordx4 v[168:171], v174, s[44:47], s3 offen sc1
s_mov_b64 exec, -1
L_56:
L_55:
v_cvt_pk_bf16_f32 v116, v164, v165
v_cvt_pk_bf16_f32 v117, v166, v167
v_cvt_pk_bf16_f32 v108, v148, v149
v_cvt_pk_bf16_f32 v109, v150, v151
v_cvt_pk_bf16_f32 v110, v152, v153
v_cvt_pk_bf16_f32 v111, v154, v155
v_cvt_pk_bf16_f32 v112, v156, v157
v_cvt_pk_bf16_f32 v113, v158, v159
v_cvt_pk_bf16_f32 v114, v160, v161
v_cvt_pk_bf16_f32 v115, v162, v163
v_permlane16_swap_b32 v116, v118
v_permlane16_swap_b32 v117, v119
s_mov_b64 exec, s[54:55]
buffer_store_dwordx4 v[108:111], v22, s[44:47], s89 offen offset:640 sc1
buffer_store_dwordx4 v[112:115], v22, s[44:47], s89 offen offset:704 sc1
s_and_b64 exec, s[54:55], 0xffff
buffer_store_dwordx4 v[116:119], v22, s[44:47], s89 offen offset:768 sc1
s_mov_b64 exec, -1
s_lshl_b32 s0, s77, 5
s_add_u32 s0, s0, s75
s_cmp_lt_u32 s0, 18
s_cbranch_scc0 L_57
s_waitcnt vmcnt(3)
v_cmp_ne_u32 vcc, s80, v71
v_bfrev_b32 v76, 1
s_andn2_b32 s52, vcc_lo, s8
s_or_b32 vcc_lo, vcc_lo, s8
v_cndmask_b32 v68, v68, v76, vcc
s_nop 1
v_max_i32_dpp v76, v68, v68 row_ror:8 row_mask:0xf bank_mask:0xf
v_mov_b32 v71, v0
s_nop 0
v_max_i32_dpp v76, v76, v76 row_ror:4 row_mask:0xf bank_mask:0xf
s_nop 1
v_max_i32_dpp v76, v76, v76 row_ror:2 row_mask:0xf bank_mask:0xf
s_nop 1
v_max_i32_dpp v76, v76, v76 row_ror:1 row_mask:0xf bank_mask:0xf
s_nop 0
v_readlane_b32 s3, v76, 0
v_readlane_b32 s4, v76, 16
s_max_i32 s57, s3, s4
v_cmp_eq_u32 vcc, s57, v68
s_bfe_u32 s5, s57, 0x20004
s_lshl_b32 s5, s5, 10
s_add_u32 s5, s5, 4350592
s_ff1_i32_b32 s3, vcc_lo
s_mul_i32 s4, s3, 286720
s_add_u32 s4, s4, s5
L_57:
v_add_f32 v142, 1.0, v142
v_pk_fma_f32 v[148:149], v[28:29], v[142:143], v[142:143] op_sel:[0,0,1] op_sel_hi:[1,0,1]
v_pk_fma_f32 v[150:151], v[30:31], v[142:143], v[142:143] op_sel:[0,0,1] op_sel_hi:[1,0,1]
v_pk_fma_f32 v[152:153], v[32:33], v[142:143], v[142:143] op_sel:[0,0,1] op_sel_hi:[1,0,1]
v_pk_fma_f32 v[154:155], v[34:35], v[142:143], v[142:143] op_sel:[0,0,1] op_sel_hi:[1,0,1]
v_pk_fma_f32 v[156:157], v[36:37], v[142:143], v[142:143] op_sel:[0,0,1] op_sel_hi:[1,0,1]
v_pk_fma_f32 v[158:159], v[38:39], v[142:143], v[142:143] op_sel:[0,0,1] op_sel_hi:[1,0,1]
v_pk_fma_f32 v[160:161], v[40:41], v[142:143], v[142:143] op_sel:[0,0,1] op_sel_hi:[1,0,1]
v_pk_fma_f32 v[162:163], v[42:43], v[142:143], v[142:143] op_sel:[0,0,1] op_sel_hi:[1,0,1]
v_pk_fma_f32 v[164:165], v[44:45], v[142:143], v[142:143] op_sel:[0,0,1] op_sel_hi:[1,0,1]
v_pk_fma_f32 v[166:167], v[46:47], v[142:143], v[142:143] op_sel:[0,0,1] op_sel_hi:[1,0,1]
v_cvt_pk_bf16_f32 v184, v164, v165
v_cvt_pk_bf16_f32 v185, v166, v167
s_waitcnt lgkmcnt(1)
v_cvt_pk_bf16_f32 v176, v148, v149
v_cvt_pk_bf16_f32 v177, v150, v151
v_cvt_pk_bf16_f32 v178, v152, v153
v_cvt_pk_bf16_f32 v179, v154, v155
v_cvt_pk_bf16_f32 v180, v156, v157
v_cvt_pk_bf16_f32 v181, v158, v159
v_cvt_pk_bf16_f32 v182, v160, v161
v_cvt_pk_bf16_f32 v183, v162, v163
v_permlane16_swap_b32 v184, v186
v_permlane16_swap_b32 v185, v187
s_not_b64 s[52:53], s[54:55]
s_cmp_ge_u32 s77, 1
s_cbranch_scc0 L_58
s_mov_b64 exec, s[52:53]
buffer_store_dwordx4 v[176:179], v1, s[28:31], s94 offen offset:0
buffer_store_dwordx4 v[180:183], v1, s[28:31], s94 offen offset:64
s_and_b64 exec, s[52:53], 0xffff
buffer_store_dwordx4 v[184:187], v1, s[28:31], s94 offen offset:128
s_mov_b64 exec, -1
L_58:
s_lshl_b32 s83, s75, 3
s_add_u32 s83, s83, s74
s_sub_u32 s83, s83, 192
s_cmp_lt_u32 s77, 1
s_cselect_b32 s83, s83, 99
s_mov_b32 s12, 0
s_cmp_lt_u32 s75, 18
s_cbranch_scc0 L_60
s_waitcnt lgkmcnt(0)
L_59:
s_cmp_eq_u32 s77, 0
s_cbranch_scc0 L_63
v_mul_u32_u24 v50, 7282, v0
v_lshrrev_b32 v50, 16, v50
v_mul_u32_u24 v50, 3952, v50
v_add_u32 v50, v50, v5
v_lshlrev_b32 v38, 8, v0
v_mov_b32 v44, 0
v_mov_b32 v45, 0
v_mov_b32 v46, 0
v_mov_b32 v47, 0
v_mov_b32 v37, 163712
s_lshl_b32 s1, s74, 13
s_add_u32 s1, s1, 2949120
s_not_b32 exec_lo, s8
s_mov_b32 exec_hi, 0
buffer_load_dwordx4 v[28:31], v38, s[44:47], s1 offen sc1
s_mov_b64 exec, -1
buffer_load_dwordx4 v[40:43], v50, s[44:47], s4 offen sc1
s_add_u32 s1, s4, 28688
s_mov_b64 exec, 255
buffer_load_dwordx4 v[44:47], v5, s[44:47], s1 offen sc1
s_mov_b64 exec, -1
L_63:
s_add_u32 s13, s13, 331776
v_mul_u32_u24 v26, 9216, v7
v_lshl_add_u32 v26, v6, 2, v26
s_lshl_b32 s1, s77, 4
s_add_u32 s1, s1, 158080
v_lshl_add_u32 v22, v0, 1, s1
v_lshlrev_b32 v23, 4, v7
v_add_u32 v23, 158080, v23
ds_read_b64_tr_b16 a[0:1], v24 offset:0
ds_read_b64_tr_b16 a[2:3], v24 offset:1024
ds_read_b64_tr_b16 a[4:5], v24 offset:2048
ds_read_b64_tr_b16 a[6:7], v24 offset:3072
ds_read_b64_tr_b16 a[8:9], v24 offset:4096
ds_read_b64_tr_b16 a[10:11], v24 offset:5120
ds_read_b64_tr_b16 a[12:13], v24 offset:6144
ds_read_b64_tr_b16 a[14:15], v24 offset:7168
ds_read_b64_tr_b16 a[16:17], v24 offset:8192
ds_read_b64_tr_b16 a[18:19], v24 offset:9216
ds_read_b64_tr_b16 a[20:21], v24 offset:10240
ds_read_b64_tr_b16 a[22:23], v24 offset:11264
ds_read_b64_tr_b16 a[24:25], v24 offset:12288
ds_read_b64_tr_b16 a[26:27], v24 offset:13312
ds_read_b64_tr_b16 a[28:29], v24 offset:14336
ds_read_b64_tr_b16 a[30:31], v24 offset:15360
ds_read_b64_tr_b16 a[32:33], v24 offset:16384
ds_read_b64_tr_b16 a[34:35], v24 offset:17408
ds_read_b64_tr_b16 a[36:37], v24 offset:18432
ds_read_b64_tr_b16 a[38:39], v24 offset:19456
ds_read_b64_tr_b16 a[40:41], v24 offset:20480
ds_read_b64_tr_b16 a[42:43], v24 offset:21504
ds_read_b64_tr_b16 a[44:45], v24 offset:22528
ds_read_b64_tr_b16 a[46:47], v24 offset:23552
ds_read_b64_tr_b16 a[48:49], v24 offset:24576
ds_read_b64_tr_b16 a[50:51], v24 offset:25600
ds_read_b64_tr_b16 a[52:53], v24 offset:26624
ds_read_b64_tr_b16 a[54:55], v24 offset:27648
ds_read_b64_tr_b16 a[56:57], v24 offset:28672
ds_read_b64_tr_b16 a[58:59], v24 offset:29696
ds_read_b64_tr_b16 a[60:61], v24 offset:30720
ds_read_b64_tr_b16 a[62:63], v24 offset:31744
ds_read_b64_tr_b16 a[64:65], v24 offset:32768
ds_read_b64_tr_b16 a[66:67], v24 offset:33792
ds_read_b64_tr_b16 a[68:69], v24 offset:34816
ds_read_b64_tr_b16 a[70:71], v24 offset:35840
s_cmp_eq_u32 s77, 0
s_cbranch_scc0 L_64
s_mov_b32 s52, -1
s_branch C_65
R_66:
s_sub_u32 s82, s82, 1
s_cbranch_scc1 L_exit
s_waitcnt vmcnt(0)
s_lshl_b32 s1, s74, 13
s_add_u32 s1, s1, 2949120
s_mov_b32 exec_lo, s52
s_mov_b32 exec_hi, 0
buffer_load_dwordx4 v[28:31], v38, s[44:47], s1 offen sc1
s_mov_b64 exec, -1
buffer_load_dwordx4 v[40:43], v50, s[44:47], s4 offen sc1
s_add_u32 s1, s4, 28688
s_mov_b64 exec, 255
buffer_load_dwordx4 v[44:47], v5, s[44:47], s1 offen sc1
s_mov_b64 exec, -1
s_waitcnt vmcnt(0)
C_65:
s_mov_b32 s9, s4
s_waitcnt vmcnt(2)
v_cmp_ne_u32 vcc, s80, v31
v_bfrev_b32 v36, 1
s_and_b32 vcc_lo, vcc_lo, s52
s_andn2_b32 s52, vcc_lo, s8
s_or_b32 vcc_lo, vcc_lo, s8
v_cndmask_b32 v28, v28, v36, vcc
s_nop 1
v_max_i32_dpp v36, v28, v28 row_ror:8 row_mask:0xf bank_mask:0xf
v_mov_b32 v31, v0
s_nop 0
v_max_i32_dpp v36, v36, v36 row_ror:4 row_mask:0xf bank_mask:0xf
s_nop 1
v_max_i32_dpp v36, v36, v36 row_ror:2 row_mask:0xf bank_mask:0xf
s_nop 1
v_max_i32_dpp v36, v36, v36 row_ror:1 row_mask:0xf bank_mask:0xf
s_nop 0
v_readlane_b32 s3, v36, 0
v_readlane_b32 s4, v36, 16
s_max_i32 s57, s3, s4
v_cmp_eq_u32 vcc, s57, v28
s_bfe_u32 s5, s57, 0x20004
s_lshl_b32 s5, s5, 10
s_add_u32 s5, s5, 4350592
s_ff1_i32_b32 s3, vcc_lo
s_mul_i32 s4, s3, 286720
s_add_u32 s4, s4, s5
s_waitcnt vmcnt(1)
v_max_u32 v48, v40, v41
v_max3_u32 v48, v48, v42, v43
s_waitcnt vmcnt(0)
v_max3_u32 v48, v48, v44, v45
v_max3_u32 v48, v48, v46, v47
v_cmp_eq_u32 vcc, -1, v48
s_xor_b32 s9, s9, s4
s_or_b32 s9, s9, vcc_lo
s_or_b32 s9, s9, vcc_hi
s_cbranch_scc1 R_66
v_add_u32 v48, 161408, v5
ds_write_b128 v48, v[40:43]
s_mov_b64 exec, 255
ds_write_b128 v48, v[44:47] offset:1024
s_mov_b64 exec, -1
s_lshl_b64 exec, 1, s3
ds_write_b128 v37, v[28:31]
s_mov_b64 exec, -1
s_cmp_lg_u32 s52, 0
s_cbranch_scc0 L_68
s_waitcnt lgkmcnt(0)
P_67:
s_sub_u32 s82, s82, 1
s_cbranch_scc1 L_exit
s_lshl_b32 s1, s74, 13
s_add_u32 s1, s1, 2949120
s_mov_b32 exec_lo, s52
s_mov_b32 exec_hi, 0
buffer_load_dwordx4 v[28:31], v38, s[44:47], s1 offen sc1
s_mov_b64 exec, -1
s_waitcnt vmcnt(0)
v_cmp_eq_u32 vcc, s80, v31
s_and_b32 s9, vcc_lo, s52
v_cmp_le_i32 vcc, s57, v28
s_and_b32 vcc_lo, vcc_lo, s9
s_cbranch_scc1 C_65
s_andn2_b32 s52, s52, s9
s_cbranch_scc1 P_67
L_68:
L_64:
s_waitcnt lgkmcnt(0)
s_barrier
v_mov_b32 v112, 163712
ds_read_b128 v[108:111], v112
ds_read_b128 v[68:71], v25 offset:0
ds_read_b128 v[72:75], v25 offset:192
ds_read_b128 v[76:79], v25 offset:384
ds_read_b128 v[80:83], v25 offset:576
ds_read_b128 v[84:87], v25 offset:768
ds_read_b128 v[88:91], v25 offset:960
s_waitcnt lgkmcnt(5)
v_mfma_f32_16x16x32_bf16 v[28:31], v[68:71], a[0:3], 0
v_mfma_f32_16x16x32_bf16 v[32:35], v[68:71], a[4:7], 0
v_mfma_f32_16x16x32_bf16 v[36:39], v[68:71], a[8:11], 0
s_waitcnt lgkmcnt(4)
v_mfma_f32_16x16x32_bf16 v[28:31], v[72:75], a[12:15], v[28:31]
v_mfma_f32_16x16x32_bf16 v[32:35], v[72:75], a[16:19], v[32:35]
v_mfma_f32_16x16x32_bf16 v[36:39], v[72:75], a[20:23], v[36:39]
s_waitcnt lgkmcnt(3)
v_mfma_f32_16x16x32_bf16 v[28:31], v[76:79], a[24:27], v[28:31]
v_mfma_f32_16x16x32_bf16 v[32:35], v[76:79], a[28:31], v[32:35]
v_mfma_f32_16x16x32_bf16 v[36:39], v[76:79], a[32:35], v[36:39]
s_waitcnt lgkmcnt(2)
v_mfma_f32_16x16x32_bf16 v[28:31], v[80:83], a[36:39], v[28:31]
v_mfma_f32_16x16x32_bf16 v[32:35], v[80:83], a[40:43], v[32:35]
v_mfma_f32_16x16x32_bf16 v[36:39], v[80:83], a[44:47], v[36:39]
s_waitcnt lgkmcnt(1)
v_mfma_f32_16x16x32_bf16 v[28:31], v[84:87], a[48:51], v[28:31]
s_cmp_eq_u32 s77, 0
s_cbranch_scc0 L_69
v_and_b32 v78, 31, v0
v_lshlrev_b32 v78, 8, v78
v_mov_b32 v77, 163712
s_lshl_b32 s1, s74, 13
s_add_u32 s1, s1, 2949120
s_mov_b32 exec_hi, 0
buffer_load_dwordx4 v[68:71], v78, s[44:47], s1 offen sc1
s_mov_b64 exec, -1
L_69:
v_mfma_f32_16x16x32_bf16 v[32:35], v[84:87], a[52:55], v[32:35]
v_mfma_f32_16x16x32_bf16 v[36:39], v[84:87], a[56:59], v[36:39]
s_waitcnt lgkmcnt(0)
v_mfma_f32_16x16x32_bf16 v[28:31], v[88:91], a[60:63], v[28:31]
v_mfma_f32_16x16x32_bf16 v[32:35], v[88:91], a[64:67], v[32:35]
v_mfma_f32_16x16x32_bf16 v[36:39], v[88:91], a[68:71], v[36:39]
s_nop 6
v_add_f32 v28, v28, v33
v_add_f32 v28, v28, v38
v_mul_f32 v29, 0xbfb8aa3b, v28
v_exp_f32 v29, v29
v_mul_f32_dpp v28, v28, v28 row_ror:8 row_mask:0xf bank_mask:0xf
v_add_f32 v29, 1.0, v29
v_rcp_f32 v29, v29
s_mov_b64 exec, 0xff
v_mul_f32 v28, v28, v29
v_cvt_pk_bf16_f32 v28, v28, v28
ds_write_b16 v22, v28
s_mov_b64 exec, -1
s_waitcnt lgkmcnt(0)
s_barrier
ds_read_b128 v[28:31], v23
s_waitcnt lgkmcnt(0)
v_mfma_f32_16x16x32_bf16 v[32:35], v[28:31], v[188:191], 0
v_mfma_f32_16x16x32_bf16 v[36:39], v[28:31], v[192:195], 0
v_mfma_f32_16x16x32_bf16 v[40:43], v[28:31], v[196:199], 0
v_mfma_f32_16x16x32_bf16 v[44:47], v[28:31], v[200:203], 0
v_mfma_f32_16x16x32_bf16 v[48:51], v[28:31], v[204:207], 0
s_nop 4
v_mov_b32_dpp v32, v36 quad_perm:[0,1,2,3] row_mask:2 bank_mask:0xf
v_mfma_f32_16x16x32_bf16 v[52:55], v[28:31], v[208:211], 0
s_nop 0
v_mov_b32_dpp v32, v40 quad_perm:[0,1,2,3] row_mask:4 bank_mask:0xf
v_mfma_f32_16x16x32_bf16 v[56:59], v[28:31], v[212:215], 0
s_nop 0
v_mov_b32_dpp v32, v44 quad_perm:[0,1,2,3] row_mask:8 bank_mask:0xf
buffer_store_dword v32, v26, s[24:27], s13 offen sc1
s_add_u32 s1, s13, 36864
v_mfma_f32_16x16x32_bf16 v[60:63], v[28:31], v[216:219], 0
v_mfma_f32_16x16x32_bf16 v[64:67], v[28:31], v[220:223], 0
v_mov_b32_dpp v48, v52 quad_perm:[0,1,2,3] row_mask:2 bank_mask:0xf
s_nop 1
v_mov_b32_dpp v48, v56 quad_perm:[0,1,2,3] row_mask:4 bank_mask:0xf
s_nop 2
v_mov_b32_dpp v48, v60 quad_perm:[0,1,2,3] row_mask:8 bank_mask:0xf
buffer_store_dword v48, v26, s[24:27], s1 offen sc1
s_add_u32 s1, s13, 73728
s_mov_b64 exec, 0xffff
buffer_store_dword v64, v26, s[24:27], s1 offen sc1
s_mov_b64 exec, -1
v_readfirstlane_b32 s57, v108
v_readfirstlane_b32 s58, v109
v_readfirstlane_b32 s59, v110
v_readfirstlane_b32 s56, v111
s_mov_b32 s11, s57
s_mov_b32 s10, s56
s_cmp_eq_u32 s77, 0
s_cbranch_scc0 L_70
s_branch C_71
R_72:
s_sub_u32 s82, s82, 1
s_cbranch_scc1 L_exit
s_waitcnt vmcnt(0)
s_lshl_b32 s1, s74, 13
s_add_u32 s1, s1, 2949120
s_mov_b32 exec_lo, vcc_lo
s_mov_b32 exec_hi, 0
buffer_load_dwordx4 v[68:71], v78, s[44:47], s1 offen sc1
s_mov_b64 exec, -1
s_waitcnt vmcnt(0)
C_71:
s_waitcnt vmcnt(3)
v_cmp_ne_u32 vcc, s80, v71
s_mov_b32 vcc_hi, 0
s_cbranch_vccnz R_72
s_mov_b32 s6, s5
v_max_i32_dpp v76, v68, v68 row_ror:8 row_mask:0xf bank_mask:0xf
v_mov_b32 v71, v0
s_nop 0
v_max_i32_dpp v76, v76, v76 row_ror:4 row_mask:0xf bank_mask:0xf
s_nop 1
v_max_i32_dpp v76, v76, v76 row_ror:2 row_mask:0xf bank_mask:0xf
s_nop 1
v_max_i32_dpp v76, v76, v76 row_ror:1 row_mask:0xf bank_mask:0xf
s_nop 0
v_readlane_b32 s3, v76, 0
v_readlane_b32 s4, v76, 16
s_max_i32 s57, s3, s4
v_cmp_eq_u32 vcc, s57, v68
s_bfe_u32 s5, s57, 0x20004
s_lshl_b32 s5, s5, 10
s_add_u32 s5, s5, 4350592
s_ff1_i32_b32 s3, vcc_lo
s_mul_i32 s4, s3, 286720
s_add_u32 s4, s4, s5
s_mov_b32 s5, s6
s_lshl_b64 exec, 1, s3
ds_write_b128 v77, v[68:71]
s_mov_b64 exec, -1
L_70:
s_waitcnt lgkmcnt(0)
s_barrier
s_mov_b32 s6, s5
v_mov_b32 v72, 163712
s_waitcnt vmcnt(3)
ds_read_b128 v[68:71], v72
s_waitcnt lgkmcnt(0)
v_readfirstlane_b32 s57, v68
v_readfirstlane_b32 s58, v69
v_readfirstlane_b32 s59, v70
v_readfirstlane_b32 s56, v71
s_sub_u32 s3, s56, s78
s_lshl_b32 s3, s3, 6
s_and_b32 s5, s57, 63
s_add_u32 s3, s3, 16
s_add_u32 s60, s3, s5
s_mov_b32 s5, s6
s_cmp_eq_u64 s[10:11], s[56:57]
s_cbranch_scc0 L_62
s_branch L_61
L_60:
s_cmp_eq_u32 s77, 0
s_cbranch_scc0 L_73
v_mul_u32_u24 v50, 7282, v0
v_lshrrev_b32 v50, 16, v50
v_mul_u32_u24 v50, 3952, v50
v_add_u32 v50, v50, v5
v_lshlrev_b32 v38, 8, v0
v_mov_b32 v44, 0
v_mov_b32 v45, 0
v_mov_b32 v46, 0
v_mov_b32 v47, 0
v_mov_b32 v37, 163712
s_mov_b32 vcc_lo, -1
P_74:
s_sub_u32 s82, s82, 1
s_cbranch_scc1 L_exit
s_lshl_b32 s1, s74, 13
s_add_u32 s1, s1, 2949120
s_mov_b32 exec_lo, vcc_lo
s_mov_b32 exec_hi, 0
buffer_load_dwordx4 v[28:31], v38, s[44:47], s1 offen sc1
s_mov_b64 exec, -1
s_waitcnt vmcnt(0)
v_cmp_ne_u32 vcc, s80, v31
s_mov_b32 vcc_hi, 0
s_cbranch_vccnz P_74
v_max_i32_dpp v36, v28, v28 row_ror:8 row_mask:0xf bank_mask:0xf
v_mov_b32 v31, v0
s_nop 0
v_max_i32_dpp v36, v36, v36 row_ror:4 row_mask:0xf bank_mask:0xf
s_nop 1
v_max_i32_dpp v36, v36, v36 row_ror:2 row_mask:0xf bank_mask:0xf
s_nop 1
v_max_i32_dpp v36, v36, v36 row_ror:1 row_mask:0xf bank_mask:0xf
s_nop 0
v_readlane_b32 s3, v36, 0
v_readlane_b32 s4, v36, 16
s_max_i32 s57, s3, s4
v_cmp_eq_u32 vcc, s57, v28
s_bfe_u32 s5, s57, 0x20004
s_lshl_b32 s5, s5, 10
s_add_u32 s5, s5, 4350592
s_ff1_i32_b32 s3, vcc_lo
s_mul_i32 s4, s3, 286720
s_add_u32 s4, s4, s5
s_lshl_b64 exec, 1, s3
ds_write_b128 v37, v[28:31]
s_mov_b64 exec, -1
L_73:
s_waitcnt lgkmcnt(0)
s_barrier
v_mov_b32 v32, 163712
ds_read_b128 v[28:31], v32
s_waitcnt lgkmcnt(0)
v_readfirstlane_b32 s57, v28
v_readfirstlane_b32 s58, v29
v_readfirstlane_b32 s59, v30
v_readfirstlane_b32 s56, v31
s_sub_u32 s3, s56, s78
s_lshl_b32 s3, s3, 6
s_and_b32 s5, s57, 63
s_add_u32 s3, s3, 16
s_add_u32 s60, s3, s5
L_61:
s_cmp_lt_u32 s77, 1
s_cselect_b64 s[52:53], -1, s[54:55]
s_lshr_b32 s3, s60, 4
s_sub_u32 s3, s3, 1
s_cmp_eq_u32 s3, s77
s_cselect_b64 s[54:55], s[54:55], 0
s_andn2_b64 s[52:53], s[52:53], s[54:55]
s_cbranch_scc0 L_75
s_mov_b64 exec, s[52:53]
buffer_store_dwordx4 v[176:179], v1, s[28:31], s94 offen offset:0
buffer_store_dwordx4 v[180:183], v1, s[28:31], s94 offen offset:64
s_and_b64 exec, s[52:53], 0xffff
buffer_store_dwordx4 v[184:187], v1, s[28:31], s94 offen offset:128
s_mov_b64 exec, -1
L_75:
s_cmp_lt_u32 s83, 36
s_cbranch_scc0 L_76
s_or_b32 s3, s83, s77
s_cmp_eq_u32 s3, 0
s_cbranch_scc0 L_77
s_mov_b64 exec, 1
v_mov_b32 v24, s80
buffer_store_dword v24, v5, s[24:27], 0 offen sc1
s_mov_b64 exec, -1
L_77:
s_bitcmp1_b32 s8, s56
s_cselect_b32 s12, 331776, 0
s_bfe_u32 s5, s57, 0x20004
s_lshl_b32 s5, s5, 10
s_add_u32 s5, s5, 4350592
s_mul_i32 s4, s56, 286720
s_add_u32 s4, s4, s5
s_mul_i32 s5, s83, 9216
v_and_b32 v23, 3, v0
v_lshrrev_b32 v22, 5, v0
v_lshl_add_u32 v23, v23, 1, v22
v_mov_b32 v22, s59
v_add_f32 v22, 1.0, v22
v_lshlrev_b32 v23, 2, v23
s_lshl_b32 s6, s83, 5
v_add_u32 v26, s6, v23
v_lshrrev_b32 v27, 4, v26
v_mul_u32_u24 v27, 7282, v27
v_lshrrev_b32 v27, 16, v27
v_mul_u32_u24 v27, 3952, v27
v_add_u32 v27, v27, v26
s_ashr_i32 s3, s57, 31
s_lshr_b32 s3, s3, 1
s_xor_b32 s3, s3, s57
v_mov_b32 v26, 0xbfb8aa3b
v_mul_f32 v26, s3, v26
v_exp_f32 v26, v26
s_nop 0
v_add_f32 v26, 1.0, v26
v_rcp_f32 v26, v26
s_add_u32 s5, s5, s12
s_and_b32 s3, s56, 15
s_lshl_b32 s3, s3, 6
s_and_b32 s7, s57, 63
s_add_u32 s3, s3, s7
s_lshl_b32 s3, s3, 1
s_lshr_b32 s7, s56, 4
s_add_u32 s3, s3, s7
s_mul_i32 s3, s3, 36
s_add_u32 s3, s3, s83
s_lshl_b32 s7, s3, 5
s_mov_b64 vcc, -1
P_78:
s_sub_u32 s82, s82, 1
s_cbranch_scc1 L_exit
s_mov_b64 exec, vcc
buffer_load_dword v64, v27, s[44:47], s4 offen sc1
s_add_u32 s1, s5, 3477504
buffer_load_dwordx4 v[28:31], v5, s[24:27], s1 offen offset:0 sc1
buffer_load_dwordx4 v[32:35], v5, s[24:27], s1 offen offset:1024 sc1
buffer_load_dwordx4 v[36:39], v5, s[24:27], s1 offen offset:2048 sc1
buffer_load_dwordx4 v[40:43], v5, s[24:27], s1 offen offset:3072 sc1
s_add_u32 s1, s5, 3481600
buffer_load_dwordx4 v[44:47], v5, s[24:27], s1 offen offset:0 sc1
buffer_load_dwordx4 v[48:51], v5, s[24:27], s1 offen offset:1024 sc1
buffer_load_dwordx4 v[52:55], v5, s[24:27], s1 offen offset:2048 sc1
buffer_load_dwordx4 v[56:59], v5, s[24:27], s1 offen offset:3072 sc1
s_add_u32 s1, s5, 3485696
buffer_load_dwordx4 v[60:63], v5, s[24:27], s1 offen offset:0 sc1
s_waitcnt vmcnt(8)
v_max3_u32 v66, v64, v28, v29
v_max3_u32 v66, v66, v30, v31
s_waitcnt vmcnt(7)
v_max3_u32 v66, v66, v32, v33
v_max3_u32 v66, v66, v34, v35
v_pk_add_f32 v[28:29], v[28:29], v[32:33]
v_pk_add_f32 v[30:31], v[30:31], v[34:35]
s_waitcnt vmcnt(6)
v_max3_u32 v66, v66, v36, v37
v_max3_u32 v66, v66, v38, v39
v_pk_add_f32 v[28:29], v[28:29], v[36:37]
v_pk_add_f32 v[30:31], v[30:31], v[38:39]
s_waitcnt vmcnt(5)
v_max3_u32 v66, v66, v40, v41
v_max3_u32 v66, v66, v42, v43
v_pk_add_f32 v[28:29], v[28:29], v[40:41]
v_pk_add_f32 v[30:31], v[30:31], v[42:43]
s_waitcnt vmcnt(4)
v_max3_u32 v66, v66, v44, v45
v_max3_u32 v66, v66, v46, v47
v_pk_add_f32 v[28:29], v[28:29], v[44:45]
v_pk_add_f32 v[30:31], v[30:31], v[46:47]
s_waitcnt vmcnt(3)
v_max3_u32 v66, v66, v48, v49
v_max3_u32 v66, v66, v50, v51
v_pk_add_f32 v[28:29], v[28:29], v[48:49]
v_pk_add_f32 v[30:31], v[30:31], v[50:51]
s_waitcnt vmcnt(2)
v_max3_u32 v66, v66, v52, v53
v_max3_u32 v66, v66, v54, v55
v_pk_add_f32 v[28:29], v[28:29], v[52:53]
v_pk_add_f32 v[30:31], v[30:31], v[54:55]
s_waitcnt vmcnt(1)
v_max3_u32 v66, v66, v56, v57
v_max3_u32 v66, v66, v58, v59
v_pk_add_f32 v[28:29], v[28:29], v[56:57]
v_pk_add_f32 v[30:31], v[30:31], v[58:59]
s_waitcnt vmcnt(0)
v_max3_u32 v66, v66, v60, v61
v_max3_u32 v66, v66, v62, v63
v_cmp_eq_u32 vcc, -1, v66
v_pk_add_f32 v[28:29], v[28:29], v[60:61]
v_pk_add_f32 v[30:31], v[30:31], v[62:63]
s_cbranch_vccnz P_78
s_mov_b64 exec, -1
L_pad7:
s_cbranch_execz L_padret
v_lshlrev_b32 v36, 16, v64
v_and_b32 v37, 0xffff0000, v64
v_permlane32_swap_b32 v28, v30
v_permlane32_swap_b32 v29, v31
v_pk_add_f32 v[28:29], v[28:29], v[30:31]
v_fma_f32 v36, v36, v22, s58
v_fma_f32 v37, v37, v22, s58
v_permlane16_swap_b32 v28, v30
v_permlane16_swap_b32 v29, v31
v_pk_add_f32 v[28:29], v[28:29], v[30:31]
s_nop 1
v_add_f32_dpp v28, v28, v28 row_ror:8 row_mask:0xf bank_mask:0xf
v_add_f32_dpp v29, v29, v29 row_ror:8 row_mask:0xf bank_mask:0xf
s_nop 0
v_add_f32_dpp v28, v28, v28 row_ror:4 row_mask:0xf bank_mask:0xf
v_add_f32_dpp v29, v29, v29 row_ror:4 row_mask:0xf bank_mask:0xf
s_mov_b32 exec_lo, 0xf
s_mov_b32 exec_hi, 0xf
v_fma_f32 v28, v28, v26, v36
v_fma_f32 v29, v29, v26, v37
v_cvt_pk_bf16_f32 v28, v28, v29
buffer_store_dword v28, v23, s[28:31], s7 offen
s_mov_b64 exec, -1
L_79:
s_mov_b64 exec, -1
L_76:
s_endpgm
L_patch:
L_pad8:
s_cbranch_execz L_padret
s_waitcnt lgkmcnt(0)
s_barrier
ds_read_b128 v[76:79], v23 offset:64
ds_read_b128 v[80:83], v23 offset:384
ds_read_b128 v[68:71], v23 offset:128
ds_read_b128 v[72:75], v23 offset:448
s_mul_i32 s18, s76, 82944
s_add_u32 s18, s18, s62
s_add_u32 m0, s62, 0
s_add_u32 s19, s18, 2228224
buffer_load_dwordx4 v5, s[24:27], s19 offen offset:0 sc1 lds
v_mul_f32 v39, 0x3eae1a93, v31
v_mul_f32 v40, 0x3eae1a93, v33
v_mul_f32 v41, 0x3eae1a93, v35
v_mul_f32 v42, 0x3eae1a93, v37
v_pk_fma_f32 v[172:173], v[52:53], v[30:31], v[172:173] op_sel_hi:[1,0,1]
v_pk_fma_f32 v[174:175], v[54:55], v[30:31], v[174:175] op_sel_hi:[1,0,1]
v_pk_fma_f32 v[132:133], v[48:49], v[30:31], v[132:133] op_sel_hi:[1,0,1]
v_pk_fma_f32 v[134:135], v[50:51], v[30:31], v[134:135] op_sel_hi:[1,0,1]
v_pk_mul_f32 v[174:175], v[174:175], v[38:39] op_sel:[0,1] op_sel_hi:[1,1]
v_pk_mul_f32 v[132:133], v[132:133], v[38:39] op_sel:[0,1] op_sel_hi:[1,1]
buffer_load_dwordx4 v5, s[24:27], s19 offen offset:1024 sc1 lds
v_pk_mul_f32 v[134:135], v[134:135], v[38:39] op_sel:[0,1] op_sel_hi:[1,1]
v_pk_mul_f32 v[172:173], v[172:173], v[30:31] op_sel:[0,1] op_sel_hi:[1,1]
v_cvt_pk_bf16_f32 v132, v132, v133
v_cvt_pk_bf16_f32 v133, v134, v135
v_cvt_pk_bf16_f32 v134, v174, v175
v_mov_b32 v135, 0
v_pk_fma_f32 v[112:113], v[44:45], v[30:31], v[112:113] op_sel_hi:[1,0,1]
v_pk_fma_f32 v[114:115], v[46:47], v[30:31], v[114:115] op_sel_hi:[1,0,1]
v_pk_mul_f32 v[112:113], v[112:113], v[30:31] op_sel:[0,1] op_sel_hi:[1,1]
v_pk_mul_f32 v[114:115], v[114:115], v[30:31] op_sel:[0,1] op_sel_hi:[1,1]
buffer_load_dwordx4 v5, s[24:27], s19 offen offset:2048 sc1 lds
v_cvt_pk_bf16_f32 v112, v112, v113
v_cvt_pk_bf16_f32 v113, v114, v115
v_cvt_pk_bf16_f32 v114, v172, v173
v_mov_b32 v115, 0x3f80
s_waitcnt lgkmcnt(3)
v_pk_fma_f32 v[152:153], v[76:77], v[56:57], v[152:153] op_sel_hi:[1,0,1]
v_pk_fma_f32 v[154:155], v[78:79], v[56:57], v[154:155] op_sel_hi:[1,0,1]
s_waitcnt lgkmcnt(2)
v_pk_mul_f32 v[152:153], v[152:153], v[80:81]
v_pk_mul_f32 v[154:155], v[154:155], v[82:83]
v_cvt_pk_bf16_f32 v152, v152, v153
v_cvt_pk_bf16_f32 v153, v154, v155
buffer_load_dwordx4 v5, s[24:27], s19 offen offset:3072 sc1 lds
ds_read_b128 v[76:79], v23 offset:192
ds_read_b128 v[80:83], v23 offset:512
v_pk_fma_f32 v[176:177], v[52:53], v[32:33], v[176:177] op_sel_hi:[1,0,1]
v_pk_fma_f32 v[178:179], v[54:55], v[32:33], v[178:179] op_sel_hi:[1,0,1]
v_pk_fma_f32 v[136:137], v[48:49], v[32:33], v[136:137] op_sel_hi:[1,0,1]
v_pk_fma_f32 v[138:139], v[50:51], v[32:33], v[138:139] op_sel_hi:[1,0,1]
v_pk_mul_f32 v[178:179], v[178:179], v[40:41] op_sel:[0,0] op_sel_hi:[1,0]
v_pk_mul_f32 v[136:137], v[136:137], v[40:41] op_sel:[0,0] op_sel_hi:[1,0]
v_pk_mul_f32 v[138:139], v[138:139], v[40:41] op_sel:[0,0] op_sel_hi:[1,0]
v_pk_mul_f32 v[176:177], v[176:177], v[32:33] op_sel:[0,1] op_sel_hi:[1,1]
s_add_u32 m0, s62, 4096
s_add_u32 s19, s18, 2232320
buffer_load_dwordx4 v5, s[24:27], s19 offen offset:0 sc1 lds
v_cvt_pk_bf16_f32 v136, v136, v137
v_cvt_pk_bf16_f32 v137, v138, v139
v_cvt_pk_bf16_f32 v138, v178, v179
v_mov_b32 v139, 0
v_pk_fma_f32 v[116:117], v[44:45], v[32:33], v[116:117] op_sel_hi:[1,0,1]
v_pk_fma_f32 v[118:119], v[46:47], v[32:33], v[118:119] op_sel_hi:[1,0,1]
v_pk_mul_f32 v[116:117], v[116:117], v[32:33] op_sel:[0,1] op_sel_hi:[1,1]
v_pk_mul_f32 v[118:119], v[118:119], v[32:33] op_sel:[0,1] op_sel_hi:[1,1]
v_cvt_pk_bf16_f32 v116, v116, v117
v_cvt_pk_bf16_f32 v117, v118, v119
buffer_load_dwordx4 v5, s[24:27], s19 offen offset:1024 sc1 lds
v_cvt_pk_bf16_f32 v118, v176, v177
v_mov_b32 v119, 0x3f80
s_waitcnt lgkmcnt(3)
v_pk_fma_f32 v[156:157], v[68:69], v[56:57], v[156:157] op_sel_hi:[1,0,1]
v_pk_fma_f32 v[158:159], v[70:71], v[56:57], v[158:159] op_sel_hi:[1,0,1]
s_waitcnt lgkmcnt(2)
v_pk_mul_f32 v[156:157], v[156:157], v[72:73]
v_pk_mul_f32 v[158:159], v[158:159], v[74:75]
v_cvt_pk_bf16_f32 v154, v156, v157
v_cvt_pk_bf16_f32 v155, v158, v159
ds_read_b128 v[68:71], v23 offset:256
ds_read_b128 v[72:75], v23 offset:576
buffer_load_dwordx4 v5, s[24:27], s19 offen offset:2048 sc1 lds
v_pk_fma_f32 v[180:181], v[52:53], v[34:35], v[180:181] op_sel_hi:[1,0,1]
v_pk_fma_f32 v[182:183], v[54:55], v[34:35], v[182:183] op_sel_hi:[1,0,1]
v_pk_fma_f32 v[140:141], v[48:49], v[34:35], v[140:141] op_sel_hi:[1,0,1]
v_pk_fma_f32 v[142:143], v[50:51], v[34:35], v[142:143] op_sel_hi:[1,0,1]
v_pk_mul_f32 v[182:183], v[182:183], v[40:41] op_sel:[0,1] op_sel_hi:[1,1]
v_pk_mul_f32 v[140:141], v[140:141], v[40:41] op_sel:[0,1] op_sel_hi:[1,1]
v_pk_mul_f32 v[142:143], v[142:143], v[40:41] op_sel:[0,1] op_sel_hi:[1,1]
v_pk_mul_f32 v[180:181], v[180:181], v[34:35] op_sel:[0,1] op_sel_hi:[1,1]
v_cvt_pk_bf16_f32 v140, v140, v141
v_cvt_pk_bf16_f32 v141, v142, v143
buffer_load_dwordx4 v5, s[24:27], s19 offen offset:3072 sc1 lds
v_cvt_pk_bf16_f32 v142, v182, v183
v_mov_b32 v143, 0
v_pk_fma_f32 v[120:121], v[44:45], v[34:35], v[120:121] op_sel_hi:[1,0,1]
v_pk_fma_f32 v[122:123], v[46:47], v[34:35], v[122:123] op_sel_hi:[1,0,1]
v_pk_mul_f32 v[120:121], v[120:121], v[34:35] op_sel:[0,1] op_sel_hi:[1,1]
v_pk_mul_f32 v[122:123], v[122:123], v[34:35] op_sel:[0,1] op_sel_hi:[1,1]
v_cvt_pk_bf16_f32 v120, v120, v121
s_cmp_eq_u32 s77, 1
s_cbranch_scc0 L_80
v_mov_b32 v88, 0
v_mov_b32 v89, 0
v_mov_b32 v90, 0
v_mov_b32 v91, 0
s_mov_b32 s6, 5211008
v_bfe_u32 v94, v0, 1, 3
v_mul_u32_u24 v94, 1146880, v94
v_lshl_add_u32 v94, v7, 12, v94
v_and_b32 v96, 1, v0
v_lshl_add_u32 v94, v96, 4, v94
buffer_load_dwordx4 v[84:87], v94, s[24:27], s6 offen sc1
s_add_u32 s1, s6, 16384
s_mov_b64 exec, 255
buffer_load_dwordx4 v[88:91], v94, s[24:27], s1 offen sc1
s_mov_b64 exec, -1
L_80:
v_cvt_pk_bf16_f32 v121, v122, v123
v_cvt_pk_bf16_f32 v122, v180, v181
v_mov_b32 v123, 0x3f80
s_add_u32 m0, s62, 8192
s_add_u32 s19, s18, 2236416
buffer_load_dwordx4 v5, s[24:27], s19 offen offset:0 sc1 lds
s_waitcnt lgkmcnt(3)
v_pk_fma_f32 v[160:161], v[76:77], v[56:57], v[160:161] op_sel_hi:[1,0,1]
v_pk_fma_f32 v[162:163], v[78:79], v[56:57], v[162:163] op_sel_hi:[1,0,1]
s_waitcnt lgkmcnt(2)
v_pk_mul_f32 v[160:161], v[160:161], v[80:81]
v_pk_mul_f32 v[162:163], v[162:163], v[82:83]
v_cvt_pk_bf16_f32 v156, v160, v161
v_cvt_pk_bf16_f32 v157, v162, v163
v_pk_fma_f32 v[184:185], v[52:53], v[36:37], v[184:185] op_sel_hi:[1,0,1]
v_pk_fma_f32 v[186:187], v[54:55], v[36:37], v[186:187] op_sel_hi:[1,0,1]
v_pk_fma_f32 v[144:145], v[48:49], v[36:37], v[144:145] op_sel_hi:[1,0,1]
v_pk_fma_f32 v[146:147], v[50:51], v[36:37], v[146:147] op_sel_hi:[1,0,1]
buffer_load_dwordx4 v5, s[24:27], s19 offen offset:1024 sc1 lds
v_pk_mul_f32 v[186:187], v[186:187], v[42:43] op_sel:[0,0] op_sel_hi:[1,0]
v_pk_mul_f32 v[144:145], v[144:145], v[42:43] op_sel:[0,0] op_sel_hi:[1,0]
v_pk_mul_f32 v[146:147], v[146:147], v[42:43] op_sel:[0,0] op_sel_hi:[1,0]
v_pk_mul_f32 v[184:185], v[184:185], v[36:37] op_sel:[0,1] op_sel_hi:[1,1]
v_cvt_pk_bf16_f32 v144, v144, v145
v_cvt_pk_bf16_f32 v145, v146, v147
v_cvt_pk_bf16_f32 v146, v186, v187
v_mov_b32 v147, 0
v_pk_fma_f32 v[124:125], v[44:45], v[36:37], v[124:125] op_sel_hi:[1,0,1]
v_pk_fma_f32 v[126:127], v[46:47], v[36:37], v[126:127] op_sel_hi:[1,0,1]
buffer_load_dwordx4 v5, s[24:27], s19 offen offset:2048 sc1 lds
v_pk_mul_f32 v[124:125], v[124:125], v[36:37] op_sel:[0,1] op_sel_hi:[1,1]
v_pk_mul_f32 v[126:127], v[126:127], v[36:37] op_sel:[0,1] op_sel_hi:[1,1]
v_cvt_pk_bf16_f32 v124, v124, v125
v_cvt_pk_bf16_f32 v125, v126, v127
v_cvt_pk_bf16_f32 v126, v184, v185
v_mov_b32 v127, 0x3f80
s_waitcnt lgkmcnt(1)
v_pk_fma_f32 v[164:165], v[68:69], v[56:57], v[164:165] op_sel_hi:[1,0,1]
v_pk_fma_f32 v[166:167], v[70:71], v[56:57], v[166:167] op_sel_hi:[1,0,1]
s_waitcnt lgkmcnt(0)
v_pk_mul_f32 v[164:165], v[164:165], v[72:73]
v_pk_mul_f32 v[166:167], v[166:167], v[74:75]
v_cvt_pk_bf16_f32 v158, v164, v165
v_cvt_pk_bf16_f32 v159, v166, v167
s_mul_i32 s3, s76, 9
v_add_u32 v19, s3, v7
v_add_u32 v20, 4, v19
s_add_u32 s3, s3, 8
v_mov_b32 v21, s3
v_lshrrev_b32 v52, 3, v19
v_mul_u32_u24 v52, 1040, v52
v_lshl_add_u32 v19, v19, 4, v52
v_add_u32 v19, 74768, v19
v_lshrrev_b32 v52, 3, v20
v_mul_u32_u24 v52, 1040, v52
v_lshl_add_u32 v20, v20, 4, v52
v_add_u32 v20, 74768, v20
v_lshrrev_b32 v52, 3, v21
v_mul_u32_u24 v52, 1040, v52
v_lshl_add_u32 v21, v21, 4, v52
v_add_u32 v21, 74768, v21
v_and_b32 v52, 1, v7
v_lshl_add_u32 v21, v52, 3, v21
s_lshl_b32 s3, s77, 4
s_sub_u32 s3, s60, s3
s_sub_u32 s3, s3, 16
v_cmp_eq_u32 s[14:15], s3, v6
v_lshrrev_b32 v22, 3, v0
v_mul_u32_u24 v51, 1040, v22
s_mov_b32 s3, 74768
v_add3_u32 v51, v51, v5, s3
v_and_b32 v52, 11, v0
v_cmp_eq_u32 vcc, 1, v52
v_lshl_add_u32 v52, v7, 4, s3
v_add_u32 v53, 64, v52
v_cndmask_b32 v3, v3, v52, vcc
v_cndmask_b32 v4, v4, v53, vcc
s_cmp_eq_u32 s77, 1
s_cbranch_scc0 L_81
s_lshr_b32 s4, s60, 3
s_sub_u32 s4, s4, 2
s_mul_i32 s4, s4, 9216
s_cmp_lt_u32 s60, 16
s_cselect_b32 s4, 73728, s4
s_cselect_b32 s5, 144, 0
s_and_b32 s3, s60, 7
s_lshl_b32 s3, s3, 4
s_add_u32 s4, s4, s3
v_mul_u32_u24 v22, s5, v22
v_lshl_add_u32 v22, v0, 7, v22
v_add_u32 v22, s4, v22
s_lshl_b32 s5, s5, 3
v_add_u32 v23, s5, v22
s_branch C_82
R_83:
s_sub_u32 s82, s82, 1
s_cbranch_scc1 L_exit
s_waitcnt vmcnt(0)
buffer_load_dwordx4 v[84:87], v94, s[24:27], s6 offen sc1
s_add_u32 s1, s6, 16384
s_mov_b64 exec, 255
buffer_load_dwordx4 v[88:91], v94, s[24:27], s1 offen sc1
s_mov_b64 exec, -1
s_waitcnt vmcnt(0)
C_82:
s_waitcnt vmcnt(4)
v_max_u32 v92, v84, v85
v_max3_u32 v92, v92, v86, v87
s_waitcnt vmcnt(3)
v_max3_u32 v92, v92, v88, v89
v_max3_u32 v92, v92, v90, v91
v_cmp_eq_u32 vcc, -1, v92
s_cbranch_vccnz R_83
ds_write_b128 v51, v[84:87]
s_cmp_lt_u32 s60, 16
s_cselect_b64 exec, -1, 0
ds_write_b128 v22, v[84:87]
s_mov_b64 exec, 255
ds_write_b128 v51, v[88:91] offset:9344
s_cselect_b64 exec, exec, 0
ds_write_b128 v23, v[88:91] offset:8192
s_mov_b64 exec, -1
L_81:
s_cmp_eq_u32 s77, 0
s_cbranch_scc0 L_84
s_mov_b64 exec, 0
s_branch L_patched
L_pw:
s_mov_b64 exec, -1
L_84:
v_lshlrev_b32 v50, 1, v0
v_add_u32 v50, 84112, v50
s_waitcnt lgkmcnt(0)
s_barrier
s_waitcnt vmcnt(4)
ds_read_b128 v[84:87], v3 offset:0
s_waitcnt vmcnt(3)
ds_read_b128 v[88:91], v4 offset:0
ds_read_b128 v[92:95], v3 offset:1168
ds_read_b128 v[96:99], v4 offset:1168
ds_read_b128 v[100:103], v3 offset:2336
ds_read_b128 v[40:43], v51
ds_read_u16 v48, v50
s_waitcnt lgkmcnt(6)
v_mfma_f32_16x16x32_bf16 v[168:171], a[12:15], v[84:87], 0
ds_read_b128 v[104:107], v4 offset:2336
s_lshl_b32 s3, s60, 2
s_add_u32 s3, s3, 160128
v_mfma_f32_16x16x32_bf16 v[128:131], a[4:7], v[84:87], 0
v_mov_b32 v22, s3
s_and_b32 s4, s60, 15
s_mov_b32 s52, 0x10001
v_mfma_f32_16x16x32_bf16 v[108:111], a[0:3], v[84:87], 0
buffer_load_dwordx4 v5, s[24:27], s19 offen offset:3072 sc1 lds
s_mov_b32 s53, 0x10001
s_lshl_b64 s[52:53], s[52:53], s4
v_mfma_f32_16x16x32_bf16 v[148:151], v[84:87], a[8:11], 0
s_not_b64 vcc, s[52:53]
s_lshr_b32 s5, s4, 2
s_lshl_b32 s5, s5, 4
s_waitcnt lgkmcnt(6)
v_mfma_f32_16x16x32_bf16 v[168:171], a[28:31], v[88:91], v[168:171]
ds_read_b128 v[84:87], v3 offset:3504
s_mov_b64 s[52:53], 0xffff
s_lshl_b64 s[52:53], s[52:53], s5
v_mfma_f32_16x16x32_bf16 v[128:131], a[20:23], v[88:91], v[128:131]
s_and_b32 s4, s4, 3
s_lshr_b32 s3, s60, 4
v_mfma_f32_16x16x32_bf16 v[108:111], a[16:19], v[88:91], v[108:111]
s_bitcmp1_b32 s4, 0
s_cselect_b32 s5, 16, 0
v_mfma_f32_16x16x32_bf16 v[148:151], v[88:91], a[24:27], v[148:151]
s_lshl_b32 s5, 0xffff, s5
s_lshr_b32 s4, s4, 1
s_waitcnt lgkmcnt(6)
v_mfma_f32_16x16x32_bf16 v[168:171], a[44:47], v[92:95], v[168:171]
ds_read_b128 v[88:91], v4 offset:3504
s_mov_b64 exec, s[14:15]
ds_read_b128 v[58:61], v19
ds_read_b128 v[62:65], v20
ds_read_b64 v[66:67], v21
s_mov_b64 exec, -1
v_mfma_f32_16x16x32_bf16 v[128:131], a[36:39], v[92:95], v[128:131]
s_cmp_eq_u32 s3, 1
s_cselect_b64 s[14:15], vcc, -1
v_mfma_f32_16x16x32_bf16 v[108:111], a[32:35], v[92:95], v[108:111]
s_add_u32 m0, s62, 12288
s_add_u32 s19, s18, 2240512
buffer_load_dwordx4 v5, s[24:27], s19 offen offset:0 sc1 lds
v_mfma_f32_16x16x32_bf16 v[148:151], v[92:95], a[40:43], v[148:151]
s_cmp_eq_u32 s3, 2
s_cselect_b64 s[16:17], vcc, -1
s_waitcnt lgkmcnt(9)
v_mfma_f32_16x16x32_bf16 v[168:171], a[60:63], v[96:99], v[168:171]
ds_read_b128 v[92:95], v3 offset:4672
s_cmp_eq_u32 s3, 3
s_cselect_b64 s[20:21], vcc, -1
v_mfma_f32_16x16x32_bf16 v[128:131], a[52:55], v[96:99], v[128:131]
s_cmp_eq_u32 s3, 4
s_cselect_b64 s[22:23], vcc, -1
v_mfma_f32_16x16x32_bf16 v[108:111], a[48:51], v[96:99], v[108:111]
s_waitcnt lgkmcnt(7)
v_lshlrev_b32 v48, 16, v48
v_mul_f32 v49, v48, v48
v_mfma_f32_16x16x32_bf16 v[148:151], v[96:99], a[56:59], v[148:151]
v_lshlrev_b32 v44, 16, v40
v_and_b32 v45, 0xffff0000, v40
v_mfma_f32_16x16x32_bf16 v[168:171], a[76:79], v[100:103], v[168:171]
ds_read_b128 v[96:99], v4 offset:4672
v_add_f32 v48, v48, v44
v_mfma_f32_16x16x32_bf16 v[128:131], a[68:71], v[100:103], v[128:131]
v_fmac_f32 v49, v44, v44
v_add_f32 v48, v48, v45
v_mfma_f32_16x16x32_bf16 v[108:111], a[64:67], v[100:103], v[108:111]
buffer_load_dwordx4 v5, s[24:27], s19 offen offset:1024 sc1 lds
v_fmac_f32 v49, v45, v45
v_mfma_f32_16x16x32_bf16 v[148:151], v[100:103], a[72:75], v[148:151]
v_lshlrev_b32 v44, 16, v41
v_and_b32 v45, 0xffff0000, v41
s_waitcnt lgkmcnt(7)
v_mfma_f32_16x16x32_bf16 v[168:171], a[92:95], v[104:107], v[168:171]
ds_read_b128 v[100:103], v3 offset:5840
v_add_f32 v48, v48, v44
v_mfma_f32_16x16x32_bf16 v[128:131], a[84:87], v[104:107], v[128:131]
v_fmac_f32 v49, v44, v44
v_add_f32 v48, v48, v45
v_mfma_f32_16x16x32_bf16 v[108:111], a[80:83], v[104:107], v[108:111]
v_fmac_f32 v49, v45, v45
v_lshlrev_b32 v44, 16, v42
v_mfma_f32_16x16x32_bf16 v[148:151], v[104:107], a[88:91], v[148:151]
v_and_b32 v45, 0xffff0000, v42
v_add_f32 v48, v48, v44
s_waitcnt lgkmcnt(7)
v_mfma_f32_16x16x32_bf16 v[168:171], a[108:111], v[84:87], v[168:171]
ds_read_b128 v[104:107], v4 offset:5840
v_fmac_f32 v49, v44, v44
v_mfma_f32_16x16x32_bf16 v[128:131], a[100:103], v[84:87], v[128:131]
v_add_f32 v48, v48, v45
v_fmac_f32 v49, v45, v45
v_mfma_f32_16x16x32_bf16 v[108:111], a[96:99], v[84:87], v[108:111]
buffer_load_dwordx4 v5, s[24:27], s19 offen offset:2048 sc1 lds
v_lshlrev_b32 v44, 16, v43
v_mfma_f32_16x16x32_bf16 v[148:151], v[84:87], a[104:107], v[148:151]
v_and_b32 v45, 0xffff0000, v43
v_add_f32 v48, v48, v44
s_waitcnt lgkmcnt(7)
v_mfma_f32_16x16x32_bf16 v[168:171], a[124:127], v[88:91], v[168:171]
ds_read_b128 v[84:87], v3 offset:7008
v_fmac_f32 v49, v44, v44
v_mfma_f32_16x16x32_bf16 v[128:131], a[116:119], v[88:91], v[128:131]
v_add_f32 v48, v48, v45
v_fmac_f32 v49, v45, v45
v_mfma_f32_16x16x32_bf16 v[108:111], a[112:115], v[88:91], v[108:111]
v_add_f32_dpp v48, v48, v48 row_ror:8 row_mask:0xf bank_mask:0xf
v_add_f32_dpp v49, v49, v49 row_ror:8 row_mask:0xf bank_mask:0xf
v_mfma_f32_16x16x32_bf16 v[148:151], v[88:91], a[120:123], v[148:151]
v_add_f32_dpp v48, v48, v48 row_ror:4 row_mask:0xf bank_mask:0xf
v_add_f32_dpp v49, v49, v49 row_ror:4 row_mask:0xf bank_mask:0xf
s_waitcnt lgkmcnt(4)
v_mfma_f32_16x16x32_bf16 v[168:171], a[140:143], v[92:95], v[168:171]
ds_read_b128 v[88:91], v4 offset:7008
v_add_f32_dpp v48, v48, v48 row_ror:2 row_mask:0xf bank_mask:0xf
v_mfma_f32_16x16x32_bf16 v[128:131], a[132:135], v[92:95], v[128:131]
v_add_f32_dpp v49, v49, v49 row_ror:2 row_mask:0xf bank_mask:0xf
v_add_f32_dpp v48, v48, v48 row_ror:1 row_mask:0xf bank_mask:0xf
v_mfma_f32_16x16x32_bf16 v[108:111], a[128:131], v[92:95], v[108:111]
buffer_load_dwordx4 v5, s[24:27], s19 offen offset:3072 sc1 lds
v_add_f32_dpp v49, v49, v49 row_ror:1 row_mask:0xf bank_mask:0xf
v_mfma_f32_16x16x32_bf16 v[148:151], v[92:95], a[136:139], v[148:151]
v_permlane32_swap_b32 v48, v52
v_permlane32_swap_b32 v49, v53
s_waitcnt lgkmcnt(4)
v_mfma_f32_16x16x32_bf16 v[168:171], a[156:159], v[96:99], v[168:171]
ds_read_b128 v[92:95], v3 offset:8176
v_add_f32 v48, v48, v52
v_mfma_f32_16x16x32_bf16 v[128:131], a[148:151], v[96:99], v[128:131]
v_add_f32 v49, v49, v53
v_permlane16_swap_b32 v48, v52
v_mfma_f32_16x16x32_bf16 v[108:111], a[144:147], v[96:99], v[108:111]
v_permlane16_swap_b32 v49, v53
v_add_f32 v48, v48, v52
v_mfma_f32_16x16x32_bf16 v[148:151], v[96:99], a[152:155], v[148:151]
v_add_f32 v49, v49, v53
v_mul_f32 v48, 0xbae38e39, v48
s_waitcnt lgkmcnt(4)
v_mfma_f32_16x16x32_bf16 v[168:171], a[172:175], v[100:103], v[168:171]
ds_read_b128 v[96:99], v4 offset:8176
v_mul_f32 v49, 0x3ae38e39, v49
v_mfma_f32_16x16x32_bf16 v[128:131], a[164:167], v[100:103], v[128:131]
v_fma_f32 v49, -v48, v48, v49
v_max_f32 v49, 0, v49
v_mfma_f32_16x16x32_bf16 v[108:111], a[160:163], v[100:103], v[108:111]
s_add_u32 m0, s62, 16384
s_add_u32 s19, s18, 2244608
buffer_load_dwordx4 v5, s[24:27], s19 offen offset:0 sc1 lds
v_mfma_f32_16x16x32_bf16 v[148:151], v[100:103], a[168:171], v[148:151]
v_add_f32 v49, 0x3727c5ac, v49
v_rsq_f32 v49, v49
s_waitcnt lgkmcnt(4)
v_mfma_f32_16x16x32_bf16 v[168:171], a[188:191], v[104:107], v[168:171]
ds_read_b128 v[100:103], v3 offset:9344
v_mov_b32 v52, 1.0
v_mfma_f32_16x16x32_bf16 v[128:131], a[180:183], v[104:107], v[128:131]
v_mov_b32 v53, 0
s_mov_b64 exec, 1
ds_write2_b32 v22, v48, v49 offset0:0 offset1:80
ds_write2_b32 v22, v52, v53 offset0:160 offset1:240
v_mov_b32 v22, 160128
ds_write2_b32 v22, v48, v49 offset0:1 offset1:81
ds_write2_b32 v22, v48, v49 offset0:5 offset1:85
s_mov_b64 exec, -1
v_mfma_f32_16x16x32_bf16 v[108:111], a[176:179], v[104:107], v[108:111]
v_lshlrev_b32 v22, 2, v6
v_add_u32 v22, 160128, v22
v_mfma_f32_16x16x32_bf16 v[148:151], v[104:107], a[184:187], v[148:151]
v_lshlrev_b32 v23, 4, v7
v_add_u32 v23, 160128, v23
s_waitcnt lgkmcnt(8)
v_mfma_f32_16x16x32_bf16 v[168:171], a[204:207], v[84:87], v[168:171]
ds_read_b128 v[104:107], v4 offset:9344
ds_read2_b32 v[28:29], v22 offset0:0 offset1:80
v_mfma_f32_16x16x32_bf16 v[128:131], a[196:199], v[84:87], v[128:131]
ds_read_b128 v[52:55], v26 offset:128
ds_read_b128 v[48:51], v26 offset:64
v_mfma_f32_16x16x32_bf16 v[108:111], a[192:195], v[84:87], v[108:111]
buffer_load_dwordx4 v5, s[24:27], s19 offen offset:1024 sc1 lds
ds_read_b128 v[44:47], v26 offset:0
v_mfma_f32_16x16x32_bf16 v[148:151], v[84:87], a[200:203], v[148:151]
ds_read_b32 v56, v27 offset:192
ds_read_b128 v[76:79], v23 offset:0
s_waitcnt lgkmcnt(14)
v_mfma_f32_16x16x32_bf16 v[168:171], a[220:223], v[88:91], v[168:171]
ds_read_b128 v[80:83], v23 offset:320
s_lshl1_add_u32 s4, s3, s4
v_mfma_f32_16x16x32_bf16 v[128:131], a[212:215], v[88:91], v[128:131]
v_mov_b32 v41, s4
v_cndmask_b32 v41, -1, v41, s[52:53]
v_mfma_f32_16x16x32_bf16 v[108:111], a[208:211], v[88:91], v[108:111]
v_mov_b32 v42, s5
v_cmp_eq_u32 vcc, 2, v41
v_mfma_f32_16x16x32_bf16 v[148:151], v[88:91], a[216:219], v[148:151]
s_nop 0
v_cndmask_b32 v68, 0, v42, vcc
v_cmp_eq_u32 vcc, 3, v41
s_waitcnt lgkmcnt(14)
v_mfma_f32_16x16x32_bf16 v[168:171], a[236:239], v[92:95], v[168:171]
v_cndmask_b32 v69, 0, v42, vcc
v_cmp_eq_u32 vcc, 4, v41
v_mfma_f32_16x16x32_bf16 v[128:131], a[228:231], v[92:95], v[128:131]
s_nop 0
v_cndmask_b32 v70, 0, v42, vcc
v_cmp_eq_u32 vcc, 5, v41
v_mfma_f32_16x16x32_bf16 v[108:111], a[224:227], v[92:95], v[108:111]
s_nop 0
v_cndmask_b32 v71, 0, v42, vcc
v_cmp_eq_u32 vcc, 6, v41
v_mfma_f32_16x16x32_bf16 v[148:151], v[92:95], a[232:235], v[148:151]
s_nop 0
v_cndmask_b32 v72, 0, v42, vcc
s_waitcnt lgkmcnt(13)
v_mfma_f32_16x16x32_bf16 v[168:171], a[252:255], v[96:99], v[168:171]
v_cmp_eq_u32 vcc, 7, v41
v_mfma_f32_16x16x32_bf16 v[128:131], a[244:247], v[96:99], v[128:131]
s_nop 0
v_cndmask_b32 v73, 0, v42, vcc
v_mfma_f32_16x16x32_bf16 v[108:111], a[240:243], v[96:99], v[108:111]
v_cmp_eq_u32 vcc, 8, v41
v_mfma_f32_16x16x32_bf16 v[148:151], v[96:99], a[248:251], v[148:151]
s_nop 0
v_cndmask_b32 v74, 0, v42, vcc
s_waitcnt lgkmcnt(12)
v_mfma_f32_16x16x32_bf16 v[168:171], v[236:239], v[100:103], v[168:171]
v_cmp_eq_u32 vcc, 9, v41
v_mfma_f32_16x16x32_bf16 v[128:131], v[228:231], v[100:103], v[128:131]
s_nop 0
v_cndmask_b32 v75, 0, v42, vcc
v_mfma_f32_16x16x32_bf16 v[108:111], v[224:227], v[100:103], v[108:111]
s_waitcnt lgkmcnt(6)
v_mul_f32 v38, 0x3eae1a93, v29
v_mfma_f32_16x16x32_bf16 v[148:151], v[100:103], v[232:235], v[148:151]
s_lshl_b32 s0, s77, 11
v_mfma_f32_16x16x32_bf16 v[168:171], v[252:255], v[104:107], v[168:171]
s_add_u32 m0, s0, 73728
v_mfma_f32_16x16x32_bf16 v[128:131], v[244:247], v[104:107], v[128:131]
s_sub_u32 s18, s18, s62
v_mfma_f32_16x16x32_bf16 v[108:111], v[240:243], v[104:107], v[108:111]
s_add_u32 s18, s18, s0
v_mfma_f32_16x16x32_bf16 v[148:151], v[104:107], v[248:251], v[148:151]
s_add_u32 s19, s18, 2301952
s_waitcnt lgkmcnt(0)
s_barrier
v_pk_fma_f32 v[168:169], v[52:53], v[28:29], v[168:169] op_sel_hi:[1,0,1]
v_pk_fma_f32 v[170:171], v[54:55], v[28:29], v[170:171] op_sel_hi:[1,0,1]
v_pk_fma_f32 v[128:129], v[48:49], v[28:29], v[128:129] op_sel_hi:[1,0,1]
v_pk_fma_f32 v[130:131], v[50:51], v[28:29], v[130:131] op_sel_hi:[1,0,1]
v_pk_mul_f32 v[170:171], v[170:171], v[38:39] op_sel:[0,0] op_sel_hi:[1,0]
buffer_load_dwordx4 v5, s[24:27], s19 offen offset:0 sc1 lds
v_pk_mul_f32 v[128:129], v[128:129], v[38:39] op_sel:[0,0] op_sel_hi:[1,0]
v_pk_mul_f32 v[130:131], v[130:131], v[38:39] op_sel:[0,0] op_sel_hi:[1,0]
v_pk_mul_f32 v[168:169], v[168:169], v[28:29] op_sel:[0,1] op_sel_hi:[1,1]
v_cvt_pk_bf16_f32 v128, v128, v129
v_cvt_pk_bf16_f32 v129, v130, v131
buffer_load_dwordx4 v5, s[24:27], s19 offen offset:1024 sc1 lds
v_cvt_pk_bf16_f32 v130, v170, v171
v_mov_b32 v131, 0
buffer_load_dwordx4 v5, s[24:27], s19 offen offset:2048 sc1 lds
v_pk_fma_f32 v[108:109], v[44:45], v[28:29], v[108:109] op_sel_hi:[1,0,1]
v_pk_fma_f32 v[110:111], v[46:47], v[28:29], v[110:111] op_sel_hi:[1,0,1]
v_pk_mul_f32 v[108:109], v[108:109], v[28:29] op_sel:[0,1] op_sel_hi:[1,1]
v_pk_mul_f32 v[110:111], v[110:111], v[28:29] op_sel:[0,1] op_sel_hi:[1,1]
v_cvt_pk_bf16_f32 v108, v108, v109
v_cvt_pk_bf16_f32 v109, v110, v111
v_cvt_pk_bf16_f32 v110, v168, v169
v_mov_b32 v111, 0x3f80
s_mov_b64 vcc, s[14:15]
v_cndmask_b32_dpp v132, v128, v132, vcc row_newbcast:1 row_mask:0xf bank_mask:0xf
v_mfma_f32_16x16x16_bf16 v[168:171], v[110:111], v[14:15], 0
v_cndmask_b32_dpp v133, v129, v133, vcc row_newbcast:1 row_mask:0xf bank_mask:0xf
v_cndmask_b32_dpp v134, v130, v134, vcc row_newbcast:1 row_mask:0xf bank_mask:0xf
v_cndmask_b32_dpp v112, v108, v112, vcc row_newbcast:1 row_mask:0xf bank_mask:0xf
v_cndmask_b32_dpp v113, v109, v113, vcc row_newbcast:1 row_mask:0xf bank_mask:0xf
v_cndmask_b32_dpp v114, v110, v114, vcc row_newbcast:1 row_mask:0xf bank_mask:0xf
s_mov_b64 vcc, s[16:17]
v_cndmask_b32_dpp v136, v128, v136, vcc row_newbcast:1 row_mask:0xf bank_mask:0xf
v_mfma_f32_16x16x32_bf16 v[88:91], v[132:135], v[112:115], v[8:11]
v_cndmask_b32_dpp v137, v129, v137, vcc row_newbcast:1 row_mask:0xf bank_mask:0xf
v_cndmask_b32_dpp v138, v130, v138, vcc row_newbcast:1 row_mask:0xf bank_mask:0xf
v_cndmask_b32_dpp v116, v108, v116, vcc row_newbcast:1 row_mask:0xf bank_mask:0xf
v_mfma_f32_16x16x16_bf16 v[172:175], v[114:115], v[14:15], 0
v_cndmask_b32_dpp v117, v109, v117, vcc row_newbcast:1 row_mask:0xf bank_mask:0xf
v_cndmask_b32_dpp v118, v110, v118, vcc row_newbcast:1 row_mask:0xf bank_mask:0xf
s_mov_b64 vcc, s[20:21]
v_cndmask_b32_dpp v140, v128, v140, vcc row_newbcast:1 row_mask:0xf bank_mask:0xf
v_mfma_f32_16x16x32_bf16 v[92:95], v[136:139], v[116:119], v[8:11]
v_cndmask_b32_dpp v141, v129, v141, vcc row_newbcast:1 row_mask:0xf bank_mask:0xf
v_cndmask_b32_dpp v142, v130, v142, vcc row_newbcast:1 row_mask:0xf bank_mask:0xf
v_cndmask_b32_dpp v120, v108, v120, vcc row_newbcast:1 row_mask:0xf bank_mask:0xf
v_mfma_f32_16x16x16_bf16 v[176:179], v[118:119], v[14:15], 0
v_cndmask_b32_dpp v121, v109, v121, vcc row_newbcast:1 row_mask:0xf bank_mask:0xf
v_cndmask_b32_dpp v122, v110, v122, vcc row_newbcast:1 row_mask:0xf bank_mask:0xf
s_mov_b64 vcc, s[22:23]
v_cndmask_b32_dpp v144, v128, v144, vcc row_newbcast:1 row_mask:0xf bank_mask:0xf
v_mfma_f32_16x16x32_bf16 v[96:99], v[140:143], v[120:123], v[8:11]
v_cndmask_b32_dpp v145, v129, v145, vcc row_newbcast:1 row_mask:0xf bank_mask:0xf
v_cndmask_b32_dpp v146, v130, v146, vcc row_newbcast:1 row_mask:0xf bank_mask:0xf
v_cndmask_b32_dpp v124, v108, v124, vcc row_newbcast:1 row_mask:0xf bank_mask:0xf
L_pad9:
s_cbranch_execz L_padret
v_mfma_f32_16x16x16_bf16 v[180:183], v[122:123], v[14:15], 0
v_cndmask_b32_dpp v125, v109, v125, vcc row_newbcast:1 row_mask:0xf bank_mask:0xf
v_cndmask_b32_dpp v126, v110, v126, vcc row_newbcast:1 row_mask:0xf bank_mask:0xf
v_mfma_f32_16x16x32_bf16 v[108:111], v[128:131], v[112:115], v[8:11]
v_fmac_f32 v148, v76, v56
v_fmac_f32 v149, v77, v56
v_fmac_f32 v150, v78, v56
v_mfma_f32_16x16x32_bf16 v[100:103], v[144:147], v[124:127], v[8:11]
v_fmac_f32 v151, v79, v56
v_mul_f32 v148, v148, v80
v_mul_f32 v149, v149, v81
v_mfma_f32_16x16x32_bf16 v[112:115], v[132:135], v[116:119], v[8:11]
v_mul_f32 v150, v150, v82
v_mul_f32 v151, v151, v83
v_mov_b32 v40, v149
v_mfma_f32_16x16x32_bf16 v[116:119], v[136:139], v[120:123], v[8:11]
v_mov_b32 v41, v149
v_cvt_pk_bf16_f32 v151, v150, v151
v_cvt_pk_bf16_f32 v150, v148, v149
v_mfma_f32_16x16x32_bf16 v[120:123], v[140:143], v[124:127], v[8:11]
v_permlane32_swap_b32 v40, v41
v_cvt_pk_bf16_f32 v40, v40, v40
v_bfi_b32 v152, v68, v40, v152
v_mfma_f32_16x16x16_bf16 v[184:187], v[126:127], v[14:15], 0
v_bfi_b32 v153, v69, v40, v153
v_bfi_b32 v154, v70, v40, v154
v_bfi_b32 v155, v71, v40, v155
v_bfi_b32 v156, v72, v40, v156
v_bfi_b32 v157, v73, v40, v157
v_bfi_b32 v158, v74, v40, v158
v_bfi_b32 v159, v75, v40, v159
s_waitcnt lgkmcnt(0)
s_nop 3
s_branch L_patched
R_17:
s_waitcnt vmcnt(0) lgkmcnt(0)
P_85:
s_sub_u32 s82, s82, 1
s_cbranch_scc1 L_exit
buffer_load_dword v54, v26, s[24:27], 0 offen sc1
s_waitcnt vmcnt(0)
v_xor_b32 v47, v54, v46
v_cmp_lt_u32 vcc, 15, v47
s_cbranch_vccnz P_85
v_cmp_ne_u32 vcc, 0, v47
s_cbranch_vccz C_18
s_mov_b32 s93, 1
s_branch C_18
L_20:
v_lshlrev_b32 v28, 16, v58
v_and_b32 v29, 0xffff0000, v58
v_lshlrev_b32 v30, 16, v59
v_and_b32 v31, 0xffff0000, v59
v_lshlrev_b32 v32, 16, v60
v_and_b32 v33, 0xffff0000, v60
v_lshlrev_b32 v34, 16, v61
v_and_b32 v35, 0xffff0000, v61
v_lshlrev_b32 v36, 16, v62
v_and_b32 v37, 0xffff0000, v62
v_lshlrev_b32 v38, 16, v63
v_and_b32 v39, 0xffff0000, v63
v_lshlrev_b32 v40, 16, v64
v_and_b32 v41, 0xffff0000, v64
v_lshlrev_b32 v42, 16, v65
v_and_b32 v43, 0xffff0000, v65
v_lshlrev_b32 v44, 16, v66
v_and_b32 v45, 0xffff0000, v66
v_lshlrev_b32 v46, 16, v67
v_and_b32 v47, 0xffff0000, v67
ds_read_b128 v[68:71], v180 offset:32256
ds_read_b128 v[72:75], v180 offset:33280
ds_read_b128 v[76:79], v180 offset:34304
ds_read_b128 v[80:83], v180 offset:35328
ds_read_b128 v[84:87], v182 offset:36352
ds_read_b128 v[88:91], v180 offset:36864
ds_read_b128 v[92:95], v180 offset:37888
ds_read_b128 v[96:99], v180 offset:38912
ds_read_b128 v[100:103], v180 offset:39936
ds_read_b128 v[104:107], v182 offset:40960
ds_read_b128 v[188:191], v5 offset:0
ds_read_b128 v[192:195], v5 offset:1024
ds_read_b128 v[196:199], v5 offset:2048
ds_read_b128 v[200:203], v5 offset:3072
ds_read_b128 v[204:207], v181 offset:4096
ds_read_b128 v[208:211], v5 offset:4608
ds_read_b128 v[212:215], v5 offset:5632
ds_read_b128 v[216:219], v5 offset:6656
s_waitcnt vmcnt(0) lgkmcnt(0)
s_branch L_21
L_38:
s_branch C_86
R_87:
s_sub_u32 s82, s82, 1
s_cbranch_scc1 L_exit
s_waitcnt vmcnt(0)
s_lshl_b32 s1, s74, 13
s_add_u32 s1, s1, 2949120
s_mov_b32 exec_lo, s52
s_mov_b32 exec_hi, 0
buffer_load_dwordx4 v[28:31], v38, s[24:27], s1 offen sc1
s_mov_b64 exec, -1
buffer_load_dwordx4 v[40:43], v50, s[24:27], s4 offen sc1
s_add_u32 s1, s4, 28688
s_mov_b64 exec, 255
buffer_load_dwordx4 v[44:47], v5, s[24:27], s1 offen sc1
s_mov_b64 exec, -1
s_waitcnt vmcnt(0)
C_86:
s_mov_b32 s9, s4
v_cmp_ne_u32 vcc, s80, v31
v_bfrev_b32 v36, 1
s_and_b32 vcc_lo, vcc_lo, s52
s_mov_b32 s52, vcc_lo
v_cndmask_b32 v28, v28, v36, vcc
s_nop 1
v_max_i32_dpp v36, v28, v28 row_ror:8 row_mask:0xf bank_mask:0xf
v_mov_b32 v31, v0
s_nop 0
v_max_i32_dpp v36, v36, v36 row_ror:4 row_mask:0xf bank_mask:0xf
s_nop 1
v_max_i32_dpp v36, v36, v36 row_ror:2 row_mask:0xf bank_mask:0xf
s_nop 1
v_max_i32_dpp v36, v36, v36 row_ror:1 row_mask:0xf bank_mask:0xf
s_nop 0
v_readlane_b32 s3, v36, 0
v_readlane_b32 s4, v36, 16
s_max_i32 s57, s3, s4
v_cmp_eq_u32 vcc, s57, v28
s_bfe_u32 s5, s57, 0x20004
s_lshl_b32 s5, s5, 10
s_add_u32 s5, s5, 4350592
s_ff1_i32_b32 s3, vcc_lo
s_mul_i32 s4, s3, 286720
s_add_u32 s4, s4, s5
v_max_u32 v48, v40, v41
v_max3_u32 v48, v48, v42, v43
v_max3_u32 v48, v48, v44, v45
v_max3_u32 v48, v48, v46, v47
v_cmp_eq_u32 vcc, -1, v48
s_xor_b32 s9, s9, s4
s_or_b32 s9, s9, vcc_lo
s_or_b32 s9, s9, vcc_hi
s_cbranch_scc1 R_87
v_add_u32 v48, 161408, v5
ds_write_b128 v48, v[40:43]
s_mov_b64 exec, 255
ds_write_b128 v48, v[44:47] offset:1024
s_mov_b64 exec, -1
s_lshl_b64 exec, 1, s3
ds_write_b128 v37, v[28:31]
s_mov_b64 exec, -1
s_cmp_lg_u32 s52, 0
s_cbranch_scc0 L_89
s_waitcnt lgkmcnt(0)
P_88:
s_sub_u32 s82, s82, 1
s_cbranch_scc1 L_exit
s_lshl_b32 s1, s74, 13
s_add_u32 s1, s1, 2949120
s_mov_b32 exec_lo, s52
s_mov_b32 exec_hi, 0
buffer_load_dwordx4 v[28:31], v38, s[24:27], s1 offen sc1
s_mov_b64 exec, -1
s_waitcnt vmcnt(0)
v_cmp_eq_u32 vcc, s80, v31
s_and_b32 s9, vcc_lo, s52
v_cmp_le_i32 vcc, s57, v28
s_and_b32 vcc_lo, vcc_lo, s9
s_cbranch_scc1 C_86
s_andn2_b32 s52, s52, s9
s_cbranch_scc1 P_88
L_89:
s_waitcnt vmcnt(0) lgkmcnt(0)
s_branch L_37
L_31:
s_waitcnt vmcnt(0) lgkmcnt(0)
s_cmp_eq_u32 s77, 0
s_cbranch_scc0 L_90
s_lshl_b32 s1, s74, 13
s_add_u32 s1, s1, 2949120
s_mov_b32 exec_hi, 0
buffer_load_dwordx4 v[28:31], v38, s[24:27], s1 offen sc1
s_mov_b64 exec, -1
L_90:
s_branch L_32
R_40:
s_sub_u32 s82, s82, 1
s_cbranch_scc1 L_exit
s_waitcnt vmcnt(0) lgkmcnt(0)
s_add_u32 s1, s85, 197632
buffer_load_dwordx4 v[60:63], v5, s[24:27], s1 offen sc1
s_waitcnt vmcnt(0) lgkmcnt(0)
s_branch C_39
L_41:
s_cmp_eq_u32 s77, 0
s_cbranch_scc0 L_91
s_waitcnt vmcnt(4)
s_branch C_92
R_93:
s_sub_u32 s82, s82, 1
s_cbranch_scc1 L_exit
s_waitcnt vmcnt(0)
s_lshl_b32 s1, s74, 13
s_add_u32 s1, s1, 2949120
s_mov_b32 exec_lo, vcc_lo
s_mov_b32 exec_hi, 0
buffer_load_dwordx4 v[28:31], v38, s[24:27], s1 offen sc1
s_mov_b64 exec, -1
s_waitcnt vmcnt(0)
C_92:
v_cmp_ne_u32 vcc, s80, v31
s_mov_b32 vcc_hi, 0
s_cbranch_vccnz R_93
v_max_i32_dpp v36, v28, v28 row_ror:8 row_mask:0xf bank_mask:0xf
v_mov_b32 v31, v0
s_nop 0
v_max_i32_dpp v36, v36, v36 row_ror:4 row_mask:0xf bank_mask:0xf
s_nop 1
v_max_i32_dpp v36, v36, v36 row_ror:2 row_mask:0xf bank_mask:0xf
s_nop 1
v_max_i32_dpp v36, v36, v36 row_ror:1 row_mask:0xf bank_mask:0xf
s_nop 0
v_readlane_b32 s3, v36, 0
v_readlane_b32 s4, v36, 16
s_max_i32 s57, s3, s4
v_cmp_eq_u32 vcc, s57, v28
s_bfe_u32 s5, s57, 0x20004
s_lshl_b32 s5, s5, 10
s_add_u32 s5, s5, 4350592
s_ff1_i32_b32 s3, vcc_lo
s_mul_i32 s4, s3, 286720
s_add_u32 s4, s4, s5
s_lshl_b64 exec, 1, s3
ds_write_b128 v37, v[28:31]
s_mov_b64 exec, -1
L_91:
s_waitcnt lgkmcnt(0)
s_branch L_42
R_45:
s_sub_u32 s82, s82, 1
s_cbranch_scc1 L_exit
s_waitcnt vmcnt(0) lgkmcnt(0)
buffer_load_dword v105, v104, s[24:27], 0 offen sc1
s_waitcnt vmcnt(0) lgkmcnt(0)
s_branch C_44
L_46:
s_branch C_94
R_95:
s_sub_u32 s82, s82, 1
s_cbranch_scc1 L_exit
s_mov_b64 exec, vcc
s_waitcnt vmcnt(0)
buffer_load_dword v64, v27, s[24:27], s4 offen sc1
s_add_u32 s1, s5, 3145728
buffer_load_dwordx4 v[28:31], v5, s[24:27], s1 offen offset:0 sc1
buffer_load_dwordx4 v[32:35], v5, s[24:27], s1 offen offset:1024 sc1
buffer_load_dwordx4 v[36:39], v5, s[24:27], s1 offen offset:2048 sc1
buffer_load_dwordx4 v[40:43], v5, s[24:27], s1 offen offset:3072 sc1
s_add_u32 s1, s5, 3149824
buffer_load_dwordx4 v[44:47], v5, s[24:27], s1 offen offset:0 sc1
buffer_load_dwordx4 v[48:51], v5, s[24:27], s1 offen offset:1024 sc1
buffer_load_dwordx4 v[52:55], v5, s[24:27], s1 offen offset:2048 sc1
buffer_load_dwordx4 v[56:59], v5, s[24:27], s1 offen offset:3072 sc1
s_add_u32 s1, s5, 3153920
buffer_load_dwordx4 v[60:63], v5, s[24:27], s1 offen offset:0 sc1
C_94:
s_waitcnt vmcnt(8)
v_max3_u32 v66, v64, v28, v29
v_max3_u32 v66, v66, v30, v31
s_waitcnt vmcnt(7)
v_max3_u32 v66, v66, v32, v33
v_max3_u32 v66, v66, v34, v35
v_pk_add_f32 v[28:29], v[28:29], v[32:33]
v_pk_add_f32 v[30:31], v[30:31], v[34:35]
s_waitcnt vmcnt(6)
v_max3_u32 v66, v66, v36, v37
v_max3_u32 v66, v66, v38, v39
v_pk_add_f32 v[28:29], v[28:29], v[36:37]
v_pk_add_f32 v[30:31], v[30:31], v[38:39]
s_waitcnt vmcnt(5)
v_max3_u32 v66, v66, v40, v41
v_max3_u32 v66, v66, v42, v43
v_pk_add_f32 v[28:29], v[28:29], v[40:41]
v_pk_add_f32 v[30:31], v[30:31], v[42:43]
s_waitcnt vmcnt(4)
v_max3_u32 v66, v66, v44, v45
v_max3_u32 v66, v66, v46, v47
v_pk_add_f32 v[28:29], v[28:29], v[44:45]
v_pk_add_f32 v[30:31], v[30:31], v[46:47]
s_waitcnt vmcnt(3)
v_max3_u32 v66, v66, v48, v49
v_max3_u32 v66, v66, v50, v51
v_pk_add_f32 v[28:29], v[28:29], v[48:49]
v_pk_add_f32 v[30:31], v[30:31], v[50:51]
s_waitcnt vmcnt(2)
v_max3_u32 v66, v66, v52, v53
v_max3_u32 v66, v66, v54, v55
v_pk_add_f32 v[28:29], v[28:29], v[52:53]
v_pk_add_f32 v[30:31], v[30:31], v[54:55]
s_waitcnt vmcnt(1)
v_max3_u32 v66, v66, v56, v57
v_max3_u32 v66, v66, v58, v59
v_pk_add_f32 v[28:29], v[28:29], v[56:57]
v_pk_add_f32 v[30:31], v[30:31], v[58:59]
s_waitcnt vmcnt(0)
v_max3_u32 v66, v66, v60, v61
v_max3_u32 v66, v66, v62, v63
v_cmp_eq_u32 vcc, -1, v66
v_pk_add_f32 v[28:29], v[28:29], v[60:61]
v_pk_add_f32 v[30:31], v[30:31], v[62:63]
s_cbranch_vccnz R_95
s_mov_b64 exec, -1
v_lshlrev_b32 v36, 16, v64
v_and_b32 v37, 0xffff0000, v64
v_permlane32_swap_b32 v28, v30
v_permlane32_swap_b32 v29, v31
v_pk_add_f32 v[28:29], v[28:29], v[30:31]
v_fma_f32 v36, v36, v22, s58
v_fma_f32 v37, v37, v22, s58
v_permlane16_swap_b32 v28, v30
v_permlane16_swap_b32 v29, v31
v_pk_add_f32 v[28:29], v[28:29], v[30:31]
s_nop 1
v_add_f32_dpp v28, v28, v28 row_ror:8 row_mask:0xf bank_mask:0xf
v_add_f32_dpp v29, v29, v29 row_ror:8 row_mask:0xf bank_mask:0xf
s_nop 0
v_add_f32_dpp v28, v28, v28 row_ror:4 row_mask:0xf bank_mask:0xf
v_add_f32_dpp v29, v29, v29 row_ror:4 row_mask:0xf bank_mask:0xf
s_mov_b32 exec_lo, 0xf
s_mov_b32 exec_hi, 0xf
v_fma_f32 v28, v28, v26, v36
v_fma_f32 v29, v29, v26, v37
v_cvt_pk_bf16_f32 v28, v28, v29
buffer_store_dword v28, v23, s[24:27], s89 offen offset:896 sc1
s_mov_b64 exec, -1
s_nop 1
s_branch L_47
L_49:
v_lshlrev_b32 v28, 16, v58
v_and_b32 v29, 0xffff0000, v58
v_pk_fma_f32 v[28:29], v[28:29], v[184:185], v[184:185] op_sel:[0,0,1] op_sel_hi:[1,0,1]
v_lshlrev_b32 v30, 16, v59
v_and_b32 v31, 0xffff0000, v59
v_pk_fma_f32 v[30:31], v[30:31], v[184:185], v[184:185] op_sel:[0,0,1] op_sel_hi:[1,0,1]
v_lshlrev_b32 v32, 16, v60
v_and_b32 v33, 0xffff0000, v60
v_pk_fma_f32 v[32:33], v[32:33], v[184:185], v[184:185] op_sel:[0,0,1] op_sel_hi:[1,0,1]
v_lshlrev_b32 v34, 16, v61
v_and_b32 v35, 0xffff0000, v61
v_pk_fma_f32 v[34:35], v[34:35], v[184:185], v[184:185] op_sel:[0,0,1] op_sel_hi:[1,0,1]
v_lshlrev_b32 v36, 16, v62
v_and_b32 v37, 0xffff0000, v62
v_pk_fma_f32 v[36:37], v[36:37], v[184:185], v[184:185] op_sel:[0,0,1] op_sel_hi:[1,0,1]
v_lshlrev_b32 v38, 16, v63
v_and_b32 v39, 0xffff0000, v63
v_pk_fma_f32 v[38:39], v[38:39], v[184:185], v[184:185] op_sel:[0,0,1] op_sel_hi:[1,0,1]
v_lshlrev_b32 v40, 16, v64
v_and_b32 v41, 0xffff0000, v64
v_pk_fma_f32 v[40:41], v[40:41], v[184:185], v[184:185] op_sel:[0,0,1] op_sel_hi:[1,0,1]
v_lshlrev_b32 v42, 16, v65
v_and_b32 v43, 0xffff0000, v65
v_pk_fma_f32 v[42:43], v[42:43], v[184:185], v[184:185] op_sel:[0,0,1] op_sel_hi:[1,0,1]
v_lshlrev_b32 v44, 16, v66
v_and_b32 v45, 0xffff0000, v66
v_pk_fma_f32 v[44:45], v[44:45], v[184:185], v[184:185] op_sel:[0,0,1] op_sel_hi:[1,0,1]
v_lshlrev_b32 v46, 16, v67
v_and_b32 v47, 0xffff0000, v67
v_pk_fma_f32 v[46:47], v[46:47], v[184:185], v[184:185] op_sel:[0,0,1] op_sel_hi:[1,0,1]
ds_read_b128 v[68:71], v180 offset:32256
ds_read_b128 v[72:75], v180 offset:33280
ds_read_b128 v[76:79], v180 offset:34304
ds_read_b128 v[80:83], v180 offset:35328
ds_read_b128 v[84:87], v182 offset:36352
ds_read_b128 v[88:91], v180 offset:36864
ds_read_b128 v[92:95], v180 offset:37888
ds_read_b128 v[96:99], v180 offset:38912
ds_read_b128 v[100:103], v180 offset:39936
ds_read_b128 v[104:107], v182 offset:40960
ds_read_b128 v[224:227], v5 offset:0
ds_read_b128 v[228:231], v5 offset:1024
ds_read_b128 v[232:235], v5 offset:2048
ds_read_b128 v[236:239], v5 offset:3072
ds_read_b128 v[240:243], v181 offset:4096
ds_read_b128 v[244:247], v5 offset:4608
ds_read_b128 v[248:251], v5 offset:5632
ds_read_b128 v[252:255], v5 offset:6656
ds_read_b128 a[0:3], v5 offset:7680
ds_read_b128 a[4:7], v181 offset:8704
ds_read_b128 a[8:11], v5 offset:9216
ds_read_b128 a[12:15], v5 offset:10240
ds_read_b128 a[16:19], v5 offset:11264
ds_read_b128 a[20:23], v5 offset:12288
ds_read_b128 a[24:27], v181 offset:13312
s_waitcnt vmcnt(0) lgkmcnt(0)
s_branch L_50
L_62:
s_waitcnt vmcnt(0) lgkmcnt(0)
s_sub_u32 s82, s82, 1
s_cbranch_scc1 L_exit
s_barrier
s_mov_b32 s8, 0
s_mov_b32 s12, 331776
s_add_u32 s89, s89, 32768
s_branch L_59
L_hotend:
L_slow:
s_waitcnt vmcnt(0) lgkmcnt(0)
v_mov_b32 v44, -1
v_mov_b32 v45, -1
v_mov_b32 v46, -1
v_mov_b32 v47, -1
s_lshl_b32 s1, s76, 2
s_add_u32 s1, s1, s77
s_mul_i32 s1, s1, 2560
v_add_u32 v48, s1, v5
buffer_store_dwordx4 v[44:47], v48, s[24:27], s84 offen offset:0 sc1
buffer_store_dwordx4 v[44:47], v48, s[24:27], s84 offen offset:1024 sc1
s_mov_b32 exec_hi, 0
buffer_store_dwordx4 v[44:47], v48, s[24:27], s84 offen offset:2048 sc1
s_mov_b64 exec, -1
s_waitcnt vmcnt(0) lgkmcnt(0)
s_barrier
s_cmp_eq_u32 s77, 0
s_cbranch_scc0 L_96
s_lshl_b32 s4, s78, 10
s_add_u32 s4, s4, 3080192
s_lshl_b32 s5, s76, 7
s_add_u32 s5, s5, s4
v_mov_b32 v44, s80
v_lshlrev_b32 v45, 7, v0
s_mov_b64 exec, 1
buffer_store_dword v44, v45, s[24:27], s5 offen sc1
s_mov_b64 exec, 255
P_97:
s_sub_u32 s82, s82, 1
s_cbranch_scc1 L_exit
buffer_load_dword v46, v45, s[24:27], s4 offen sc1
s_waitcnt vmcnt(0)
v_cmp_ne_u32 vcc, s80, v46
s_cbranch_vccnz P_97
s_mov_b64 exec, -1
L_96:
s_barrier
s_mul_i32 s3, s77, 20480
s_mul_i32 s4, s76, 82944
s_add_u32 s4, s4, s3
v_mul_f32 v38, 0x3eae1a93, v29
v_mul_f32 v39, 0x3eae1a93, v31
v_mul_f32 v40, 0x3eae1a93, v33
v_mul_f32 v41, 0x3eae1a93, v35
v_mul_f32 v42, 0x3eae1a93, v37
v_mov_b32 v56, v148
v_mov_b32 v57, v148
v_mov_b32_dpp v52, v168 row_newbcast:0 row_mask:0xf bank_mask:0xf
v_mov_b32_dpp v53, v169 row_newbcast:0 row_mask:0xf bank_mask:0xf
v_mov_b32_dpp v54, v170 row_newbcast:0 row_mask:0xf bank_mask:0xf
v_mov_b32_dpp v55, v171 row_newbcast:0 row_mask:0xf bank_mask:0xf
v_mov_b32_dpp v48, v128 row_newbcast:0 row_mask:0xf bank_mask:0xf
s_add_u32 m0, s3, 0
s_add_u32 s5, s4, 2228224
buffer_load_dwordx4 v5, s[24:27], s5 offen offset:0 sc1 lds
v_mov_b32_dpp v49, v129 row_newbcast:0 row_mask:0xf bank_mask:0xf
v_mov_b32_dpp v50, v130 row_newbcast:0 row_mask:0xf bank_mask:0xf
v_mov_b32_dpp v51, v131 row_newbcast:0 row_mask:0xf bank_mask:0xf
v_mov_b32_dpp v44, v108 row_newbcast:0 row_mask:0xf bank_mask:0xf
v_mov_b32_dpp v45, v109 row_newbcast:0 row_mask:0xf bank_mask:0xf
v_mov_b32_dpp v46, v110 row_newbcast:0 row_mask:0xf bank_mask:0xf
v_mov_b32_dpp v47, v111 row_newbcast:0 row_mask:0xf bank_mask:0xf
v_permlane32_swap_b32 v56, v57
s_lshl_b32 s1, s77, 8
s_add_u32 s1, s1, 159104
v_lshl_add_u32 v26, v7, 4, s1
v_lshl_add_u32 v27, v6, 2, s1
ds_write_b128 v26, v[44:47] offset:0
ds_write_b128 v26, v[48:51] offset:64
ds_write_b128 v26, v[52:55] offset:128
ds_write_b32 v27, v56 offset:192
v_pk_fma_f32 v[168:169], v[52:53], v[28:29], v[168:169] op_sel_hi:[1,0,1]
v_pk_fma_f32 v[170:171], v[54:55], v[28:29], v[170:171] op_sel_hi:[1,0,1]
v_pk_fma_f32 v[128:129], v[48:49], v[28:29], v[128:129] op_sel_hi:[1,0,1]
v_pk_fma_f32 v[130:131], v[50:51], v[28:29], v[130:131] op_sel_hi:[1,0,1]
buffer_load_dwordx4 v5, s[24:27], s5 offen offset:1024 sc1 lds
v_pk_mul_f32 v[168:169], v[168:169], v[28:29] op_sel:[0,1] op_sel_hi:[1,1]
v_pk_mul_f32 v[170:171], v[170:171], v[38:39] op_sel:[0,0] op_sel_hi:[1,0]
v_pk_mul_f32 v[128:129], v[128:129], v[38:39] op_sel:[0,0] op_sel_hi:[1,0]
v_pk_mul_f32 v[130:131], v[130:131], v[38:39] op_sel:[0,0] op_sel_hi:[1,0]
v_pk_fma_f32 v[148:149], v[68:69], v[56:57], v[148:149] op_sel_hi:[1,0,1]
v_pk_fma_f32 v[150:151], v[70:71], v[56:57], v[150:151] op_sel_hi:[1,0,1]
v_pk_mul_f32 v[148:149], v[148:149], v[72:73]
v_pk_mul_f32 v[150:151], v[150:151], v[74:75]
v_cvt_pk_bf16_f32 v110, v168, v169
v_mov_b32 v111, 0x3f80
v_cvt_pk_bf16_f32 v128, v128, v129
v_cvt_pk_bf16_f32 v129, v130, v131
buffer_load_dwordx4 v5, s[24:27], s5 offen offset:2048 sc1 lds
v_cvt_pk_bf16_f32 v130, v170, v171
v_mov_b32 v131, 0
v_mfma_f32_16x16x16_bf16 v[168:171], v[110:111], v[14:15], 0
v_cvt_pk_bf16_f32 v151, v150, v151
v_cvt_pk_bf16_f32 v150, v148, v149
ds_read_b128 v[68:71], v23 offset:128
ds_read_b128 v[72:75], v23 offset:448
v_pk_fma_f32 v[172:173], v[52:53], v[30:31], v[172:173] op_sel_hi:[1,0,1]
v_pk_fma_f32 v[174:175], v[54:55], v[30:31], v[174:175] op_sel_hi:[1,0,1]
v_pk_fma_f32 v[132:133], v[48:49], v[30:31], v[132:133] op_sel_hi:[1,0,1]
v_pk_fma_f32 v[134:135], v[50:51], v[30:31], v[134:135] op_sel_hi:[1,0,1]
v_pk_fma_f32 v[112:113], v[44:45], v[30:31], v[112:113] op_sel_hi:[1,0,1]
buffer_load_dwordx4 v5, s[24:27], s5 offen offset:3072 sc1 lds
v_pk_fma_f32 v[114:115], v[46:47], v[30:31], v[114:115] op_sel_hi:[1,0,1]
v_pk_mul_f32 v[172:173], v[172:173], v[30:31] op_sel:[0,1] op_sel_hi:[1,1]
v_pk_mul_f32 v[174:175], v[174:175], v[38:39] op_sel:[0,1] op_sel_hi:[1,1]
v_pk_mul_f32 v[132:133], v[132:133], v[38:39] op_sel:[0,1] op_sel_hi:[1,1]
v_pk_mul_f32 v[134:135], v[134:135], v[38:39] op_sel:[0,1] op_sel_hi:[1,1]
v_pk_mul_f32 v[112:113], v[112:113], v[30:31] op_sel:[0,1] op_sel_hi:[1,1]
v_pk_mul_f32 v[114:115], v[114:115], v[30:31] op_sel:[0,1] op_sel_hi:[1,1]
v_pk_fma_f32 v[152:153], v[76:77], v[56:57], v[152:153] op_sel_hi:[1,0,1]
v_pk_fma_f32 v[154:155], v[78:79], v[56:57], v[154:155] op_sel_hi:[1,0,1]
v_pk_mul_f32 v[152:153], v[152:153], v[80:81]
v_pk_mul_f32 v[154:155], v[154:155], v[82:83]
v_cvt_pk_bf16_f32 v112, v112, v113
s_add_u32 m0, s3, 4096
s_add_u32 s5, s4, 2232320
buffer_load_dwordx4 v5, s[24:27], s5 offen offset:0 sc1 lds
v_cvt_pk_bf16_f32 v113, v114, v115
v_cvt_pk_bf16_f32 v114, v172, v173
v_mov_b32 v115, 0x3f80
v_cvt_pk_bf16_f32 v132, v132, v133
v_cvt_pk_bf16_f32 v133, v134, v135
v_mfma_f32_16x16x32_bf16 v[108:111], v[128:131], v[112:115], v[8:11]
v_cvt_pk_bf16_f32 v134, v174, v175
v_mov_b32 v135, 0
v_mfma_f32_16x16x16_bf16 v[172:175], v[114:115], v[14:15], 0
v_cvt_pk_bf16_f32 v152, v152, v153
v_cvt_pk_bf16_f32 v153, v154, v155
v_mfma_f32_16x16x32_bf16 v[88:91], v[132:135], v[112:115], v[8:11]
buffer_load_dwordx4 v5, s[24:27], s5 offen offset:1024 sc1 lds
ds_read_b128 v[76:79], v23 offset:192
ds_read_b128 v[80:83], v23 offset:512
v_pk_fma_f32 v[176:177], v[52:53], v[32:33], v[176:177] op_sel_hi:[1,0,1]
v_pk_fma_f32 v[178:179], v[54:55], v[32:33], v[178:179] op_sel_hi:[1,0,1]
v_pk_fma_f32 v[136:137], v[48:49], v[32:33], v[136:137] op_sel_hi:[1,0,1]
v_pk_fma_f32 v[138:139], v[50:51], v[32:33], v[138:139] op_sel_hi:[1,0,1]
v_pk_fma_f32 v[116:117], v[44:45], v[32:33], v[116:117] op_sel_hi:[1,0,1]
v_pk_fma_f32 v[118:119], v[46:47], v[32:33], v[118:119] op_sel_hi:[1,0,1]
v_pk_mul_f32 v[176:177], v[176:177], v[32:33] op_sel:[0,1] op_sel_hi:[1,1]
v_pk_mul_f32 v[178:179], v[178:179], v[40:41] op_sel:[0,0] op_sel_hi:[1,0]
v_pk_mul_f32 v[136:137], v[136:137], v[40:41] op_sel:[0,0] op_sel_hi:[1,0]
v_pk_mul_f32 v[138:139], v[138:139], v[40:41] op_sel:[0,0] op_sel_hi:[1,0]
buffer_load_dwordx4 v5, s[24:27], s5 offen offset:2048 sc1 lds
v_pk_mul_f32 v[116:117], v[116:117], v[32:33] op_sel:[0,1] op_sel_hi:[1,1]
v_pk_mul_f32 v[118:119], v[118:119], v[32:33] op_sel:[0,1] op_sel_hi:[1,1]
s_waitcnt lgkmcnt(3)
v_pk_fma_f32 v[156:157], v[68:69], v[56:57], v[156:157] op_sel_hi:[1,0,1]
v_pk_fma_f32 v[158:159], v[70:71], v[56:57], v[158:159] op_sel_hi:[1,0,1]
s_waitcnt lgkmcnt(2)
v_pk_mul_f32 v[156:157], v[156:157], v[72:73]
v_pk_mul_f32 v[158:159], v[158:159], v[74:75]
v_cvt_pk_bf16_f32 v116, v116, v117
v_cvt_pk_bf16_f32 v117, v118, v119
v_cvt_pk_bf16_f32 v118, v176, v177
v_mov_b32 v119, 0x3f80
v_cvt_pk_bf16_f32 v136, v136, v137
v_cvt_pk_bf16_f32 v137, v138, v139
buffer_load_dwordx4 v5, s[24:27], s5 offen offset:3072 sc1 lds
v_mfma_f32_16x16x32_bf16 v[112:115], v[132:135], v[116:119], v[8:11]
v_cvt_pk_bf16_f32 v138, v178, v179
v_mov_b32 v139, 0
v_mfma_f32_16x16x16_bf16 v[176:179], v[118:119], v[14:15], 0
v_cvt_pk_bf16_f32 v154, v156, v157
v_cvt_pk_bf16_f32 v155, v158, v159
v_mfma_f32_16x16x32_bf16 v[92:95], v[136:139], v[116:119], v[8:11]
ds_read_b128 v[68:71], v23 offset:256
ds_read_b128 v[72:75], v23 offset:576
v_pk_fma_f32 v[180:181], v[52:53], v[34:35], v[180:181] op_sel_hi:[1,0,1]
v_pk_fma_f32 v[182:183], v[54:55], v[34:35], v[182:183] op_sel_hi:[1,0,1]
v_pk_fma_f32 v[140:141], v[48:49], v[34:35], v[140:141] op_sel_hi:[1,0,1]
s_add_u32 m0, s3, 8192
s_add_u32 s5, s4, 2236416
buffer_load_dwordx4 v5, s[24:27], s5 offen offset:0 sc1 lds
v_pk_fma_f32 v[142:143], v[50:51], v[34:35], v[142:143] op_sel_hi:[1,0,1]
v_pk_fma_f32 v[120:121], v[44:45], v[34:35], v[120:121] op_sel_hi:[1,0,1]
v_pk_fma_f32 v[122:123], v[46:47], v[34:35], v[122:123] op_sel_hi:[1,0,1]
v_pk_mul_f32 v[180:181], v[180:181], v[34:35] op_sel:[0,1] op_sel_hi:[1,1]
v_pk_mul_f32 v[182:183], v[182:183], v[40:41] op_sel:[0,1] op_sel_hi:[1,1]
v_pk_mul_f32 v[140:141], v[140:141], v[40:41] op_sel:[0,1] op_sel_hi:[1,1]
v_pk_mul_f32 v[142:143], v[142:143], v[40:41] op_sel:[0,1] op_sel_hi:[1,1]
v_pk_mul_f32 v[120:121], v[120:121], v[34:35] op_sel:[0,1] op_sel_hi:[1,1]
v_pk_mul_f32 v[122:123], v[122:123], v[34:35] op_sel:[0,1] op_sel_hi:[1,1]
s_waitcnt lgkmcnt(3)
v_pk_fma_f32 v[160:161], v[76:77], v[56:57], v[160:161] op_sel_hi:[1,0,1]
v_pk_fma_f32 v[162:163], v[78:79], v[56:57], v[162:163] op_sel_hi:[1,0,1]
s_waitcnt lgkmcnt(2)
v_pk_mul_f32 v[160:161], v[160:161], v[80:81]
buffer_load_dwordx4 v5, s[24:27], s5 offen offset:1024 sc1 lds
v_pk_mul_f32 v[162:163], v[162:163], v[82:83]
v_cvt_pk_bf16_f32 v120, v120, v121
v_cvt_pk_bf16_f32 v121, v122, v123
v_cvt_pk_bf16_f32 v122, v180, v181
v_mov_b32 v123, 0x3f80
v_cvt_pk_bf16_f32 v140, v140, v141
v_cvt_pk_bf16_f32 v141, v142, v143
v_mfma_f32_16x16x32_bf16 v[116:119], v[136:139], v[120:123], v[8:11]
v_cvt_pk_bf16_f32 v142, v182, v183
v_mov_b32 v143, 0
v_mfma_f32_16x16x16_bf16 v[180:183], v[122:123], v[14:15], 0
v_cvt_pk_bf16_f32 v156, v160, v161
buffer_load_dwordx4 v5, s[24:27], s5 offen offset:2048 sc1 lds
v_cvt_pk_bf16_f32 v157, v162, v163
v_mfma_f32_16x16x32_bf16 v[96:99], v[140:143], v[120:123], v[8:11]
v_pk_fma_f32 v[184:185], v[52:53], v[36:37], v[184:185] op_sel_hi:[1,0,1]
v_pk_fma_f32 v[186:187], v[54:55], v[36:37], v[186:187] op_sel_hi:[1,0,1]
v_pk_fma_f32 v[144:145], v[48:49], v[36:37], v[144:145] op_sel_hi:[1,0,1]
v_pk_fma_f32 v[146:147], v[50:51], v[36:37], v[146:147] op_sel_hi:[1,0,1]
v_pk_fma_f32 v[124:125], v[44:45], v[36:37], v[124:125] op_sel_hi:[1,0,1]
v_pk_fma_f32 v[126:127], v[46:47], v[36:37], v[126:127] op_sel_hi:[1,0,1]
v_pk_mul_f32 v[184:185], v[184:185], v[36:37] op_sel:[0,1] op_sel_hi:[1,1]
v_pk_mul_f32 v[186:187], v[186:187], v[42:43] op_sel:[0,0] op_sel_hi:[1,0]
v_pk_mul_f32 v[144:145], v[144:145], v[42:43] op_sel:[0,0] op_sel_hi:[1,0]
v_pk_mul_f32 v[146:147], v[146:147], v[42:43] op_sel:[0,0] op_sel_hi:[1,0]
buffer_load_dwordx4 v5, s[24:27], s5 offen offset:3072 sc1 lds
v_pk_mul_f32 v[124:125], v[124:125], v[36:37] op_sel:[0,1] op_sel_hi:[1,1]
v_pk_mul_f32 v[126:127], v[126:127], v[36:37] op_sel:[0,1] op_sel_hi:[1,1]
s_waitcnt lgkmcnt(1)
v_pk_fma_f32 v[164:165], v[68:69], v[56:57], v[164:165] op_sel_hi:[1,0,1]
v_pk_fma_f32 v[166:167], v[70:71], v[56:57], v[166:167] op_sel_hi:[1,0,1]
s_waitcnt lgkmcnt(0)
v_pk_mul_f32 v[164:165], v[164:165], v[72:73]
v_pk_mul_f32 v[166:167], v[166:167], v[74:75]
v_cvt_pk_bf16_f32 v124, v124, v125
v_cvt_pk_bf16_f32 v125, v126, v127
v_cvt_pk_bf16_f32 v126, v184, v185
v_mov_b32 v127, 0x3f80
v_cvt_pk_bf16_f32 v144, v144, v145
v_cvt_pk_bf16_f32 v145, v146, v147
s_add_u32 m0, s3, 12288
s_add_u32 s5, s4, 2240512
buffer_load_dwordx4 v5, s[24:27], s5 offen offset:0 sc1 lds
v_mfma_f32_16x16x32_bf16 v[120:123], v[140:143], v[124:127], v[8:11]
v_cvt_pk_bf16_f32 v146, v186, v187
v_mov_b32 v147, 0
v_mfma_f32_16x16x16_bf16 v[184:187], v[126:127], v[14:15], 0
v_cvt_pk_bf16_f32 v158, v164, v165
v_cvt_pk_bf16_f32 v159, v166, v167
v_mfma_f32_16x16x32_bf16 v[100:103], v[144:147], v[124:127], v[8:11]
v_pk_add_f32 v[108:109], v[108:109], s[72:73]
v_pk_add_f32 v[110:111], v[110:111], s[72:73]
v_cndmask_b32 v88, v108, v88, s[64:65]
v_cndmask_b32 v89, v109, v89, s[66:67]
v_cndmask_b32 v90, v110, v90, s[68:69]
buffer_load_dwordx4 v5, s[24:27], s5 offen offset:1024 sc1 lds
v_cndmask_b32 v91, v111, v91, s[70:71]
v_max3_f32 v84, v88, v89, v90
v_max_f32 v84, v84, v91
v_cndmask_b32 v92, v112, v92, s[64:65]
v_cndmask_b32 v93, v113, v93, s[66:67]
v_cndmask_b32 v94, v114, v94, s[68:69]
v_cndmask_b32 v95, v115, v95, s[70:71]
v_max3_f32 v85, v92, v93, v94
v_max_f32 v85, v85, v95
v_cndmask_b32 v96, v116, v96, s[64:65]
v_cndmask_b32 v97, v117, v97, s[66:67]
v_cndmask_b32 v98, v118, v98, s[68:69]
buffer_load_dwordx4 v5, s[24:27], s5 offen offset:2048 sc1 lds
v_cndmask_b32 v99, v119, v99, s[70:71]
v_max3_f32 v86, v96, v97, v98
v_max_f32 v86, v86, v99
v_cndmask_b32 v100, v120, v100, s[64:65]
v_cndmask_b32 v101, v121, v101, s[66:67]
v_cndmask_b32 v102, v122, v102, s[68:69]
v_cndmask_b32 v103, v123, v103, s[70:71]
v_max3_f32 v87, v100, v101, v102
v_max_f32 v87, v87, v103
v_permlane32_swap_b32 v84, v85
v_cvt_pk_bf16_f32 v168, v168, v169
v_permlane32_swap_b32 v86, v87
buffer_load_dwordx4 v5, s[24:27], s5 offen offset:3072 sc1 lds
v_max_f32 v84, v84, v85
v_max_f32 v86, v86, v87
v_cvt_pk_bf16_f32 v169, v170, v171
v_cvt_pk_bf16_f32 v170, v172, v173
v_permlane16_swap_b32 v84, v86
v_max_f32 v84, v84, v86
v_mov_b32 v86, v84
v_cvt_pk_bf16_f32 v171, v174, v175
v_cvt_pk_bf16_f32 v172, v176, v177
v_permlane16_swap_b32 v84, v86
v_mov_b32 v85, v84
v_mov_b32 v87, v86
s_add_u32 m0, s3, 16384
s_add_u32 s5, s4, 2244608
buffer_load_dwordx4 v5, s[24:27], s5 offen offset:0 sc1 lds
v_cvt_pk_bf16_f32 v173, v178, v179
v_permlane32_swap_b32 v84, v85
v_permlane32_swap_b32 v86, v87
v_cvt_pk_bf16_f32 v174, v180, v181
v_cvt_pk_bf16_f32 v175, v182, v183
v_cvt_pk_bf16_f32 v176, v184, v185
v_cvt_pk_bf16_f32 v177, v186, v187
v_pk_add_f32 v[88:89], v[88:89], v[84:85] op_sel:[0,0] op_sel_hi:[1,0] neg_lo:[0,1] neg_hi:[0,1]
v_pk_add_f32 v[90:91], v[90:91], v[84:85] op_sel:[0,0] op_sel_hi:[1,0] neg_lo:[0,1] neg_hi:[0,1]
v_pk_add_f32 v[92:93], v[92:93], v[84:85] op_sel:[0,1] op_sel_hi:[1,1] neg_lo:[0,1] neg_hi:[0,1]
v_pk_add_f32 v[94:95], v[94:95], v[84:85] op_sel:[0,1] op_sel_hi:[1,1] neg_lo:[0,1] neg_hi:[0,1]
v_pk_add_f32 v[96:97], v[96:97], v[86:87] op_sel:[0,0] op_sel_hi:[1,0] neg_lo:[0,1] neg_hi:[0,1]
buffer_load_dwordx4 v5, s[24:27], s5 offen offset:1024 sc1 lds
v_pk_add_f32 v[98:99], v[98:99], v[86:87] op_sel:[0,0] op_sel_hi:[1,0] neg_lo:[0,1] neg_hi:[0,1]
v_pk_add_f32 v[100:101], v[100:101], v[86:87] op_sel:[0,1] op_sel_hi:[1,1] neg_lo:[0,1] neg_hi:[0,1]
v_pk_add_f32 v[102:103], v[102:103], v[86:87] op_sel:[0,1] op_sel_hi:[1,1] neg_lo:[0,1] neg_hi:[0,1]
v_exp_f32 v88, v88
v_exp_f32 v89, v89
v_exp_f32 v90, v90
v_exp_f32 v91, v91
v_cvt_pk_bf16_f32 v130, v88, v89
v_cvt_pk_bf16_f32 v131, v90, v91
v_bfi_b32 v128, v12, 0, v130
v_bfi_b32 v129, v13, 0, v131
v_and_b32 v130, v12, v130
buffer_load_dwordx4 v5, s[24:27], s5 offen offset:2048 sc1 lds
v_and_b32 v131, v13, v131
v_exp_f32 v92, v92
v_exp_f32 v93, v93
v_mfma_f32_16x16x32_bf16 v[68:71], v[168:171], v[128:131], 0
v_exp_f32 v94, v94
v_mfma_f32_16x16x32_bf16 v[88:91], v[150:153], v[128:131], 0
v_exp_f32 v95, v95
v_cvt_pk_bf16_f32 v134, v92, v93
v_cvt_pk_bf16_f32 v135, v94, v95
v_bfi_b32 v132, v12, 0, v134
v_bfi_b32 v133, v13, 0, v135
v_and_b32 v134, v12, v134
buffer_load_dwordx4 v5, s[24:27], s5 offen offset:3072 sc1 lds
v_and_b32 v135, v13, v135
v_exp_f32 v96, v96
v_exp_f32 v97, v97
v_mfma_f32_16x16x32_bf16 v[72:75], v[170:173], v[132:135], 0
v_exp_f32 v98, v98
v_mfma_f32_16x16x32_bf16 v[92:95], v[152:155], v[132:135], 0
v_exp_f32 v99, v99
v_cvt_pk_bf16_f32 v138, v96, v97
v_cvt_pk_bf16_f32 v139, v98, v99
v_bfi_b32 v136, v12, 0, v138
v_bfi_b32 v137, v13, 0, v139
v_and_b32 v138, v12, v138
s_add_u32 m0, s3, 20480
s_add_u32 s5, s4, 2248704
buffer_load_dwordx4 v5, s[24:27], s5 offen offset:0 sc1 lds
v_and_b32 v139, v13, v139
v_exp_f32 v100, v100
v_exp_f32 v101, v101
v_mfma_f32_16x16x32_bf16 v[76:79], v[172:175], v[136:139], 0
v_exp_f32 v102, v102
v_mfma_f32_16x16x32_bf16 v[96:99], v[154:157], v[136:139], 0
v_exp_f32 v103, v103
v_cvt_pk_bf16_f32 v142, v100, v101
v_cvt_pk_bf16_f32 v143, v102, v103
v_bfi_b32 v140, v12, 0, v142
v_bfi_b32 v141, v13, 0, v143
v_and_b32 v142, v12, v142
v_and_b32 v143, v13, v143
v_rcp_f32 v70, v70
v_rcp_f32 v74, v74
v_mfma_f32_16x16x32_bf16 v[80:83], v[174:177], v[140:143], 0
v_rcp_f32 v78, v78
v_mfma_f32_16x16x32_bf16 v[100:103], v[156:159], v[140:143], 0
s_mul_i32 s7, s77, 252
s_sub_u32 s7, s87, s7
s_add_u32 s6, s86, 32768
v_pk_mul_f32 v[88:89], v[88:89], v[70:71] op_sel_hi:[1,0]
v_pk_mul_f32 v[90:91], v[90:91], v[70:71] op_sel_hi:[1,0]
v_pk_mul_f32 v[68:69], v[68:69], v[70:71] op_sel_hi:[1,0]
v_cvt_pk_bf16_f32 v108, v88, v89
v_cvt_pk_bf16_f32 v109, v90, v91
v_cvt_pk_bf16_f32 v116, v68, v69
v_pk_mul_f32 v[92:93], v[92:93], v[74:75] op_sel_hi:[1,0]
v_pk_mul_f32 v[94:95], v[94:95], v[74:75] op_sel_hi:[1,0]
v_pk_mul_f32 v[72:73], v[72:73], v[74:75] op_sel_hi:[1,0]
v_cvt_pk_bf16_f32 v110, v92, v93
v_cvt_pk_bf16_f32 v111, v94, v95
v_cvt_pk_bf16_f32 v117, v72, v73
v_rcp_f32 v82, v82
v_pk_mul_f32 v[96:97], v[96:97], v[78:79] op_sel_hi:[1,0]
v_pk_mul_f32 v[98:99], v[98:99], v[78:79] op_sel_hi:[1,0]
v_pk_mul_f32 v[76:77], v[76:77], v[78:79] op_sel_hi:[1,0]
v_cvt_pk_bf16_f32 v112, v96, v97
v_cvt_pk_bf16_f32 v113, v98, v99
v_cvt_pk_bf16_f32 v118, v76, v77
v_permlane16_swap_b32 v108, v110
v_permlane16_swap_b32 v109, v111
buffer_store_dwordx4 v[108:111], v17, s[24:27], s86 offen sc1
v_pk_mul_f32 v[100:101], v[100:101], v[82:83] op_sel_hi:[1,0]
v_pk_mul_f32 v[102:103], v[102:103], v[82:83] op_sel_hi:[1,0]
v_pk_mul_f32 v[80:81], v[80:81], v[82:83] op_sel_hi:[1,0]
v_cvt_pk_bf16_f32 v114, v100, v101
v_cvt_pk_bf16_f32 v115, v102, v103
v_cvt_pk_bf16_f32 v119, v80, v81
v_mov_b32_dpp v116, v117 quad_perm:[0,1,2,3] row_mask:2 bank_mask:0xf
s_nop 1
v_mov_b32_dpp v116, v118 quad_perm:[0,1,2,3] row_mask:4 bank_mask:0xf
v_permlane16_swap_b32 v112, v114
v_permlane16_swap_b32 v113, v115
v_mov_b32_dpp v116, v119 quad_perm:[0,1,2,3] row_mask:8 bank_mask:0xf
buffer_store_dwordx4 v[112:115], v17, s[24:27], s6 offen sc1
buffer_store_dword v116, v5, s[24:27], s7 offen sc1
s_add_u32 s63, s80, 0
v_lshlrev_b32 v26, 10, v7
v_lshl_add_u32 v26, v6, 4, v26
s_lshl_b32 s3, s77, 14
s_add_u32 s3, s3, s84
s_lshl_b32 s5, s77, 8
s_add_u32 s5, s5, s84
s_add_u32 s5, s5, 65536
s_add_u32 s6, s5, 4096
v_add_u32 v180, 41472, v5
v_and_b32 v181, 7, v0
v_lshlrev_b32 v181, 4, v181
v_lshl_add_u32 v181, v7, 7, v181
v_add_u32 v182, 41472, v181
v_lshlrev_b32 v28, 16, v58
v_and_b32 v29, 0xffff0000, v58
v_lshlrev_b32 v30, 16, v59
v_and_b32 v31, 0xffff0000, v59
v_lshlrev_b32 v32, 16, v60
v_and_b32 v33, 0xffff0000, v60
v_lshlrev_b32 v34, 16, v61
v_and_b32 v35, 0xffff0000, v61
v_lshlrev_b32 v36, 16, v62
v_and_b32 v37, 0xffff0000, v62
v_lshlrev_b32 v38, 16, v63
v_and_b32 v39, 0xffff0000, v63
v_lshlrev_b32 v40, 16, v64
v_and_b32 v41, 0xffff0000, v64
v_lshlrev_b32 v42, 16, v65
v_and_b32 v43, 0xffff0000, v65
v_lshlrev_b32 v44, 16, v66
v_and_b32 v45, 0xffff0000, v66
v_lshlrev_b32 v46, 16, v67
v_and_b32 v47, 0xffff0000, v67
s_waitcnt vmcnt(3)
s_barrier
ds_read_b128 v[68:71], v180 offset:32256
ds_read_b128 v[72:75], v180 offset:33280
ds_read_b128 v[76:79], v180 offset:34304
ds_read_b128 v[80:83], v180 offset:35328
ds_read_b128 v[84:87], v182 offset:36352
ds_read_b128 v[88:91], v180 offset:36864
ds_read_b128 v[92:95], v180 offset:37888
ds_read_b128 v[96:99], v180 offset:38912
s_waitcnt vmcnt(0)
buffer_load_dwordx4 v[172:175], v26, s[24:27], s5 offen sc1
buffer_load_dwordx4 v[176:179], v26, s[24:27], s6 offen sc1
s_add_u32 s4, s3, 0
buffer_load_dwordx4 v[108:111], v5, s[24:27], s4 offen offset:0 sc1
buffer_load_dwordx4 v[112:115], v5, s[24:27], s4 offen offset:1024 sc1
ds_read_b128 v[100:103], v180 offset:39936
ds_read_b128 v[104:107], v182 offset:40960
ds_read_b128 v[188:191], v5 offset:0
ds_read_b128 v[192:195], v5 offset:1024
ds_read_b128 v[196:199], v5 offset:2048
ds_read_b128 v[200:203], v5 offset:3072
ds_read_b128 v[204:207], v181 offset:4096
ds_read_b128 v[208:211], v5 offset:4608
ds_read_b128 v[212:215], v5 offset:5632
ds_read_b128 v[216:219], v5 offset:6656
L_98:
s_waitcnt vmcnt(3)
v_max_u32 v183, v172, v173
v_max3_u32 v183, v183, v174, v175
s_waitcnt vmcnt(2)
v_max3_u32 v183, v183, v176, v177
v_max3_u32 v183, v183, v178, v179
v_cmp_eq_u32 vcc, -1, v183
s_cbranch_vccz L_101
L_100:
s_sub_u32 s82, s82, 1
s_cbranch_scc1 L_exit
s_waitcnt vmcnt(0)
buffer_load_dwordx4 v[172:175], v26, s[24:27], s5 offen sc1
buffer_load_dwordx4 v[176:179], v26, s[24:27], s6 offen sc1
s_add_u32 s4, s3, 0
buffer_load_dwordx4 v[108:111], v5, s[24:27], s4 offen offset:0 sc1
buffer_load_dwordx4 v[112:115], v5, s[24:27], s4 offen offset:1024 sc1
s_waitcnt vmcnt(0)
s_branch L_98
L_101:
buffer_load_dwordx4 v[116:119], v5, s[24:27], s4 offen offset:2048 sc1
buffer_load_dwordx4 v[120:123], v5, s[24:27], s4 offen offset:3072 sc1
s_add_u32 s4, s3, 4096
buffer_load_dwordx4 v[124:127], v5, s[24:27], s4 offen offset:0 sc1
buffer_load_dwordx4 v[128:131], v5, s[24:27], s4 offen offset:1024 sc1
ds_read_b128 v[220:223], v5 offset:7680
s_waitcnt lgkmcnt(15)
v_mfma_f32_16x16x32_bf16 v[28:31], v[68:71], v[172:175], v[28:31]
buffer_load_dwordx4 v[132:135], v5, s[24:27], s4 offen offset:2048 sc1
ds_read_b128 v[68:71], v181 offset:8704
v_mfma_f32_16x16x32_bf16 v[32:35], v[72:75], v[172:175], v[32:35]
s_mul_i32 s7, s76, 144
s_add_u32 s7, s7, 162560
v_lshl_add_u32 v22, v7, 4, s7
ds_read_b128 v[72:75], v5 offset:9216
v_mfma_f32_16x16x32_bf16 v[36:39], v[76:79], v[172:175], v[36:39]
v_and_b32 v23, 1, v7
v_lshl_add_u32 v23, v23, 3, s7
ds_read_b128 v[76:79], v5 offset:10240
v_mfma_f32_16x16x32_bf16 v[40:43], v[80:83], v[172:175], v[40:43]
ds_read_b128 v[48:51], v22
ds_read_b128 v[80:83], v5 offset:11264
s_waitcnt lgkmcnt(15)
v_mfma_f32_16x16x32_bf16 v[44:47], v[84:87], v[172:175], v[44:47]
ds_read_b128 v[52:55], v22 offset:64
ds_read_b128 v[84:87], v5 offset:12288
v_mfma_f32_16x16x32_bf16 v[28:31], v[88:91], v[176:179], v[28:31]
buffer_load_dwordx4 v[136:139], v5, s[24:27], s4 offen offset:3072 sc1
ds_read_b128 v[88:91], v181 offset:13312
v_mfma_f32_16x16x32_bf16 v[32:35], v[92:95], v[176:179], v[32:35]
ds_read_b64 v[56:57], v23 offset:128
ds_read_b128 v[92:95], v5 offset:13824
v_mfma_f32_16x16x32_bf16 v[36:39], v[96:99], v[176:179], v[36:39]
v_lshrrev_b32 v22, 3, v6
ds_read_b128 v[96:99], v5 offset:14848
v_mfma_f32_16x16x32_bf16 v[40:43], v[100:103], v[176:179], v[40:43]
v_mul_u32_u24 v22, 9216, v22
ds_read_b128 v[100:103], v5 offset:15872
s_waitcnt lgkmcnt(15)
v_mfma_f32_16x16x32_bf16 v[44:47], v[104:107], v[176:179], v[44:47]
v_add_u32 v1, v22, v181
ds_read_b128 v[104:107], v5 offset:16896
s_waitcnt vmcnt(7)
v_mfma_f32_16x16x32_bf16 v[28:31], v[188:191], v[108:111], v[28:31]
s_add_u32 s4, s3, 8192
buffer_load_dwordx4 v[140:143], v5, s[24:27], s4 offen offset:0 sc1
ds_read_b128 v[188:191], v181 offset:17920
v_mfma_f32_16x16x32_bf16 v[32:35], v[192:195], v[108:111], v[32:35]
v_add_u32 v2, 512, v1
ds_read_b128 v[192:195], v5 offset:18432
v_mfma_f32_16x16x32_bf16 v[36:39], v[196:199], v[108:111], v[36:39]
v_max3_u32 v183, v183, v108, v109
ds_read_b128 v[196:199], v5 offset:19456
v_mfma_f32_16x16x32_bf16 v[40:43], v[200:203], v[108:111], v[40:43]
v_max3_u32 v183, v183, v110, v111
ds_read_b128 v[200:203], v5 offset:20480
v_mfma_f32_16x16x32_bf16 v[44:47], v[204:207], v[108:111], v[44:47]
v_cmp_gt_u32 vcc, 8, v6
ds_read_b128 v[204:207], v5 offset:21504
s_waitcnt vmcnt(7)
v_mfma_f32_16x16x32_bf16 v[28:31], v[208:211], v[112:115], v[28:31]
buffer_load_dwordx4 v[144:147], v5, s[24:27], s4 offen offset:1024 sc1
ds_read_b128 v[208:211], v181 offset:22528
s_waitcnt lgkmcnt(15)
v_mfma_f32_16x16x32_bf16 v[32:35], v[212:215], v[112:115], v[32:35]
v_mov_b32 v22, 74752
ds_read_b128 v[212:215], v5 offset:23040
v_mfma_f32_16x16x32_bf16 v[36:39], v[216:219], v[112:115], v[36:39]
v_max3_u32 v183, v183, v112, v113
ds_read_b128 v[216:219], v5 offset:24064
v_mfma_f32_16x16x32_bf16 v[40:43], v[220:223], v[112:115], v[40:43]
v_max3_u32 v183, v183, v114, v115
ds_read_b128 v[220:223], v5 offset:25088
v_mfma_f32_16x16x32_bf16 v[44:47], v[68:71], v[112:115], v[44:47]
v_add_u32 v3, 64512, v1
ds_read_b128 v[68:71], v5 offset:26112
s_waitcnt vmcnt(7)
v_mfma_f32_16x16x32_bf16 v[28:31], v[72:75], v[116:119], v[28:31]
buffer_load_dwordx4 v[148:151], v5, s[24:27], s4 offen offset:2048 sc1
ds_read_b128 v[72:75], v181 offset:27136
v_mfma_f32_16x16x32_bf16 v[32:35], v[76:79], v[116:119], v[32:35]
v_add_u32 v4, 64512, v2
ds_read_b128 v[76:79], v5 offset:27648
s_waitcnt lgkmcnt(15)
v_mfma_f32_16x16x32_bf16 v[36:39], v[80:83], v[116:119], v[36:39]
v_max3_u32 v183, v183, v116, v117
ds_read_b128 v[80:83], v5 offset:28672
v_mfma_f32_16x16x32_bf16 v[40:43], v[84:87], v[116:119], v[40:43]
v_max3_u32 v183, v183, v118, v119
ds_read_b128 v[84:87], v5 offset:29696
v_mfma_f32_16x16x32_bf16 v[44:47], v[88:91], v[116:119], v[44:47]
v_cndmask_b32 v3, v3, v22, vcc
ds_read_b128 v[88:91], v5 offset:30720
s_waitcnt vmcnt(7)
v_mfma_f32_16x16x32_bf16 v[28:31], v[92:95], v[120:123], v[28:31]
buffer_load_dwordx4 v[152:155], v5, s[24:27], s4 offen offset:3072 sc1
ds_read_b128 v[92:95], v181 offset:31744
s_waitcnt lgkmcnt(15)
v_mfma_f32_16x16x32_bf16 v[32:35], v[96:99], v[120:123], v[32:35]
v_cndmask_b32 v4, v4, v22, vcc
ds_read_b128 v[96:99], v5 offset:32256
v_mfma_f32_16x16x32_bf16 v[36:39], v[100:103], v[120:123], v[36:39]
v_max3_u32 v183, v183, v120, v121
ds_read_b128 v[100:103], v5 offset:33280
v_mfma_f32_16x16x32_bf16 v[40:43], v[104:107], v[120:123], v[40:43]
v_max3_u32 v183, v183, v122, v123
ds_read_b128 v[104:107], v5 offset:34304
v_mfma_f32_16x16x32_bf16 v[44:47], v[188:191], v[120:123], v[44:47]
s_lshl_b32 s7, s77, 4
ds_read_b128 v[188:191], v5 offset:35328
s_waitcnt vmcnt(7) lgkmcnt(15)
v_mfma_f32_16x16x32_bf16 v[28:31], v[192:195], v[124:127], v[28:31]
s_add_u32 s4, s3, 12288
buffer_load_dwordx4 v[156:159], v5, s[24:27], s4 offen offset:0 sc1
ds_read_b128 v[192:195], v181 offset:36352
v_mfma_f32_16x16x32_bf16 v[32:35], v[196:199], v[124:127], v[32:35]
s_add_u32 s7, s7, s76
ds_read_b128 v[196:199], v5 offset:36864
v_mfma_f32_16x16x32_bf16 v[36:39], v[200:203], v[124:127], v[36:39]
v_max3_u32 v183, v183, v124, v125
ds_read_b128 v[200:203], v5 offset:37888
v_mfma_f32_16x16x32_bf16 v[40:43], v[204:207], v[124:127], v[40:43]
v_max3_u32 v183, v183, v126, v127
ds_read_b128 v[204:207], v5 offset:38912
s_waitcnt lgkmcnt(15)
v_mfma_f32_16x16x32_bf16 v[44:47], v[208:211], v[124:127], v[44:47]
s_mul_i32 s7, s7, 1152
ds_read_b128 v[208:211], v5 offset:39936
s_waitcnt vmcnt(7)
v_mfma_f32_16x16x32_bf16 v[28:31], v[212:215], v[128:131], v[28:31]
buffer_load_dwordx4 v[160:163], v5, s[24:27], s4 offen offset:1024 sc1
ds_read_b128 v[212:215], v181 offset:40960
v_mfma_f32_16x16x32_bf16 v[32:35], v[216:219], v[128:131], v[32:35]
v_add_u32 v19, s7, v1
ds_read_b128 v[216:219], v180 offset:0
v_mfma_f32_16x16x32_bf16 v[36:39], v[220:223], v[128:131], v[36:39]
v_max3_u32 v183, v183, v128, v129
ds_read_b128 v[220:223], v180 offset:1024
s_waitcnt lgkmcnt(15)
v_mfma_f32_16x16x32_bf16 v[40:43], v[68:71], v[128:131], v[40:43]
v_max3_u32 v183, v183, v130, v131
ds_read_b128 v[68:71], v180 offset:2048
v_mfma_f32_16x16x32_bf16 v[44:47], v[72:75], v[128:131], v[44:47]
v_add_u32 v20, 512, v19
ds_read_b128 v[72:75], v180 offset:3072
s_waitcnt vmcnt(7)
v_mfma_f32_16x16x32_bf16 v[28:31], v[76:79], v[132:135], v[28:31]
buffer_load_dwordx4 v[164:167], v5, s[24:27], s4 offen offset:2048 sc1
ds_read_b128 v[76:79], v182 offset:4096
v_mfma_f32_16x16x32_bf16 v[32:35], v[80:83], v[132:135], v[32:35]
v_lshlrev_b32 v22, 7, v7
ds_read_b128 v[80:83], v180 offset:4608
s_waitcnt lgkmcnt(15)
v_mfma_f32_16x16x32_bf16 v[36:39], v[84:87], v[132:135], v[36:39]
v_max3_u32 v183, v183, v132, v133
ds_read_b128 v[84:87], v180 offset:5632
v_mfma_f32_16x16x32_bf16 v[40:43], v[88:91], v[132:135], v[40:43]
v_max3_u32 v183, v183, v134, v135
ds_read_b128 v[88:91], v180 offset:6656
v_mfma_f32_16x16x32_bf16 v[44:47], v[92:95], v[132:135], v[44:47]
v_sub_u32 v22, v19, v22
ds_read_b128 v[92:95], v180 offset:7680
s_waitcnt vmcnt(7)
v_mfma_f32_16x16x32_bf16 v[28:31], v[96:99], v[136:139], v[28:31]
buffer_load_dwordx4 v[168:171], v5, s[24:27], s4 offen offset:3072 sc1
ds_read_b128 v[96:99], v182 offset:8704
s_waitcnt lgkmcnt(15)
v_mfma_f32_16x16x32_bf16 v[32:35], v[100:103], v[136:139], v[32:35]
v_and_b32 v23, 1, v7
ds_read_b128 v[100:103], v180 offset:9216
v_mfma_f32_16x16x32_bf16 v[36:39], v[104:107], v[136:139], v[36:39]
v_max3_u32 v183, v183, v136, v137
ds_read_b128 v[104:107], v180 offset:10240
v_mfma_f32_16x16x32_bf16 v[40:43], v[188:191], v[136:139], v[40:43]
v_max3_u32 v183, v183, v138, v139
ds_read_b128 v[188:191], v180 offset:11264
v_mfma_f32_16x16x32_bf16 v[44:47], v[192:195], v[136:139], v[44:47]
v_lshl_add_u32 v22, v23, 3, v22
ds_read_b128 v[192:195], v180 offset:12288
s_waitcnt vmcnt(7) lgkmcnt(15)
v_mfma_f32_16x16x32_bf16 v[28:31], v[196:199], v[140:143], v[28:31]
v_add_u32 v21, 1024, v22
ds_read_b128 v[196:199], v182 offset:13312
v_mfma_f32_16x16x32_bf16 v[32:35], v[200:203], v[140:143], v[32:35]
v_add_u32 v22, 0, v0
v_min_u32 v22, 40, v22
ds_read_b128 v[200:203], v180 offset:13824
v_mfma_f32_16x16x32_bf16 v[36:39], v[204:207], v[140:143], v[36:39]
v_max3_u32 v183, v183, v140, v141
ds_read_b128 v[204:207], v180 offset:14848
v_mfma_f32_16x16x32_bf16 v[40:43], v[208:211], v[140:143], v[40:43]
v_max3_u32 v183, v183, v142, v143
ds_read_b128 v[208:211], v180 offset:15872
s_waitcnt lgkmcnt(15)
v_mfma_f32_16x16x32_bf16 v[44:47], v[212:215], v[140:143], v[44:47]
s_mul_i32 s1, s77, 41
s_sub_u32 s1, s1, 0
v_add_u32 v22, s1, v22
v_min_u32 v22, 161, v22
ds_read_b128 v[212:215], v180 offset:16896
s_waitcnt vmcnt(6)
v_mfma_f32_16x16x32_bf16 v[28:31], v[216:219], v[144:147], v[28:31]
v_mul_u32_u24 v23, 7282, v22
v_lshrrev_b32 v23, 16, v23
ds_read_b128 v[216:219], v182 offset:17920
v_mfma_f32_16x16x32_bf16 v[32:35], v[220:223], v[144:147], v[32:35]
v_mul_u32_u24 v23, 8064, v23
v_lshl_add_u32 v22, v22, 7, v23
ds_read_b128 v[220:223], v180 offset:18432
v_mfma_f32_16x16x32_bf16 v[36:39], v[68:71], v[144:147], v[36:39]
v_max3_u32 v183, v183, v144, v145
ds_read_b128 v[68:71], v180 offset:19456
s_waitcnt lgkmcnt(15)
v_mfma_f32_16x16x32_bf16 v[40:43], v[72:75], v[144:147], v[40:43]
v_max3_u32 v183, v183, v146, v147
ds_read_b128 v[72:75], v180 offset:20480
v_mfma_f32_16x16x32_bf16 v[44:47], v[76:79], v[144:147], v[44:47]
s_mul_i32 s1, s75, 144
s_add_u32 s1, s1, s74
s_mul_i32 s1, s1, 1152
s_mov_b32 s34, 5308416
buffer_load_dword v18, v22, s[32:35], s1 offen
s_mov_b32 s34, s95
ds_read_b128 v[76:79], v180 offset:21504
s_waitcnt vmcnt(6)
v_mfma_f32_16x16x32_bf16 v[28:31], v[80:83], v[148:151], v[28:31]
v_add_u32 v22, 0, v0
v_min_u32 v22, 40, v22
ds_read_b128 v[80:83], v182 offset:22528
v_mfma_f32_16x16x32_bf16 v[32:35], v[84:87], v[148:151], v[32:35]
s_mul_i32 s1, s77, 41
s_sub_u32 s1, s1, 0
v_add_u32 v22, s1, v22
v_min_u32 v22, 161, v22
ds_read_b128 v[84:87], v180 offset:23040
s_waitcnt lgkmcnt(15)
v_mfma_f32_16x16x32_bf16 v[36:39], v[88:91], v[148:151], v[36:39]
v_max3_u32 v183, v183, v148, v149
ds_read_b128 v[88:91], v180 offset:24064
v_mfma_f32_16x16x32_bf16 v[40:43], v[92:95], v[148:151], v[40:43]
v_max3_u32 v183, v183, v150, v151
ds_read_b128 v[92:95], v180 offset:25088
v_mfma_f32_16x16x32_bf16 v[44:47], v[96:99], v[148:151], v[44:47]
v_mul_u32_u24 v23, 7282, v22
v_lshrrev_b32 v23, 16, v23
ds_read_b128 v[96:99], v180 offset:26112
s_waitcnt vmcnt(5)
v_mfma_f32_16x16x32_bf16 v[28:31], v[100:103], v[152:155], v[28:31]
v_mul_u32_u24 v23, 8064, v23
v_lshl_add_u32 v22, v22, 7, v23
ds_read_b128 v[100:103], v182 offset:27136
s_waitcnt lgkmcnt(15)
v_mfma_f32_16x16x32_bf16 v[32:35], v[104:107], v[152:155], v[32:35]
s_mul_i32 s1, s75, 144
s_add_u32 s1, s1, s74
s_mul_i32 s1, s1, 1152
s_mov_b32 s38, 5308416
buffer_load_dword v18, v22, s[36:39], s1 offen
s_mov_b32 s38, s95
ds_read_b128 v[104:107], v180 offset:27648
v_mfma_f32_16x16x32_bf16 v[36:39], v[188:191], v[152:155], v[36:39]
v_max3_u32 v183, v183, v152, v153
ds_read_b128 v[188:191], v180 offset:28672
v_mfma_f32_16x16x32_bf16 v[40:43], v[192:195], v[152:155], v[40:43]
v_max3_u32 v183, v183, v154, v155
ds_read_b128 v[192:195], v180 offset:29696
v_mfma_f32_16x16x32_bf16 v[44:47], v[196:199], v[152:155], v[44:47]
ds_read_b128 v[196:199], v180 offset:30720
s_waitcnt vmcnt(5) lgkmcnt(15)
v_mfma_f32_16x16x32_bf16 v[28:31], v[200:203], v[156:159], v[28:31]
ds_read_b128 v[200:203], v182 offset:31744
v_mfma_f32_16x16x32_bf16 v[32:35], v[204:207], v[156:159], v[32:35]
v_mfma_f32_16x16x32_bf16 v[36:39], v[208:211], v[156:159], v[36:39]
v_max3_u32 v183, v183, v156, v157
v_mfma_f32_16x16x32_bf16 v[40:43], v[212:215], v[156:159], v[40:43]
v_max3_u32 v183, v183, v158, v159
s_waitcnt lgkmcnt(15)
v_mfma_f32_16x16x32_bf16 v[44:47], v[216:219], v[156:159], v[44:47]
s_waitcnt vmcnt(4) lgkmcnt(14)
v_mfma_f32_16x16x32_bf16 v[28:31], v[220:223], v[160:163], v[28:31]
s_waitcnt lgkmcnt(13)
v_mfma_f32_16x16x32_bf16 v[32:35], v[68:71], v[160:163], v[32:35]
s_waitcnt lgkmcnt(12)
v_mfma_f32_16x16x32_bf16 v[36:39], v[72:75], v[160:163], v[36:39]
v_max3_u32 v183, v183, v160, v161
s_waitcnt lgkmcnt(11)
v_mfma_f32_16x16x32_bf16 v[40:43], v[76:79], v[160:163], v[40:43]
v_max3_u32 v183, v183, v162, v163
s_waitcnt lgkmcnt(10)
v_mfma_f32_16x16x32_bf16 v[44:47], v[80:83], v[160:163], v[44:47]
s_waitcnt vmcnt(3) lgkmcnt(9)
v_mfma_f32_16x16x32_bf16 v[28:31], v[84:87], v[164:167], v[28:31]
s_waitcnt lgkmcnt(8)
v_mfma_f32_16x16x32_bf16 v[32:35], v[88:91], v[164:167], v[32:35]
s_waitcnt lgkmcnt(7)
v_mfma_f32_16x16x32_bf16 v[36:39], v[92:95], v[164:167], v[36:39]
v_max3_u32 v183, v183, v164, v165
s_waitcnt lgkmcnt(6)
v_mfma_f32_16x16x32_bf16 v[40:43], v[96:99], v[164:167], v[40:43]
v_max3_u32 v183, v183, v166, v167
s_waitcnt lgkmcnt(5)
v_mfma_f32_16x16x32_bf16 v[44:47], v[100:103], v[164:167], v[44:47]
s_waitcnt vmcnt(2) lgkmcnt(4)
v_mfma_f32_16x16x32_bf16 v[28:31], v[104:107], v[168:171], v[28:31]
s_waitcnt lgkmcnt(3)
v_mfma_f32_16x16x32_bf16 v[32:35], v[188:191], v[168:171], v[32:35]
s_waitcnt lgkmcnt(2)
v_mfma_f32_16x16x32_bf16 v[36:39], v[192:195], v[168:171], v[36:39]
v_max3_u32 v183, v183, v168, v169
s_waitcnt lgkmcnt(1)
v_mfma_f32_16x16x32_bf16 v[40:43], v[196:199], v[168:171], v[40:43]
v_max3_u32 v183, v183, v170, v171
s_waitcnt lgkmcnt(0)
v_mfma_f32_16x16x32_bf16 v[44:47], v[200:203], v[168:171], v[44:47]
v_cmp_eq_u32 vcc, -1, v183
s_cbranch_vccnz L_99
s_mov_b32 s3, 1065369472
s_add_u32 s4, s84, 81920
v_cvt_pk_bf16_f32 v108, v28, v29
v_cvt_pk_bf16_f32 v109, v30, v31
v_cvt_pk_bf16_f32 v110, v32, v33
v_cvt_pk_bf16_f32 v111, v34, v35
buffer_store_dwordx4 v[108:111], v19, s[24:27], s4 offen offset:0 sc1
v_cvt_pk_bf16_f32 v112, v36, v37
v_cvt_pk_bf16_f32 v113, v38, v39
v_cvt_pk_bf16_f32 v114, v40, v41
v_cvt_pk_bf16_f32 v115, v42, v43
buffer_store_dwordx4 v[112:115], v19, s[24:27], s4 offen offset:512 sc1
v_cvt_pk_bf16_f32 v116, v44, v45
v_cvt_pk_bf16_f32 v117, v46, v47
v_dot2_f32_bf16 v120, v108, s3, 0
v_dot2_f32_bf16 v121, v108, v108, 0
v_dot2_f32_bf16 v122, v108, v48, 0
s_mov_b32 exec_hi, 0
v_dot2_f32_bf16 v120, v116, s3, v120
v_dot2_f32_bf16 v121, v116, v116, v121
v_dot2_f32_bf16 v122, v116, v56, v122
v_dot2_f32_bf16 v120, v117, s3, v120
v_dot2_f32_bf16 v121, v117, v117, v121
v_dot2_f32_bf16 v122, v117, v57, v122
s_mov_b64 exec, -1
v_permlane16_swap_b32 v116, v118
v_permlane16_swap_b32 v117, v119
s_mov_b64 exec, 65535
buffer_store_dwordx4 v[116:119], v19, s[24:27], s4 offen offset:1024 sc1
s_mov_b64 exec, -1
v_dot2_f32_bf16 v120, v109, s3, v120
v_dot2_f32_bf16 v121, v109, v109, v121
v_dot2_f32_bf16 v122, v109, v49, v122
v_dot2_f32_bf16 v120, v110, s3, v120
v_dot2_f32_bf16 v121, v110, v110, v121
v_dot2_f32_bf16 v122, v110, v50, v122
v_dot2_f32_bf16 v120, v111, s3, v120
v_dot2_f32_bf16 v121, v111, v111, v121
v_dot2_f32_bf16 v122, v111, v51, v122
v_dot2_f32_bf16 v120, v112, s3, v120
v_dot2_f32_bf16 v121, v112, v112, v121
v_dot2_f32_bf16 v122, v112, v52, v122
v_dot2_f32_bf16 v120, v113, s3, v120
v_dot2_f32_bf16 v121, v113, v113, v121
v_dot2_f32_bf16 v122, v113, v53, v122
v_dot2_f32_bf16 v120, v114, s3, v120
v_dot2_f32_bf16 v121, v114, v114, v121
v_dot2_f32_bf16 v122, v114, v54, v122
v_dot2_f32_bf16 v120, v115, s3, v120
v_dot2_f32_bf16 v121, v115, v115, v121
v_dot2_f32_bf16 v122, v115, v55, v122
v_mov_b32 v123, s63
v_permlane32_swap_b32 v120, v124
v_permlane32_swap_b32 v121, v125
v_permlane32_swap_b32 v122, v126
v_add_f32 v120, v120, v124
v_add_f32 v121, v121, v125
v_add_f32 v122, v122, v126
v_permlane16_swap_b32 v120, v124
v_permlane16_swap_b32 v121, v125
v_permlane16_swap_b32 v122, v126
v_add_f32 v120, v120, v124
v_add_f32 v121, v121, v125
v_add_f32 v122, v122, v126
s_lshl_b32 s4, s77, 8
s_add_u32 s4, s4, s84
s_add_u32 s4, s4, 73728
s_add_u32 s5, s4, 4096
s_barrier
s_cmp_eq_u32 s77, 2
s_cbranch_scc0 L_102
v_mul_u32_u24 v22, 1168, v0
v_add_u32 v22, 74752, v22
v_mov_b32 v68, 1065369472
v_mov_b32 v69, 1065369472
v_mov_b32 v70, 1065369472
v_mov_b32 v71, 1065369472
s_mov_b64 exec, 511
ds_write_b128 v22, v[68:71]
s_mov_b64 exec, -1
L_102:
s_mul_i32 s62, s77, 18432
s_add_u32 s92, s84, 81920
s_add_u32 s92, s92, s62
v_bfe_u32 v22, v0, 2, 2
v_lshl_add_u32 v22, v7, 3, v22
v_mul_u32_u24 v22, 1152, v22
v_and_b32 v23, 3, v0
v_lshl_add_u32 v22, v23, 3, v22
s_mul_i32 s3, s77, 288
s_add_u32 s3, s3, 121216
v_add_u32 v22, s3, v22
ds_read_b64_tr_b16 v[188:189], v22 offset:0
ds_read_b64_tr_b16 v[190:191], v22 offset:4608
ds_read_b64_tr_b16 v[192:193], v22 offset:32
ds_read_b64_tr_b16 v[194:195], v22 offset:4640
ds_read_b64_tr_b16 v[196:197], v22 offset:64
ds_read_b64_tr_b16 v[198:199], v22 offset:4672
ds_read_b64_tr_b16 v[200:201], v22 offset:96
ds_read_b64_tr_b16 v[202:203], v22 offset:4704
ds_read_b64_tr_b16 v[204:205], v22 offset:128
ds_read_b64_tr_b16 v[206:207], v22 offset:4736
ds_read_b64_tr_b16 v[208:209], v22 offset:160
ds_read_b64_tr_b16 v[210:211], v22 offset:4768
ds_read_b64_tr_b16 v[212:213], v22 offset:192
ds_read_b64_tr_b16 v[214:215], v22 offset:4800
ds_read_b64_tr_b16 v[216:217], v22 offset:224
ds_read_b64_tr_b16 v[218:219], v22 offset:4832
ds_read_b64_tr_b16 v[220:221], v22 offset:256
ds_read_b64_tr_b16 v[222:223], v22 offset:4864
v_mul_u32_u24 v55, 9216, v7
v_lshl_add_u32 v55, v6, 2, v55
s_lshl_b32 s1, s77, 4
s_add_u32 s1, s1, 158080
v_lshl_add_u32 v53, v0, 1, s1
v_lshlrev_b32 v54, 4, v7
v_add_u32 v54, 158080, v54
v_bfe_u32 v56, v0, 1, 1
v_lshlrev_b32 v57, 1, v56
v_and_or_b32 v57, v7, 1, v57
v_xor_b32 v57, s77, v57
v_mul_u32_u24 v56, 36864, v56
v_lshl_add_u32 v56, v57, 4, v56
v_lshrrev_b32 v57, 2, v0
v_lshl_add_u32 v56, v57, 6, v56
v_and_b32 v57, 1, v0
v_lshl_add_u32 v56, v57, 3, v56
v_add_u32 v56, 84352, v56
v_and_b32 v57, 3, v0
v_lshl_add_u32 v57, v57, 2, v7
v_lshlrev_b32 v57, 4, v57
v_add_u32 v57, 161408, v57
v_mul_u32_u24 v50, 7282, v0
v_lshrrev_b32 v50, 16, v50
v_mul_u32_u24 v50, 3952, v50
v_add_u32 v50, v50, v5
s_waitcnt vmcnt(0)
s_mov_b64 exec, 65535
buffer_store_dwordx4 v[120:123], v5, s[24:27], s88 offen sc1
s_mov_b64 exec, -1
s_waitcnt vmcnt(0)
buffer_load_dwordx4 v[128:131], v26, s[24:27], s4 offen sc1
buffer_load_dwordx4 v[132:135], v26, s[24:27], s5 offen sc1
v_mov_b32 v175, 163792
ds_read_b32 v175, v175
v_lshlrev_b32 v22, 4, v7
v_mov_b32 v139, s80
s_lshl_b32 s3, s77, 4
v_or_b32 v141, s3, v6
s_add_u32 s3, s3, 163728
v_mov_b32 v23, s3
v_and_b32 v173, 3, v0
v_lshlrev_b32 v173, 4, v173
v_add_u32 v173, 163728, v173
v_lshrrev_b32 v174, 2, v0
v_lshlrev_b32 v174, 13, v174
s_lshl_b32 s3, s78, 8
s_add_u32 s3, s3, 2949120
s_mov_b32 s7, -64
v_mov_b32 v176, 163796
v_mov_b32 v177, 1
s_branch C_103
R_104:
s_sub_u32 s82, s82, 1
s_cbranch_scc1 L_exit
s_waitcnt vmcnt(0)
buffer_load_dwordx4 v[128:131], v26, s[24:27], s4 offen sc1
buffer_load_dwordx4 v[132:135], v26, s[24:27], s5 offen sc1
s_waitcnt vmcnt(0)
C_103:
s_waitcnt vmcnt(1)
v_cmp_ne_u32 s[52:53], s63, v131
s_waitcnt vmcnt(0)
v_cmp_ne_u32 vcc, s63, v135
s_or_b64 vcc, vcc, s[52:53]
s_cbranch_vccnz R_104
s_add_u32 m0, s62, 0
s_add_u32 s1, s92, 0
buffer_load_dwordx4 v5, s[24:27], s1 offen sc1 lds
s_add_u32 m0, s62, 9216
s_add_u32 s1, s92, 9216
buffer_load_dwordx4 v5, s[24:27], s1 offen sc1 lds
s_add_u32 m0, s62, 1024
s_add_u32 s1, s92, 1024
buffer_load_dwordx4 v5, s[24:27], s1 offen sc1 lds
s_add_u32 m0, s62, 10240
s_add_u32 s1, s92, 10240
buffer_load_dwordx4 v5, s[24:27], s1 offen sc1 lds
v_add_f32 v128, v128, v132
v_add_f32 v129, v129, v133
v_add_f32 v130, v130, v134
v_mov_b32 v132, v128
v_mov_b32 v133, v129
v_mov_b32 v134, v130
v_permlane32_swap_b32 v128, v132
v_permlane32_swap_b32 v129, v133
v_permlane32_swap_b32 v130, v134
v_add_f32 v128, v128, v132
v_add_f32 v129, v129, v133
v_add_f32 v130, v130, v134
v_mov_b32 v132, v128
v_mov_b32 v133, v129
v_mov_b32 v134, v130
v_permlane16_swap_b32 v128, v132
v_permlane16_swap_b32 v129, v133
v_permlane16_swap_b32 v130, v134
v_add_f32 v128, v128, v132
v_add_f32 v129, v129, v133
v_add_f32 v130, v130, v134
v_mul_f32 v128, 0xbae38e39, v128
v_mul_f32 v129, 0x3ae38e39, v129
v_fma_f32 v129, -v128, v128, v129
v_max_f32 v129, 0, v129
v_add_f32 v132, 0x3727c5ac, v129
v_rsq_f32 v131, v132
s_waitcnt lgkmcnt(0)
v_fma_f32 v136, v128, v175, v130
v_mul_f32 v136, v136, v131
v_ashrrev_i32 v140, 31, v136
v_lshrrev_b32 v140, 1, v140
v_xor_b32 v136, v136, v140
v_and_or_b32 v136, v136, s7, v141
v_mov_b32 v142, v131
v_mul_f32 v143, v128, v131
v_max_i32_dpp v140, v136, v136 row_ror:8 row_mask:0xf bank_mask:0xf
v_mul_f32 v138, v132, v131
v_sub_f32 v137, 0, v128
v_max_i32_dpp v140, v140, v140 row_ror:4 row_mask:0xf bank_mask:0xf
v_pk_fma_f32 v[164:165], v[44:45], v[142:143], v[142:143] op_sel:[0,0,1] op_sel_hi:[1,0,1]
v_pk_fma_f32 v[166:167], v[46:47], v[142:143], v[142:143] op_sel:[0,0,1] op_sel_hi:[1,0,1]
v_max_i32_dpp v140, v140, v140 row_ror:2 row_mask:0xf bank_mask:0xf
v_pk_fma_f32 v[148:149], v[28:29], v[142:143], v[142:143] op_sel:[0,0,1] op_sel_hi:[1,0,1]
v_pk_fma_f32 v[150:151], v[30:31], v[142:143], v[142:143] op_sel:[0,0,1] op_sel_hi:[1,0,1]
v_max_i32_dpp v140, v140, v140 row_ror:1 row_mask:0xf bank_mask:0xf
v_cmp_eq_u32 s[54:55], v136, v140
v_pk_fma_f32 v[152:153], v[32:33], v[142:143], v[142:143] op_sel:[0,0,1] op_sel_hi:[1,0,1]
v_pk_fma_f32 v[154:155], v[34:35], v[142:143], v[142:143] op_sel:[0,0,1] op_sel_hi:[1,0,1]
s_and_b64 exec, s[54:55], 0xffff
ds_write_b128 v23, v[136:139]
ds_add_rtn_u32 v176, v176, v177
s_mov_b64 exec, -1
ds_read_b128 v[168:171], v173
v_pk_fma_f32 v[156:157], v[36:37], v[142:143], v[142:143] op_sel:[0,0,1] op_sel_hi:[1,0,1]
v_pk_fma_f32 v[158:159], v[38:39], v[142:143], v[142:143] op_sel:[0,0,1] op_sel_hi:[1,0,1]
v_pk_fma_f32 v[160:161], v[40:41], v[142:143], v[142:143] op_sel:[0,0,1] op_sel_hi:[1,0,1]
v_pk_fma_f32 v[162:163], v[42:43], v[142:143], v[142:143] op_sel:[0,0,1] op_sel_hi:[1,0,1]
s_cmp_eq_u32 s76, 0
s_cbranch_scc0 L_105
s_waitcnt lgkmcnt(1)
v_cmp_eq_u32 vcc, 3, v176
s_cbranch_vccz L_106
s_waitcnt lgkmcnt(0)
v_max_i32_dpp v172, v168, v168 quad_perm:[1,0,3,2] row_mask:0xf bank_mask:0xf
s_nop 1
v_max_i32_dpp v172, v172, v172 quad_perm:[2,3,0,1] row_mask:0xf bank_mask:0xf
v_cmp_eq_u32 vcc, v168, v172
s_mov_b32 exec_hi, 0
s_mov_b32 exec_lo, vcc_lo
buffer_store_dwordx4 v[168:171], v174, s[24:27], s3 offen sc1
s_mov_b64 exec, -1
L_106:
L_105:
v_cvt_pk_bf16_f32 v116, v164, v165
v_cvt_pk_bf16_f32 v117, v166, v167
v_cvt_pk_bf16_f32 v108, v148, v149
v_cvt_pk_bf16_f32 v109, v150, v151
v_cvt_pk_bf16_f32 v110, v152, v153
v_cvt_pk_bf16_f32 v111, v154, v155
v_cvt_pk_bf16_f32 v112, v156, v157
v_cvt_pk_bf16_f32 v113, v158, v159
v_cvt_pk_bf16_f32 v114, v160, v161
v_cvt_pk_bf16_f32 v115, v162, v163
v_permlane16_swap_b32 v116, v118
v_permlane16_swap_b32 v117, v119
s_mov_b64 exec, s[54:55]
buffer_store_dwordx4 v[108:111], v22, s[24:27], s89 offen offset:640 sc1
buffer_store_dwordx4 v[112:115], v22, s[24:27], s89 offen offset:704 sc1
s_and_b64 exec, s[54:55], 0xffff
buffer_store_dwordx4 v[116:119], v22, s[24:27], s89 offen offset:768 sc1
s_mov_b64 exec, -1
s_add_u32 m0, s62, 2048
s_add_u32 s1, s92, 2048
buffer_load_dwordx4 v5, s[24:27], s1 offen sc1 lds
s_add_u32 m0, s62, 11264
s_add_u32 s1, s92, 11264
buffer_load_dwordx4 v5, s[24:27], s1 offen sc1 lds
s_add_u32 m0, s62, 3072
s_add_u32 s1, s92, 3072
buffer_load_dwordx4 v5, s[24:27], s1 offen sc1 lds
s_add_u32 m0, s62, 12288
s_add_u32 s1, s92, 12288
buffer_load_dwordx4 v5, s[24:27], s1 offen sc1 lds
s_add_u32 m0, s62, 4096
s_add_u32 s1, s92, 4096
buffer_load_dwordx4 v5, s[24:27], s1 offen sc1 lds
s_add_u32 m0, s62, 13312
s_add_u32 s1, s92, 13312
buffer_load_dwordx4 v5, s[24:27], s1 offen sc1 lds
v_add_f32 v133, 1.0, v131
v_mul_f32 v134, v133, v133
v_mul_f32 v134, v134, v129
v_add_f32 v134, 0x3727c5ac, v134
v_rsq_f32 v134, v134
s_nop 0
v_mul_f32 v134, v134, v133
s_lshl_b32 s3, s77, 6
s_add_u32 s3, s3, 160192
v_lshl_add_u32 v23, v6, 2, s3
v_mov_b32 v60, v128
v_mov_b32 v61, v134
v_mov_b32 v62, 0
v_mov_b32 v63, s80
s_mov_b64 exec, 65535
ds_write2_b32 v23, v128, v134 offset0:0 offset1:80
ds_write2_b32 v23, v133, v143 offset0:160 offset1:240
s_mov_b64 exec, -1
v_lshlrev_b32 v38, 8, v0
v_mov_b32 v44, 0
v_mov_b32 v45, 0
v_mov_b32 v46, 0
v_mov_b32 v47, 0
v_mov_b32 v37, 163712
s_waitcnt vmcnt(9)
s_waitcnt lgkmcnt(0)
s_barrier
ds_read_b128 v[84:87], v1 offset:0
ds_read_b128 v[88:91], v1 offset:18432
ds_read_b128 v[92:95], v1 offset:36864
ds_read_b128 v[96:99], v1 offset:55296
s_waitcnt lgkmcnt(3)
v_mfma_f32_16x16x32_bf16 v[112:115], a[0:3], v[84:87], 0
v_mfma_f32_16x16x32_bf16 v[132:135], a[4:7], v[84:87], 0
ds_read_b128 v[68:71], v2 offset:0
v_mfma_f32_16x16x32_bf16 v[152:155], v[84:87], a[8:11], 0
v_mfma_f32_16x16x32_bf16 v[172:175], a[12:15], v[84:87], 0
ds_read_b128 v[72:75], v2 offset:18432
s_waitcnt lgkmcnt(4)
v_mfma_f32_16x16x32_bf16 v[116:119], a[0:3], v[88:91], 0
v_mfma_f32_16x16x32_bf16 v[136:139], a[4:7], v[88:91], 0
ds_read_b128 v[76:79], v2 offset:36864
v_mfma_f32_16x16x32_bf16 v[156:159], v[88:91], a[8:11], 0
v_mfma_f32_16x16x32_bf16 v[176:179], a[12:15], v[88:91], 0
ds_read_b128 v[80:83], v2 offset:55296
s_waitcnt lgkmcnt(5)
v_mfma_f32_16x16x32_bf16 v[120:123], a[0:3], v[92:95], 0
v_mfma_f32_16x16x32_bf16 v[140:143], a[4:7], v[92:95], 0
s_add_u32 m0, s62, 5120
s_add_u32 s1, s92, 5120
buffer_load_dwordx4 v5, s[24:27], s1 offen sc1 lds
v_mfma_f32_16x16x32_bf16 v[160:163], v[92:95], a[8:11], 0
v_mfma_f32_16x16x32_bf16 v[180:183], a[12:15], v[92:95], 0
s_add_u32 m0, s62, 14336
s_add_u32 s1, s92, 14336
buffer_load_dwordx4 v5, s[24:27], s1 offen sc1 lds
s_waitcnt lgkmcnt(4)
v_mfma_f32_16x16x32_bf16 v[124:127], a[0:3], v[96:99], 0
v_mfma_f32_16x16x32_bf16 v[144:147], a[4:7], v[96:99], 0
s_add_u32 m0, s62, 6144
s_add_u32 s1, s92, 6144
buffer_load_dwordx4 v5, s[24:27], s1 offen sc1 lds
v_mfma_f32_16x16x32_bf16 v[164:167], v[96:99], a[8:11], 0
v_mfma_f32_16x16x32_bf16 v[184:187], a[12:15], v[96:99], 0
s_waitcnt lgkmcnt(3)
v_mfma_f32_16x16x32_bf16 v[112:115], a[16:19], v[68:71], v[112:115]
v_mfma_f32_16x16x32_bf16 v[132:135], a[20:23], v[68:71], v[132:135]
ds_read_b128 v[84:87], v1 offset:1024
v_mfma_f32_16x16x32_bf16 v[152:155], v[68:71], a[24:27], v[152:155]
v_mfma_f32_16x16x32_bf16 v[172:175], a[28:31], v[68:71], v[172:175]
ds_read_b128 v[88:91], v1 offset:19456
s_waitcnt lgkmcnt(4)
v_mfma_f32_16x16x32_bf16 v[116:119], a[16:19], v[72:75], v[116:119]
v_mfma_f32_16x16x32_bf16 v[136:139], a[20:23], v[72:75], v[136:139]
ds_read_b128 v[92:95], v1 offset:37888
v_mfma_f32_16x16x32_bf16 v[156:159], v[72:75], a[24:27], v[156:159]
v_mfma_f32_16x16x32_bf16 v[176:179], a[28:31], v[72:75], v[176:179]
ds_read_b128 v[96:99], v1 offset:56320
s_waitcnt lgkmcnt(5)
v_mfma_f32_16x16x32_bf16 v[120:123], a[16:19], v[76:79], v[120:123]
v_mfma_f32_16x16x32_bf16 v[140:143], a[20:23], v[76:79], v[140:143]
s_add_u32 m0, s62, 15360
s_add_u32 s1, s92, 15360
buffer_load_dwordx4 v5, s[24:27], s1 offen sc1 lds
v_mfma_f32_16x16x32_bf16 v[160:163], v[76:79], a[24:27], v[160:163]
v_mfma_f32_16x16x32_bf16 v[180:183], a[28:31], v[76:79], v[180:183]
s_add_u32 m0, s91, 84352
s_add_u32 s1, s90, 0
buffer_load_dwordx4 v24, s[32:35], s1 offen lds
s_waitcnt lgkmcnt(4)
v_mfma_f32_16x16x32_bf16 v[124:127], a[16:19], v[80:83], v[124:127]
v_mfma_f32_16x16x32_bf16 v[144:147], a[20:23], v[80:83], v[144:147]
s_add_u32 m0, s91, 88448
s_add_u32 s1, s90, 589824
buffer_load_dwordx4 v24, s[32:35], s1 offen lds
v_mfma_f32_16x16x32_bf16 v[164:167], v[80:83], a[24:27], v[164:167]
v_mfma_f32_16x16x32_bf16 v[184:187], a[28:31], v[80:83], v[184:187]
s_cmp_eq_u32 s77, 0
s_cbranch_scc0 L_107
s_lshl_b32 s1, s74, 13
s_add_u32 s1, s1, 2949120
s_mov_b32 exec_hi, 0
buffer_load_dwordx4 v[28:31], v38, s[24:27], s1 offen sc1
s_mov_b64 exec, -1
L_107:
s_waitcnt lgkmcnt(3)
v_mfma_f32_16x16x32_bf16 v[112:115], a[32:35], v[84:87], v[112:115]
v_mfma_f32_16x16x32_bf16 v[132:135], a[36:39], v[84:87], v[132:135]
ds_read_b128 v[68:71], v2 offset:1024
v_mfma_f32_16x16x32_bf16 v[152:155], v[84:87], a[40:43], v[152:155]
v_mfma_f32_16x16x32_bf16 v[172:175], a[44:47], v[84:87], v[172:175]
ds_read_b128 v[72:75], v2 offset:19456
s_waitcnt lgkmcnt(4)
v_mfma_f32_16x16x32_bf16 v[116:119], a[32:35], v[88:91], v[116:119]
v_mfma_f32_16x16x32_bf16 v[136:139], a[36:39], v[88:91], v[136:139]
ds_read_b128 v[76:79], v2 offset:37888
v_mfma_f32_16x16x32_bf16 v[156:159], v[88:91], a[40:43], v[156:159]
v_mfma_f32_16x16x32_bf16 v[176:179], a[44:47], v[88:91], v[176:179]
ds_read_b128 v[80:83], v2 offset:56320
s_waitcnt lgkmcnt(5)
v_mfma_f32_16x16x32_bf16 v[120:123], a[32:35], v[92:95], v[120:123]
v_mfma_f32_16x16x32_bf16 v[140:143], a[36:39], v[92:95], v[140:143]
s_add_u32 m0, s91, 92544
s_add_u32 s1, s90, 1179648
buffer_load_dwordx4 v24, s[32:35], s1 offen lds
v_mfma_f32_16x16x32_bf16 v[160:163], v[92:95], a[40:43], v[160:163]
v_mfma_f32_16x16x32_bf16 v[180:183], a[44:47], v[92:95], v[180:183]
s_add_u32 m0, s91, 96640
s_add_u32 s1, s90, 1769472
buffer_load_dwordx4 v24, s[32:35], s1 offen lds
s_waitcnt lgkmcnt(4)
v_mfma_f32_16x16x32_bf16 v[124:127], a[32:35], v[96:99], v[124:127]
v_mfma_f32_16x16x32_bf16 v[144:147], a[36:39], v[96:99], v[144:147]
s_add_u32 m0, s91, 100736
s_add_u32 s1, s90, 2359296
buffer_load_dwordx4 v24, s[32:35], s1 offen lds
v_mfma_f32_16x16x32_bf16 v[164:167], v[96:99], a[40:43], v[164:167]
v_mfma_f32_16x16x32_bf16 v[184:187], a[44:47], v[96:99], v[184:187]
v_mov_b32 v22, v53
v_mov_b32 v23, v54
v_mov_b32 v26, v55
s_waitcnt vmcnt(5)
s_cmp_eq_u32 s77, 3
s_cbranch_scc0 L_108
s_lshl_b32 s3, s76, 7
s_add_u32 s3, s3, s84
s_add_u32 s3, s3, 197504
s_mov_b64 exec, 65280
buffer_store_dwordx4 v[60:63], v5, s[24:27], s3 offen sc1
s_mov_b64 exec, -1
L_108:
s_barrier
s_waitcnt lgkmcnt(3)
v_mfma_f32_16x16x32_bf16 v[112:115], a[48:51], v[68:71], v[112:115]
v_mfma_f32_16x16x32_bf16 v[132:135], a[52:55], v[68:71], v[132:135]
ds_read_b128 v[84:87], v1 offset:2048
v_mfma_f32_16x16x32_bf16 v[152:155], v[68:71], a[56:59], v[152:155]
v_mfma_f32_16x16x32_bf16 v[172:175], a[60:63], v[68:71], v[172:175]
ds_read_b128 v[88:91], v1 offset:20480
s_waitcnt lgkmcnt(4)
v_mfma_f32_16x16x32_bf16 v[116:119], a[48:51], v[72:75], v[116:119]
v_mfma_f32_16x16x32_bf16 v[136:139], a[52:55], v[72:75], v[136:139]
ds_read_b128 v[92:95], v1 offset:38912
v_mfma_f32_16x16x32_bf16 v[156:159], v[72:75], a[56:59], v[156:159]
v_mfma_f32_16x16x32_bf16 v[176:179], a[60:63], v[72:75], v[176:179]
ds_read_b128 v[96:99], v1 offset:57344
s_waitcnt lgkmcnt(5)
v_mfma_f32_16x16x32_bf16 v[120:123], a[48:51], v[76:79], v[120:123]
v_mfma_f32_16x16x32_bf16 v[140:143], a[52:55], v[76:79], v[140:143]
s_add_u32 m0, s91, 104832
s_add_u32 s1, s90, 2949120
buffer_load_dwordx4 v24, s[32:35], s1 offen lds
v_mfma_f32_16x16x32_bf16 v[160:163], v[76:79], a[56:59], v[160:163]
v_mfma_f32_16x16x32_bf16 v[180:183], a[60:63], v[76:79], v[180:183]
s_add_u32 m0, s91, 108928
s_add_u32 s1, s90, 3538944
buffer_load_dwordx4 v24, s[32:35], s1 offen lds
s_waitcnt lgkmcnt(4)
v_mfma_f32_16x16x32_bf16 v[124:127], a[48:51], v[80:83], v[124:127]
v_mfma_f32_16x16x32_bf16 v[144:147], a[52:55], v[80:83], v[144:147]
s_add_u32 m0, s91, 113024
s_add_u32 s1, s90, 4128768
buffer_load_dwordx4 v24, s[32:35], s1 offen lds
v_mfma_f32_16x16x32_bf16 v[164:167], v[80:83], a[56:59], v[164:167]
v_mfma_f32_16x16x32_bf16 v[184:187], a[60:63], v[80:83], v[184:187]
s_waitcnt lgkmcnt(3)
v_mfma_f32_16x16x32_bf16 v[112:115], a[64:67], v[84:87], v[112:115]
v_mfma_f32_16x16x32_bf16 v[132:135], a[68:71], v[84:87], v[132:135]
ds_read_b128 v[68:71], v2 offset:2048
v_mfma_f32_16x16x32_bf16 v[152:155], v[84:87], a[72:75], v[152:155]
v_mfma_f32_16x16x32_bf16 v[172:175], a[76:79], v[84:87], v[172:175]
ds_read_b128 v[72:75], v2 offset:20480
s_waitcnt lgkmcnt(4)
v_mfma_f32_16x16x32_bf16 v[116:119], a[64:67], v[88:91], v[116:119]
v_mfma_f32_16x16x32_bf16 v[136:139], a[68:71], v[88:91], v[136:139]
ds_read_b128 v[76:79], v2 offset:38912
v_mfma_f32_16x16x32_bf16 v[156:159], v[88:91], a[72:75], v[156:159]
v_mfma_f32_16x16x32_bf16 v[176:179], a[76:79], v[88:91], v[176:179]
ds_read_b128 v[80:83], v2 offset:57344
s_waitcnt lgkmcnt(5)
v_mfma_f32_16x16x32_bf16 v[120:123], a[64:67], v[92:95], v[120:123]
v_mfma_f32_16x16x32_bf16 v[140:143], a[68:71], v[92:95], v[140:143]
s_add_u32 m0, s91, 117120
s_add_u32 s1, s90, 4718592
buffer_load_dwordx4 v24, s[32:35], s1 offen lds
v_mfma_f32_16x16x32_bf16 v[160:163], v[92:95], a[72:75], v[160:163]
v_mfma_f32_16x16x32_bf16 v[180:183], a[76:79], v[92:95], v[180:183]
s_add_u32 m0, s91, 121216
s_add_u32 s1, s90, 0
buffer_load_dwordx4 v25, s[36:39], s1 offen lds
s_waitcnt lgkmcnt(4)
v_mfma_f32_16x16x32_bf16 v[124:127], a[64:67], v[96:99], v[124:127]
v_mfma_f32_16x16x32_bf16 v[144:147], a[68:71], v[96:99], v[144:147]
s_add_u32 m0, s91, 125312
s_add_u32 s1, s90, 589824
buffer_load_dwordx4 v25, s[36:39], s1 offen lds
v_mfma_f32_16x16x32_bf16 v[164:167], v[96:99], a[72:75], v[164:167]
v_mfma_f32_16x16x32_bf16 v[184:187], a[76:79], v[96:99], v[184:187]
s_lshl_b32 s3, s77, 5
s_add_u32 s3, s3, s75
s_cmp_lt_u32 s3, 18
s_cbranch_scc0 L_109
s_waitcnt vmcnt(9)
v_cmp_ne_u32 vcc, s80, v31
v_bfrev_b32 v36, 1
s_mov_b32 s52, vcc_lo
v_cndmask_b32 v28, v28, v36, vcc
s_nop 1
v_max_i32_dpp v36, v28, v28 row_ror:8 row_mask:0xf bank_mask:0xf
v_mov_b32 v31, v0
s_nop 0
v_max_i32_dpp v36, v36, v36 row_ror:4 row_mask:0xf bank_mask:0xf
s_nop 1
v_max_i32_dpp v36, v36, v36 row_ror:2 row_mask:0xf bank_mask:0xf
s_nop 1
v_max_i32_dpp v36, v36, v36 row_ror:1 row_mask:0xf bank_mask:0xf
s_nop 0
v_readlane_b32 s3, v36, 0
v_readlane_b32 s4, v36, 16
s_max_i32 s57, s3, s4
v_cmp_eq_u32 vcc, s57, v28
s_bfe_u32 s5, s57, 0x20004
s_lshl_b32 s5, s5, 10
s_add_u32 s5, s5, 4350592
s_ff1_i32_b32 s3, vcc_lo
s_mul_i32 s4, s3, 286720
s_add_u32 s4, s4, s5
s_lshl_b32 s1, s74, 13
s_add_u32 s1, s1, 2949120
s_mov_b32 exec_lo, s52
s_mov_b32 exec_hi, 0
buffer_load_dwordx4 v[28:31], v38, s[24:27], s1 offen sc1
s_mov_b64 exec, -1
buffer_load_dwordx4 v[40:43], v50, s[24:27], s4 offen sc1
s_add_u32 s1, s4, 28688
s_mov_b64 exec, 255
buffer_load_dwordx4 v[44:47], v5, s[24:27], s1 offen sc1
s_mov_b64 exec, -1
L_109:
s_waitcnt lgkmcnt(3)
v_mfma_f32_16x16x32_bf16 v[112:115], a[80:83], v[68:71], v[112:115]
v_mfma_f32_16x16x32_bf16 v[132:135], a[84:87], v[68:71], v[132:135]
ds_read_b128 v[84:87], v1 offset:3072
v_mfma_f32_16x16x32_bf16 v[152:155], v[68:71], a[88:91], v[152:155]
v_mfma_f32_16x16x32_bf16 v[172:175], a[92:95], v[68:71], v[172:175]
ds_read_b128 v[88:91], v1 offset:21504
s_waitcnt lgkmcnt(4)
v_mfma_f32_16x16x32_bf16 v[116:119], a[80:83], v[72:75], v[116:119]
v_mfma_f32_16x16x32_bf16 v[136:139], a[84:87], v[72:75], v[136:139]
ds_read_b128 v[92:95], v1 offset:39936
v_mfma_f32_16x16x32_bf16 v[156:159], v[72:75], a[88:91], v[156:159]
v_mfma_f32_16x16x32_bf16 v[176:179], a[92:95], v[72:75], v[176:179]
ds_read_b128 v[96:99], v1 offset:58368
s_waitcnt lgkmcnt(5)
v_mfma_f32_16x16x32_bf16 v[120:123], a[80:83], v[76:79], v[120:123]
v_mfma_f32_16x16x32_bf16 v[140:143], a[84:87], v[76:79], v[140:143]
s_add_u32 m0, s91, 129408
s_add_u32 s1, s90, 1179648
buffer_load_dwordx4 v25, s[36:39], s1 offen lds
v_mfma_f32_16x16x32_bf16 v[160:163], v[76:79], a[88:91], v[160:163]
v_mfma_f32_16x16x32_bf16 v[180:183], a[92:95], v[76:79], v[180:183]
s_add_u32 m0, s91, 133504
s_add_u32 s1, s90, 1769472
buffer_load_dwordx4 v25, s[36:39], s1 offen lds
s_waitcnt lgkmcnt(4)
v_mfma_f32_16x16x32_bf16 v[124:127], a[80:83], v[80:83], v[124:127]
v_mfma_f32_16x16x32_bf16 v[144:147], a[84:87], v[80:83], v[144:147]
s_add_u32 m0, s91, 137600
s_add_u32 s1, s90, 2359296
buffer_load_dwordx4 v25, s[36:39], s1 offen lds
v_mfma_f32_16x16x32_bf16 v[164:167], v[80:83], a[88:91], v[164:167]
v_mfma_f32_16x16x32_bf16 v[184:187], a[92:95], v[80:83], v[184:187]
s_waitcnt lgkmcnt(3)
v_mfma_f32_16x16x32_bf16 v[112:115], a[96:99], v[84:87], v[112:115]
ds_read_b128 v[68:71], v2 offset:3072
v_mfma_f32_16x16x32_bf16 v[132:135], a[100:103], v[84:87], v[132:135]
ds_read_b128 v[72:75], v2 offset:21504
v_mfma_f32_16x16x32_bf16 v[152:155], v[84:87], a[104:107], v[152:155]
v_mfma_f32_16x16x32_bf16 v[172:175], a[108:111], v[84:87], v[172:175]
ds_read_b128 v[76:79], v2 offset:39936
s_waitcnt lgkmcnt(5)
v_mfma_f32_16x16x32_bf16 v[116:119], a[96:99], v[88:91], v[116:119]
v_mfma_f32_16x16x32_bf16 v[136:139], a[100:103], v[88:91], v[136:139]
ds_read_b128 v[80:83], v2 offset:58368
v_mfma_f32_16x16x32_bf16 v[156:159], v[88:91], a[104:107], v[156:159]
v_mfma_f32_16x16x32_bf16 v[176:179], a[108:111], v[88:91], v[176:179]
s_add_u32 m0, s91, 141696
s_add_u32 s1, s90, 2949120
buffer_load_dwordx4 v25, s[36:39], s1 offen lds
s_waitcnt lgkmcnt(5)
v_mfma_f32_16x16x32_bf16 v[120:123], a[96:99], v[92:95], v[120:123]
v_mfma_f32_16x16x32_bf16 v[140:143], a[100:103], v[92:95], v[140:143]
s_add_u32 m0, s91, 145792
s_add_u32 s1, s90, 3538944
buffer_load_dwordx4 v25, s[36:39], s1 offen lds
v_mfma_f32_16x16x32_bf16 v[160:163], v[92:95], a[104:107], v[160:163]
v_mfma_f32_16x16x32_bf16 v[180:183], a[108:111], v[92:95], v[180:183]
s_add_u32 m0, s91, 149888
s_add_u32 s1, s90, 4128768
buffer_load_dwordx4 v25, s[36:39], s1 offen lds
s_waitcnt lgkmcnt(4)
v_mfma_f32_16x16x32_bf16 v[124:127], a[96:99], v[96:99], v[124:127]
v_mfma_f32_16x16x32_bf16 v[144:147], a[100:103], v[96:99], v[144:147]
v_mov_b32 v100, -1
v_mov_b32 v101, -1
v_mov_b32 v102, -1
v_mov_b32 v103, -1
v_mfma_f32_16x16x32_bf16 v[164:167], v[96:99], a[104:107], v[164:167]
v_mfma_f32_16x16x32_bf16 v[184:187], a[108:111], v[96:99], v[184:187]
buffer_store_dwordx4 v[100:103], v17, s[24:27], s86 offen sc1
s_waitcnt lgkmcnt(3)
v_mfma_f32_16x16x32_bf16 v[112:115], a[112:115], v[68:71], v[112:115]
v_mfma_f32_16x16x32_bf16 v[132:135], a[116:119], v[68:71], v[132:135]
ds_read_b128 v[84:87], v1 offset:4096
v_mfma_f32_16x16x32_bf16 v[152:155], v[68:71], a[120:123], v[152:155]
v_mfma_f32_16x16x32_bf16 v[172:175], a[124:127], v[68:71], v[172:175]
ds_read_b128 v[88:91], v1 offset:22528
s_waitcnt lgkmcnt(4)
v_mfma_f32_16x16x32_bf16 v[116:119], a[112:115], v[72:75], v[116:119]
v_mfma_f32_16x16x32_bf16 v[136:139], a[116:119], v[72:75], v[136:139]
ds_read_b128 v[92:95], v1 offset:40960
v_mfma_f32_16x16x32_bf16 v[156:159], v[72:75], a[120:123], v[156:159]
v_mfma_f32_16x16x32_bf16 v[176:179], a[124:127], v[72:75], v[176:179]
ds_read_b128 v[96:99], v1 offset:59392
s_waitcnt lgkmcnt(5)
v_mfma_f32_16x16x32_bf16 v[120:123], a[112:115], v[76:79], v[120:123]
v_mfma_f32_16x16x32_bf16 v[140:143], a[116:119], v[76:79], v[140:143]
s_add_u32 m0, s91, 153984
s_add_u32 s1, s90, 4718592
buffer_load_dwordx4 v25, s[36:39], s1 offen lds
v_mfma_f32_16x16x32_bf16 v[160:163], v[76:79], a[120:123], v[160:163]
v_mfma_f32_16x16x32_bf16 v[180:183], a[124:127], v[76:79], v[180:183]
s_add_u32 s1, s86, 32768
buffer_store_dwordx4 v[100:103], v17, s[24:27], s1 offen sc1
s_waitcnt lgkmcnt(4)
v_mfma_f32_16x16x32_bf16 v[124:127], a[112:115], v[80:83], v[124:127]
v_mfma_f32_16x16x32_bf16 v[144:147], a[116:119], v[80:83], v[144:147]
s_mov_b64 exec, 65535
buffer_store_dwordx4 v[100:103], v5, s[24:27], s87 offen sc1
s_mov_b64 exec, -1
v_mfma_f32_16x16x32_bf16 v[164:167], v[80:83], a[120:123], v[164:167]
v_mfma_f32_16x16x32_bf16 v[184:187], a[124:127], v[80:83], v[184:187]
v_mov_b32 v24, v56
v_mov_b32 v25, v57
s_cmp_lt_u32 s75, 18
s_cbranch_scc0 L_110
s_cmp_eq_u32 s77, 0
s_cbranch_scc0 L_112
s_waitcnt vmcnt(12)
v_cmp_ne_u32 vcc, s80, v31
s_mov_b32 s9, vcc_lo
v_cmp_le_i32 vcc, s57, v28
s_or_b32 s9, s9, vcc_lo
s_and_b32 s9, s9, s52
s_waitcnt vmcnt(11)
v_max_u32 v48, v40, v41
v_max3_u32 v48, v48, v42, v43
s_waitcnt vmcnt(10)
v_max3_u32 v48, v48, v44, v45
v_max3_u32 v48, v48, v46, v47
v_cmp_eq_u32 vcc, -1, v48
v_add_u32 v48, 161408, v5
ds_write_b128 v48, v[40:43]
s_mov_b64 exec, 255
ds_write_b128 v48, v[44:47] offset:1024
s_mov_b64 exec, -1
s_lshl_b64 exec, 1, s3
ds_write_b128 v37, v[28:31]
s_mov_b64 exec, -1
s_or_b32 s9, s9, vcc_lo
s_or_b32 s9, s9, vcc_hi
s_cbranch_scc1 L_117
L_116:
L_112:
s_waitcnt vmcnt(2)
s_waitcnt lgkmcnt(0)
s_barrier
ds_read_b128 v[108:111], v25 offset:0
ds_read_b64_tr_b16 v[40:41], v24 offset:0
ds_read_b64_tr_b16 v[42:43], v24 offset:1024
ds_read_b64_tr_b16 v[44:45], v24 offset:2048
ds_read_b64_tr_b16 v[46:47], v24 offset:3072
ds_read_b64_tr_b16 v[48:49], v24 offset:4096
ds_read_b64_tr_b16 v[50:51], v24 offset:5120
ds_read_b128 v[128:131], v25 offset:192
ds_read_b64_tr_b16 v[52:53], v24 offset:6144
ds_read_b64_tr_b16 v[54:55], v24 offset:7168
ds_read_b64_tr_b16 v[56:57], v24 offset:8192
ds_read_b64_tr_b16 v[58:59], v24 offset:9216
ds_read_b64_tr_b16 v[60:61], v24 offset:10240
ds_read_b64_tr_b16 v[62:63], v24 offset:11264
ds_read_b128 v[148:151], v25 offset:384
ds_read_b64_tr_b16 v[64:65], v24 offset:12288
ds_read_b64_tr_b16 v[66:67], v24 offset:13312
s_waitcnt lgkmcnt(14)
v_mfma_f32_16x16x32_bf16 v[28:31], v[108:111], v[40:43], 0
ds_read_b64_tr_b16 v[40:41], v24 offset:14336
ds_read_b64_tr_b16 v[42:43], v24 offset:15360
s_waitcnt lgkmcnt(14)
v_mfma_f32_16x16x32_bf16 v[32:35], v[108:111], v[44:47], 0
ds_read_b64_tr_b16 v[44:45], v24 offset:16384
ds_read_b64_tr_b16 v[46:47], v24 offset:17408
s_waitcnt lgkmcnt(14)
v_mfma_f32_16x16x32_bf16 v[36:39], v[108:111], v[48:51], 0
ds_read_b128 v[168:171], v25 offset:576
ds_read_b64_tr_b16 v[48:49], v24 offset:18432
ds_read_b64_tr_b16 v[50:51], v24 offset:19456
s_waitcnt lgkmcnt(14)
v_mfma_f32_16x16x32_bf16 v[28:31], v[128:131], v[52:55], v[28:31]
ds_read_b64_tr_b16 v[52:53], v24 offset:20480
ds_read_b64_tr_b16 v[54:55], v24 offset:21504
s_waitcnt lgkmcnt(14)
v_mfma_f32_16x16x32_bf16 v[32:35], v[128:131], v[56:59], v[32:35]
ds_read_b64_tr_b16 v[56:57], v24 offset:22528
ds_read_b64_tr_b16 v[58:59], v24 offset:23552
s_waitcnt lgkmcnt(14)
v_mfma_f32_16x16x32_bf16 v[36:39], v[128:131], v[60:63], v[36:39]
ds_read_b128 v[108:111], v25 offset:768
ds_read_b64_tr_b16 v[60:61], v24 offset:24576
ds_read_b64_tr_b16 v[62:63], v24 offset:25600
s_waitcnt lgkmcnt(14)
v_mfma_f32_16x16x32_bf16 v[28:31], v[148:151], v[64:67], v[28:31]
ds_read_b64_tr_b16 v[64:65], v24 offset:26624
ds_read_b64_tr_b16 v[66:67], v24 offset:27648
s_waitcnt lgkmcnt(14)
v_mfma_f32_16x16x32_bf16 v[32:35], v[148:151], v[40:43], v[32:35]
ds_read_b64_tr_b16 v[40:41], v24 offset:28672
ds_read_b64_tr_b16 v[42:43], v24 offset:29696
s_waitcnt lgkmcnt(14)
v_mfma_f32_16x16x32_bf16 v[36:39], v[148:151], v[44:47], v[36:39]
ds_read_b128 v[128:131], v25 offset:960
ds_read_b64_tr_b16 v[44:45], v24 offset:30720
ds_read_b64_tr_b16 v[46:47], v24 offset:31744
s_waitcnt lgkmcnt(14)
v_mfma_f32_16x16x32_bf16 v[28:31], v[168:171], v[48:51], v[28:31]
ds_read_b64_tr_b16 v[48:49], v24 offset:32768
ds_read_b64_tr_b16 v[50:51], v24 offset:33792
s_waitcnt lgkmcnt(14)
v_mfma_f32_16x16x32_bf16 v[32:35], v[168:171], v[52:55], v[32:35]
ds_read_b64_tr_b16 v[52:53], v24 offset:34816
ds_read_b64_tr_b16 v[54:55], v24 offset:35840
s_waitcnt lgkmcnt(14)
v_mfma_f32_16x16x32_bf16 v[36:39], v[168:171], v[56:59], v[36:39]
s_waitcnt lgkmcnt(11)
v_mfma_f32_16x16x32_bf16 v[28:31], v[108:111], v[60:63], v[28:31]
s_waitcnt lgkmcnt(9)
v_mfma_f32_16x16x32_bf16 v[32:35], v[108:111], v[64:67], v[32:35]
s_waitcnt lgkmcnt(7)
v_mfma_f32_16x16x32_bf16 v[36:39], v[108:111], v[40:43], v[36:39]
s_waitcnt lgkmcnt(4)
v_mfma_f32_16x16x32_bf16 v[28:31], v[128:131], v[44:47], v[28:31]
s_waitcnt lgkmcnt(2)
v_mfma_f32_16x16x32_bf16 v[32:35], v[128:131], v[48:51], v[32:35]
s_waitcnt lgkmcnt(0)
v_mfma_f32_16x16x32_bf16 v[36:39], v[128:131], v[52:55], v[36:39]
s_nop 5
v_add_f32 v28, v28, v33
s_nop 0
v_add_f32 v28, v28, v38
v_mul_f32 v29, 0xbfb8aa3b, v28
v_exp_f32 v29, v29
v_mul_f32_dpp v28, v28, v28 row_ror:8 row_mask:0xf bank_mask:0xf
v_add_f32 v29, 1.0, v29
v_rcp_f32 v29, v29
s_mov_b64 exec, 0xff
v_mul_f32 v28, v28, v29
v_cvt_pk_bf16_f32 v28, v28, v28
ds_write_b16 v22, v28
s_mov_b64 exec, -1
s_waitcnt lgkmcnt(0)
s_barrier
ds_read_b128 v[28:31], v23
s_waitcnt lgkmcnt(0)
v_mfma_f32_16x16x32_bf16 v[32:35], v[28:31], v[188:191], 0
v_mfma_f32_16x16x32_bf16 v[36:39], v[28:31], v[192:195], 0
v_mfma_f32_16x16x32_bf16 v[40:43], v[28:31], v[196:199], 0
v_mfma_f32_16x16x32_bf16 v[44:47], v[28:31], v[200:203], 0
v_mfma_f32_16x16x32_bf16 v[48:51], v[28:31], v[204:207], 0
s_nop 4
v_mov_b32_dpp v32, v36 quad_perm:[0,1,2,3] row_mask:2 bank_mask:0xf
v_mfma_f32_16x16x32_bf16 v[52:55], v[28:31], v[208:211], 0
s_nop 0
v_mov_b32_dpp v32, v40 quad_perm:[0,1,2,3] row_mask:4 bank_mask:0xf
v_mfma_f32_16x16x32_bf16 v[56:59], v[28:31], v[212:215], 0
s_nop 0
v_mov_b32_dpp v32, v44 quad_perm:[0,1,2,3] row_mask:8 bank_mask:0xf
buffer_store_dword v32, v26, s[24:27], s13 offen sc1
s_add_u32 s1, s13, 36864
v_mfma_f32_16x16x32_bf16 v[60:63], v[28:31], v[216:219], 0
v_mfma_f32_16x16x32_bf16 v[64:67], v[28:31], v[220:223], 0
v_mov_b32_dpp v48, v52 quad_perm:[0,1,2,3] row_mask:2 bank_mask:0xf
s_nop 1
v_mov_b32_dpp v48, v56 quad_perm:[0,1,2,3] row_mask:4 bank_mask:0xf
s_nop 2
v_mov_b32_dpp v48, v60 quad_perm:[0,1,2,3] row_mask:8 bank_mask:0xf
buffer_store_dword v48, v26, s[24:27], s1 offen sc1
s_add_u32 s1, s13, 73728
s_mov_b64 exec, 0xffff
buffer_store_dword v64, v26, s[24:27], s1 offen sc1
s_mov_b64 exec, -1
L_111:
v_mfma_f32_16x16x32_bf16 v[112:115], a[128:131], v[84:87], v[112:115]
v_mfma_f32_16x16x32_bf16 v[132:135], a[132:135], v[84:87], v[132:135]
ds_read_b128 v[68:71], v2 offset:4096
v_mfma_f32_16x16x32_bf16 v[152:155], v[84:87], a[136:139], v[152:155]
v_mfma_f32_16x16x32_bf16 v[172:175], a[140:143], v[84:87], v[172:175]
ds_read_b128 v[72:75], v2 offset:22528
v_mfma_f32_16x16x32_bf16 v[116:119], a[128:131], v[88:91], v[116:119]
v_mfma_f32_16x16x32_bf16 v[136:139], a[132:135], v[88:91], v[136:139]
ds_read_b128 v[76:79], v2 offset:40960
v_mfma_f32_16x16x32_bf16 v[156:159], v[88:91], a[136:139], v[156:159]
v_mfma_f32_16x16x32_bf16 v[176:179], a[140:143], v[88:91], v[176:179]
ds_read_b128 v[80:83], v2 offset:59392
v_mfma_f32_16x16x32_bf16 v[120:123], a[128:131], v[92:95], v[120:123]
v_mfma_f32_16x16x32_bf16 v[140:143], a[132:135], v[92:95], v[140:143]
s_add_u32 m0, s62, 7168
s_add_u32 s1, s92, 7168
buffer_load_dwordx4 v5, s[24:27], s1 offen sc1 lds
v_mfma_f32_16x16x32_bf16 v[160:163], v[92:95], a[136:139], v[160:163]
v_mfma_f32_16x16x32_bf16 v[180:183], a[140:143], v[92:95], v[180:183]
s_add_u32 m0, s62, 16384
s_add_u32 s1, s92, 16384
buffer_load_dwordx4 v5, s[24:27], s1 offen sc1 lds
v_mfma_f32_16x16x32_bf16 v[124:127], a[128:131], v[96:99], v[124:127]
v_mfma_f32_16x16x32_bf16 v[144:147], a[132:135], v[96:99], v[144:147]
s_add_u32 m0, s62, 8192
s_add_u32 s1, s92, 8192
buffer_load_dwordx4 v5, s[24:27], s1 offen sc1 lds
v_mfma_f32_16x16x32_bf16 v[164:167], v[96:99], a[136:139], v[164:167]
v_mfma_f32_16x16x32_bf16 v[184:187], a[140:143], v[96:99], v[184:187]
s_add_u32 m0, s62, 17408
s_add_u32 s1, s92, 17408
buffer_load_dwordx4 v5, s[24:27], s1 offen sc1 lds
s_waitcnt lgkmcnt(3)
v_mfma_f32_16x16x32_bf16 v[112:115], a[144:147], v[68:71], v[112:115]
v_mfma_f32_16x16x32_bf16 v[132:135], a[148:151], v[68:71], v[132:135]
ds_read_b128 v[84:87], v1 offset:5120
v_mfma_f32_16x16x32_bf16 v[152:155], v[68:71], a[152:155], v[152:155]
v_mfma_f32_16x16x32_bf16 v[172:175], a[156:159], v[68:71], v[172:175]
ds_read_b128 v[88:91], v1 offset:23552
s_waitcnt lgkmcnt(4)
v_mfma_f32_16x16x32_bf16 v[116:119], a[144:147], v[72:75], v[116:119]
v_mfma_f32_16x16x32_bf16 v[136:139], a[148:151], v[72:75], v[136:139]
ds_read_b128 v[92:95], v1 offset:41984
v_mfma_f32_16x16x32_bf16 v[156:159], v[72:75], a[152:155], v[156:159]
v_mfma_f32_16x16x32_bf16 v[176:179], a[156:159], v[72:75], v[176:179]
ds_read_b128 v[96:99], v1 offset:60416
s_waitcnt lgkmcnt(5)
v_mfma_f32_16x16x32_bf16 v[120:123], a[144:147], v[76:79], v[120:123]
v_mfma_f32_16x16x32_bf16 v[140:143], a[148:151], v[76:79], v[140:143]
v_lshlrev_b32 v107, 2, v0
v_mov_b32 v106, s80
s_waitcnt vmcnt(7)
s_lshl_b32 s1, s78, 3
s_add_u32 s1, s1, s76
s_lshl_b32 s1, s1, 2
s_add_u32 s1, s1, s77
s_lshl_b32 s1, s1, 7
s_add_u32 s1, s1, 65536
s_mov_b32 exec_hi, 0
buffer_store_dword v106, v107, s[24:27], s1 offen sc1
s_mov_b64 exec, -1
v_mfma_f32_16x16x32_bf16 v[160:163], v[76:79], a[152:155], v[160:163]
v_mfma_f32_16x16x32_bf16 v[180:183], a[156:159], v[76:79], v[180:183]
s_add_u32 s1, s85, 197632
buffer_load_dwordx4 v[60:63], v5, s[24:27], s1 offen sc1
s_waitcnt lgkmcnt(4)
v_mfma_f32_16x16x32_bf16 v[124:127], a[144:147], v[80:83], v[124:127]
v_mfma_f32_16x16x32_bf16 v[144:147], a[148:151], v[80:83], v[144:147]
v_mfma_f32_16x16x32_bf16 v[164:167], v[80:83], a[152:155], v[164:167]
v_mfma_f32_16x16x32_bf16 v[184:187], a[156:159], v[80:83], v[184:187]
s_waitcnt lgkmcnt(3)
v_mfma_f32_16x16x32_bf16 v[112:115], a[160:163], v[84:87], v[112:115]
v_mfma_f32_16x16x32_bf16 v[132:135], a[164:167], v[84:87], v[132:135]
ds_read_b128 v[68:71], v2 offset:5120
v_mfma_f32_16x16x32_bf16 v[152:155], v[84:87], a[168:171], v[152:155]
v_mfma_f32_16x16x32_bf16 v[172:175], a[172:175], v[84:87], v[172:175]
ds_read_b128 v[72:75], v2 offset:23552
s_waitcnt lgkmcnt(4)
v_mfma_f32_16x16x32_bf16 v[116:119], a[160:163], v[88:91], v[116:119]
v_mfma_f32_16x16x32_bf16 v[136:139], a[164:167], v[88:91], v[136:139]
ds_read_b128 v[76:79], v2 offset:41984
v_mfma_f32_16x16x32_bf16 v[156:159], v[88:91], a[168:171], v[156:159]
v_mfma_f32_16x16x32_bf16 v[176:179], a[172:175], v[88:91], v[176:179]
ds_read_b128 v[80:83], v2 offset:60416
s_waitcnt lgkmcnt(5)
v_mfma_f32_16x16x32_bf16 v[120:123], a[160:163], v[92:95], v[120:123]
v_mfma_f32_16x16x32_bf16 v[140:143], a[164:167], v[92:95], v[140:143]
s_mov_b32 exec_hi, 0xffff00
s_mov_b32 exec_lo, 0
buffer_store_dwordx4 v[100:103], v5, s[44:47], s89 offen offset:0 sc1
s_mov_b64 exec, -1
v_mfma_f32_16x16x32_bf16 v[160:163], v[92:95], a[168:171], v[160:163]
v_mfma_f32_16x16x32_bf16 v[180:183], a[172:175], v[92:95], v[180:183]
s_waitcnt lgkmcnt(4)
v_mfma_f32_16x16x32_bf16 v[124:127], a[160:163], v[96:99], v[124:127]
v_mfma_f32_16x16x32_bf16 v[144:147], a[164:167], v[96:99], v[144:147]
v_mfma_f32_16x16x32_bf16 v[164:167], v[96:99], a[168:171], v[164:167]
v_mfma_f32_16x16x32_bf16 v[184:187], a[172:175], v[96:99], v[184:187]
s_waitcnt lgkmcnt(3)
v_mfma_f32_16x16x32_bf16 v[112:115], a[176:179], v[68:71], v[112:115]
ds_read_b128 v[84:87], v1 offset:6144
v_mfma_f32_16x16x32_bf16 v[132:135], a[180:183], v[68:71], v[132:135]
ds_read_b128 v[88:91], v1 offset:24576
v_mfma_f32_16x16x32_bf16 v[152:155], v[68:71], a[184:187], v[152:155]
v_mfma_f32_16x16x32_bf16 v[172:175], a[188:191], v[68:71], v[172:175]
ds_read_b128 v[92:95], v1 offset:43008
s_waitcnt lgkmcnt(5)
v_mfma_f32_16x16x32_bf16 v[116:119], a[176:179], v[72:75], v[116:119]
v_mfma_f32_16x16x32_bf16 v[136:139], a[180:183], v[72:75], v[136:139]
ds_read_b128 v[96:99], v1 offset:61440
v_mfma_f32_16x16x32_bf16 v[156:159], v[72:75], a[184:187], v[156:159]
v_mfma_f32_16x16x32_bf16 v[176:179], a[188:191], v[72:75], v[176:179]
v_lshrrev_b32 v105, 2, v0
v_mul_u32_u24 v105, 9152, v105
v_add_u32 v105, v105, v5
s_waitcnt lgkmcnt(5)
v_mfma_f32_16x16x32_bf16 v[120:123], a[176:179], v[76:79], v[120:123]
v_mfma_f32_16x16x32_bf16 v[140:143], a[180:183], v[76:79], v[140:143]
s_add_u32 s1, s13, 331776
s_cmp_lt_u32 s75, 18
s_cselect_b32 exec_lo, -1, 0
s_cselect_b32 exec_hi, 15, 0
buffer_store_dwordx4 v[100:103], v105, s[24:27], s1 offen sc1
s_mov_b64 exec, -1
v_mfma_f32_16x16x32_bf16 v[160:163], v[76:79], a[184:187], v[160:163]
v_mfma_f32_16x16x32_bf16 v[180:183], a[188:191], v[76:79], v[180:183]
s_add_u32 s1, s13, 663552
s_cmp_lt_u32 s75, 18
s_cselect_b32 exec_lo, -1, 0
s_cselect_b32 exec_hi, 15, 0
buffer_store_dwordx4 v[100:103], v105, s[24:27], s1 offen sc1
s_mov_b64 exec, -1
s_waitcnt lgkmcnt(4)
v_mfma_f32_16x16x32_bf16 v[124:127], a[176:179], v[80:83], v[124:127]
v_mfma_f32_16x16x32_bf16 v[144:147], a[180:183], v[80:83], v[144:147]
s_mul_i32 s14, s77, 1168
s_lshl_b32 s15, s77, 10
s_add_u32 s15, s15, s85
v_mfma_f32_16x16x32_bf16 v[164:167], v[80:83], a[184:187], v[164:167]
v_mfma_f32_16x16x32_bf16 v[184:187], a[188:191], v[80:83], v[184:187]
v_lshlrev_b32 v64, 2, v0
v_add_u32 v64, 160128, v64
C_118:
s_waitcnt vmcnt(3)
v_cmp_ne_u32 vcc, s80, v63
s_cbranch_vccnz R_119
s_waitcnt lgkmcnt(3)
v_mfma_f32_16x16x32_bf16 v[112:115], a[192:195], v[84:87], v[112:115]
v_mfma_f32_16x16x32_bf16 v[132:135], a[196:199], v[84:87], v[132:135]
ds_read_b128 v[68:71], v2 offset:6144
v_mfma_f32_16x16x32_bf16 v[152:155], v[84:87], a[200:203], v[152:155]
v_mfma_f32_16x16x32_bf16 v[172:175], a[204:207], v[84:87], v[172:175]
ds_read_b128 v[72:75], v2 offset:24576
s_waitcnt lgkmcnt(4)
v_mfma_f32_16x16x32_bf16 v[116:119], a[192:195], v[88:91], v[116:119]
v_mfma_f32_16x16x32_bf16 v[136:139], a[196:199], v[88:91], v[136:139]
ds_read_b128 v[76:79], v2 offset:43008
v_mfma_f32_16x16x32_bf16 v[156:159], v[88:91], a[200:203], v[156:159]
v_mfma_f32_16x16x32_bf16 v[176:179], a[204:207], v[88:91], v[176:179]
ds_read_b128 v[80:83], v2 offset:61440
s_waitcnt lgkmcnt(5)
v_mfma_f32_16x16x32_bf16 v[120:123], a[192:195], v[92:95], v[120:123]
v_mfma_f32_16x16x32_bf16 v[140:143], a[196:199], v[92:95], v[140:143]
s_add_u32 m0, s14, 73728
s_add_u32 s1, s15, 146432
buffer_load_dwordx4 v5, s[24:27], s1 offen sc1 lds
v_mfma_f32_16x16x32_bf16 v[160:163], v[92:95], a[200:203], v[160:163]
v_mfma_f32_16x16x32_bf16 v[180:183], a[204:207], v[92:95], v[180:183]
s_mov_b64 exec, 0xffff
ds_write2_b32 v64, v60, v61 offset0:0 offset1:80
s_mov_b64 exec, -1
s_waitcnt lgkmcnt(5)
v_mfma_f32_16x16x32_bf16 v[124:127], a[192:195], v[96:99], v[124:127]
v_mfma_f32_16x16x32_bf16 v[144:147], a[196:199], v[96:99], v[144:147]
v_mfma_f32_16x16x32_bf16 v[164:167], v[96:99], a[200:203], v[164:167]
v_mfma_f32_16x16x32_bf16 v[184:187], a[204:207], v[96:99], v[184:187]
s_cmp_ge_u32 s75, 18
s_cbranch_scc1 L_120
L_121:
s_barrier
s_waitcnt lgkmcnt(4)
v_mfma_f32_16x16x32_bf16 v[112:115], a[208:211], v[68:71], v[112:115]
ds_read_b128 v[84:87], v1 offset:7168
v_mfma_f32_16x16x32_bf16 v[132:135], a[212:215], v[68:71], v[132:135]
ds_read_b128 v[88:91], v1 offset:25600
v_mfma_f32_16x16x32_bf16 v[152:155], v[68:71], a[216:219], v[152:155]
ds_read_b128 v[92:95], v1 offset:44032
v_mfma_f32_16x16x32_bf16 v[172:175], a[220:223], v[68:71], v[172:175]
ds_read_b128 v[96:99], v1 offset:62464
s_waitcnt lgkmcnt(7)
v_mfma_f32_16x16x32_bf16 v[116:119], a[208:211], v[72:75], v[116:119]
v_mfma_f32_16x16x32_bf16 v[136:139], a[212:215], v[72:75], v[136:139]
v_mov_b32 v32, 163712
ds_read_b128 v[28:31], v32
v_mfma_f32_16x16x32_bf16 v[156:159], v[72:75], a[216:219], v[156:159]
v_mfma_f32_16x16x32_bf16 v[176:179], a[220:223], v[72:75], v[176:179]
s_lshl_b32 s1, s78, 12
s_add_u32 s1, s1, 65536
v_min_u32 v104, 31, v0
v_lshl_add_u32 v104, v104, 7, s1
s_waitcnt lgkmcnt(7)
v_mfma_f32_16x16x32_bf16 v[120:123], a[208:211], v[76:79], v[120:123]
v_mfma_f32_16x16x32_bf16 v[140:143], a[212:215], v[76:79], v[140:143]
buffer_load_dword v105, v104, s[24:27], 0 offen sc1
v_mfma_f32_16x16x32_bf16 v[160:163], v[76:79], a[216:219], v[160:163]
v_mfma_f32_16x16x32_bf16 v[180:183], a[220:223], v[76:79], v[180:183]
s_add_u32 m0, s14, 78400
s_add_u32 s1, s15, 150528
buffer_load_dwordx4 v5, s[24:27], s1 offen sc1 lds
s_waitcnt lgkmcnt(6)
v_mfma_f32_16x16x32_bf16 v[124:127], a[208:211], v[80:83], v[124:127]
v_mfma_f32_16x16x32_bf16 v[144:147], a[212:215], v[80:83], v[144:147]
s_waitcnt lgkmcnt(0)
v_readfirstlane_b32 s57, v28
v_readfirstlane_b32 s58, v29
v_mfma_f32_16x16x32_bf16 v[164:167], v[80:83], a[216:219], v[164:167]
v_mfma_f32_16x16x32_bf16 v[184:187], a[220:223], v[80:83], v[184:187]
v_readfirstlane_b32 s59, v30
v_readfirstlane_b32 s56, v31
v_mfma_f32_16x16x32_bf16 v[112:115], a[224:227], v[84:87], v[112:115]
v_mfma_f32_16x16x32_bf16 v[132:135], a[228:231], v[84:87], v[132:135]
ds_read_b128 v[68:71], v2 offset:7168
v_mfma_f32_16x16x32_bf16 v[152:155], v[84:87], a[232:235], v[152:155]
v_mfma_f32_16x16x32_bf16 v[172:175], a[236:239], v[84:87], v[172:175]
ds_read_b128 v[72:75], v2 offset:25600
v_mfma_f32_16x16x32_bf16 v[116:119], a[224:227], v[88:91], v[116:119]
v_mfma_f32_16x16x32_bf16 v[136:139], a[228:231], v[88:91], v[136:139]
ds_read_b128 v[76:79], v2 offset:44032
v_mfma_f32_16x16x32_bf16 v[156:159], v[88:91], a[232:235], v[156:159]
v_mfma_f32_16x16x32_bf16 v[176:179], a[236:239], v[88:91], v[176:179]
ds_read_b128 v[80:83], v2 offset:62464
v_mfma_f32_16x16x32_bf16 v[120:123], a[224:227], v[92:95], v[120:123]
v_mfma_f32_16x16x32_bf16 v[140:143], a[228:231], v[92:95], v[140:143]
s_mov_b32 m0, 83072
s_add_u32 s1, s85, 154624
buffer_load_dwordx4 v5, s[24:27], s1 offen sc1 lds
v_mfma_f32_16x16x32_bf16 v[160:163], v[92:95], a[232:235], v[160:163]
v_mfma_f32_16x16x32_bf16 v[180:183], a[236:239], v[92:95], v[180:183]
v_mfma_f32_16x16x32_bf16 v[124:127], a[224:227], v[96:99], v[124:127]
v_mfma_f32_16x16x32_bf16 v[144:147], a[228:231], v[96:99], v[144:147]
v_mfma_f32_16x16x32_bf16 v[164:167], v[96:99], a[232:235], v[164:167]
v_mfma_f32_16x16x32_bf16 v[184:187], a[236:239], v[96:99], v[184:187]
s_cmp_lt_u32 s83, 36
s_cbranch_scc0 L_122
s_mul_i32 s5, s83, 9216
v_and_b32 v23, 3, v0
v_lshrrev_b32 v22, 5, v0
v_lshl_add_u32 v23, v23, 1, v22
v_mov_b32 v22, s59
v_add_f32 v22, 1.0, v22
v_lshlrev_b32 v23, 2, v23
s_lshl_b32 s6, s83, 5
v_add_u32 v26, s6, v23
v_lshrrev_b32 v27, 4, v26
v_mul_u32_u24 v27, 7282, v27
v_lshrrev_b32 v27, 16, v27
v_mul_u32_u24 v27, 3952, v27
v_add_u32 v27, v27, v26
s_ashr_i32 s3, s57, 31
s_lshr_b32 s3, s3, 1
s_xor_b32 s3, s3, s57
v_mov_b32 v26, 0xbfb8aa3b
v_mul_f32 v26, s3, v26
v_exp_f32 v26, v26
s_nop 0
v_add_f32 v26, 1.0, v26
v_rcp_f32 v26, v26
buffer_load_dword v64, v27, s[24:27], s4 offen sc1
s_add_u32 s1, s5, 3145728
buffer_load_dwordx4 v[28:31], v5, s[24:27], s1 offen offset:0 sc1
buffer_load_dwordx4 v[32:35], v5, s[24:27], s1 offen offset:1024 sc1
buffer_load_dwordx4 v[36:39], v5, s[24:27], s1 offen offset:2048 sc1
buffer_load_dwordx4 v[40:43], v5, s[24:27], s1 offen offset:3072 sc1
s_add_u32 s1, s5, 3149824
buffer_load_dwordx4 v[44:47], v5, s[24:27], s1 offen offset:0 sc1
buffer_load_dwordx4 v[48:51], v5, s[24:27], s1 offen offset:1024 sc1
buffer_load_dwordx4 v[52:55], v5, s[24:27], s1 offen offset:2048 sc1
buffer_load_dwordx4 v[56:59], v5, s[24:27], s1 offen offset:3072 sc1
s_add_u32 s1, s5, 3153920
buffer_load_dwordx4 v[60:63], v5, s[24:27], s1 offen offset:0 sc1
L_122:
s_waitcnt lgkmcnt(3)
v_mfma_f32_16x16x32_bf16 v[112:115], a[240:243], v[68:71], v[112:115]
ds_read_b128 v[84:87], v1 offset:8192
v_mfma_f32_16x16x32_bf16 v[132:135], a[244:247], v[68:71], v[132:135]
ds_read_b128 v[88:91], v1 offset:26624
v_mfma_f32_16x16x32_bf16 v[152:155], v[68:71], a[248:251], v[152:155]
ds_read_b128 v[92:95], v1 offset:45056
v_mfma_f32_16x16x32_bf16 v[172:175], a[252:255], v[68:71], v[172:175]
ds_read_b128 v[96:99], v1 offset:63488
s_waitcnt lgkmcnt(6)
v_mfma_f32_16x16x32_bf16 v[116:119], a[240:243], v[72:75], v[116:119]
s_sub_u32 s16, s56, s78
s_lshl_b32 s16, s16, 6
s_and_b32 s17, s57, 63
v_mfma_f32_16x16x32_bf16 v[136:139], a[244:247], v[72:75], v[136:139]
s_add_u32 s16, s16, 16
s_add_u32 s60, s16, s17
v_mfma_f32_16x16x32_bf16 v[156:159], v[72:75], a[248:251], v[156:159]
v_mfma_f32_16x16x32_bf16 v[176:179], a[252:255], v[72:75], v[176:179]
s_cmp_eq_u32 s79, 0
s_cselect_b32 s16, 16, 8
s_sub_u32 s17, s60, s16
s_waitcnt lgkmcnt(5)
v_mfma_f32_16x16x32_bf16 v[120:123], a[240:243], v[76:79], v[120:123]
v_mfma_f32_16x16x32_bf16 v[140:143], a[244:247], v[76:79], v[140:143]
s_sub_u32 s16, 80, s16
s_cmp_lt_u32 s17, s16
s_cselect_b32 s61, 1, 0
v_mfma_f32_16x16x32_bf16 v[160:163], v[76:79], a[248:251], v[160:163]
v_mfma_f32_16x16x32_bf16 v[180:183], a[252:255], v[76:79], v[180:183]
s_and_b32 s16, s57, 56
s_cmp_eq_u32 s16, 56
s_cselect_b32 s16, 3, 1
s_waitcnt lgkmcnt(4)
v_mfma_f32_16x16x32_bf16 v[124:127], a[240:243], v[80:83], v[124:127]
v_mfma_f32_16x16x32_bf16 v[144:147], a[244:247], v[80:83], v[144:147]
s_and_b32 s17, s56, 15
s_cmp_eq_u32 s17, 15
s_cselect_b32 s16, 1, s16
v_mfma_f32_16x16x32_bf16 v[164:167], v[80:83], a[248:251], v[164:167]
v_mfma_f32_16x16x32_bf16 v[184:187], a[252:255], v[80:83], v[184:187]
s_lshl_b32 s8, s16, s56
s_waitcnt lgkmcnt(3)
v_mfma_f32_16x16x32_bf16 v[112:115], v[224:227], v[84:87], v[112:115]
v_mfma_f32_16x16x32_bf16 v[132:135], v[228:231], v[84:87], v[132:135]
ds_read_b128 v[68:71], v2 offset:8192
v_mfma_f32_16x16x32_bf16 v[152:155], v[84:87], v[232:235], v[152:155]
v_mfma_f32_16x16x32_bf16 v[172:175], v[236:239], v[84:87], v[172:175]
ds_read_b128 v[72:75], v2 offset:26624
s_waitcnt lgkmcnt(4)
v_mfma_f32_16x16x32_bf16 v[116:119], v[224:227], v[88:91], v[116:119]
v_mfma_f32_16x16x32_bf16 v[136:139], v[228:231], v[88:91], v[136:139]
ds_read_b128 v[76:79], v2 offset:45056
v_mfma_f32_16x16x32_bf16 v[156:159], v[88:91], v[232:235], v[156:159]
v_mfma_f32_16x16x32_bf16 v[176:179], v[236:239], v[88:91], v[176:179]
ds_read_b128 v[80:83], v2 offset:63488
s_waitcnt lgkmcnt(5)
v_mfma_f32_16x16x32_bf16 v[120:123], v[224:227], v[92:95], v[120:123]
v_mfma_f32_16x16x32_bf16 v[140:143], v[228:231], v[92:95], v[140:143]
v_mfma_f32_16x16x32_bf16 v[160:163], v[92:95], v[232:235], v[160:163]
v_mfma_f32_16x16x32_bf16 v[180:183], v[236:239], v[92:95], v[180:183]
s_waitcnt lgkmcnt(4)
v_mfma_f32_16x16x32_bf16 v[124:127], v[224:227], v[96:99], v[124:127]
v_mfma_f32_16x16x32_bf16 v[144:147], v[228:231], v[96:99], v[144:147]
v_mfma_f32_16x16x32_bf16 v[164:167], v[96:99], v[232:235], v[164:167]
v_mfma_f32_16x16x32_bf16 v[184:187], v[236:239], v[96:99], v[184:187]
s_waitcnt vmcnt(0)
s_barrier
C_123:
v_cmp_ne_u32 vcc, s80, v105
s_cbranch_vccnz R_124
s_cmp_lt_u32 s83, 36
s_cbranch_scc1 L_125
L_126:
s_waitcnt lgkmcnt(3)
v_mfma_f32_16x16x32_bf16 v[112:115], v[240:243], v[68:71], v[112:115]
ds_read_b128 v[84:87], v3 offset:0
v_mfma_f32_16x16x32_bf16 v[132:135], v[244:247], v[68:71], v[132:135]
ds_read_b128 v[88:91], v4 offset:0
v_mfma_f32_16x16x32_bf16 v[152:155], v[68:71], v[248:251], v[152:155]
ds_read_b128 v[92:95], v3 offset:1168
v_mfma_f32_16x16x32_bf16 v[172:175], v[252:255], v[68:71], v[172:175]
ds_read_b128 v[96:99], v4 offset:1168
s_waitcnt lgkmcnt(6)
v_mfma_f32_16x16x32_bf16 v[116:119], v[240:243], v[72:75], v[116:119]
ds_read_b128 v[100:103], v3 offset:2336
v_mfma_f32_16x16x32_bf16 v[136:139], v[244:247], v[72:75], v[136:139]
v_lshlrev_b32 v22, 2, v6
v_add_u32 v22, 160128, v22
v_mfma_f32_16x16x32_bf16 v[156:159], v[72:75], v[248:251], v[156:159]
v_lshlrev_b32 v23, 4, v7
v_add_u32 v23, 160128, v23
v_mfma_f32_16x16x32_bf16 v[176:179], v[252:255], v[72:75], v[176:179]
ds_read_b128 v[58:61], v19
ds_read_b128 v[62:65], v20
s_waitcnt lgkmcnt(8)
v_mfma_f32_16x16x32_bf16 v[120:123], v[240:243], v[76:79], v[120:123]
ds_read_b64 v[66:67], v21
v_mfma_f32_16x16x32_bf16 v[140:143], v[244:247], v[76:79], v[140:143]
ds_read2_b32 v[28:29], v22 offset0:0 offset1:80
ds_read2_b32 v[30:31], v22 offset0:16 offset1:96
v_mfma_f32_16x16x32_bf16 v[160:163], v[76:79], v[248:251], v[160:163]
ds_read2_b32 v[32:33], v22 offset0:32 offset1:112
ds_read2_b32 v[34:35], v22 offset0:48 offset1:128
ds_read2_b32 v[36:37], v22 offset0:64 offset1:144
v_mfma_f32_16x16x32_bf16 v[180:183], v[252:255], v[76:79], v[180:183]
s_lshl_b32 s1, s77, 8
s_add_u32 s1, s1, 159104
v_lshl_add_u32 v26, v7, 4, s1
v_lshl_add_u32 v27, v6, 2, s1
s_waitcnt lgkmcnt(13)
v_mfma_f32_16x16x32_bf16 v[124:127], v[240:243], v[80:83], v[124:127]
v_mfma_f32_16x16x32_bf16 v[144:147], v[244:247], v[80:83], v[144:147]
ds_read_b128 v[52:55], v26 offset:128
ds_read_b128 v[48:51], v26 offset:64
v_mfma_f32_16x16x32_bf16 v[164:167], v[80:83], v[248:251], v[164:167]
v_mfma_f32_16x16x32_bf16 v[184:187], v[252:255], v[80:83], v[184:187]
ds_read_b128 v[44:47], v26 offset:0
ds_read_b32 v56, v27 offset:192
s_cmp_lg_u32 s61, 0
s_cbranch_scc1 L_patch_s
s_waitcnt lgkmcnt(15)
v_mfma_f32_16x16x32_bf16 v[168:171], a[12:15], v[84:87], 0
ds_read_b128 v[104:107], v4 offset:2336
ds_read_b128 v[76:79], v23 offset:64
ds_read_b128 v[80:83], v23 offset:384
ds_read_b128 v[68:71], v23 offset:128
ds_read_b128 v[72:75], v23 offset:448
v_mfma_f32_16x16x32_bf16 v[128:131], a[4:7], v[84:87], 0
s_waitcnt lgkmcnt(12)
v_mul_f32 v39, 0x3eae1a93, v31
s_waitcnt lgkmcnt(11)
v_mul_f32 v40, 0x3eae1a93, v33
s_waitcnt lgkmcnt(10)
v_mul_f32 v41, 0x3eae1a93, v35
s_waitcnt lgkmcnt(9)
v_mul_f32 v42, 0x3eae1a93, v37
s_waitcnt lgkmcnt(8)
v_fmac_f32 v172, v52, v30
v_mfma_f32_16x16x32_bf16 v[148:151], v[84:87], a[8:11], 0
v_fmac_f32 v173, v53, v30
v_fmac_f32 v174, v54, v30
v_fmac_f32 v175, v55, v30
s_waitcnt lgkmcnt(7)
v_fmac_f32 v132, v48, v30
v_fmac_f32 v133, v49, v30
v_mfma_f32_16x16x32_bf16 v[168:171], a[28:31], v[88:91], v[168:171]
ds_read_b128 v[84:87], v3 offset:3504
s_barrier
v_fmac_f32 v134, v50, v30
v_fmac_f32 v135, v51, v30
v_mul_f32 v174, v174, v39
v_mfma_f32_16x16x32_bf16 v[128:131], a[20:23], v[88:91], v[128:131]
s_mul_i32 s18, s76, 82944
s_add_u32 s18, s18, s62
s_add_u32 m0, s62, 0
s_add_u32 s19, s18, 2228224
buffer_load_dwordx4 v5, s[24:27], s19 offen offset:0 sc1 lds
v_mfma_f32_16x16x32_bf16 v[148:151], v[88:91], a[24:27], v[148:151]
v_mul_f32 v175, v175, v39
v_mul_f32 v132, v132, v39
v_mul_f32 v133, v133, v39
v_mul_f32 v134, v134, v39
v_mul_f32 v135, v135, v39
v_mfma_f32_16x16x32_bf16 v[168:171], a[44:47], v[92:95], v[168:171]
ds_read_b128 v[88:91], v4 offset:3504
buffer_load_dwordx4 v5, s[24:27], s19 offen offset:1024 sc1 lds
v_mul_f32 v172, v172, v31
v_mul_f32 v173, v173, v31
v_cvt_pk_bf16_f32 v132, v132, v133
v_mfma_f32_16x16x32_bf16 v[128:131], a[36:39], v[92:95], v[128:131]
v_cvt_pk_bf16_f32 v133, v134, v135
v_cvt_pk_bf16_f32 v134, v174, v175
v_mov_b32 v135, 0
s_waitcnt lgkmcnt(8)
v_fmac_f32 v112, v44, v30
v_fmac_f32 v113, v45, v30
v_mfma_f32_16x16x32_bf16 v[148:151], v[92:95], a[40:43], v[148:151]
v_fmac_f32 v114, v46, v30
v_fmac_f32 v115, v47, v30
v_mul_f32 v112, v112, v31
v_mul_f32 v113, v113, v31
v_mul_f32 v114, v114, v31
v_mfma_f32_16x16x32_bf16 v[168:171], a[60:63], v[96:99], v[168:171]
ds_read_b128 v[92:95], v3 offset:4672
buffer_load_dwordx4 v5, s[24:27], s19 offen offset:2048 sc1 lds
v_mul_f32 v115, v115, v31
v_cvt_pk_bf16_f32 v112, v112, v113
v_cvt_pk_bf16_f32 v113, v114, v115
v_mfma_f32_16x16x32_bf16 v[128:131], a[52:55], v[96:99], v[128:131]
v_cvt_pk_bf16_f32 v114, v172, v173
v_mov_b32 v115, 0x3f80
s_waitcnt lgkmcnt(6)
v_fmac_f32 v152, v76, v56
v_fmac_f32 v153, v77, v56
v_fmac_f32 v154, v78, v56
v_mfma_f32_16x16x32_bf16 v[148:151], v[96:99], a[56:59], v[148:151]
buffer_load_dwordx4 v5, s[24:27], s19 offen offset:3072 sc1 lds
v_fmac_f32 v155, v79, v56
s_waitcnt lgkmcnt(5)
v_mul_f32 v152, v152, v80
v_mul_f32 v153, v153, v81
v_mfma_f32_16x16x32_bf16 v[168:171], a[76:79], v[100:103], v[168:171]
ds_read_b128 v[96:99], v4 offset:4672
v_mul_f32 v154, v154, v82
v_mul_f32 v155, v155, v83
v_cvt_pk_bf16_f32 v152, v152, v153
v_mfma_f32_16x16x32_bf16 v[128:131], a[68:71], v[100:103], v[128:131]
s_add_u32 m0, s62, 4096
s_add_u32 s19, s18, 2232320
buffer_load_dwordx4 v5, s[24:27], s19 offen offset:0 sc1 lds
v_cvt_pk_bf16_f32 v153, v154, v155
v_mfma_f32_16x16x32_bf16 v[148:151], v[100:103], a[72:75], v[148:151]
ds_read_b128 v[76:79], v23 offset:192
ds_read_b128 v[80:83], v23 offset:512
v_fmac_f32 v176, v52, v32
v_fmac_f32 v177, v53, v32
v_mfma_f32_16x16x32_bf16 v[168:171], a[92:95], v[104:107], v[168:171]
ds_read_b128 v[100:103], v3 offset:5840
buffer_load_dwordx4 v5, s[24:27], s19 offen offset:1024 sc1 lds
v_fmac_f32 v178, v54, v32
v_fmac_f32 v179, v55, v32
v_mfma_f32_16x16x32_bf16 v[128:131], a[84:87], v[104:107], v[128:131]
v_fmac_f32 v136, v48, v32
v_fmac_f32 v137, v49, v32
v_fmac_f32 v138, v50, v32
v_fmac_f32 v139, v51, v32
v_mfma_f32_16x16x32_bf16 v[148:151], v[104:107], a[88:91], v[148:151]
v_mul_f32 v178, v178, v40
v_mul_f32 v179, v179, v40
v_mul_f32 v136, v136, v40
v_mul_f32 v137, v137, v40
s_waitcnt lgkmcnt(6)
v_mfma_f32_16x16x32_bf16 v[168:171], a[108:111], v[84:87], v[168:171]
ds_read_b128 v[104:107], v4 offset:5840
buffer_load_dwordx4 v5, s[24:27], s19 offen offset:2048 sc1 lds
v_mul_f32 v138, v138, v40
v_mul_f32 v139, v139, v40
v_mfma_f32_16x16x32_bf16 v[128:131], a[100:103], v[84:87], v[128:131]
v_mul_f32 v176, v176, v33
v_mul_f32 v177, v177, v33
v_cvt_pk_bf16_f32 v136, v136, v137
v_cvt_pk_bf16_f32 v137, v138, v139
v_mfma_f32_16x16x32_bf16 v[148:151], v[84:87], a[104:107], v[148:151]
buffer_load_dwordx4 v5, s[24:27], s19 offen offset:3072 sc1 lds
v_cvt_pk_bf16_f32 v138, v178, v179
v_mov_b32 v139, 0
v_fmac_f32 v116, v44, v32
s_waitcnt lgkmcnt(6)
v_mfma_f32_16x16x32_bf16 v[168:171], a[124:127], v[88:91], v[168:171]
ds_read_b128 v[84:87], v3 offset:7008
v_fmac_f32 v117, v45, v32
v_fmac_f32 v118, v46, v32
v_fmac_f32 v119, v47, v32
v_mfma_f32_16x16x32_bf16 v[128:131], a[116:119], v[88:91], v[128:131]
s_add_u32 m0, s62, 8192
s_add_u32 s19, s18, 2236416
buffer_load_dwordx4 v5, s[24:27], s19 offen offset:0 sc1 lds
v_mul_f32 v116, v116, v33
v_mfma_f32_16x16x32_bf16 v[148:151], v[88:91], a[120:123], v[148:151]
v_mul_f32 v117, v117, v33
v_mul_f32 v118, v118, v33
v_mul_f32 v119, v119, v33
v_cvt_pk_bf16_f32 v116, v116, v117
s_waitcnt lgkmcnt(6)
v_mfma_f32_16x16x32_bf16 v[168:171], a[140:143], v[92:95], v[168:171]
ds_read_b128 v[88:91], v4 offset:7008
buffer_load_dwordx4 v5, s[24:27], s19 offen offset:1024 sc1 lds
v_cvt_pk_bf16_f32 v117, v118, v119
v_cvt_pk_bf16_f32 v118, v176, v177
v_mfma_f32_16x16x32_bf16 v[128:131], a[132:135], v[92:95], v[128:131]
v_mov_b32 v119, 0x3f80
v_fmac_f32 v156, v68, v56
v_fmac_f32 v157, v69, v56
v_fmac_f32 v158, v70, v56
v_mfma_f32_16x16x32_bf16 v[148:151], v[92:95], a[136:139], v[148:151]
v_fmac_f32 v159, v71, v56
v_mul_f32 v156, v156, v72
v_mul_f32 v157, v157, v73
v_mul_f32 v158, v158, v74
s_waitcnt lgkmcnt(6)
v_mfma_f32_16x16x32_bf16 v[168:171], a[156:159], v[96:99], v[168:171]
ds_read_b128 v[92:95], v3 offset:8176
buffer_load_dwordx4 v5, s[24:27], s19 offen offset:2048 sc1 lds
v_mul_f32 v159, v159, v75
v_cvt_pk_bf16_f32 v154, v156, v157
v_mfma_f32_16x16x32_bf16 v[128:131], a[148:151], v[96:99], v[128:131]
v_cvt_pk_bf16_f32 v155, v158, v159
ds_read_b128 v[68:71], v23 offset:256
ds_read_b128 v[72:75], v23 offset:576
v_fmac_f32 v180, v52, v34
v_mfma_f32_16x16x32_bf16 v[148:151], v[96:99], a[152:155], v[148:151]
buffer_load_dwordx4 v5, s[24:27], s19 offen offset:3072 sc1 lds
v_fmac_f32 v181, v53, v34
v_fmac_f32 v182, v54, v34
v_fmac_f32 v183, v55, v34
s_waitcnt lgkmcnt(6)
v_mfma_f32_16x16x32_bf16 v[168:171], a[172:175], v[100:103], v[168:171]
ds_read_b128 v[96:99], v4 offset:8176
v_fmac_f32 v140, v48, v34
v_fmac_f32 v141, v49, v34
v_fmac_f32 v142, v50, v34
v_mfma_f32_16x16x32_bf16 v[128:131], a[164:167], v[100:103], v[128:131]
s_add_u32 m0, s62, 12288
s_add_u32 s19, s18, 2240512
buffer_load_dwordx4 v5, s[24:27], s19 offen offset:0 sc1 lds
v_fmac_f32 v143, v51, v34
v_mfma_f32_16x16x32_bf16 v[148:151], v[100:103], a[168:171], v[148:151]
v_mul_f32 v182, v182, v41
v_mul_f32 v183, v183, v41
v_mul_f32 v140, v140, v41
v_mul_f32 v141, v141, v41
s_waitcnt lgkmcnt(6)
v_mfma_f32_16x16x32_bf16 v[168:171], a[188:191], v[104:107], v[168:171]
ds_read_b128 v[100:103], v3 offset:9344
buffer_load_dwordx4 v5, s[24:27], s19 offen offset:1024 sc1 lds
v_mul_f32 v142, v142, v41
v_mul_f32 v143, v143, v41
v_mfma_f32_16x16x32_bf16 v[128:131], a[180:183], v[104:107], v[128:131]
v_mul_f32 v180, v180, v35
v_mul_f32 v181, v181, v35
v_cvt_pk_bf16_f32 v140, v140, v141
v_cvt_pk_bf16_f32 v141, v142, v143
v_mfma_f32_16x16x32_bf16 v[148:151], v[104:107], a[184:187], v[148:151]
v_cvt_pk_bf16_f32 v142, v182, v183
v_mov_b32 v143, 0
v_fmac_f32 v120, v44, v34
v_fmac_f32 v121, v45, v34
s_waitcnt lgkmcnt(6)
v_mfma_f32_16x16x32_bf16 v[168:171], a[204:207], v[84:87], v[168:171]
ds_read_b128 v[104:107], v4 offset:9344
buffer_load_dwordx4 v5, s[24:27], s19 offen offset:2048 sc1 lds
v_fmac_f32 v122, v46, v34
v_fmac_f32 v123, v47, v34
v_mfma_f32_16x16x32_bf16 v[128:131], a[196:199], v[84:87], v[128:131]
v_mul_f32 v120, v120, v35
v_mul_f32 v121, v121, v35
v_mul_f32 v122, v122, v35
v_mul_f32 v123, v123, v35
v_mfma_f32_16x16x32_bf16 v[148:151], v[84:87], a[200:203], v[148:151]
buffer_load_dwordx4 v5, s[24:27], s19 offen offset:3072 sc1 lds
v_cvt_pk_bf16_f32 v120, v120, v121
v_cvt_pk_bf16_f32 v121, v122, v123
v_cvt_pk_bf16_f32 v122, v180, v181
s_waitcnt lgkmcnt(6)
v_mfma_f32_16x16x32_bf16 v[168:171], a[220:223], v[88:91], v[168:171]
v_mov_b32 v123, 0x3f80
v_fmac_f32 v160, v76, v56
v_fmac_f32 v161, v77, v56
v_fmac_f32 v162, v78, v56
v_mfma_f32_16x16x32_bf16 v[128:131], a[212:215], v[88:91], v[128:131]
s_add_u32 m0, s62, 16384
s_add_u32 s19, s18, 2244608
buffer_load_dwordx4 v5, s[24:27], s19 offen offset:0 sc1 lds
v_fmac_f32 v163, v79, v56
v_mfma_f32_16x16x32_bf16 v[148:151], v[88:91], a[216:219], v[148:151]
v_mul_f32 v160, v160, v80
v_mul_f32 v161, v161, v81
v_mul_f32 v162, v162, v82
v_mul_f32 v163, v163, v83
s_waitcnt lgkmcnt(5)
v_mfma_f32_16x16x32_bf16 v[168:171], a[236:239], v[92:95], v[168:171]
buffer_load_dwordx4 v5, s[24:27], s19 offen offset:1024 sc1 lds
v_cvt_pk_bf16_f32 v156, v160, v161
v_cvt_pk_bf16_f32 v157, v162, v163
ds_read_b128 v[76:79], v23 offset:0
v_mfma_f32_16x16x32_bf16 v[128:131], a[228:231], v[92:95], v[128:131]
ds_read_b128 v[80:83], v23 offset:320
v_fmac_f32 v184, v52, v36
v_fmac_f32 v185, v53, v36
v_fmac_f32 v186, v54, v36
v_mfma_f32_16x16x32_bf16 v[148:151], v[92:95], a[232:235], v[148:151]
v_fmac_f32 v187, v55, v36
v_fmac_f32 v144, v48, v36
v_fmac_f32 v145, v49, v36
v_fmac_f32 v146, v50, v36
s_waitcnt lgkmcnt(4)
v_mfma_f32_16x16x32_bf16 v[168:171], a[252:255], v[96:99], v[168:171]
v_fmac_f32 v147, v51, v36
v_mul_f32 v186, v186, v42
v_mul_f32 v187, v187, v42
v_mul_f32 v144, v144, v42
v_mfma_f32_16x16x32_bf16 v[128:131], a[244:247], v[96:99], v[128:131]
v_mul_f32 v145, v145, v42
v_mul_f32 v146, v146, v42
v_mul_f32 v147, v147, v42
v_mul_f32 v184, v184, v37
v_mfma_f32_16x16x32_bf16 v[148:151], v[96:99], a[248:251], v[148:151]
v_mul_f32 v185, v185, v37
v_cvt_pk_bf16_f32 v144, v144, v145
v_cvt_pk_bf16_f32 v145, v146, v147
v_cvt_pk_bf16_f32 v146, v186, v187
s_waitcnt lgkmcnt(3)
v_mfma_f32_16x16x32_bf16 v[168:171], v[236:239], v[100:103], v[168:171]
v_mov_b32 v147, 0
v_fmac_f32 v124, v44, v36
v_fmac_f32 v125, v45, v36
v_fmac_f32 v126, v46, v36
v_mfma_f32_16x16x32_bf16 v[128:131], v[228:231], v[100:103], v[128:131]
v_fmac_f32 v127, v47, v36
v_mul_f32 v124, v124, v37
v_mul_f32 v125, v125, v37
v_mul_f32 v126, v126, v37
v_mfma_f32_16x16x32_bf16 v[148:151], v[100:103], v[232:235], v[148:151]
v_mul_f32 v127, v127, v37
v_cvt_pk_bf16_f32 v124, v124, v125
v_cvt_pk_bf16_f32 v125, v126, v127
v_cvt_pk_bf16_f32 v126, v184, v185
s_waitcnt lgkmcnt(2)
v_mfma_f32_16x16x32_bf16 v[168:171], v[252:255], v[104:107], v[168:171]
v_mov_b32 v127, 0x3f80
v_fmac_f32 v164, v68, v56
v_fmac_f32 v165, v69, v56
v_fmac_f32 v166, v70, v56
v_mfma_f32_16x16x32_bf16 v[128:131], v[244:247], v[104:107], v[128:131]
v_fmac_f32 v167, v71, v56
v_mul_f32 v164, v164, v72
v_mul_f32 v165, v165, v73
v_mul_f32 v166, v166, v74
v_mfma_f32_16x16x32_bf16 v[148:151], v[104:107], v[248:251], v[148:151]
v_mul_f32 v167, v167, v75
v_cvt_pk_bf16_f32 v158, v164, v165
v_cvt_pk_bf16_f32 v159, v166, v167
v_mul_f32 v38, 0x3eae1a93, v29
s_waitcnt lgkmcnt(0)
s_barrier
v_mfma_f32_16x16x32_bf16 v[88:91], v[132:135], v[112:115], v[8:11]
s_lshl_b32 s0, s77, 11
s_add_u32 m0, s0, 73728
s_sub_u32 s18, s18, s62
s_add_u32 s18, s18, s0
s_add_u32 s19, s18, 2301952
buffer_load_dwordx4 v5, s[24:27], s19 offen offset:0 sc1 lds
v_mfma_f32_16x16x32_bf16 v[92:95], v[136:139], v[116:119], v[8:11]
buffer_load_dwordx4 v5, s[24:27], s19 offen offset:1024 sc1 lds
buffer_load_dwordx4 v5, s[24:27], s19 offen offset:2048 sc1 lds
v_fmac_f32 v168, v52, v28
v_fmac_f32 v169, v53, v28
v_mfma_f32_16x16x32_bf16 v[96:99], v[140:143], v[120:123], v[8:11]
v_fmac_f32 v170, v54, v28
v_fmac_f32 v171, v55, v28
v_fmac_f32 v128, v48, v28
v_fmac_f32 v129, v49, v28
v_mfma_f32_16x16x32_bf16 v[100:103], v[144:147], v[124:127], v[8:11]
v_fmac_f32 v130, v50, v28
v_fmac_f32 v131, v51, v28
v_mul_f32 v170, v170, v38
v_mul_f32 v171, v171, v38
v_mfma_f32_16x16x16_bf16 v[172:175], v[114:115], v[14:15], 0
v_mul_f32 v128, v128, v38
v_mul_f32 v129, v129, v38
v_mul_f32 v130, v130, v38
v_mfma_f32_16x16x16_bf16 v[176:179], v[118:119], v[14:15], 0
v_mul_f32 v131, v131, v38
v_mul_f32 v168, v168, v29
v_mul_f32 v169, v169, v29
v_mfma_f32_16x16x16_bf16 v[180:183], v[122:123], v[14:15], 0
v_cvt_pk_bf16_f32 v128, v128, v129
v_cvt_pk_bf16_f32 v129, v130, v131
v_cvt_pk_bf16_f32 v130, v170, v171
v_mfma_f32_16x16x16_bf16 v[184:187], v[126:127], v[14:15], 0
v_mov_b32 v131, 0
v_cvt_pk_bf16_f32 v110, v168, v169
v_mov_b32 v111, 0x3f80
s_nop 1
v_mfma_f32_16x16x16_bf16 v[168:171], v[110:111], v[14:15], 0
v_fmac_f32 v148, v76, v56
v_fmac_f32 v149, v77, v56
v_mfma_f32_16x16x32_bf16 v[108:111], v[128:131], v[112:115], v[8:11]
v_fmac_f32 v150, v78, v56
v_fmac_f32 v151, v79, v56
v_mfma_f32_16x16x32_bf16 v[112:115], v[132:135], v[116:119], v[8:11]
v_mul_f32 v148, v148, v80
v_mul_f32 v149, v149, v81
v_mfma_f32_16x16x32_bf16 v[116:119], v[136:139], v[120:123], v[8:11]
v_mul_f32 v150, v150, v82
v_mul_f32 v151, v151, v83
v_mfma_f32_16x16x32_bf16 v[120:123], v[140:143], v[124:127], v[8:11]
v_cvt_pk_bf16_f32 v151, v150, v151
v_cvt_pk_bf16_f32 v150, v148, v149
L_patched_s:
s_cbranch_execz L_pw_s
v_pk_add_f32 v[108:109], v[108:109], s[72:73]
v_pk_add_f32 v[110:111], v[110:111], s[72:73]
v_cndmask_b32 v88, v108, v88, s[64:65]
v_cndmask_b32 v89, v109, v89, s[66:67]
v_cndmask_b32 v90, v110, v90, s[68:69]
v_cndmask_b32 v91, v111, v91, s[70:71]
v_max3_f32 v84, v88, v89, v90
v_max_f32 v84, v84, v91
v_cndmask_b32 v92, v112, v92, s[64:65]
v_cndmask_b32 v93, v113, v93, s[66:67]
v_cndmask_b32 v94, v114, v94, s[68:69]
v_cndmask_b32 v95, v115, v95, s[70:71]
v_max3_f32 v85, v92, v93, v94
v_max_f32 v85, v85, v95
v_cndmask_b32 v96, v116, v96, s[64:65]
v_cndmask_b32 v97, v117, v97, s[66:67]
v_cndmask_b32 v98, v118, v98, s[68:69]
v_cndmask_b32 v99, v119, v99, s[70:71]
v_max3_f32 v86, v96, v97, v98
v_max_f32 v86, v86, v99
v_cndmask_b32 v100, v120, v100, s[64:65]
v_cndmask_b32 v101, v121, v101, s[66:67]
v_cndmask_b32 v102, v122, v102, s[68:69]
v_cndmask_b32 v103, v123, v103, s[70:71]
v_max3_f32 v87, v100, v101, v102
v_max_f32 v87, v87, v103
v_permlane32_swap_b32 v84, v85
v_cvt_pk_bf16_f32 v168, v168, v169
v_permlane32_swap_b32 v86, v87
v_max_f32 v84, v84, v85
v_max_f32 v86, v86, v87
v_cvt_pk_bf16_f32 v169, v170, v171
v_cvt_pk_bf16_f32 v170, v172, v173
v_permlane16_swap_b32 v84, v86
v_max_f32 v84, v84, v86
v_mov_b32 v86, v84
v_cvt_pk_bf16_f32 v171, v174, v175
v_cvt_pk_bf16_f32 v172, v176, v177
v_permlane16_swap_b32 v84, v86
v_mov_b32 v85, v84
v_mov_b32 v87, v86
v_cvt_pk_bf16_f32 v173, v178, v179
v_permlane32_swap_b32 v84, v85
v_permlane32_swap_b32 v86, v87
v_cvt_pk_bf16_f32 v174, v180, v181
v_cvt_pk_bf16_f32 v175, v182, v183
v_cvt_pk_bf16_f32 v176, v184, v185
v_cvt_pk_bf16_f32 v177, v186, v187
v_pk_add_f32 v[88:89], v[88:89], v[84:85] op_sel:[0,0] op_sel_hi:[1,0] neg_lo:[0,1] neg_hi:[0,1]
v_pk_add_f32 v[90:91], v[90:91], v[84:85] op_sel:[0,0] op_sel_hi:[1,0] neg_lo:[0,1] neg_hi:[0,1]
v_pk_add_f32 v[92:93], v[92:93], v[84:85] op_sel:[0,1] op_sel_hi:[1,1] neg_lo:[0,1] neg_hi:[0,1]
v_pk_add_f32 v[94:95], v[94:95], v[84:85] op_sel:[0,1] op_sel_hi:[1,1] neg_lo:[0,1] neg_hi:[0,1]
v_pk_add_f32 v[96:97], v[96:97], v[86:87] op_sel:[0,0] op_sel_hi:[1,0] neg_lo:[0,1] neg_hi:[0,1]
v_pk_add_f32 v[98:99], v[98:99], v[86:87] op_sel:[0,0] op_sel_hi:[1,0] neg_lo:[0,1] neg_hi:[0,1]
v_pk_add_f32 v[100:101], v[100:101], v[86:87] op_sel:[0,1] op_sel_hi:[1,1] neg_lo:[0,1] neg_hi:[0,1]
v_pk_add_f32 v[102:103], v[102:103], v[86:87] op_sel:[0,1] op_sel_hi:[1,1] neg_lo:[0,1] neg_hi:[0,1]
v_exp_f32 v88, v88
v_exp_f32 v89, v89
v_exp_f32 v90, v90
v_exp_f32 v91, v91
v_cvt_pk_bf16_f32 v130, v88, v89
v_cvt_pk_bf16_f32 v131, v90, v91
v_bfi_b32 v128, v12, 0, v130
v_bfi_b32 v129, v13, 0, v131
v_and_b32 v130, v12, v130
v_and_b32 v131, v13, v131
v_exp_f32 v92, v92
v_exp_f32 v93, v93
v_mfma_f32_16x16x32_bf16 v[68:71], v[168:171], v[128:131], 0
v_exp_f32 v94, v94
v_mfma_f32_16x16x32_bf16 v[88:91], v[150:153], v[128:131], 0
v_exp_f32 v95, v95
v_cvt_pk_bf16_f32 v134, v92, v93
v_cvt_pk_bf16_f32 v135, v94, v95
v_bfi_b32 v132, v12, 0, v134
v_bfi_b32 v133, v13, 0, v135
v_and_b32 v134, v12, v134
v_and_b32 v135, v13, v135
v_exp_f32 v96, v96
v_exp_f32 v97, v97
v_mfma_f32_16x16x32_bf16 v[72:75], v[170:173], v[132:135], 0
v_exp_f32 v98, v98
v_mfma_f32_16x16x32_bf16 v[92:95], v[152:155], v[132:135], 0
v_exp_f32 v99, v99
v_cvt_pk_bf16_f32 v138, v96, v97
v_cvt_pk_bf16_f32 v139, v98, v99
v_bfi_b32 v136, v12, 0, v138
v_bfi_b32 v137, v13, 0, v139
v_and_b32 v138, v12, v138
v_and_b32 v139, v13, v139
v_exp_f32 v100, v100
v_exp_f32 v101, v101
v_mfma_f32_16x16x32_bf16 v[76:79], v[172:175], v[136:139], 0
v_exp_f32 v102, v102
v_mfma_f32_16x16x32_bf16 v[96:99], v[154:157], v[136:139], 0
v_exp_f32 v103, v103
v_cvt_pk_bf16_f32 v142, v100, v101
v_cvt_pk_bf16_f32 v143, v102, v103
v_bfi_b32 v140, v12, 0, v142
v_bfi_b32 v141, v13, 0, v143
v_and_b32 v142, v12, v142
v_and_b32 v143, v13, v143
v_rcp_f32 v70, v70
v_rcp_f32 v74, v74
v_mfma_f32_16x16x32_bf16 v[80:83], v[174:177], v[140:143], 0
v_rcp_f32 v78, v78
v_mfma_f32_16x16x32_bf16 v[100:103], v[156:159], v[140:143], 0
s_mul_i32 s7, s77, 252
s_sub_u32 s7, s87, s7
s_add_u32 s6, s86, 32768
v_pk_mul_f32 v[88:89], v[88:89], v[70:71] op_sel_hi:[1,0]
v_pk_mul_f32 v[90:91], v[90:91], v[70:71] op_sel_hi:[1,0]
v_pk_mul_f32 v[68:69], v[68:69], v[70:71] op_sel_hi:[1,0]
v_cvt_pk_bf16_f32 v108, v88, v89
v_cvt_pk_bf16_f32 v109, v90, v91
v_cvt_pk_bf16_f32 v116, v68, v69
v_pk_mul_f32 v[92:93], v[92:93], v[74:75] op_sel_hi:[1,0]
v_pk_mul_f32 v[94:95], v[94:95], v[74:75] op_sel_hi:[1,0]
v_pk_mul_f32 v[72:73], v[72:73], v[74:75] op_sel_hi:[1,0]
v_cvt_pk_bf16_f32 v110, v92, v93
v_cvt_pk_bf16_f32 v111, v94, v95
v_cvt_pk_bf16_f32 v117, v72, v73
v_rcp_f32 v82, v82
v_pk_mul_f32 v[96:97], v[96:97], v[78:79] op_sel_hi:[1,0]
v_pk_mul_f32 v[98:99], v[98:99], v[78:79] op_sel_hi:[1,0]
v_pk_mul_f32 v[76:77], v[76:77], v[78:79] op_sel_hi:[1,0]
v_cvt_pk_bf16_f32 v112, v96, v97
v_cvt_pk_bf16_f32 v113, v98, v99
v_cvt_pk_bf16_f32 v118, v76, v77
v_permlane16_swap_b32 v108, v110
v_permlane16_swap_b32 v109, v111
buffer_store_dwordx4 v[108:111], v17, s[24:27], s86 offen sc1
v_pk_mul_f32 v[100:101], v[100:101], v[82:83] op_sel_hi:[1,0]
v_pk_mul_f32 v[102:103], v[102:103], v[82:83] op_sel_hi:[1,0]
v_pk_mul_f32 v[80:81], v[80:81], v[82:83] op_sel_hi:[1,0]
v_cvt_pk_bf16_f32 v114, v100, v101
v_cvt_pk_bf16_f32 v115, v102, v103
v_cvt_pk_bf16_f32 v119, v80, v81
v_mov_b32_dpp v116, v117 quad_perm:[0,1,2,3] row_mask:2 bank_mask:0xf
s_nop 1
v_mov_b32_dpp v116, v118 quad_perm:[0,1,2,3] row_mask:4 bank_mask:0xf
v_permlane16_swap_b32 v112, v114
v_permlane16_swap_b32 v113, v115
v_mov_b32_dpp v116, v119 quad_perm:[0,1,2,3] row_mask:8 bank_mask:0xf
buffer_store_dwordx4 v[112:115], v17, s[24:27], s6 offen sc1
buffer_store_dword v116, v5, s[24:27], s7 offen sc1
s_add_u32 s63, s80, 1
s_lshl_b32 s3, s77, 6
s_add_u32 s3, s3, 160832
v_lshl_add_u32 v22, v6, 2, s3
ds_read2_b32 v[184:185], v22 offset0:0 offset1:80
v_lshlrev_b32 v26, 10, v7
v_lshl_add_u32 v26, v6, 4, v26
s_lshl_b32 s3, s77, 14
s_add_u32 s3, s3, s84
s_lshl_b32 s5, s77, 8
s_add_u32 s5, s5, s84
s_add_u32 s5, s5, 65536
s_add_u32 s6, s5, 4096
v_add_u32 v180, 41472, v5
v_and_b32 v181, 7, v0
v_lshlrev_b32 v181, 4, v181
v_lshl_add_u32 v181, v7, 7, v181
v_add_u32 v182, 41472, v181
v_lshlrev_b32 v28, 16, v58
v_and_b32 v29, 0xffff0000, v58
s_waitcnt lgkmcnt(0)
v_pk_fma_f32 v[28:29], v[28:29], v[184:185], v[184:185] op_sel:[0,0,1] op_sel_hi:[1,0,1]
v_lshlrev_b32 v30, 16, v59
v_and_b32 v31, 0xffff0000, v59
v_pk_fma_f32 v[30:31], v[30:31], v[184:185], v[184:185] op_sel:[0,0,1] op_sel_hi:[1,0,1]
v_lshlrev_b32 v32, 16, v60
v_and_b32 v33, 0xffff0000, v60
v_pk_fma_f32 v[32:33], v[32:33], v[184:185], v[184:185] op_sel:[0,0,1] op_sel_hi:[1,0,1]
v_lshlrev_b32 v34, 16, v61
v_and_b32 v35, 0xffff0000, v61
v_pk_fma_f32 v[34:35], v[34:35], v[184:185], v[184:185] op_sel:[0,0,1] op_sel_hi:[1,0,1]
v_lshlrev_b32 v36, 16, v62
v_and_b32 v37, 0xffff0000, v62
v_pk_fma_f32 v[36:37], v[36:37], v[184:185], v[184:185] op_sel:[0,0,1] op_sel_hi:[1,0,1]
v_lshlrev_b32 v38, 16, v63
v_and_b32 v39, 0xffff0000, v63
v_pk_fma_f32 v[38:39], v[38:39], v[184:185], v[184:185] op_sel:[0,0,1] op_sel_hi:[1,0,1]
v_lshlrev_b32 v40, 16, v64
v_and_b32 v41, 0xffff0000, v64
v_pk_fma_f32 v[40:41], v[40:41], v[184:185], v[184:185] op_sel:[0,0,1] op_sel_hi:[1,0,1]
v_lshlrev_b32 v42, 16, v65
v_and_b32 v43, 0xffff0000, v65
v_pk_fma_f32 v[42:43], v[42:43], v[184:185], v[184:185] op_sel:[0,0,1] op_sel_hi:[1,0,1]
v_lshlrev_b32 v44, 16, v66
v_and_b32 v45, 0xffff0000, v66
v_pk_fma_f32 v[44:45], v[44:45], v[184:185], v[184:185] op_sel:[0,0,1] op_sel_hi:[1,0,1]
v_lshlrev_b32 v46, 16, v67
v_and_b32 v47, 0xffff0000, v67
v_pk_fma_f32 v[46:47], v[46:47], v[184:185], v[184:185] op_sel:[0,0,1] op_sel_hi:[1,0,1]
s_waitcnt vmcnt(3)
s_barrier
ds_read_b128 v[68:71], v180 offset:32256
ds_read_b128 v[72:75], v180 offset:33280
ds_read_b128 v[76:79], v180 offset:34304
ds_read_b128 v[80:83], v180 offset:35328
ds_read_b128 v[84:87], v182 offset:36352
ds_read_b128 v[88:91], v180 offset:36864
ds_read_b128 v[92:95], v180 offset:37888
ds_read_b128 v[96:99], v180 offset:38912
s_waitcnt vmcnt(0)
buffer_load_dwordx4 v[172:175], v26, s[24:27], s5 offen sc1
buffer_load_dwordx4 v[176:179], v26, s[24:27], s6 offen sc1
s_add_u32 s4, s3, 0
buffer_load_dwordx4 v[108:111], v5, s[24:27], s4 offen offset:0 sc1
buffer_load_dwordx4 v[112:115], v5, s[24:27], s4 offen offset:1024 sc1
ds_read_b128 v[100:103], v180 offset:39936
ds_read_b128 v[104:107], v182 offset:40960
ds_read_b128 v[224:227], v5 offset:0
ds_read_b128 v[228:231], v5 offset:1024
ds_read_b128 v[232:235], v5 offset:2048
ds_read_b128 v[236:239], v5 offset:3072
ds_read_b128 v[240:243], v181 offset:4096
ds_read_b128 v[244:247], v5 offset:4608
ds_read_b128 v[248:251], v5 offset:5632
ds_read_b128 v[252:255], v5 offset:6656
ds_read_b128 a[0:3], v5 offset:7680
ds_read_b128 a[4:7], v181 offset:8704
ds_read_b128 a[8:11], v5 offset:9216
ds_read_b128 a[12:15], v5 offset:10240
ds_read_b128 a[16:19], v5 offset:11264
ds_read_b128 a[20:23], v5 offset:12288
ds_read_b128 a[24:27], v181 offset:13312
L_127:
s_waitcnt vmcnt(3)
v_max_u32 v183, v172, v173
v_max3_u32 v183, v183, v174, v175
s_waitcnt vmcnt(2)
v_max3_u32 v183, v183, v176, v177
v_max3_u32 v183, v183, v178, v179
v_cmp_eq_u32 vcc, -1, v183
s_cbranch_vccz L_130
L_129:
s_sub_u32 s82, s82, 1
s_cbranch_scc1 L_exit
s_waitcnt vmcnt(0)
buffer_load_dwordx4 v[172:175], v26, s[24:27], s5 offen sc1
buffer_load_dwordx4 v[176:179], v26, s[24:27], s6 offen sc1
s_add_u32 s4, s3, 0
buffer_load_dwordx4 v[108:111], v5, s[24:27], s4 offen offset:0 sc1
buffer_load_dwordx4 v[112:115], v5, s[24:27], s4 offen offset:1024 sc1
s_waitcnt vmcnt(0)
s_branch L_127
L_130:
buffer_load_dwordx4 v[116:119], v5, s[24:27], s4 offen offset:2048 sc1
buffer_load_dwordx4 v[120:123], v5, s[24:27], s4 offen offset:3072 sc1
s_add_u32 s4, s3, 4096
buffer_load_dwordx4 v[124:127], v5, s[24:27], s4 offen offset:0 sc1
buffer_load_dwordx4 v[128:131], v5, s[24:27], s4 offen offset:1024 sc1
ds_read_b128 a[28:31], v5 offset:13824
s_waitcnt lgkmcnt(15)
v_mfma_f32_16x16x32_bf16 v[28:31], v[68:71], v[172:175], v[28:31]
buffer_load_dwordx4 v[132:135], v5, s[24:27], s4 offen offset:2048 sc1
ds_read_b128 v[68:71], v5 offset:14848
v_mfma_f32_16x16x32_bf16 v[32:35], v[72:75], v[172:175], v[32:35]
s_mul_i32 s7, s76, 144
s_add_u32 s7, s7, 162560
v_lshl_add_u32 v22, v7, 4, s7
ds_read_b128 v[72:75], v5 offset:15872
v_mfma_f32_16x16x32_bf16 v[36:39], v[76:79], v[172:175], v[36:39]
v_and_b32 v23, 1, v7
v_lshl_add_u32 v23, v23, 3, s7
ds_read_b128 v[76:79], v5 offset:16896
v_mfma_f32_16x16x32_bf16 v[40:43], v[80:83], v[172:175], v[40:43]
ds_read_b128 v[48:51], v22
ds_read_b128 v[80:83], v181 offset:17920
v_mfma_f32_16x16x32_bf16 v[44:47], v[84:87], v[172:175], v[44:47]
ds_read_b128 v[52:55], v22 offset:64
ds_read_b128 v[84:87], v5 offset:18432
v_mfma_f32_16x16x32_bf16 v[28:31], v[88:91], v[176:179], v[28:31]
buffer_load_dwordx4 v[136:139], v5, s[24:27], s4 offen offset:3072 sc1
ds_read_b128 v[88:91], v5 offset:19456
v_mfma_f32_16x16x32_bf16 v[32:35], v[92:95], v[176:179], v[32:35]
ds_read_b64 v[56:57], v23 offset:128
ds_read_b128 v[92:95], v5 offset:20480
v_mfma_f32_16x16x32_bf16 v[36:39], v[96:99], v[176:179], v[36:39]
v_mul_u32_u24 v1, 2304, v6
ds_read_b128 v[96:99], v5 offset:21504
v_mfma_f32_16x16x32_bf16 v[40:43], v[100:103], v[176:179], v[40:43]
v_lshl_add_u32 v1, v7, 4, v1
ds_read_b128 v[100:103], v181 offset:22528
v_mfma_f32_16x16x32_bf16 v[44:47], v[104:107], v[176:179], v[44:47]
ds_read_b128 v[104:107], v5 offset:23040
s_waitcnt vmcnt(7)
v_mfma_f32_16x16x32_bf16 v[28:31], v[224:227], v[108:111], v[28:31]
s_add_u32 s4, s3, 8192
buffer_load_dwordx4 v[140:143], v5, s[24:27], s4 offen offset:0 sc1
ds_read_b128 v[224:227], v5 offset:24064
s_waitcnt lgkmcnt(15)
v_mfma_f32_16x16x32_bf16 v[32:35], v[228:231], v[108:111], v[32:35]
ds_read_b128 v[228:231], v5 offset:25088
v_mfma_f32_16x16x32_bf16 v[36:39], v[232:235], v[108:111], v[36:39]
v_max3_u32 v183, v183, v108, v109
ds_read_b128 v[232:235], v5 offset:26112
v_mfma_f32_16x16x32_bf16 v[40:43], v[236:239], v[108:111], v[40:43]
v_max3_u32 v183, v183, v110, v111
ds_read_b128 v[236:239], v181 offset:27136
v_mfma_f32_16x16x32_bf16 v[44:47], v[240:243], v[108:111], v[44:47]
ds_read_b128 v[240:243], v5 offset:27648
s_waitcnt vmcnt(7)
v_mfma_f32_16x16x32_bf16 v[28:31], v[244:247], v[112:115], v[28:31]
buffer_load_dwordx4 v[144:147], v5, s[24:27], s4 offen offset:1024 sc1
ds_read_b128 v[244:247], v5 offset:28672
v_mfma_f32_16x16x32_bf16 v[32:35], v[248:251], v[112:115], v[32:35]
ds_read_b128 v[248:251], v5 offset:29696
v_mfma_f32_16x16x32_bf16 v[36:39], v[252:255], v[112:115], v[36:39]
v_max3_u32 v183, v183, v112, v113
ds_read_b128 v[252:255], v5 offset:30720
v_mfma_f32_16x16x32_bf16 v[40:43], a[0:3], v[112:115], v[40:43]
v_max3_u32 v183, v183, v114, v115
ds_read_b128 a[0:3], v181 offset:31744
v_mfma_f32_16x16x32_bf16 v[44:47], a[4:7], v[112:115], v[44:47]
ds_read_b128 a[4:7], v5 offset:32256
s_waitcnt vmcnt(7)
v_mfma_f32_16x16x32_bf16 v[28:31], a[8:11], v[116:119], v[28:31]
buffer_load_dwordx4 v[148:151], v5, s[24:27], s4 offen offset:2048 sc1
ds_read_b128 a[8:11], v5 offset:33280
v_mfma_f32_16x16x32_bf16 v[32:35], a[12:15], v[116:119], v[32:35]
ds_read_b128 a[12:15], v5 offset:34304
v_mfma_f32_16x16x32_bf16 v[36:39], a[16:19], v[116:119], v[36:39]
v_max3_u32 v183, v183, v116, v117
ds_read_b128 a[16:19], v5 offset:35328
v_mfma_f32_16x16x32_bf16 v[40:43], a[20:23], v[116:119], v[40:43]
v_max3_u32 v183, v183, v118, v119
ds_read_b128 a[20:23], v181 offset:36352
v_mfma_f32_16x16x32_bf16 v[44:47], a[24:27], v[116:119], v[44:47]
ds_read_b128 a[24:27], v5 offset:36864
s_waitcnt vmcnt(7) lgkmcnt(15)
v_mfma_f32_16x16x32_bf16 v[28:31], a[28:31], v[120:123], v[28:31]
buffer_load_dwordx4 v[152:155], v5, s[24:27], s4 offen offset:3072 sc1
ds_read_b128 a[28:31], v5 offset:37888
v_mfma_f32_16x16x32_bf16 v[32:35], v[68:71], v[120:123], v[32:35]
ds_read_b128 v[68:71], v5 offset:38912
v_mfma_f32_16x16x32_bf16 v[36:39], v[72:75], v[120:123], v[36:39]
v_max3_u32 v183, v183, v120, v121
ds_read_b128 v[72:75], v5 offset:39936
v_mfma_f32_16x16x32_bf16 v[40:43], v[76:79], v[120:123], v[40:43]
v_max3_u32 v183, v183, v122, v123
ds_read_b128 v[76:79], v181 offset:40960
v_mfma_f32_16x16x32_bf16 v[44:47], v[80:83], v[120:123], v[44:47]
ds_read_b128 v[80:83], v180 offset:0
s_waitcnt vmcnt(7)
v_mfma_f32_16x16x32_bf16 v[28:31], v[84:87], v[124:127], v[28:31]
s_add_u32 s4, s3, 12288
buffer_load_dwordx4 v[156:159], v5, s[24:27], s4 offen offset:0 sc1
ds_read_b128 v[84:87], v180 offset:1024
v_mfma_f32_16x16x32_bf16 v[32:35], v[88:91], v[124:127], v[32:35]
ds_read_b128 v[88:91], v180 offset:2048
v_mfma_f32_16x16x32_bf16 v[36:39], v[92:95], v[124:127], v[36:39]
v_max3_u32 v183, v183, v124, v125
ds_read_b128 v[92:95], v180 offset:3072
v_mfma_f32_16x16x32_bf16 v[40:43], v[96:99], v[124:127], v[40:43]
v_max3_u32 v183, v183, v126, v127
ds_read_b128 v[96:99], v182 offset:4096
v_mfma_f32_16x16x32_bf16 v[44:47], v[100:103], v[124:127], v[44:47]
ds_read_b128 v[100:103], v180 offset:4608
s_waitcnt vmcnt(7)
v_mfma_f32_16x16x32_bf16 v[28:31], v[104:107], v[128:131], v[28:31]
buffer_load_dwordx4 v[160:163], v5, s[24:27], s4 offen offset:1024 sc1
ds_read_b128 v[104:107], v180 offset:5632
s_waitcnt lgkmcnt(15)
v_mfma_f32_16x16x32_bf16 v[32:35], v[224:227], v[128:131], v[32:35]
ds_read_b128 v[224:227], v180 offset:6656
v_mfma_f32_16x16x32_bf16 v[36:39], v[228:231], v[128:131], v[36:39]
v_max3_u32 v183, v183, v128, v129
ds_read_b128 v[228:231], v180 offset:7680
v_mfma_f32_16x16x32_bf16 v[40:43], v[232:235], v[128:131], v[40:43]
v_max3_u32 v183, v183, v130, v131
ds_read_b128 v[232:235], v182 offset:8704
v_mfma_f32_16x16x32_bf16 v[44:47], v[236:239], v[128:131], v[44:47]
ds_read_b128 v[236:239], v180 offset:9216
s_waitcnt vmcnt(7)
v_mfma_f32_16x16x32_bf16 v[28:31], v[240:243], v[132:135], v[28:31]
buffer_load_dwordx4 v[164:167], v5, s[24:27], s4 offen offset:2048 sc1
ds_read_b128 v[240:243], v180 offset:10240
v_mfma_f32_16x16x32_bf16 v[32:35], v[244:247], v[132:135], v[32:35]
ds_read_b128 v[244:247], v180 offset:11264
v_mfma_f32_16x16x32_bf16 v[36:39], v[248:251], v[132:135], v[36:39]
v_max3_u32 v183, v183, v132, v133
ds_read_b128 v[248:251], v180 offset:12288
v_mfma_f32_16x16x32_bf16 v[40:43], v[252:255], v[132:135], v[40:43]
v_max3_u32 v183, v183, v134, v135
ds_read_b128 v[252:255], v182 offset:13312
v_mfma_f32_16x16x32_bf16 v[44:47], a[0:3], v[132:135], v[44:47]
ds_read_b128 a[0:3], v180 offset:13824
s_waitcnt vmcnt(7)
v_mfma_f32_16x16x32_bf16 v[28:31], a[4:7], v[136:139], v[28:31]
buffer_load_dwordx4 v[168:171], v5, s[24:27], s4 offen offset:3072 sc1
ds_read_b128 a[4:7], v180 offset:14848
v_mfma_f32_16x16x32_bf16 v[32:35], a[8:11], v[136:139], v[32:35]
ds_read_b128 a[8:11], v180 offset:15872
s_waitcnt lgkmcnt(15)
v_mfma_f32_16x16x32_bf16 v[36:39], a[12:15], v[136:139], v[36:39]
v_max3_u32 v183, v183, v136, v137
ds_read_b128 a[12:15], v180 offset:16896
v_mfma_f32_16x16x32_bf16 v[40:43], a[16:19], v[136:139], v[40:43]
v_max3_u32 v183, v183, v138, v139
ds_read_b128 a[16:19], v182 offset:17920
v_mfma_f32_16x16x32_bf16 v[44:47], a[20:23], v[136:139], v[44:47]
ds_read_b128 a[20:23], v180 offset:18432
s_waitcnt vmcnt(7)
v_mfma_f32_16x16x32_bf16 v[28:31], a[24:27], v[140:143], v[28:31]
ds_read_b128 a[24:27], v180 offset:19456
v_mfma_f32_16x16x32_bf16 v[32:35], a[28:31], v[140:143], v[32:35]
ds_read_b128 a[28:31], v180 offset:20480
v_mfma_f32_16x16x32_bf16 v[36:39], v[68:71], v[140:143], v[36:39]
v_max3_u32 v183, v183, v140, v141
ds_read_b128 v[68:71], v180 offset:21504
v_mfma_f32_16x16x32_bf16 v[40:43], v[72:75], v[140:143], v[40:43]
v_max3_u32 v183, v183, v142, v143
ds_read_b128 v[72:75], v182 offset:22528
v_mfma_f32_16x16x32_bf16 v[44:47], v[76:79], v[140:143], v[44:47]
ds_read_b128 v[76:79], v180 offset:23040
s_waitcnt vmcnt(6)
v_mfma_f32_16x16x32_bf16 v[28:31], v[80:83], v[144:147], v[28:31]
ds_read_b128 v[80:83], v180 offset:24064
v_mfma_f32_16x16x32_bf16 v[32:35], v[84:87], v[144:147], v[32:35]
ds_read_b128 v[84:87], v180 offset:25088
v_mfma_f32_16x16x32_bf16 v[36:39], v[88:91], v[144:147], v[36:39]
v_max3_u32 v183, v183, v144, v145
ds_read_b128 v[88:91], v180 offset:26112
s_waitcnt lgkmcnt(15)
v_mfma_f32_16x16x32_bf16 v[40:43], v[92:95], v[144:147], v[40:43]
v_max3_u32 v183, v183, v146, v147
ds_read_b128 v[92:95], v182 offset:27136
v_mfma_f32_16x16x32_bf16 v[44:47], v[96:99], v[144:147], v[44:47]
ds_read_b128 v[96:99], v180 offset:27648
s_waitcnt vmcnt(5)
v_mfma_f32_16x16x32_bf16 v[28:31], v[100:103], v[148:151], v[28:31]
ds_read_b128 v[100:103], v180 offset:28672
v_mfma_f32_16x16x32_bf16 v[32:35], v[104:107], v[148:151], v[32:35]
ds_read_b128 v[104:107], v180 offset:29696
v_mfma_f32_16x16x32_bf16 v[36:39], v[224:227], v[148:151], v[36:39]
v_max3_u32 v183, v183, v148, v149
ds_read_b128 v[224:227], v180 offset:30720
v_mfma_f32_16x16x32_bf16 v[40:43], v[228:231], v[148:151], v[40:43]
v_max3_u32 v183, v183, v150, v151
ds_read_b128 v[228:231], v182 offset:31744
v_mfma_f32_16x16x32_bf16 v[44:47], v[232:235], v[148:151], v[44:47]
s_waitcnt vmcnt(4)
v_mfma_f32_16x16x32_bf16 v[28:31], v[236:239], v[152:155], v[28:31]
v_mfma_f32_16x16x32_bf16 v[32:35], v[240:243], v[152:155], v[32:35]
v_mfma_f32_16x16x32_bf16 v[36:39], v[244:247], v[152:155], v[36:39]
v_max3_u32 v183, v183, v152, v153
v_mfma_f32_16x16x32_bf16 v[40:43], v[248:251], v[152:155], v[40:43]
v_max3_u32 v183, v183, v154, v155
s_waitcnt lgkmcnt(15)
v_mfma_f32_16x16x32_bf16 v[44:47], v[252:255], v[152:155], v[44:47]
s_waitcnt vmcnt(3)
v_mfma_f32_16x16x32_bf16 v[28:31], a[0:3], v[156:159], v[28:31]
v_mfma_f32_16x16x32_bf16 v[32:35], a[4:7], v[156:159], v[32:35]
v_mfma_f32_16x16x32_bf16 v[36:39], a[8:11], v[156:159], v[36:39]
v_max3_u32 v183, v183, v156, v157
v_mfma_f32_16x16x32_bf16 v[40:43], a[12:15], v[156:159], v[40:43]
v_max3_u32 v183, v183, v158, v159
v_mfma_f32_16x16x32_bf16 v[44:47], a[16:19], v[156:159], v[44:47]
s_waitcnt vmcnt(2) lgkmcnt(14)
v_mfma_f32_16x16x32_bf16 v[28:31], a[20:23], v[160:163], v[28:31]
s_waitcnt lgkmcnt(13)
v_mfma_f32_16x16x32_bf16 v[32:35], a[24:27], v[160:163], v[32:35]
s_waitcnt lgkmcnt(12)
v_mfma_f32_16x16x32_bf16 v[36:39], a[28:31], v[160:163], v[36:39]
v_max3_u32 v183, v183, v160, v161
s_waitcnt lgkmcnt(11)
v_mfma_f32_16x16x32_bf16 v[40:43], v[68:71], v[160:163], v[40:43]
v_max3_u32 v183, v183, v162, v163
s_waitcnt lgkmcnt(10)
v_mfma_f32_16x16x32_bf16 v[44:47], v[72:75], v[160:163], v[44:47]
s_waitcnt vmcnt(1) lgkmcnt(9)
v_mfma_f32_16x16x32_bf16 v[28:31], v[76:79], v[164:167], v[28:31]
s_waitcnt lgkmcnt(8)
v_mfma_f32_16x16x32_bf16 v[32:35], v[80:83], v[164:167], v[32:35]
s_waitcnt lgkmcnt(7)
v_mfma_f32_16x16x32_bf16 v[36:39], v[84:87], v[164:167], v[36:39]
v_max3_u32 v183, v183, v164, v165
s_waitcnt lgkmcnt(6)
v_mfma_f32_16x16x32_bf16 v[40:43], v[88:91], v[164:167], v[40:43]
v_max3_u32 v183, v183, v166, v167
s_waitcnt lgkmcnt(5)
v_mfma_f32_16x16x32_bf16 v[44:47], v[92:95], v[164:167], v[44:47]
s_waitcnt vmcnt(0) lgkmcnt(4)
v_mfma_f32_16x16x32_bf16 v[28:31], v[96:99], v[168:171], v[28:31]
s_waitcnt lgkmcnt(3)
v_mfma_f32_16x16x32_bf16 v[32:35], v[100:103], v[168:171], v[32:35]
s_waitcnt lgkmcnt(2)
v_mfma_f32_16x16x32_bf16 v[36:39], v[104:107], v[168:171], v[36:39]
v_max3_u32 v183, v183, v168, v169
s_waitcnt lgkmcnt(1)
v_mfma_f32_16x16x32_bf16 v[40:43], v[224:227], v[168:171], v[40:43]
v_max3_u32 v183, v183, v170, v171
s_waitcnt lgkmcnt(0)
v_mfma_f32_16x16x32_bf16 v[44:47], v[228:231], v[168:171], v[44:47]
v_cmp_eq_u32 vcc, -1, v183
s_cbranch_vccnz L_128
s_mov_b32 s3, 1065369472
v_cvt_pk_bf16_f32 v108, v28, v29
v_cvt_pk_bf16_f32 v109, v30, v31
v_cvt_pk_bf16_f32 v110, v32, v33
v_cvt_pk_bf16_f32 v111, v34, v35
v_cvt_pk_bf16_f32 v112, v36, v37
v_cvt_pk_bf16_f32 v113, v38, v39
v_cvt_pk_bf16_f32 v114, v40, v41
v_cvt_pk_bf16_f32 v115, v42, v43
v_cvt_pk_bf16_f32 v116, v44, v45
v_cvt_pk_bf16_f32 v117, v46, v47
v_dot2_f32_bf16 v120, v108, s3, 0
v_dot2_f32_bf16 v121, v108, v108, 0
v_dot2_f32_bf16 v122, v108, v48, 0
s_mov_b32 exec_hi, 0
v_dot2_f32_bf16 v120, v116, s3, v120
v_dot2_f32_bf16 v121, v116, v116, v121
v_dot2_f32_bf16 v122, v116, v56, v122
v_dot2_f32_bf16 v120, v117, s3, v120
v_dot2_f32_bf16 v121, v117, v117, v121
v_dot2_f32_bf16 v122, v117, v57, v122
s_mov_b64 exec, -1
v_dot2_f32_bf16 v120, v109, s3, v120
v_dot2_f32_bf16 v121, v109, v109, v121
v_dot2_f32_bf16 v122, v109, v49, v122
v_dot2_f32_bf16 v120, v110, s3, v120
v_dot2_f32_bf16 v121, v110, v110, v121
v_dot2_f32_bf16 v122, v110, v50, v122
v_dot2_f32_bf16 v120, v111, s3, v120
v_dot2_f32_bf16 v121, v111, v111, v121
v_dot2_f32_bf16 v122, v111, v51, v122
v_dot2_f32_bf16 v120, v112, s3, v120
v_dot2_f32_bf16 v121, v112, v112, v121
v_dot2_f32_bf16 v122, v112, v52, v122
v_dot2_f32_bf16 v120, v113, s3, v120
v_dot2_f32_bf16 v121, v113, v113, v121
v_dot2_f32_bf16 v122, v113, v53, v122
v_dot2_f32_bf16 v120, v114, s3, v120
v_dot2_f32_bf16 v121, v114, v114, v121
v_dot2_f32_bf16 v122, v114, v54, v122
v_dot2_f32_bf16 v120, v115, s3, v120
v_dot2_f32_bf16 v121, v115, v115, v121
v_dot2_f32_bf16 v122, v115, v55, v122
v_mov_b32 v123, s63
v_permlane32_swap_b32 v120, v124
v_permlane32_swap_b32 v121, v125
v_permlane32_swap_b32 v122, v126
v_add_f32 v120, v120, v124
v_add_f32 v121, v121, v125
v_add_f32 v122, v122, v126
v_permlane16_swap_b32 v120, v124
v_permlane16_swap_b32 v121, v125
v_permlane16_swap_b32 v122, v126
v_add_f32 v120, v120, v124
v_add_f32 v121, v121, v125
v_add_f32 v122, v122, v126
s_mov_b64 exec, 65535
buffer_store_dwordx4 v[120:123], v5, s[24:27], s88 offen sc1
s_mov_b64 exec, -1
s_lshl_b32 s4, s77, 8
s_add_u32 s4, s4, s84
s_add_u32 s4, s4, 73728
s_add_u32 s5, s4, 4096
s_waitcnt vmcnt(0)
buffer_load_dwordx4 v[128:131], v26, s[24:27], s4 offen sc1
buffer_load_dwordx4 v[132:135], v26, s[24:27], s5 offen sc1
v_and_b32 v78, 31, v0
v_lshlrev_b32 v78, 8, v78
v_mov_b32 v175, 163792
ds_read_b32 v175, v175
v_lshlrev_b32 v22, 4, v7
v_mov_b32 v139, s80
s_lshl_b32 s3, s77, 4
v_or_b32 v141, s3, v6
s_add_u32 s3, s3, 163728
v_mov_b32 v23, s3
v_and_b32 v173, 3, v0
v_lshlrev_b32 v173, 4, v173
v_add_u32 v173, 163728, v173
v_lshrrev_b32 v174, 2, v0
v_lshlrev_b32 v174, 13, v174
s_lshl_b32 s3, s78, 8
s_add_u32 s3, s3, 2949120
s_mov_b32 s7, -64
v_mov_b32 v176, 163796
v_mov_b32 v177, 1
s_branch C_131
R_132:
s_sub_u32 s82, s82, 1
s_cbranch_scc1 L_exit
s_waitcnt vmcnt(0)
buffer_load_dwordx4 v[128:131], v26, s[24:27], s4 offen sc1
buffer_load_dwordx4 v[132:135], v26, s[24:27], s5 offen sc1
s_waitcnt vmcnt(0)
C_131:
s_waitcnt vmcnt(1)
v_cmp_ne_u32 s[52:53], s63, v131
s_waitcnt vmcnt(0)
v_cmp_ne_u32 vcc, s63, v135
s_or_b64 vcc, vcc, s[52:53]
s_cbranch_vccnz R_132
s_lshl_b32 s0, s77, 5
s_add_u32 s0, s0, s75
s_cmp_lt_u32 s0, 18
s_cbranch_scc0 L_133
s_lshl_b32 s1, s74, 13
s_add_u32 s1, s1, 2949120
s_not_b32 exec_lo, s8
s_mov_b32 exec_hi, 0
buffer_load_dwordx4 v[68:71], v78, s[44:47], s1 offen sc1
s_mov_b64 exec, -1
L_133:
v_add_f32 v128, v128, v132
v_add_f32 v129, v129, v133
v_add_f32 v130, v130, v134
v_mov_b32 v132, v128
v_mov_b32 v133, v129
v_mov_b32 v134, v130
v_permlane32_swap_b32 v128, v132
v_permlane32_swap_b32 v129, v133
v_permlane32_swap_b32 v130, v134
v_add_f32 v128, v128, v132
v_add_f32 v129, v129, v133
v_add_f32 v130, v130, v134
v_mov_b32 v132, v128
v_mov_b32 v133, v129
v_mov_b32 v134, v130
v_permlane16_swap_b32 v128, v132
v_permlane16_swap_b32 v129, v133
v_permlane16_swap_b32 v130, v134
v_add_f32 v128, v128, v132
v_add_f32 v129, v129, v133
v_add_f32 v130, v130, v134
v_mul_f32 v128, 0xbae38e39, v128
v_mul_f32 v129, 0x3ae38e39, v129
v_fma_f32 v129, -v128, v128, v129
v_max_f32 v129, 0, v129
v_add_f32 v132, 0x3727c5ac, v129
v_rsq_f32 v131, v132
s_waitcnt lgkmcnt(0)
v_fma_f32 v136, v128, v175, v130
v_mul_f32 v136, v136, v131
v_ashrrev_i32 v140, 31, v136
v_lshrrev_b32 v140, 1, v140
v_xor_b32 v136, v136, v140
v_and_or_b32 v136, v136, s7, v141
v_mov_b32 v142, v131
v_mul_f32 v143, v128, v131
v_max_i32_dpp v140, v136, v136 row_ror:8 row_mask:0xf bank_mask:0xf
v_mul_f32 v138, v132, v131
v_sub_f32 v137, 0, v128
v_max_i32_dpp v140, v140, v140 row_ror:4 row_mask:0xf bank_mask:0xf
v_pk_fma_f32 v[164:165], v[44:45], v[142:143], v[142:143] op_sel:[0,0,1] op_sel_hi:[1,0,1]
v_pk_fma_f32 v[166:167], v[46:47], v[142:143], v[142:143] op_sel:[0,0,1] op_sel_hi:[1,0,1]
v_max_i32_dpp v140, v140, v140 row_ror:2 row_mask:0xf bank_mask:0xf
v_pk_fma_f32 v[148:149], v[28:29], v[142:143], v[142:143] op_sel:[0,0,1] op_sel_hi:[1,0,1]
v_pk_fma_f32 v[150:151], v[30:31], v[142:143], v[142:143] op_sel:[0,0,1] op_sel_hi:[1,0,1]
v_max_i32_dpp v140, v140, v140 row_ror:1 row_mask:0xf bank_mask:0xf
v_cmp_eq_u32 s[54:55], v136, v140
v_pk_fma_f32 v[152:153], v[32:33], v[142:143], v[142:143] op_sel:[0,0,1] op_sel_hi:[1,0,1]
v_pk_fma_f32 v[154:155], v[34:35], v[142:143], v[142:143] op_sel:[0,0,1] op_sel_hi:[1,0,1]
s_and_b64 exec, s[54:55], 0xffff
ds_write_b128 v23, v[136:139]
ds_add_rtn_u32 v176, v176, v177
s_mov_b64 exec, -1
ds_read_b128 v[168:171], v173
v_pk_fma_f32 v[156:157], v[36:37], v[142:143], v[142:143] op_sel:[0,0,1] op_sel_hi:[1,0,1]
v_pk_fma_f32 v[158:159], v[38:39], v[142:143], v[142:143] op_sel:[0,0,1] op_sel_hi:[1,0,1]
v_pk_fma_f32 v[160:161], v[40:41], v[142:143], v[142:143] op_sel:[0,0,1] op_sel_hi:[1,0,1]
v_pk_fma_f32 v[162:163], v[42:43], v[142:143], v[142:143] op_sel:[0,0,1] op_sel_hi:[1,0,1]
s_cmp_eq_u32 s76, 0
s_cbranch_scc0 L_134
s_waitcnt lgkmcnt(1)
v_cmp_eq_u32 vcc, 7, v176
s_cbranch_vccz L_135
s_waitcnt lgkmcnt(0)
v_max_i32_dpp v172, v168, v168 quad_perm:[1,0,3,2] row_mask:0xf bank_mask:0xf
s_nop 1
v_max_i32_dpp v172, v172, v172 quad_perm:[2,3,0,1] row_mask:0xf bank_mask:0xf
v_cmp_eq_u32 vcc, v168, v172
s_mov_b32 exec_hi, 0
s_mov_b32 exec_lo, vcc_lo
buffer_store_dwordx4 v[168:171], v174, s[44:47], s3 offen sc1
s_mov_b64 exec, -1
L_135:
L_134:
v_cvt_pk_bf16_f32 v116, v164, v165
v_cvt_pk_bf16_f32 v117, v166, v167
v_cvt_pk_bf16_f32 v108, v148, v149
v_cvt_pk_bf16_f32 v109, v150, v151
v_cvt_pk_bf16_f32 v110, v152, v153
v_cvt_pk_bf16_f32 v111, v154, v155
v_cvt_pk_bf16_f32 v112, v156, v157
v_cvt_pk_bf16_f32 v113, v158, v159
v_cvt_pk_bf16_f32 v114, v160, v161
v_cvt_pk_bf16_f32 v115, v162, v163
v_permlane16_swap_b32 v116, v118
v_permlane16_swap_b32 v117, v119
s_mov_b64 exec, s[54:55]
buffer_store_dwordx4 v[108:111], v22, s[44:47], s89 offen offset:640 sc1
buffer_store_dwordx4 v[112:115], v22, s[44:47], s89 offen offset:704 sc1
s_and_b64 exec, s[54:55], 0xffff
buffer_store_dwordx4 v[116:119], v22, s[44:47], s89 offen offset:768 sc1
s_mov_b64 exec, -1
s_lshl_b32 s0, s77, 5
s_add_u32 s0, s0, s75
s_cmp_lt_u32 s0, 18
s_cbranch_scc0 L_136
s_waitcnt vmcnt(3)
v_cmp_ne_u32 vcc, s80, v71
v_bfrev_b32 v76, 1
s_andn2_b32 s52, vcc_lo, s8
s_or_b32 vcc_lo, vcc_lo, s8
v_cndmask_b32 v68, v68, v76, vcc
s_nop 1
v_max_i32_dpp v76, v68, v68 row_ror:8 row_mask:0xf bank_mask:0xf
v_mov_b32 v71, v0
s_nop 0
v_max_i32_dpp v76, v76, v76 row_ror:4 row_mask:0xf bank_mask:0xf
s_nop 1
v_max_i32_dpp v76, v76, v76 row_ror:2 row_mask:0xf bank_mask:0xf
s_nop 1
v_max_i32_dpp v76, v76, v76 row_ror:1 row_mask:0xf bank_mask:0xf
s_nop 0
v_readlane_b32 s3, v76, 0
v_readlane_b32 s4, v76, 16
s_max_i32 s57, s3, s4
v_cmp_eq_u32 vcc, s57, v68
s_bfe_u32 s5, s57, 0x20004
s_lshl_b32 s5, s5, 10
s_add_u32 s5, s5, 4350592
s_ff1_i32_b32 s3, vcc_lo
s_mul_i32 s4, s3, 286720
s_add_u32 s4, s4, s5
L_136:
v_add_f32 v142, 1.0, v142
v_pk_fma_f32 v[148:149], v[28:29], v[142:143], v[142:143] op_sel:[0,0,1] op_sel_hi:[1,0,1]
v_pk_fma_f32 v[150:151], v[30:31], v[142:143], v[142:143] op_sel:[0,0,1] op_sel_hi:[1,0,1]
v_pk_fma_f32 v[152:153], v[32:33], v[142:143], v[142:143] op_sel:[0,0,1] op_sel_hi:[1,0,1]
v_pk_fma_f32 v[154:155], v[34:35], v[142:143], v[142:143] op_sel:[0,0,1] op_sel_hi:[1,0,1]
v_pk_fma_f32 v[156:157], v[36:37], v[142:143], v[142:143] op_sel:[0,0,1] op_sel_hi:[1,0,1]
v_pk_fma_f32 v[158:159], v[38:39], v[142:143], v[142:143] op_sel:[0,0,1] op_sel_hi:[1,0,1]
v_pk_fma_f32 v[160:161], v[40:41], v[142:143], v[142:143] op_sel:[0,0,1] op_sel_hi:[1,0,1]
v_pk_fma_f32 v[162:163], v[42:43], v[142:143], v[142:143] op_sel:[0,0,1] op_sel_hi:[1,0,1]
v_pk_fma_f32 v[164:165], v[44:45], v[142:143], v[142:143] op_sel:[0,0,1] op_sel_hi:[1,0,1]
v_pk_fma_f32 v[166:167], v[46:47], v[142:143], v[142:143] op_sel:[0,0,1] op_sel_hi:[1,0,1]
v_cvt_pk_bf16_f32 v184, v164, v165
v_cvt_pk_bf16_f32 v185, v166, v167
s_waitcnt lgkmcnt(1)
v_cvt_pk_bf16_f32 v176, v148, v149
v_cvt_pk_bf16_f32 v177, v150, v151
v_cvt_pk_bf16_f32 v178, v152, v153
v_cvt_pk_bf16_f32 v179, v154, v155
v_cvt_pk_bf16_f32 v180, v156, v157
v_cvt_pk_bf16_f32 v181, v158, v159
v_cvt_pk_bf16_f32 v182, v160, v161
v_cvt_pk_bf16_f32 v183, v162, v163
v_permlane16_swap_b32 v184, v186
v_permlane16_swap_b32 v185, v187
s_not_b64 s[52:53], s[54:55]
s_cmp_ge_u32 s77, 1
s_cbranch_scc0 L_137
s_mov_b64 exec, s[52:53]
buffer_store_dwordx4 v[176:179], v1, s[28:31], s94 offen offset:0
buffer_store_dwordx4 v[180:183], v1, s[28:31], s94 offen offset:64
s_and_b64 exec, s[52:53], 0xffff
buffer_store_dwordx4 v[184:187], v1, s[28:31], s94 offen offset:128
s_mov_b64 exec, -1
L_137:
s_lshl_b32 s83, s75, 3
s_add_u32 s83, s83, s74
s_sub_u32 s83, s83, 192
s_cmp_lt_u32 s77, 1
s_cselect_b32 s83, s83, 99
s_mov_b32 s12, 0
s_cmp_lt_u32 s75, 18
s_cbranch_scc0 L_139
s_waitcnt lgkmcnt(0)
L_138:
s_cmp_eq_u32 s77, 0
s_cbranch_scc0 L_142
v_mul_u32_u24 v50, 7282, v0
v_lshrrev_b32 v50, 16, v50
v_mul_u32_u24 v50, 3952, v50
v_add_u32 v50, v50, v5
v_lshlrev_b32 v38, 8, v0
v_mov_b32 v44, 0
v_mov_b32 v45, 0
v_mov_b32 v46, 0
v_mov_b32 v47, 0
v_mov_b32 v37, 163712
s_lshl_b32 s1, s74, 13
s_add_u32 s1, s1, 2949120
s_not_b32 exec_lo, s8
s_mov_b32 exec_hi, 0
buffer_load_dwordx4 v[28:31], v38, s[44:47], s1 offen sc1
s_mov_b64 exec, -1
buffer_load_dwordx4 v[40:43], v50, s[44:47], s4 offen sc1
s_add_u32 s1, s4, 28688
s_mov_b64 exec, 255
buffer_load_dwordx4 v[44:47], v5, s[44:47], s1 offen sc1
s_mov_b64 exec, -1
L_142:
s_add_u32 s13, s13, 331776
v_mul_u32_u24 v26, 9216, v7
v_lshl_add_u32 v26, v6, 2, v26
s_lshl_b32 s1, s77, 4
s_add_u32 s1, s1, 158080
v_lshl_add_u32 v22, v0, 1, s1
v_lshlrev_b32 v23, 4, v7
v_add_u32 v23, 158080, v23
ds_read_b64_tr_b16 a[0:1], v24 offset:0
ds_read_b64_tr_b16 a[2:3], v24 offset:1024
ds_read_b64_tr_b16 a[4:5], v24 offset:2048
ds_read_b64_tr_b16 a[6:7], v24 offset:3072
ds_read_b64_tr_b16 a[8:9], v24 offset:4096
ds_read_b64_tr_b16 a[10:11], v24 offset:5120
ds_read_b64_tr_b16 a[12:13], v24 offset:6144
ds_read_b64_tr_b16 a[14:15], v24 offset:7168
ds_read_b64_tr_b16 a[16:17], v24 offset:8192
ds_read_b64_tr_b16 a[18:19], v24 offset:9216
ds_read_b64_tr_b16 a[20:21], v24 offset:10240
ds_read_b64_tr_b16 a[22:23], v24 offset:11264
ds_read_b64_tr_b16 a[24:25], v24 offset:12288
ds_read_b64_tr_b16 a[26:27], v24 offset:13312
ds_read_b64_tr_b16 a[28:29], v24 offset:14336
ds_read_b64_tr_b16 a[30:31], v24 offset:15360
ds_read_b64_tr_b16 a[32:33], v24 offset:16384
ds_read_b64_tr_b16 a[34:35], v24 offset:17408
ds_read_b64_tr_b16 a[36:37], v24 offset:18432
ds_read_b64_tr_b16 a[38:39], v24 offset:19456
ds_read_b64_tr_b16 a[40:41], v24 offset:20480
ds_read_b64_tr_b16 a[42:43], v24 offset:21504
ds_read_b64_tr_b16 a[44:45], v24 offset:22528
ds_read_b64_tr_b16 a[46:47], v24 offset:23552
ds_read_b64_tr_b16 a[48:49], v24 offset:24576
ds_read_b64_tr_b16 a[50:51], v24 offset:25600
ds_read_b64_tr_b16 a[52:53], v24 offset:26624
ds_read_b64_tr_b16 a[54:55], v24 offset:27648
ds_read_b64_tr_b16 a[56:57], v24 offset:28672
ds_read_b64_tr_b16 a[58:59], v24 offset:29696
ds_read_b64_tr_b16 a[60:61], v24 offset:30720
ds_read_b64_tr_b16 a[62:63], v24 offset:31744
ds_read_b64_tr_b16 a[64:65], v24 offset:32768
ds_read_b64_tr_b16 a[66:67], v24 offset:33792
ds_read_b64_tr_b16 a[68:69], v24 offset:34816
ds_read_b64_tr_b16 a[70:71], v24 offset:35840
s_cmp_eq_u32 s77, 0
s_cbranch_scc0 L_143
s_mov_b32 s52, -1
s_branch C_144
R_145:
s_sub_u32 s82, s82, 1
s_cbranch_scc1 L_exit
s_waitcnt vmcnt(0)
s_lshl_b32 s1, s74, 13
s_add_u32 s1, s1, 2949120
s_mov_b32 exec_lo, s52
s_mov_b32 exec_hi, 0
buffer_load_dwordx4 v[28:31], v38, s[44:47], s1 offen sc1
s_mov_b64 exec, -1
buffer_load_dwordx4 v[40:43], v50, s[44:47], s4 offen sc1
s_add_u32 s1, s4, 28688
s_mov_b64 exec, 255
buffer_load_dwordx4 v[44:47], v5, s[44:47], s1 offen sc1
s_mov_b64 exec, -1
s_waitcnt vmcnt(0)
C_144:
s_mov_b32 s9, s4
s_waitcnt vmcnt(2)
v_cmp_ne_u32 vcc, s80, v31
v_bfrev_b32 v36, 1
s_and_b32 vcc_lo, vcc_lo, s52
s_andn2_b32 s52, vcc_lo, s8
s_or_b32 vcc_lo, vcc_lo, s8
v_cndmask_b32 v28, v28, v36, vcc
s_nop 1
v_max_i32_dpp v36, v28, v28 row_ror:8 row_mask:0xf bank_mask:0xf
v_mov_b32 v31, v0
s_nop 0
v_max_i32_dpp v36, v36, v36 row_ror:4 row_mask:0xf bank_mask:0xf
s_nop 1
v_max_i32_dpp v36, v36, v36 row_ror:2 row_mask:0xf bank_mask:0xf
s_nop 1
v_max_i32_dpp v36, v36, v36 row_ror:1 row_mask:0xf bank_mask:0xf
s_nop 0
v_readlane_b32 s3, v36, 0
v_readlane_b32 s4, v36, 16
s_max_i32 s57, s3, s4
v_cmp_eq_u32 vcc, s57, v28
s_bfe_u32 s5, s57, 0x20004
s_lshl_b32 s5, s5, 10
s_add_u32 s5, s5, 4350592
s_ff1_i32_b32 s3, vcc_lo
s_mul_i32 s4, s3, 286720
s_add_u32 s4, s4, s5
s_waitcnt vmcnt(1)
v_max_u32 v48, v40, v41
v_max3_u32 v48, v48, v42, v43
s_waitcnt vmcnt(0)
v_max3_u32 v48, v48, v44, v45
v_max3_u32 v48, v48, v46, v47
v_cmp_eq_u32 vcc, -1, v48
s_xor_b32 s9, s9, s4
s_or_b32 s9, s9, vcc_lo
s_or_b32 s9, s9, vcc_hi
s_cbranch_scc1 R_145
v_add_u32 v48, 161408, v5
ds_write_b128 v48, v[40:43]
s_mov_b64 exec, 255
ds_write_b128 v48, v[44:47] offset:1024
s_mov_b64 exec, -1
s_lshl_b64 exec, 1, s3
ds_write_b128 v37, v[28:31]
s_mov_b64 exec, -1
s_cmp_lg_u32 s52, 0
s_cbranch_scc0 L_147
s_waitcnt lgkmcnt(0)
P_146:
s_sub_u32 s82, s82, 1
s_cbranch_scc1 L_exit
s_lshl_b32 s1, s74, 13
s_add_u32 s1, s1, 2949120
s_mov_b32 exec_lo, s52
s_mov_b32 exec_hi, 0
buffer_load_dwordx4 v[28:31], v38, s[44:47], s1 offen sc1
s_mov_b64 exec, -1
s_waitcnt vmcnt(0)
v_cmp_eq_u32 vcc, s80, v31
s_and_b32 s9, vcc_lo, s52
v_cmp_le_i32 vcc, s57, v28
s_and_b32 vcc_lo, vcc_lo, s9
s_cbranch_scc1 C_144
s_andn2_b32 s52, s52, s9
s_cbranch_scc1 P_146
L_147:
L_143:
s_waitcnt lgkmcnt(0)
s_barrier
v_mov_b32 v112, 163712
ds_read_b128 v[108:111], v112
ds_read_b128 v[68:71], v25 offset:0
ds_read_b128 v[72:75], v25 offset:192
ds_read_b128 v[76:79], v25 offset:384
ds_read_b128 v[80:83], v25 offset:576
ds_read_b128 v[84:87], v25 offset:768
ds_read_b128 v[88:91], v25 offset:960
s_waitcnt lgkmcnt(5)
v_mfma_f32_16x16x32_bf16 v[28:31], v[68:71], a[0:3], 0
v_mfma_f32_16x16x32_bf16 v[32:35], v[68:71], a[4:7], 0
v_mfma_f32_16x16x32_bf16 v[36:39], v[68:71], a[8:11], 0
s_waitcnt lgkmcnt(4)
v_mfma_f32_16x16x32_bf16 v[28:31], v[72:75], a[12:15], v[28:31]
v_mfma_f32_16x16x32_bf16 v[32:35], v[72:75], a[16:19], v[32:35]
v_mfma_f32_16x16x32_bf16 v[36:39], v[72:75], a[20:23], v[36:39]
s_waitcnt lgkmcnt(3)
v_mfma_f32_16x16x32_bf16 v[28:31], v[76:79], a[24:27], v[28:31]
v_mfma_f32_16x16x32_bf16 v[32:35], v[76:79], a[28:31], v[32:35]
v_mfma_f32_16x16x32_bf16 v[36:39], v[76:79], a[32:35], v[36:39]
s_waitcnt lgkmcnt(2)
v_mfma_f32_16x16x32_bf16 v[28:31], v[80:83], a[36:39], v[28:31]
v_mfma_f32_16x16x32_bf16 v[32:35], v[80:83], a[40:43], v[32:35]
v_mfma_f32_16x16x32_bf16 v[36:39], v[80:83], a[44:47], v[36:39]
s_waitcnt lgkmcnt(1)
v_mfma_f32_16x16x32_bf16 v[28:31], v[84:87], a[48:51], v[28:31]
s_cmp_eq_u32 s77, 0
s_cbranch_scc0 L_148
v_and_b32 v78, 31, v0
v_lshlrev_b32 v78, 8, v78
v_mov_b32 v77, 163712
s_lshl_b32 s1, s74, 13
s_add_u32 s1, s1, 2949120
s_mov_b32 exec_hi, 0
buffer_load_dwordx4 v[68:71], v78, s[44:47], s1 offen sc1
s_mov_b64 exec, -1
L_148:
v_mfma_f32_16x16x32_bf16 v[32:35], v[84:87], a[52:55], v[32:35]
v_mfma_f32_16x16x32_bf16 v[36:39], v[84:87], a[56:59], v[36:39]
s_waitcnt lgkmcnt(0)
v_mfma_f32_16x16x32_bf16 v[28:31], v[88:91], a[60:63], v[28:31]
v_mfma_f32_16x16x32_bf16 v[32:35], v[88:91], a[64:67], v[32:35]
v_mfma_f32_16x16x32_bf16 v[36:39], v[88:91], a[68:71], v[36:39]
s_nop 6
v_add_f32 v28, v28, v33
v_add_f32 v28, v28, v38
v_mul_f32 v29, 0xbfb8aa3b, v28
v_exp_f32 v29, v29
v_mul_f32_dpp v28, v28, v28 row_ror:8 row_mask:0xf bank_mask:0xf
v_add_f32 v29, 1.0, v29
v_rcp_f32 v29, v29
s_mov_b64 exec, 0xff
v_mul_f32 v28, v28, v29
v_cvt_pk_bf16_f32 v28, v28, v28
ds_write_b16 v22, v28
s_mov_b64 exec, -1
s_waitcnt lgkmcnt(0)
s_barrier
ds_read_b128 v[28:31], v23
s_waitcnt lgkmcnt(0)
v_mfma_f32_16x16x32_bf16 v[32:35], v[28:31], v[188:191], 0
v_mfma_f32_16x16x32_bf16 v[36:39], v[28:31], v[192:195], 0
v_mfma_f32_16x16x32_bf16 v[40:43], v[28:31], v[196:199], 0
v_mfma_f32_16x16x32_bf16 v[44:47], v[28:31], v[200:203], 0
v_mfma_f32_16x16x32_bf16 v[48:51], v[28:31], v[204:207], 0
s_nop 4
v_mov_b32_dpp v32, v36 quad_perm:[0,1,2,3] row_mask:2 bank_mask:0xf
v_mfma_f32_16x16x32_bf16 v[52:55], v[28:31], v[208:211], 0
s_nop 0
v_mov_b32_dpp v32, v40 quad_perm:[0,1,2,3] row_mask:4 bank_mask:0xf
v_mfma_f32_16x16x32_bf16 v[56:59], v[28:31], v[212:215], 0
s_nop 0
v_mov_b32_dpp v32, v44 quad_perm:[0,1,2,3] row_mask:8 bank_mask:0xf
buffer_store_dword v32, v26, s[24:27], s13 offen sc1
s_add_u32 s1, s13, 36864
v_mfma_f32_16x16x32_bf16 v[60:63], v[28:31], v[216:219], 0
v_mfma_f32_16x16x32_bf16 v[64:67], v[28:31], v[220:223], 0
v_mov_b32_dpp v48, v52 quad_perm:[0,1,2,3] row_mask:2 bank_mask:0xf
s_nop 1
v_mov_b32_dpp v48, v56 quad_perm:[0,1,2,3] row_mask:4 bank_mask:0xf
s_nop 2
v_mov_b32_dpp v48, v60 quad_perm:[0,1,2,3] row_mask:8 bank_mask:0xf
buffer_store_dword v48, v26, s[24:27], s1 offen sc1
s_add_u32 s1, s13, 73728
s_mov_b64 exec, 0xffff
buffer_store_dword v64, v26, s[24:27], s1 offen sc1
s_mov_b64 exec, -1
v_readfirstlane_b32 s57, v108
v_readfirstlane_b32 s58, v109
v_readfirstlane_b32 s59, v110
v_readfirstlane_b32 s56, v111
s_mov_b32 s11, s57
s_mov_b32 s10, s56
s_cmp_eq_u32 s77, 0
s_cbranch_scc0 L_149
s_branch C_150
R_151:
s_sub_u32 s82, s82, 1
s_cbranch_scc1 L_exit
s_waitcnt vmcnt(0)
s_lshl_b32 s1, s74, 13
s_add_u32 s1, s1, 2949120
s_mov_b32 exec_lo, vcc_lo
s_mov_b32 exec_hi, 0
buffer_load_dwordx4 v[68:71], v78, s[44:47], s1 offen sc1
s_mov_b64 exec, -1
s_waitcnt vmcnt(0)
C_150:
s_waitcnt vmcnt(3)
v_cmp_ne_u32 vcc, s80, v71
s_mov_b32 vcc_hi, 0
s_cbranch_vccnz R_151
s_mov_b32 s6, s5
v_max_i32_dpp v76, v68, v68 row_ror:8 row_mask:0xf bank_mask:0xf
v_mov_b32 v71, v0
s_nop 0
v_max_i32_dpp v76, v76, v76 row_ror:4 row_mask:0xf bank_mask:0xf
s_nop 1
v_max_i32_dpp v76, v76, v76 row_ror:2 row_mask:0xf bank_mask:0xf
s_nop 1
v_max_i32_dpp v76, v76, v76 row_ror:1 row_mask:0xf bank_mask:0xf
s_nop 0
v_readlane_b32 s3, v76, 0
v_readlane_b32 s4, v76, 16
s_max_i32 s57, s3, s4
v_cmp_eq_u32 vcc, s57, v68
s_bfe_u32 s5, s57, 0x20004
s_lshl_b32 s5, s5, 10
s_add_u32 s5, s5, 4350592
s_ff1_i32_b32 s3, vcc_lo
s_mul_i32 s4, s3, 286720
s_add_u32 s4, s4, s5
s_mov_b32 s5, s6
s_lshl_b64 exec, 1, s3
ds_write_b128 v77, v[68:71]
s_mov_b64 exec, -1
L_149:
s_waitcnt lgkmcnt(0)
s_barrier
s_mov_b32 s6, s5
v_mov_b32 v72, 163712
s_waitcnt vmcnt(3)
ds_read_b128 v[68:71], v72
s_waitcnt lgkmcnt(0)
v_readfirstlane_b32 s57, v68
v_readfirstlane_b32 s58, v69
v_readfirstlane_b32 s59, v70
v_readfirstlane_b32 s56, v71
s_sub_u32 s3, s56, s78
s_lshl_b32 s3, s3, 6
s_and_b32 s5, s57, 63
s_add_u32 s3, s3, 16
s_add_u32 s60, s3, s5
s_mov_b32 s5, s6
s_cmp_eq_u64 s[10:11], s[56:57]
s_cbranch_scc0 L_141
s_branch L_140
L_139:
s_cmp_eq_u32 s77, 0
s_cbranch_scc0 L_152
v_mul_u32_u24 v50, 7282, v0
v_lshrrev_b32 v50, 16, v50
v_mul_u32_u24 v50, 3952, v50
v_add_u32 v50, v50, v5
v_lshlrev_b32 v38, 8, v0
v_mov_b32 v44, 0
v_mov_b32 v45, 0
v_mov_b32 v46, 0
v_mov_b32 v47, 0
v_mov_b32 v37, 163712
s_mov_b32 vcc_lo, -1
P_153:
s_sub_u32 s82, s82, 1
s_cbranch_scc1 L_exit
s_lshl_b32 s1, s74, 13
s_add_u32 s1, s1, 2949120
s_mov_b32 exec_lo, vcc_lo
s_mov_b32 exec_hi, 0
buffer_load_dwordx4 v[28:31], v38, s[44:47], s1 offen sc1
s_mov_b64 exec, -1
s_waitcnt vmcnt(0)
v_cmp_ne_u32 vcc, s80, v31
s_mov_b32 vcc_hi, 0
s_cbranch_vccnz P_153
v_max_i32_dpp v36, v28, v28 row_ror:8 row_mask:0xf bank_mask:0xf
v_mov_b32 v31, v0
s_nop 0
v_max_i32_dpp v36, v36, v36 row_ror:4 row_mask:0xf bank_mask:0xf
s_nop 1
v_max_i32_dpp v36, v36, v36 row_ror:2 row_mask:0xf bank_mask:0xf
s_nop 1
v_max_i32_dpp v36, v36, v36 row_ror:1 row_mask:0xf bank_mask:0xf
s_nop 0
v_readlane_b32 s3, v36, 0
v_readlane_b32 s4, v36, 16
s_max_i32 s57, s3, s4
v_cmp_eq_u32 vcc, s57, v28
s_bfe_u32 s5, s57, 0x20004
s_lshl_b32 s5, s5, 10
s_add_u32 s5, s5, 4350592
s_ff1_i32_b32 s3, vcc_lo
s_mul_i32 s4, s3, 286720
s_add_u32 s4, s4, s5
s_lshl_b64 exec, 1, s3
ds_write_b128 v37, v[28:31]
s_mov_b64 exec, -1
L_152:
s_waitcnt lgkmcnt(0)
s_barrier
v_mov_b32 v32, 163712
ds_read_b128 v[28:31], v32
s_waitcnt lgkmcnt(0)
v_readfirstlane_b32 s57, v28
v_readfirstlane_b32 s58, v29
v_readfirstlane_b32 s59, v30
v_readfirstlane_b32 s56, v31
s_sub_u32 s3, s56, s78
s_lshl_b32 s3, s3, 6
s_and_b32 s5, s57, 63
s_add_u32 s3, s3, 16
s_add_u32 s60, s3, s5
L_140:
s_cmp_lt_u32 s77, 1
s_cselect_b64 s[52:53], -1, s[54:55]
s_lshr_b32 s3, s60, 4
s_sub_u32 s3, s3, 1
s_cmp_eq_u32 s3, s77
s_cselect_b64 s[54:55], s[54:55], 0
s_andn2_b64 s[52:53], s[52:53], s[54:55]
s_cbranch_scc0 L_154
s_mov_b64 exec, s[52:53]
buffer_store_dwordx4 v[176:179], v1, s[28:31], s94 offen offset:0
buffer_store_dwordx4 v[180:183], v1, s[28:31], s94 offen offset:64
s_and_b64 exec, s[52:53], 0xffff
buffer_store_dwordx4 v[184:187], v1, s[28:31], s94 offen offset:128
s_mov_b64 exec, -1
L_154:
s_cmp_lt_u32 s83, 36
s_cbranch_scc0 L_155
s_or_b32 s3, s83, s77
s_cmp_eq_u32 s3, 0
s_cbranch_scc0 L_156
s_mov_b64 exec, 1
v_mov_b32 v24, s80
buffer_store_dword v24, v5, s[24:27], 0 offen sc1
s_mov_b64 exec, -1
L_156:
s_bitcmp1_b32 s8, s56
s_cselect_b32 s12, 331776, 0
s_bfe_u32 s5, s57, 0x20004
s_lshl_b32 s5, s5, 10
s_add_u32 s5, s5, 4350592
s_mul_i32 s4, s56, 286720
s_add_u32 s4, s4, s5
s_mul_i32 s5, s83, 9216
v_and_b32 v23, 3, v0
v_lshrrev_b32 v22, 5, v0
v_lshl_add_u32 v23, v23, 1, v22
v_mov_b32 v22, s59
v_add_f32 v22, 1.0, v22
v_lshlrev_b32 v23, 2, v23
s_lshl_b32 s6, s83, 5
v_add_u32 v26, s6, v23
v_lshrrev_b32 v27, 4, v26
v_mul_u32_u24 v27, 7282, v27
v_lshrrev_b32 v27, 16, v27
v_mul_u32_u24 v27, 3952, v27
v_add_u32 v27, v27, v26
s_ashr_i32 s3, s57, 31
s_lshr_b32 s3, s3, 1
s_xor_b32 s3, s3, s57
v_mov_b32 v26, 0xbfb8aa3b
v_mul_f32 v26, s3, v26
v_exp_f32 v26, v26
s_nop 0
v_add_f32 v26, 1.0, v26
v_rcp_f32 v26, v26
s_add_u32 s5, s5, s12
s_and_b32 s3, s56, 15
s_lshl_b32 s3, s3, 6
s_and_b32 s7, s57, 63
s_add_u32 s3, s3, s7
s_lshl_b32 s3, s3, 1
s_lshr_b32 s7, s56, 4
s_add_u32 s3, s3, s7
s_mul_i32 s3, s3, 36
s_add_u32 s3, s3, s83
s_lshl_b32 s7, s3, 5
s_mov_b64 vcc, -1
P_157:
s_sub_u32 s82, s82, 1
s_cbranch_scc1 L_exit
s_mov_b64 exec, vcc
buffer_load_dword v64, v27, s[44:47], s4 offen sc1
s_add_u32 s1, s5, 3477504
buffer_load_dwordx4 v[28:31], v5, s[24:27], s1 offen offset:0 sc1
buffer_load_dwordx4 v[32:35], v5, s[24:27], s1 offen offset:1024 sc1
buffer_load_dwordx4 v[36:39], v5, s[24:27], s1 offen offset:2048 sc1
buffer_load_dwordx4 v[40:43], v5, s[24:27], s1 offen offset:3072 sc1
s_add_u32 s1, s5, 3481600
buffer_load_dwordx4 v[44:47], v5, s[24:27], s1 offen offset:0 sc1
buffer_load_dwordx4 v[48:51], v5, s[24:27], s1 offen offset:1024 sc1
buffer_load_dwordx4 v[52:55], v5, s[24:27], s1 offen offset:2048 sc1
buffer_load_dwordx4 v[56:59], v5, s[24:27], s1 offen offset:3072 sc1
s_add_u32 s1, s5, 3485696
buffer_load_dwordx4 v[60:63], v5, s[24:27], s1 offen offset:0 sc1
s_waitcnt vmcnt(8)
v_max3_u32 v66, v64, v28, v29
v_max3_u32 v66, v66, v30, v31
s_waitcnt vmcnt(7)
v_max3_u32 v66, v66, v32, v33
v_max3_u32 v66, v66, v34, v35
v_pk_add_f32 v[28:29], v[28:29], v[32:33]
v_pk_add_f32 v[30:31], v[30:31], v[34:35]
s_waitcnt vmcnt(6)
v_max3_u32 v66, v66, v36, v37
v_max3_u32 v66, v66, v38, v39
v_pk_add_f32 v[28:29], v[28:29], v[36:37]
v_pk_add_f32 v[30:31], v[30:31], v[38:39]
s_waitcnt vmcnt(5)
v_max3_u32 v66, v66, v40, v41
v_max3_u32 v66, v66, v42, v43
v_pk_add_f32 v[28:29], v[28:29], v[40:41]
v_pk_add_f32 v[30:31], v[30:31], v[42:43]
s_waitcnt vmcnt(4)
v_max3_u32 v66, v66, v44, v45
v_max3_u32 v66, v66, v46, v47
v_pk_add_f32 v[28:29], v[28:29], v[44:45]
v_pk_add_f32 v[30:31], v[30:31], v[46:47]
s_waitcnt vmcnt(3)
v_max3_u32 v66, v66, v48, v49
v_max3_u32 v66, v66, v50, v51
v_pk_add_f32 v[28:29], v[28:29], v[48:49]
v_pk_add_f32 v[30:31], v[30:31], v[50:51]
s_waitcnt vmcnt(2)
v_max3_u32 v66, v66, v52, v53
v_max3_u32 v66, v66, v54, v55
v_pk_add_f32 v[28:29], v[28:29], v[52:53]
v_pk_add_f32 v[30:31], v[30:31], v[54:55]
s_waitcnt vmcnt(1)
v_max3_u32 v66, v66, v56, v57
v_max3_u32 v66, v66, v58, v59
v_pk_add_f32 v[28:29], v[28:29], v[56:57]
v_pk_add_f32 v[30:31], v[30:31], v[58:59]
s_waitcnt vmcnt(0)
v_max3_u32 v66, v66, v60, v61
v_max3_u32 v66, v66, v62, v63
v_cmp_eq_u32 vcc, -1, v66
v_pk_add_f32 v[28:29], v[28:29], v[60:61]
v_pk_add_f32 v[30:31], v[30:31], v[62:63]
s_cbranch_vccnz P_157
s_mov_b64 exec, -1
v_lshlrev_b32 v36, 16, v64
v_and_b32 v37, 0xffff0000, v64
v_permlane32_swap_b32 v28, v30
v_permlane32_swap_b32 v29, v31
v_pk_add_f32 v[28:29], v[28:29], v[30:31]
v_fma_f32 v36, v36, v22, s58
v_fma_f32 v37, v37, v22, s58
v_permlane16_swap_b32 v28, v30
v_permlane16_swap_b32 v29, v31
v_pk_add_f32 v[28:29], v[28:29], v[30:31]
s_nop 1
v_add_f32_dpp v28, v28, v28 row_ror:8 row_mask:0xf bank_mask:0xf
v_add_f32_dpp v29, v29, v29 row_ror:8 row_mask:0xf bank_mask:0xf
s_nop 0
v_add_f32_dpp v28, v28, v28 row_ror:4 row_mask:0xf bank_mask:0xf
v_add_f32_dpp v29, v29, v29 row_ror:4 row_mask:0xf bank_mask:0xf
s_mov_b32 exec_lo, 0xf
s_mov_b32 exec_hi, 0xf
v_fma_f32 v28, v28, v26, v36
v_fma_f32 v29, v29, v26, v37
v_cvt_pk_bf16_f32 v28, v28, v29
buffer_store_dword v28, v23, s[28:31], s7 offen
s_mov_b64 exec, -1
L_158:
s_mov_b64 exec, -1
L_155:
s_endpgm
L_patch_s:
s_waitcnt lgkmcnt(0)
s_barrier
ds_read_b128 v[76:79], v23 offset:64
ds_read_b128 v[80:83], v23 offset:384
ds_read_b128 v[68:71], v23 offset:128
ds_read_b128 v[72:75], v23 offset:448
s_mul_i32 s18, s76, 82944
s_add_u32 s18, s18, s62
s_add_u32 m0, s62, 0
s_add_u32 s19, s18, 2228224
buffer_load_dwordx4 v5, s[24:27], s19 offen offset:0 sc1 lds
v_mul_f32 v39, 0x3eae1a93, v31
v_mul_f32 v40, 0x3eae1a93, v33
v_mul_f32 v41, 0x3eae1a93, v35
v_mul_f32 v42, 0x3eae1a93, v37
v_pk_fma_f32 v[172:173], v[52:53], v[30:31], v[172:173] op_sel_hi:[1,0,1]
v_pk_fma_f32 v[174:175], v[54:55], v[30:31], v[174:175] op_sel_hi:[1,0,1]
v_pk_fma_f32 v[132:133], v[48:49], v[30:31], v[132:133] op_sel_hi:[1,0,1]
v_pk_fma_f32 v[134:135], v[50:51], v[30:31], v[134:135] op_sel_hi:[1,0,1]
v_pk_mul_f32 v[174:175], v[174:175], v[38:39] op_sel:[0,1] op_sel_hi:[1,1]
v_pk_mul_f32 v[132:133], v[132:133], v[38:39] op_sel:[0,1] op_sel_hi:[1,1]
buffer_load_dwordx4 v5, s[24:27], s19 offen offset:1024 sc1 lds
v_pk_mul_f32 v[134:135], v[134:135], v[38:39] op_sel:[0,1] op_sel_hi:[1,1]
v_pk_mul_f32 v[172:173], v[172:173], v[30:31] op_sel:[0,1] op_sel_hi:[1,1]
v_cvt_pk_bf16_f32 v132, v132, v133
v_cvt_pk_bf16_f32 v133, v134, v135
v_cvt_pk_bf16_f32 v134, v174, v175
v_mov_b32 v135, 0
v_pk_fma_f32 v[112:113], v[44:45], v[30:31], v[112:113] op_sel_hi:[1,0,1]
v_pk_fma_f32 v[114:115], v[46:47], v[30:31], v[114:115] op_sel_hi:[1,0,1]
v_pk_mul_f32 v[112:113], v[112:113], v[30:31] op_sel:[0,1] op_sel_hi:[1,1]
v_pk_mul_f32 v[114:115], v[114:115], v[30:31] op_sel:[0,1] op_sel_hi:[1,1]
buffer_load_dwordx4 v5, s[24:27], s19 offen offset:2048 sc1 lds
v_cvt_pk_bf16_f32 v112, v112, v113
v_cvt_pk_bf16_f32 v113, v114, v115
v_cvt_pk_bf16_f32 v114, v172, v173
v_mov_b32 v115, 0x3f80
s_waitcnt lgkmcnt(3)
v_pk_fma_f32 v[152:153], v[76:77], v[56:57], v[152:153] op_sel_hi:[1,0,1]
v_pk_fma_f32 v[154:155], v[78:79], v[56:57], v[154:155] op_sel_hi:[1,0,1]
s_waitcnt lgkmcnt(2)
v_pk_mul_f32 v[152:153], v[152:153], v[80:81]
v_pk_mul_f32 v[154:155], v[154:155], v[82:83]
v_cvt_pk_bf16_f32 v152, v152, v153
v_cvt_pk_bf16_f32 v153, v154, v155
buffer_load_dwordx4 v5, s[24:27], s19 offen offset:3072 sc1 lds
ds_read_b128 v[76:79], v23 offset:192
ds_read_b128 v[80:83], v23 offset:512
v_pk_fma_f32 v[176:177], v[52:53], v[32:33], v[176:177] op_sel_hi:[1,0,1]
v_pk_fma_f32 v[178:179], v[54:55], v[32:33], v[178:179] op_sel_hi:[1,0,1]
v_pk_fma_f32 v[136:137], v[48:49], v[32:33], v[136:137] op_sel_hi:[1,0,1]
v_pk_fma_f32 v[138:139], v[50:51], v[32:33], v[138:139] op_sel_hi:[1,0,1]
v_pk_mul_f32 v[178:179], v[178:179], v[40:41] op_sel:[0,0] op_sel_hi:[1,0]
v_pk_mul_f32 v[136:137], v[136:137], v[40:41] op_sel:[0,0] op_sel_hi:[1,0]
v_pk_mul_f32 v[138:139], v[138:139], v[40:41] op_sel:[0,0] op_sel_hi:[1,0]
v_pk_mul_f32 v[176:177], v[176:177], v[32:33] op_sel:[0,1] op_sel_hi:[1,1]
s_add_u32 m0, s62, 4096
s_add_u32 s19, s18, 2232320
buffer_load_dwordx4 v5, s[24:27], s19 offen offset:0 sc1 lds
v_cvt_pk_bf16_f32 v136, v136, v137
v_cvt_pk_bf16_f32 v137, v138, v139
v_cvt_pk_bf16_f32 v138, v178, v179
v_mov_b32 v139, 0
v_pk_fma_f32 v[116:117], v[44:45], v[32:33], v[116:117] op_sel_hi:[1,0,1]
v_pk_fma_f32 v[118:119], v[46:47], v[32:33], v[118:119] op_sel_hi:[1,0,1]
v_pk_mul_f32 v[116:117], v[116:117], v[32:33] op_sel:[0,1] op_sel_hi:[1,1]
v_pk_mul_f32 v[118:119], v[118:119], v[32:33] op_sel:[0,1] op_sel_hi:[1,1]
v_cvt_pk_bf16_f32 v116, v116, v117
v_cvt_pk_bf16_f32 v117, v118, v119
buffer_load_dwordx4 v5, s[24:27], s19 offen offset:1024 sc1 lds
v_cvt_pk_bf16_f32 v118, v176, v177
v_mov_b32 v119, 0x3f80
s_waitcnt lgkmcnt(3)
v_pk_fma_f32 v[156:157], v[68:69], v[56:57], v[156:157] op_sel_hi:[1,0,1]
v_pk_fma_f32 v[158:159], v[70:71], v[56:57], v[158:159] op_sel_hi:[1,0,1]
s_waitcnt lgkmcnt(2)
v_pk_mul_f32 v[156:157], v[156:157], v[72:73]
v_pk_mul_f32 v[158:159], v[158:159], v[74:75]
v_cvt_pk_bf16_f32 v154, v156, v157
v_cvt_pk_bf16_f32 v155, v158, v159
ds_read_b128 v[68:71], v23 offset:256
ds_read_b128 v[72:75], v23 offset:576
buffer_load_dwordx4 v5, s[24:27], s19 offen offset:2048 sc1 lds
v_pk_fma_f32 v[180:181], v[52:53], v[34:35], v[180:181] op_sel_hi:[1,0,1]
v_pk_fma_f32 v[182:183], v[54:55], v[34:35], v[182:183] op_sel_hi:[1,0,1]
v_pk_fma_f32 v[140:141], v[48:49], v[34:35], v[140:141] op_sel_hi:[1,0,1]
v_pk_fma_f32 v[142:143], v[50:51], v[34:35], v[142:143] op_sel_hi:[1,0,1]
v_pk_mul_f32 v[182:183], v[182:183], v[40:41] op_sel:[0,1] op_sel_hi:[1,1]
v_pk_mul_f32 v[140:141], v[140:141], v[40:41] op_sel:[0,1] op_sel_hi:[1,1]
v_pk_mul_f32 v[142:143], v[142:143], v[40:41] op_sel:[0,1] op_sel_hi:[1,1]
v_pk_mul_f32 v[180:181], v[180:181], v[34:35] op_sel:[0,1] op_sel_hi:[1,1]
v_cvt_pk_bf16_f32 v140, v140, v141
v_cvt_pk_bf16_f32 v141, v142, v143
buffer_load_dwordx4 v5, s[24:27], s19 offen offset:3072 sc1 lds
v_cvt_pk_bf16_f32 v142, v182, v183
v_mov_b32 v143, 0
v_pk_fma_f32 v[120:121], v[44:45], v[34:35], v[120:121] op_sel_hi:[1,0,1]
v_pk_fma_f32 v[122:123], v[46:47], v[34:35], v[122:123] op_sel_hi:[1,0,1]
v_pk_mul_f32 v[120:121], v[120:121], v[34:35] op_sel:[0,1] op_sel_hi:[1,1]
v_pk_mul_f32 v[122:123], v[122:123], v[34:35] op_sel:[0,1] op_sel_hi:[1,1]
v_cvt_pk_bf16_f32 v120, v120, v121
s_cmp_eq_u32 s77, 1
s_cbranch_scc0 L_159
v_mov_b32 v88, 0
v_mov_b32 v89, 0
v_mov_b32 v90, 0
v_mov_b32 v91, 0
s_mov_b32 s6, 5211008
v_bfe_u32 v94, v0, 1, 3
v_mul_u32_u24 v94, 1146880, v94
v_lshl_add_u32 v94, v7, 12, v94
v_and_b32 v96, 1, v0
v_lshl_add_u32 v94, v96, 4, v94
buffer_load_dwordx4 v[84:87], v94, s[24:27], s6 offen sc1
s_add_u32 s1, s6, 16384
s_mov_b64 exec, 255
buffer_load_dwordx4 v[88:91], v94, s[24:27], s1 offen sc1
s_mov_b64 exec, -1
L_159:
v_cvt_pk_bf16_f32 v121, v122, v123
v_cvt_pk_bf16_f32 v122, v180, v181
v_mov_b32 v123, 0x3f80
s_add_u32 m0, s62, 8192
s_add_u32 s19, s18, 2236416
buffer_load_dwordx4 v5, s[24:27], s19 offen offset:0 sc1 lds
s_waitcnt lgkmcnt(3)
v_pk_fma_f32 v[160:161], v[76:77], v[56:57], v[160:161] op_sel_hi:[1,0,1]
v_pk_fma_f32 v[162:163], v[78:79], v[56:57], v[162:163] op_sel_hi:[1,0,1]
s_waitcnt lgkmcnt(2)
v_pk_mul_f32 v[160:161], v[160:161], v[80:81]
v_pk_mul_f32 v[162:163], v[162:163], v[82:83]
v_cvt_pk_bf16_f32 v156, v160, v161
v_cvt_pk_bf16_f32 v157, v162, v163
v_pk_fma_f32 v[184:185], v[52:53], v[36:37], v[184:185] op_sel_hi:[1,0,1]
v_pk_fma_f32 v[186:187], v[54:55], v[36:37], v[186:187] op_sel_hi:[1,0,1]
v_pk_fma_f32 v[144:145], v[48:49], v[36:37], v[144:145] op_sel_hi:[1,0,1]
v_pk_fma_f32 v[146:147], v[50:51], v[36:37], v[146:147] op_sel_hi:[1,0,1]
buffer_load_dwordx4 v5, s[24:27], s19 offen offset:1024 sc1 lds
v_pk_mul_f32 v[186:187], v[186:187], v[42:43] op_sel:[0,0] op_sel_hi:[1,0]
v_pk_mul_f32 v[144:145], v[144:145], v[42:43] op_sel:[0,0] op_sel_hi:[1,0]
v_pk_mul_f32 v[146:147], v[146:147], v[42:43] op_sel:[0,0] op_sel_hi:[1,0]
v_pk_mul_f32 v[184:185], v[184:185], v[36:37] op_sel:[0,1] op_sel_hi:[1,1]
v_cvt_pk_bf16_f32 v144, v144, v145
v_cvt_pk_bf16_f32 v145, v146, v147
v_cvt_pk_bf16_f32 v146, v186, v187
v_mov_b32 v147, 0
v_pk_fma_f32 v[124:125], v[44:45], v[36:37], v[124:125] op_sel_hi:[1,0,1]
v_pk_fma_f32 v[126:127], v[46:47], v[36:37], v[126:127] op_sel_hi:[1,0,1]
buffer_load_dwordx4 v5, s[24:27], s19 offen offset:2048 sc1 lds
v_pk_mul_f32 v[124:125], v[124:125], v[36:37] op_sel:[0,1] op_sel_hi:[1,1]
v_pk_mul_f32 v[126:127], v[126:127], v[36:37] op_sel:[0,1] op_sel_hi:[1,1]
v_cvt_pk_bf16_f32 v124, v124, v125
v_cvt_pk_bf16_f32 v125, v126, v127
v_cvt_pk_bf16_f32 v126, v184, v185
v_mov_b32 v127, 0x3f80
s_waitcnt lgkmcnt(1)
v_pk_fma_f32 v[164:165], v[68:69], v[56:57], v[164:165] op_sel_hi:[1,0,1]
v_pk_fma_f32 v[166:167], v[70:71], v[56:57], v[166:167] op_sel_hi:[1,0,1]
s_waitcnt lgkmcnt(0)
v_pk_mul_f32 v[164:165], v[164:165], v[72:73]
v_pk_mul_f32 v[166:167], v[166:167], v[74:75]
v_cvt_pk_bf16_f32 v158, v164, v165
v_cvt_pk_bf16_f32 v159, v166, v167
s_mul_i32 s3, s76, 9
v_add_u32 v19, s3, v7
v_add_u32 v20, 4, v19
s_add_u32 s3, s3, 8
v_mov_b32 v21, s3
v_lshrrev_b32 v52, 3, v19
v_mul_u32_u24 v52, 1040, v52
v_lshl_add_u32 v19, v19, 4, v52
v_add_u32 v19, 74768, v19
v_lshrrev_b32 v52, 3, v20
v_mul_u32_u24 v52, 1040, v52
v_lshl_add_u32 v20, v20, 4, v52
v_add_u32 v20, 74768, v20
v_lshrrev_b32 v52, 3, v21
v_mul_u32_u24 v52, 1040, v52
v_lshl_add_u32 v21, v21, 4, v52
v_add_u32 v21, 74768, v21
v_and_b32 v52, 1, v7
v_lshl_add_u32 v21, v52, 3, v21
s_lshl_b32 s3, s77, 4
s_sub_u32 s3, s60, s3
s_sub_u32 s3, s3, 16
v_cmp_eq_u32 s[14:15], s3, v6
v_lshrrev_b32 v22, 3, v0
v_mul_u32_u24 v51, 1040, v22
s_mov_b32 s3, 74768
v_add3_u32 v51, v51, v5, s3
v_and_b32 v52, 11, v0
v_cmp_eq_u32 vcc, 1, v52
v_lshl_add_u32 v52, v7, 4, s3
v_add_u32 v53, 64, v52
v_cndmask_b32 v3, v3, v52, vcc
v_cndmask_b32 v4, v4, v53, vcc
s_cmp_eq_u32 s77, 1
s_cbranch_scc0 L_160
s_lshr_b32 s4, s60, 3
s_sub_u32 s4, s4, 2
s_mul_i32 s4, s4, 9216
s_cmp_lt_u32 s60, 16
s_cselect_b32 s4, 73728, s4
s_cselect_b32 s5, 144, 0
s_and_b32 s3, s60, 7
s_lshl_b32 s3, s3, 4
s_add_u32 s4, s4, s3
v_mul_u32_u24 v22, s5, v22
v_lshl_add_u32 v22, v0, 7, v22
v_add_u32 v22, s4, v22
s_lshl_b32 s5, s5, 3
v_add_u32 v23, s5, v22
s_branch C_161
R_162:
s_sub_u32 s82, s82, 1
s_cbranch_scc1 L_exit
s_waitcnt vmcnt(0)
buffer_load_dwordx4 v[84:87], v94, s[24:27], s6 offen sc1
s_add_u32 s1, s6, 16384
s_mov_b64 exec, 255
buffer_load_dwordx4 v[88:91], v94, s[24:27], s1 offen sc1
s_mov_b64 exec, -1
s_waitcnt vmcnt(0)
C_161:
s_waitcnt vmcnt(4)
v_max_u32 v92, v84, v85
v_max3_u32 v92, v92, v86, v87
s_waitcnt vmcnt(3)
v_max3_u32 v92, v92, v88, v89
v_max3_u32 v92, v92, v90, v91
v_cmp_eq_u32 vcc, -1, v92
s_cbranch_vccnz R_162
ds_write_b128 v51, v[84:87]
s_cmp_lt_u32 s60, 16
s_cselect_b64 exec, -1, 0
ds_write_b128 v22, v[84:87]
s_mov_b64 exec, 255
ds_write_b128 v51, v[88:91] offset:9344
s_cselect_b64 exec, exec, 0
ds_write_b128 v23, v[88:91] offset:8192
s_mov_b64 exec, -1
L_160:
s_cmp_eq_u32 s77, 0
s_cbranch_scc0 L_163
s_mov_b64 exec, 0
s_branch L_patched_s
L_pw_s:
s_mov_b64 exec, -1
L_163:
v_lshlrev_b32 v50, 1, v0
v_add_u32 v50, 84112, v50
s_waitcnt lgkmcnt(0)
s_barrier
s_waitcnt vmcnt(4)
ds_read_b128 v[84:87], v3 offset:0
s_waitcnt vmcnt(3)
ds_read_b128 v[88:91], v4 offset:0
ds_read_b128 v[92:95], v3 offset:1168
ds_read_b128 v[96:99], v4 offset:1168
ds_read_b128 v[100:103], v3 offset:2336
ds_read_b128 v[40:43], v51
ds_read_u16 v48, v50
s_waitcnt lgkmcnt(6)
v_mfma_f32_16x16x32_bf16 v[168:171], a[12:15], v[84:87], 0
ds_read_b128 v[104:107], v4 offset:2336
s_lshl_b32 s3, s60, 2
s_add_u32 s3, s3, 160128
v_mfma_f32_16x16x32_bf16 v[128:131], a[4:7], v[84:87], 0
v_mov_b32 v22, s3
s_and_b32 s4, s60, 15
s_mov_b32 s52, 0x10001
v_mfma_f32_16x16x32_bf16 v[108:111], a[0:3], v[84:87], 0
buffer_load_dwordx4 v5, s[24:27], s19 offen offset:3072 sc1 lds
s_mov_b32 s53, 0x10001
s_lshl_b64 s[52:53], s[52:53], s4
v_mfma_f32_16x16x32_bf16 v[148:151], v[84:87], a[8:11], 0
s_not_b64 vcc, s[52:53]
s_lshr_b32 s5, s4, 2
s_lshl_b32 s5, s5, 4
s_waitcnt lgkmcnt(6)
v_mfma_f32_16x16x32_bf16 v[168:171], a[28:31], v[88:91], v[168:171]
ds_read_b128 v[84:87], v3 offset:3504
s_mov_b64 s[52:53], 0xffff
s_lshl_b64 s[52:53], s[52:53], s5
v_mfma_f32_16x16x32_bf16 v[128:131], a[20:23], v[88:91], v[128:131]
s_and_b32 s4, s4, 3
s_lshr_b32 s3, s60, 4
v_mfma_f32_16x16x32_bf16 v[108:111], a[16:19], v[88:91], v[108:111]
s_bitcmp1_b32 s4, 0
s_cselect_b32 s5, 16, 0
v_mfma_f32_16x16x32_bf16 v[148:151], v[88:91], a[24:27], v[148:151]
s_lshl_b32 s5, 0xffff, s5
s_lshr_b32 s4, s4, 1
s_waitcnt lgkmcnt(6)
v_mfma_f32_16x16x32_bf16 v[168:171], a[44:47], v[92:95], v[168:171]
ds_read_b128 v[88:91], v4 offset:3504
s_mov_b64 exec, s[14:15]
ds_read_b128 v[58:61], v19
ds_read_b128 v[62:65], v20
ds_read_b64 v[66:67], v21
s_mov_b64 exec, -1
v_mfma_f32_16x16x32_bf16 v[128:131], a[36:39], v[92:95], v[128:131]
s_cmp_eq_u32 s3, 1
s_cselect_b64 s[14:15], vcc, -1
v_mfma_f32_16x16x32_bf16 v[108:111], a[32:35], v[92:95], v[108:111]
s_add_u32 m0, s62, 12288
s_add_u32 s19, s18, 2240512
buffer_load_dwordx4 v5, s[24:27], s19 offen offset:0 sc1 lds
v_mfma_f32_16x16x32_bf16 v[148:151], v[92:95], a[40:43], v[148:151]
s_cmp_eq_u32 s3, 2
s_cselect_b64 s[16:17], vcc, -1
s_waitcnt lgkmcnt(9)
v_mfma_f32_16x16x32_bf16 v[168:171], a[60:63], v[96:99], v[168:171]
ds_read_b128 v[92:95], v3 offset:4672
s_cmp_eq_u32 s3, 3
s_cselect_b64 s[20:21], vcc, -1
v_mfma_f32_16x16x32_bf16 v[128:131], a[52:55], v[96:99], v[128:131]
s_cmp_eq_u32 s3, 4
s_cselect_b64 s[22:23], vcc, -1
v_mfma_f32_16x16x32_bf16 v[108:111], a[48:51], v[96:99], v[108:111]
s_waitcnt lgkmcnt(7)
v_lshlrev_b32 v48, 16, v48
v_mul_f32 v49, v48, v48
v_mfma_f32_16x16x32_bf16 v[148:151], v[96:99], a[56:59], v[148:151]
v_lshlrev_b32 v44, 16, v40
v_and_b32 v45, 0xffff0000, v40
v_mfma_f32_16x16x32_bf16 v[168:171], a[76:79], v[100:103], v[168:171]
ds_read_b128 v[96:99], v4 offset:4672
v_add_f32 v48, v48, v44
v_mfma_f32_16x16x32_bf16 v[128:131], a[68:71], v[100:103], v[128:131]
v_fmac_f32 v49, v44, v44
v_add_f32 v48, v48, v45
v_mfma_f32_16x16x32_bf16 v[108:111], a[64:67], v[100:103], v[108:111]
buffer_load_dwordx4 v5, s[24:27], s19 offen offset:1024 sc1 lds
v_fmac_f32 v49, v45, v45
v_mfma_f32_16x16x32_bf16 v[148:151], v[100:103], a[72:75], v[148:151]
v_lshlrev_b32 v44, 16, v41
v_and_b32 v45, 0xffff0000, v41
s_waitcnt lgkmcnt(7)
v_mfma_f32_16x16x32_bf16 v[168:171], a[92:95], v[104:107], v[168:171]
ds_read_b128 v[100:103], v3 offset:5840
v_add_f32 v48, v48, v44
v_mfma_f32_16x16x32_bf16 v[128:131], a[84:87], v[104:107], v[128:131]
v_fmac_f32 v49, v44, v44
v_add_f32 v48, v48, v45
v_mfma_f32_16x16x32_bf16 v[108:111], a[80:83], v[104:107], v[108:111]
v_fmac_f32 v49, v45, v45
v_lshlrev_b32 v44, 16, v42
v_mfma_f32_16x16x32_bf16 v[148:151], v[104:107], a[88:91], v[148:151]
v_and_b32 v45, 0xffff0000, v42
v_add_f32 v48, v48, v44
s_waitcnt lgkmcnt(7)
v_mfma_f32_16x16x32_bf16 v[168:171], a[108:111], v[84:87], v[168:171]
ds_read_b128 v[104:107], v4 offset:5840
v_fmac_f32 v49, v44, v44
v_mfma_f32_16x16x32_bf16 v[128:131], a[100:103], v[84:87], v[128:131]
v_add_f32 v48, v48, v45
v_fmac_f32 v49, v45, v45
v_mfma_f32_16x16x32_bf16 v[108:111], a[96:99], v[84:87], v[108:111]
buffer_load_dwordx4 v5, s[24:27], s19 offen offset:2048 sc1 lds
v_lshlrev_b32 v44, 16, v43
v_mfma_f32_16x16x32_bf16 v[148:151], v[84:87], a[104:107], v[148:151]
v_and_b32 v45, 0xffff0000, v43
v_add_f32 v48, v48, v44
s_waitcnt lgkmcnt(7)
v_mfma_f32_16x16x32_bf16 v[168:171], a[124:127], v[88:91], v[168:171]
ds_read_b128 v[84:87], v3 offset:7008
v_fmac_f32 v49, v44, v44
v_mfma_f32_16x16x32_bf16 v[128:131], a[116:119], v[88:91], v[128:131]
v_add_f32 v48, v48, v45
v_fmac_f32 v49, v45, v45
v_mfma_f32_16x16x32_bf16 v[108:111], a[112:115], v[88:91], v[108:111]
v_add_f32_dpp v48, v48, v48 row_ror:8 row_mask:0xf bank_mask:0xf
v_add_f32_dpp v49, v49, v49 row_ror:8 row_mask:0xf bank_mask:0xf
v_mfma_f32_16x16x32_bf16 v[148:151], v[88:91], a[120:123], v[148:151]
v_add_f32_dpp v48, v48, v48 row_ror:4 row_mask:0xf bank_mask:0xf
v_add_f32_dpp v49, v49, v49 row_ror:4 row_mask:0xf bank_mask:0xf
s_waitcnt lgkmcnt(4)
v_mfma_f32_16x16x32_bf16 v[168:171], a[140:143], v[92:95], v[168:171]
ds_read_b128 v[88:91], v4 offset:7008
v_add_f32_dpp v48, v48, v48 row_ror:2 row_mask:0xf bank_mask:0xf
v_mfma_f32_16x16x32_bf16 v[128:131], a[132:135], v[92:95], v[128:131]
v_add_f32_dpp v49, v49, v49 row_ror:2 row_mask:0xf bank_mask:0xf
v_add_f32_dpp v48, v48, v48 row_ror:1 row_mask:0xf bank_mask:0xf
v_mfma_f32_16x16x32_bf16 v[108:111], a[128:131], v[92:95], v[108:111]
buffer_load_dwordx4 v5, s[24:27], s19 offen offset:3072 sc1 lds
v_add_f32_dpp v49, v49, v49 row_ror:1 row_mask:0xf bank_mask:0xf
v_mfma_f32_16x16x32_bf16 v[148:151], v[92:95], a[136:139], v[148:151]
v_permlane32_swap_b32 v48, v52
v_permlane32_swap_b32 v49, v53
s_waitcnt lgkmcnt(4)
v_mfma_f32_16x16x32_bf16 v[168:171], a[156:159], v[96:99], v[168:171]
ds_read_b128 v[92:95], v3 offset:8176
v_add_f32 v48, v48, v52
v_mfma_f32_16x16x32_bf16 v[128:131], a[148:151], v[96:99], v[128:131]
v_add_f32 v49, v49, v53
v_permlane16_swap_b32 v48, v52
v_mfma_f32_16x16x32_bf16 v[108:111], a[144:147], v[96:99], v[108:111]
v_permlane16_swap_b32 v49, v53
v_add_f32 v48, v48, v52
v_mfma_f32_16x16x32_bf16 v[148:151], v[96:99], a[152:155], v[148:151]
v_add_f32 v49, v49, v53
v_mul_f32 v48, 0xbae38e39, v48
s_waitcnt lgkmcnt(4)
v_mfma_f32_16x16x32_bf16 v[168:171], a[172:175], v[100:103], v[168:171]
ds_read_b128 v[96:99], v4 offset:8176
v_mul_f32 v49, 0x3ae38e39, v49
v_mfma_f32_16x16x32_bf16 v[128:131], a[164:167], v[100:103], v[128:131]
v_fma_f32 v49, -v48, v48, v49
v_max_f32 v49, 0, v49
v_mfma_f32_16x16x32_bf16 v[108:111], a[160:163], v[100:103], v[108:111]
s_add_u32 m0, s62, 16384
s_add_u32 s19, s18, 2244608
buffer_load_dwordx4 v5, s[24:27], s19 offen offset:0 sc1 lds
v_mfma_f32_16x16x32_bf16 v[148:151], v[100:103], a[168:171], v[148:151]
v_add_f32 v49, 0x3727c5ac, v49
v_rsq_f32 v49, v49
s_waitcnt lgkmcnt(4)
v_mfma_f32_16x16x32_bf16 v[168:171], a[188:191], v[104:107], v[168:171]
ds_read_b128 v[100:103], v3 offset:9344
v_mov_b32 v52, 1.0
v_mfma_f32_16x16x32_bf16 v[128:131], a[180:183], v[104:107], v[128:131]
v_mov_b32 v53, 0
s_mov_b64 exec, 1
ds_write2_b32 v22, v48, v49 offset0:0 offset1:80
ds_write2_b32 v22, v52, v53 offset0:160 offset1:240
v_mov_b32 v22, 160128
ds_write2_b32 v22, v48, v49 offset0:1 offset1:81
ds_write2_b32 v22, v48, v49 offset0:5 offset1:85
s_mov_b64 exec, -1
v_mfma_f32_16x16x32_bf16 v[108:111], a[176:179], v[104:107], v[108:111]
v_lshlrev_b32 v22, 2, v6
v_add_u32 v22, 160128, v22
v_mfma_f32_16x16x32_bf16 v[148:151], v[104:107], a[184:187], v[148:151]
v_lshlrev_b32 v23, 4, v7
v_add_u32 v23, 160128, v23
s_waitcnt lgkmcnt(8)
v_mfma_f32_16x16x32_bf16 v[168:171], a[204:207], v[84:87], v[168:171]
ds_read_b128 v[104:107], v4 offset:9344
ds_read2_b32 v[28:29], v22 offset0:0 offset1:80
v_mfma_f32_16x16x32_bf16 v[128:131], a[196:199], v[84:87], v[128:131]
ds_read_b128 v[52:55], v26 offset:128
ds_read_b128 v[48:51], v26 offset:64
v_mfma_f32_16x16x32_bf16 v[108:111], a[192:195], v[84:87], v[108:111]
buffer_load_dwordx4 v5, s[24:27], s19 offen offset:1024 sc1 lds
ds_read_b128 v[44:47], v26 offset:0
v_mfma_f32_16x16x32_bf16 v[148:151], v[84:87], a[200:203], v[148:151]
ds_read_b32 v56, v27 offset:192
ds_read_b128 v[76:79], v23 offset:0
s_waitcnt lgkmcnt(14)
v_mfma_f32_16x16x32_bf16 v[168:171], a[220:223], v[88:91], v[168:171]
ds_read_b128 v[80:83], v23 offset:320
s_lshl1_add_u32 s4, s3, s4
v_mfma_f32_16x16x32_bf16 v[128:131], a[212:215], v[88:91], v[128:131]
v_mov_b32 v41, s4
v_cndmask_b32 v41, -1, v41, s[52:53]
v_mfma_f32_16x16x32_bf16 v[108:111], a[208:211], v[88:91], v[108:111]
v_mov_b32 v42, s5
v_cmp_eq_u32 vcc, 2, v41
v_mfma_f32_16x16x32_bf16 v[148:151], v[88:91], a[216:219], v[148:151]
s_nop 0
v_cndmask_b32 v68, 0, v42, vcc
v_cmp_eq_u32 vcc, 3, v41
s_waitcnt lgkmcnt(14)
v_mfma_f32_16x16x32_bf16 v[168:171], a[236:239], v[92:95], v[168:171]
v_cndmask_b32 v69, 0, v42, vcc
v_cmp_eq_u32 vcc, 4, v41
v_mfma_f32_16x16x32_bf16 v[128:131], a[228:231], v[92:95], v[128:131]
s_nop 0
v_cndmask_b32 v70, 0, v42, vcc
v_cmp_eq_u32 vcc, 5, v41
v_mfma_f32_16x16x32_bf16 v[108:111], a[224:227], v[92:95], v[108:111]
s_nop 0
v_cndmask_b32 v71, 0, v42, vcc
v_cmp_eq_u32 vcc, 6, v41
v_mfma_f32_16x16x32_bf16 v[148:151], v[92:95], a[232:235], v[148:151]
s_nop 0
v_cndmask_b32 v72, 0, v42, vcc
s_waitcnt lgkmcnt(13)
v_mfma_f32_16x16x32_bf16 v[168:171], a[252:255], v[96:99], v[168:171]
v_cmp_eq_u32 vcc, 7, v41
v_mfma_f32_16x16x32_bf16 v[128:131], a[244:247], v[96:99], v[128:131]
s_nop 0
v_cndmask_b32 v73, 0, v42, vcc
v_mfma_f32_16x16x32_bf16 v[108:111], a[240:243], v[96:99], v[108:111]
v_cmp_eq_u32 vcc, 8, v41
v_mfma_f32_16x16x32_bf16 v[148:151], v[96:99], a[248:251], v[148:151]
s_nop 0
v_cndmask_b32 v74, 0, v42, vcc
s_waitcnt lgkmcnt(12)
v_mfma_f32_16x16x32_bf16 v[168:171], v[236:239], v[100:103], v[168:171]
v_cmp_eq_u32 vcc, 9, v41
v_mfma_f32_16x16x32_bf16 v[128:131], v[228:231], v[100:103], v[128:131]
s_nop 0
v_cndmask_b32 v75, 0, v42, vcc
v_mfma_f32_16x16x32_bf16 v[108:111], v[224:227], v[100:103], v[108:111]
s_waitcnt lgkmcnt(6)
v_mul_f32 v38, 0x3eae1a93, v29
v_mfma_f32_16x16x32_bf16 v[148:151], v[100:103], v[232:235], v[148:151]
s_lshl_b32 s0, s77, 11
v_mfma_f32_16x16x32_bf16 v[168:171], v[252:255], v[104:107], v[168:171]
s_add_u32 m0, s0, 73728
v_mfma_f32_16x16x32_bf16 v[128:131], v[244:247], v[104:107], v[128:131]
s_sub_u32 s18, s18, s62
v_mfma_f32_16x16x32_bf16 v[108:111], v[240:243], v[104:107], v[108:111]
s_add_u32 s18, s18, s0
v_mfma_f32_16x16x32_bf16 v[148:151], v[104:107], v[248:251], v[148:151]
s_add_u32 s19, s18, 2301952
s_waitcnt lgkmcnt(0)
s_barrier
v_pk_fma_f32 v[168:169], v[52:53], v[28:29], v[168:169] op_sel_hi:[1,0,1]
v_pk_fma_f32 v[170:171], v[54:55], v[28:29], v[170:171] op_sel_hi:[1,0,1]
v_pk_fma_f32 v[128:129], v[48:49], v[28:29], v[128:129] op_sel_hi:[1,0,1]
v_pk_fma_f32 v[130:131], v[50:51], v[28:29], v[130:131] op_sel_hi:[1,0,1]
v_pk_mul_f32 v[170:171], v[170:171], v[38:39] op_sel:[0,0] op_sel_hi:[1,0]
buffer_load_dwordx4 v5, s[24:27], s19 offen offset:0 sc1 lds
v_pk_mul_f32 v[128:129], v[128:129], v[38:39] op_sel:[0,0] op_sel_hi:[1,0]
v_pk_mul_f32 v[130:131], v[130:131], v[38:39] op_sel:[0,0] op_sel_hi:[1,0]
v_pk_mul_f32 v[168:169], v[168:169], v[28:29] op_sel:[0,1] op_sel_hi:[1,1]
v_cvt_pk_bf16_f32 v128, v128, v129
v_cvt_pk_bf16_f32 v129, v130, v131
buffer_load_dwordx4 v5, s[24:27], s19 offen offset:1024 sc1 lds
v_cvt_pk_bf16_f32 v130, v170, v171
v_mov_b32 v131, 0
buffer_load_dwordx4 v5, s[24:27], s19 offen offset:2048 sc1 lds
v_pk_fma_f32 v[108:109], v[44:45], v[28:29], v[108:109] op_sel_hi:[1,0,1]
v_pk_fma_f32 v[110:111], v[46:47], v[28:29], v[110:111] op_sel_hi:[1,0,1]
v_pk_mul_f32 v[108:109], v[108:109], v[28:29] op_sel:[0,1] op_sel_hi:[1,1]
v_pk_mul_f32 v[110:111], v[110:111], v[28:29] op_sel:[0,1] op_sel_hi:[1,1]
v_cvt_pk_bf16_f32 v108, v108, v109
v_cvt_pk_bf16_f32 v109, v110, v111
v_cvt_pk_bf16_f32 v110, v168, v169
v_mov_b32 v111, 0x3f80
s_mov_b64 vcc, s[14:15]
v_cndmask_b32_dpp v132, v128, v132, vcc row_newbcast:1 row_mask:0xf bank_mask:0xf
v_mfma_f32_16x16x16_bf16 v[168:171], v[110:111], v[14:15], 0
v_cndmask_b32_dpp v133, v129, v133, vcc row_newbcast:1 row_mask:0xf bank_mask:0xf
v_cndmask_b32_dpp v134, v130, v134, vcc row_newbcast:1 row_mask:0xf bank_mask:0xf
v_cndmask_b32_dpp v112, v108, v112, vcc row_newbcast:1 row_mask:0xf bank_mask:0xf
v_cndmask_b32_dpp v113, v109, v113, vcc row_newbcast:1 row_mask:0xf bank_mask:0xf
v_cndmask_b32_dpp v114, v110, v114, vcc row_newbcast:1 row_mask:0xf bank_mask:0xf
s_mov_b64 vcc, s[16:17]
v_cndmask_b32_dpp v136, v128, v136, vcc row_newbcast:1 row_mask:0xf bank_mask:0xf
v_mfma_f32_16x16x32_bf16 v[88:91], v[132:135], v[112:115], v[8:11]
v_cndmask_b32_dpp v137, v129, v137, vcc row_newbcast:1 row_mask:0xf bank_mask:0xf
v_cndmask_b32_dpp v138, v130, v138, vcc row_newbcast:1 row_mask:0xf bank_mask:0xf
v_cndmask_b32_dpp v116, v108, v116, vcc row_newbcast:1 row_mask:0xf bank_mask:0xf
v_mfma_f32_16x16x16_bf16 v[172:175], v[114:115], v[14:15], 0
v_cndmask_b32_dpp v117, v109, v117, vcc row_newbcast:1 row_mask:0xf bank_mask:0xf
v_cndmask_b32_dpp v118, v110, v118, vcc row_newbcast:1 row_mask:0xf bank_mask:0xf
s_mov_b64 vcc, s[20:21]
v_cndmask_b32_dpp v140, v128, v140, vcc row_newbcast:1 row_mask:0xf bank_mask:0xf
v_mfma_f32_16x16x32_bf16 v[92:95], v[136:139], v[116:119], v[8:11]
v_cndmask_b32_dpp v141, v129, v141, vcc row_newbcast:1 row_mask:0xf bank_mask:0xf
v_cndmask_b32_dpp v142, v130, v142, vcc row_newbcast:1 row_mask:0xf bank_mask:0xf
v_cndmask_b32_dpp v120, v108, v120, vcc row_newbcast:1 row_mask:0xf bank_mask:0xf
v_mfma_f32_16x16x16_bf16 v[176:179], v[118:119], v[14:15], 0
v_cndmask_b32_dpp v121, v109, v121, vcc row_newbcast:1 row_mask:0xf bank_mask:0xf
v_cndmask_b32_dpp v122, v110, v122, vcc row_newbcast:1 row_mask:0xf bank_mask:0xf
s_mov_b64 vcc, s[22:23]
v_cndmask_b32_dpp v144, v128, v144, vcc row_newbcast:1 row_mask:0xf bank_mask:0xf
v_mfma_f32_16x16x32_bf16 v[96:99], v[140:143], v[120:123], v[8:11]
v_cndmask_b32_dpp v145, v129, v145, vcc row_newbcast:1 row_mask:0xf bank_mask:0xf
v_cndmask_b32_dpp v146, v130, v146, vcc row_newbcast:1 row_mask:0xf bank_mask:0xf
v_cndmask_b32_dpp v124, v108, v124, vcc row_newbcast:1 row_mask:0xf bank_mask:0xf
v_mfma_f32_16x16x16_bf16 v[180:183], v[122:123], v[14:15], 0
v_cndmask_b32_dpp v125, v109, v125, vcc row_newbcast:1 row_mask:0xf bank_mask:0xf
v_cndmask_b32_dpp v126, v110, v126, vcc row_newbcast:1 row_mask:0xf bank_mask:0xf
v_mfma_f32_16x16x32_bf16 v[108:111], v[128:131], v[112:115], v[8:11]
v_fmac_f32 v148, v76, v56
v_fmac_f32 v149, v77, v56
v_fmac_f32 v150, v78, v56
v_mfma_f32_16x16x32_bf16 v[100:103], v[144:147], v[124:127], v[8:11]
v_fmac_f32 v151, v79, v56
v_mul_f32 v148, v148, v80
v_mul_f32 v149, v149, v81
v_mfma_f32_16x16x32_bf16 v[112:115], v[132:135], v[116:119], v[8:11]
v_mul_f32 v150, v150, v82
v_mul_f32 v151, v151, v83
v_mov_b32 v40, v149
v_mfma_f32_16x16x32_bf16 v[116:119], v[136:139], v[120:123], v[8:11]
v_mov_b32 v41, v149
v_cvt_pk_bf16_f32 v151, v150, v151
v_cvt_pk_bf16_f32 v150, v148, v149
v_mfma_f32_16x16x32_bf16 v[120:123], v[140:143], v[124:127], v[8:11]
v_permlane32_swap_b32 v40, v41
v_cvt_pk_bf16_f32 v40, v40, v40
v_bfi_b32 v152, v68, v40, v152
v_mfma_f32_16x16x16_bf16 v[184:187], v[126:127], v[14:15], 0
v_bfi_b32 v153, v69, v40, v153
v_bfi_b32 v154, v70, v40, v154
v_bfi_b32 v155, v71, v40, v155
v_bfi_b32 v156, v72, v40, v156
v_bfi_b32 v157, v73, v40, v157
v_bfi_b32 v158, v74, v40, v158
v_bfi_b32 v159, v75, v40, v159
s_waitcnt lgkmcnt(0)
s_nop 3
s_branch L_patched_s
L_99:
v_lshlrev_b32 v28, 16, v58
v_and_b32 v29, 0xffff0000, v58
v_lshlrev_b32 v30, 16, v59
v_and_b32 v31, 0xffff0000, v59
v_lshlrev_b32 v32, 16, v60
v_and_b32 v33, 0xffff0000, v60
v_lshlrev_b32 v34, 16, v61
v_and_b32 v35, 0xffff0000, v61
v_lshlrev_b32 v36, 16, v62
v_and_b32 v37, 0xffff0000, v62
v_lshlrev_b32 v38, 16, v63
v_and_b32 v39, 0xffff0000, v63
v_lshlrev_b32 v40, 16, v64
v_and_b32 v41, 0xffff0000, v64
v_lshlrev_b32 v42, 16, v65
v_and_b32 v43, 0xffff0000, v65
v_lshlrev_b32 v44, 16, v66
v_and_b32 v45, 0xffff0000, v66
v_lshlrev_b32 v46, 16, v67
v_and_b32 v47, 0xffff0000, v67
ds_read_b128 v[68:71], v180 offset:32256
ds_read_b128 v[72:75], v180 offset:33280
ds_read_b128 v[76:79], v180 offset:34304
ds_read_b128 v[80:83], v180 offset:35328
ds_read_b128 v[84:87], v182 offset:36352
ds_read_b128 v[88:91], v180 offset:36864
ds_read_b128 v[92:95], v180 offset:37888
ds_read_b128 v[96:99], v180 offset:38912
ds_read_b128 v[100:103], v180 offset:39936
ds_read_b128 v[104:107], v182 offset:40960
ds_read_b128 v[188:191], v5 offset:0
ds_read_b128 v[192:195], v5 offset:1024
ds_read_b128 v[196:199], v5 offset:2048
ds_read_b128 v[200:203], v5 offset:3072
ds_read_b128 v[204:207], v181 offset:4096
ds_read_b128 v[208:211], v5 offset:4608
ds_read_b128 v[212:215], v5 offset:5632
ds_read_b128 v[216:219], v5 offset:6656
s_waitcnt vmcnt(0) lgkmcnt(0)
s_branch L_100
L_117:
s_branch C_164
R_165:
s_sub_u32 s82, s82, 1
s_cbranch_scc1 L_exit
s_waitcnt vmcnt(0)
s_lshl_b32 s1, s74, 13
s_add_u32 s1, s1, 2949120
s_mov_b32 exec_lo, s52
s_mov_b32 exec_hi, 0
buffer_load_dwordx4 v[28:31], v38, s[24:27], s1 offen sc1
s_mov_b64 exec, -1
buffer_load_dwordx4 v[40:43], v50, s[24:27], s4 offen sc1
s_add_u32 s1, s4, 28688
s_mov_b64 exec, 255
buffer_load_dwordx4 v[44:47], v5, s[24:27], s1 offen sc1
s_mov_b64 exec, -1
s_waitcnt vmcnt(0)
C_164:
s_mov_b32 s9, s4
v_cmp_ne_u32 vcc, s80, v31
v_bfrev_b32 v36, 1
s_and_b32 vcc_lo, vcc_lo, s52
s_mov_b32 s52, vcc_lo
v_cndmask_b32 v28, v28, v36, vcc
s_nop 1
v_max_i32_dpp v36, v28, v28 row_ror:8 row_mask:0xf bank_mask:0xf
v_mov_b32 v31, v0
s_nop 0
v_max_i32_dpp v36, v36, v36 row_ror:4 row_mask:0xf bank_mask:0xf
s_nop 1
v_max_i32_dpp v36, v36, v36 row_ror:2 row_mask:0xf bank_mask:0xf
s_nop 1
v_max_i32_dpp v36, v36, v36 row_ror:1 row_mask:0xf bank_mask:0xf
s_nop 0
v_readlane_b32 s3, v36, 0
v_readlane_b32 s4, v36, 16
s_max_i32 s57, s3, s4
v_cmp_eq_u32 vcc, s57, v28
s_bfe_u32 s5, s57, 0x20004
s_lshl_b32 s5, s5, 10
s_add_u32 s5, s5, 4350592
s_ff1_i32_b32 s3, vcc_lo
s_mul_i32 s4, s3, 286720
s_add_u32 s4, s4, s5
v_max_u32 v48, v40, v41
v_max3_u32 v48, v48, v42, v43
v_max3_u32 v48, v48, v44, v45
v_max3_u32 v48, v48, v46, v47
v_cmp_eq_u32 vcc, -1, v48
s_xor_b32 s9, s9, s4
s_or_b32 s9, s9, vcc_lo
s_or_b32 s9, s9, vcc_hi
s_cbranch_scc1 R_165
v_add_u32 v48, 161408, v5
ds_write_b128 v48, v[40:43]
s_mov_b64 exec, 255
ds_write_b128 v48, v[44:47] offset:1024
s_mov_b64 exec, -1
s_lshl_b64 exec, 1, s3
ds_write_b128 v37, v[28:31]
s_mov_b64 exec, -1
s_cmp_lg_u32 s52, 0
s_cbranch_scc0 L_167
s_waitcnt lgkmcnt(0)
P_166:
s_sub_u32 s82, s82, 1
s_cbranch_scc1 L_exit
s_lshl_b32 s1, s74, 13
s_add_u32 s1, s1, 2949120
s_mov_b32 exec_lo, s52
s_mov_b32 exec_hi, 0
buffer_load_dwordx4 v[28:31], v38, s[24:27], s1 offen sc1
s_mov_b64 exec, -1
s_waitcnt vmcnt(0)
v_cmp_eq_u32 vcc, s80, v31
s_and_b32 s9, vcc_lo, s52
v_cmp_le_i32 vcc, s57, v28
s_and_b32 vcc_lo, vcc_lo, s9
s_cbranch_scc1 C_164
s_andn2_b32 s52, s52, s9
s_cbranch_scc1 P_166
L_167:
s_waitcnt vmcnt(0) lgkmcnt(0)
s_branch L_116
L_110:
s_waitcnt vmcnt(0) lgkmcnt(0)
s_cmp_eq_u32 s77, 0
s_cbranch_scc0 L_168
s_lshl_b32 s1, s74, 13
s_add_u32 s1, s1, 2949120
s_mov_b32 exec_hi, 0
buffer_load_dwordx4 v[28:31], v38, s[24:27], s1 offen sc1
s_mov_b64 exec, -1
L_168:
s_branch L_111
R_119:
s_sub_u32 s82, s82, 1
s_cbranch_scc1 L_exit
s_waitcnt vmcnt(0) lgkmcnt(0)
s_add_u32 s1, s85, 197632
buffer_load_dwordx4 v[60:63], v5, s[24:27], s1 offen sc1
s_waitcnt vmcnt(0) lgkmcnt(0)
s_branch C_118
L_120:
s_cmp_eq_u32 s77, 0
s_cbranch_scc0 L_169
s_waitcnt vmcnt(4)
s_branch C_170
R_171:
s_sub_u32 s82, s82, 1
s_cbranch_scc1 L_exit
s_waitcnt vmcnt(0)
s_lshl_b32 s1, s74, 13
s_add_u32 s1, s1, 2949120
s_mov_b32 exec_lo, vcc_lo
s_mov_b32 exec_hi, 0
buffer_load_dwordx4 v[28:31], v38, s[24:27], s1 offen sc1
s_mov_b64 exec, -1
s_waitcnt vmcnt(0)
C_170:
v_cmp_ne_u32 vcc, s80, v31
s_mov_b32 vcc_hi, 0
s_cbranch_vccnz R_171
v_max_i32_dpp v36, v28, v28 row_ror:8 row_mask:0xf bank_mask:0xf
v_mov_b32 v31, v0
s_nop 0
v_max_i32_dpp v36, v36, v36 row_ror:4 row_mask:0xf bank_mask:0xf
s_nop 1
v_max_i32_dpp v36, v36, v36 row_ror:2 row_mask:0xf bank_mask:0xf
s_nop 1
v_max_i32_dpp v36, v36, v36 row_ror:1 row_mask:0xf bank_mask:0xf
s_nop 0
v_readlane_b32 s3, v36, 0
v_readlane_b32 s4, v36, 16
s_max_i32 s57, s3, s4
v_cmp_eq_u32 vcc, s57, v28
s_bfe_u32 s5, s57, 0x20004
s_lshl_b32 s5, s5, 10
s_add_u32 s5, s5, 4350592
s_ff1_i32_b32 s3, vcc_lo
s_mul_i32 s4, s3, 286720
s_add_u32 s4, s4, s5
s_lshl_b64 exec, 1, s3
ds_write_b128 v37, v[28:31]
s_mov_b64 exec, -1
L_169:
s_waitcnt lgkmcnt(0)
s_branch L_121
R_124:
s_sub_u32 s82, s82, 1
s_cbranch_scc1 L_exit
s_waitcnt vmcnt(0) lgkmcnt(0)
buffer_load_dword v105, v104, s[24:27], 0 offen sc1
s_waitcnt vmcnt(0) lgkmcnt(0)
s_branch C_123
L_125:
s_branch C_172
R_173:
s_sub_u32 s82, s82, 1
s_cbranch_scc1 L_exit
s_mov_b64 exec, vcc
s_waitcnt vmcnt(0)
buffer_load_dword v64, v27, s[24:27], s4 offen sc1
s_add_u32 s1, s5, 3145728
buffer_load_dwordx4 v[28:31], v5, s[24:27], s1 offen offset:0 sc1
buffer_load_dwordx4 v[32:35], v5, s[24:27], s1 offen offset:1024 sc1
buffer_load_dwordx4 v[36:39], v5, s[24:27], s1 offen offset:2048 sc1
buffer_load_dwordx4 v[40:43], v5, s[24:27], s1 offen offset:3072 sc1
s_add_u32 s1, s5, 3149824
buffer_load_dwordx4 v[44:47], v5, s[24:27], s1 offen offset:0 sc1
buffer_load_dwordx4 v[48:51], v5, s[24:27], s1 offen offset:1024 sc1
buffer_load_dwordx4 v[52:55], v5, s[24:27], s1 offen offset:2048 sc1
buffer_load_dwordx4 v[56:59], v5, s[24:27], s1 offen offset:3072 sc1
s_add_u32 s1, s5, 3153920
buffer_load_dwordx4 v[60:63], v5, s[24:27], s1 offen offset:0 sc1
C_172:
s_waitcnt vmcnt(8)
v_max3_u32 v66, v64, v28, v29
v_max3_u32 v66, v66, v30, v31
s_waitcnt vmcnt(7)
v_max3_u32 v66, v66, v32, v33
v_max3_u32 v66, v66, v34, v35
v_pk_add_f32 v[28:29], v[28:29], v[32:33]
v_pk_add_f32 v[30:31], v[30:31], v[34:35]
s_waitcnt vmcnt(6)
v_max3_u32 v66, v66, v36, v37
v_max3_u32 v66, v66, v38, v39
v_pk_add_f32 v[28:29], v[28:29], v[36:37]
v_pk_add_f32 v[30:31], v[30:31], v[38:39]
s_waitcnt vmcnt(5)
v_max3_u32 v66, v66, v40, v41
v_max3_u32 v66, v66, v42, v43
v_pk_add_f32 v[28:29], v[28:29], v[40:41]
v_pk_add_f32 v[30:31], v[30:31], v[42:43]
s_waitcnt vmcnt(4)
v_max3_u32 v66, v66, v44, v45
v_max3_u32 v66, v66, v46, v47
v_pk_add_f32 v[28:29], v[28:29], v[44:45]
v_pk_add_f32 v[30:31], v[30:31], v[46:47]
s_waitcnt vmcnt(3)
v_max3_u32 v66, v66, v48, v49
v_max3_u32 v66, v66, v50, v51
v_pk_add_f32 v[28:29], v[28:29], v[48:49]
v_pk_add_f32 v[30:31], v[30:31], v[50:51]
s_waitcnt vmcnt(2)
v_max3_u32 v66, v66, v52, v53
v_max3_u32 v66, v66, v54, v55
v_pk_add_f32 v[28:29], v[28:29], v[52:53]
v_pk_add_f32 v[30:31], v[30:31], v[54:55]
s_waitcnt vmcnt(1)
v_max3_u32 v66, v66, v56, v57
v_max3_u32 v66, v66, v58, v59
v_pk_add_f32 v[28:29], v[28:29], v[56:57]
v_pk_add_f32 v[30:31], v[30:31], v[58:59]
s_waitcnt vmcnt(0)
v_max3_u32 v66, v66, v60, v61
v_max3_u32 v66, v66, v62, v63
v_cmp_eq_u32 vcc, -1, v66
v_pk_add_f32 v[28:29], v[28:29], v[60:61]
v_pk_add_f32 v[30:31], v[30:31], v[62:63]
s_cbranch_vccnz R_173
s_mov_b64 exec, -1
v_lshlrev_b32 v36, 16, v64
v_and_b32 v37, 0xffff0000, v64
v_permlane32_swap_b32 v28, v30
v_permlane32_swap_b32 v29, v31
v_pk_add_f32 v[28:29], v[28:29], v[30:31]
v_fma_f32 v36, v36, v22, s58
v_fma_f32 v37, v37, v22, s58
v_permlane16_swap_b32 v28, v30
v_permlane16_swap_b32 v29, v31
v_pk_add_f32 v[28:29], v[28:29], v[30:31]
s_nop 1
v_add_f32_dpp v28, v28, v28 row_ror:8 row_mask:0xf bank_mask:0xf
v_add_f32_dpp v29, v29, v29 row_ror:8 row_mask:0xf bank_mask:0xf
s_nop 0
v_add_f32_dpp v28, v28, v28 row_ror:4 row_mask:0xf bank_mask:0xf
v_add_f32_dpp v29, v29, v29 row_ror:4 row_mask:0xf bank_mask:0xf
s_mov_b32 exec_lo, 0xf
s_mov_b32 exec_hi, 0xf
v_fma_f32 v28, v28, v26, v36
v_fma_f32 v29, v29, v26, v37
v_cvt_pk_bf16_f32 v28, v28, v29
buffer_store_dword v28, v23, s[24:27], s89 offen offset:896 sc1
s_mov_b64 exec, -1
s_nop 1
s_branch L_126
L_128:
v_lshlrev_b32 v28, 16, v58
v_and_b32 v29, 0xffff0000, v58
v_pk_fma_f32 v[28:29], v[28:29], v[184:185], v[184:185] op_sel:[0,0,1] op_sel_hi:[1,0,1]
v_lshlrev_b32 v30, 16, v59
v_and_b32 v31, 0xffff0000, v59
v_pk_fma_f32 v[30:31], v[30:31], v[184:185], v[184:185] op_sel:[0,0,1] op_sel_hi:[1,0,1]
v_lshlrev_b32 v32, 16, v60
v_and_b32 v33, 0xffff0000, v60
v_pk_fma_f32 v[32:33], v[32:33], v[184:185], v[184:185] op_sel:[0,0,1] op_sel_hi:[1,0,1]
v_lshlrev_b32 v34, 16, v61
v_and_b32 v35, 0xffff0000, v61
v_pk_fma_f32 v[34:35], v[34:35], v[184:185], v[184:185] op_sel:[0,0,1] op_sel_hi:[1,0,1]
v_lshlrev_b32 v36, 16, v62
v_and_b32 v37, 0xffff0000, v62
v_pk_fma_f32 v[36:37], v[36:37], v[184:185], v[184:185] op_sel:[0,0,1] op_sel_hi:[1,0,1]
v_lshlrev_b32 v38, 16, v63
v_and_b32 v39, 0xffff0000, v63
v_pk_fma_f32 v[38:39], v[38:39], v[184:185], v[184:185] op_sel:[0,0,1] op_sel_hi:[1,0,1]
v_lshlrev_b32 v40, 16, v64
v_and_b32 v41, 0xffff0000, v64
v_pk_fma_f32 v[40:41], v[40:41], v[184:185], v[184:185] op_sel:[0,0,1] op_sel_hi:[1,0,1]
v_lshlrev_b32 v42, 16, v65
v_and_b32 v43, 0xffff0000, v65
v_pk_fma_f32 v[42:43], v[42:43], v[184:185], v[184:185] op_sel:[0,0,1] op_sel_hi:[1,0,1]
v_lshlrev_b32 v44, 16, v66
v_and_b32 v45, 0xffff0000, v66
v_pk_fma_f32 v[44:45], v[44:45], v[184:185], v[184:185] op_sel:[0,0,1] op_sel_hi:[1,0,1]
v_lshlrev_b32 v46, 16, v67
v_and_b32 v47, 0xffff0000, v67
v_pk_fma_f32 v[46:47], v[46:47], v[184:185], v[184:185] op_sel:[0,0,1] op_sel_hi:[1,0,1]
ds_read_b128 v[68:71], v180 offset:32256
ds_read_b128 v[72:75], v180 offset:33280
ds_read_b128 v[76:79], v180 offset:34304
ds_read_b128 v[80:83], v180 offset:35328
ds_read_b128 v[84:87], v182 offset:36352
ds_read_b128 v[88:91], v180 offset:36864
ds_read_b128 v[92:95], v180 offset:37888
ds_read_b128 v[96:99], v180 offset:38912
ds_read_b128 v[100:103], v180 offset:39936
ds_read_b128 v[104:107], v182 offset:40960
ds_read_b128 v[224:227], v5 offset:0
ds_read_b128 v[228:231], v5 offset:1024
ds_read_b128 v[232:235], v5 offset:2048
ds_read_b128 v[236:239], v5 offset:3072
ds_read_b128 v[240:243], v181 offset:4096
ds_read_b128 v[244:247], v5 offset:4608
ds_read_b128 v[248:251], v5 offset:5632
ds_read_b128 v[252:255], v5 offset:6656
ds_read_b128 a[0:3], v5 offset:7680
ds_read_b128 a[4:7], v181 offset:8704
ds_read_b128 a[8:11], v5 offset:9216
ds_read_b128 a[12:15], v5 offset:10240
ds_read_b128 a[16:19], v5 offset:11264
ds_read_b128 a[20:23], v5 offset:12288
ds_read_b128 a[24:27], v181 offset:13312
s_waitcnt vmcnt(0) lgkmcnt(0)
s_branch L_129
L_141:
s_waitcnt vmcnt(0) lgkmcnt(0)
s_sub_u32 s82, s82, 1
s_cbranch_scc1 L_exit
s_barrier
s_mov_b32 s8, 0
s_mov_b32 s12, 331776
s_add_u32 s89, s89, 32768
s_branch L_138
L_exit:
s_endpgm

.section .rodata,"a"
.p2align 6
.amdhsa_kernel interleave_layers__sliding_local_dilated__moe_arch_mod__prompt_kernel
  .amdhsa_next_free_vgpr 512
  .amdhsa_next_free_sgpr 102
  .amdhsa_accum_offset 256
  .amdhsa_group_segment_fixed_size 0
  .amdhsa_kernarg_size 88
  .amdhsa_user_sgpr_count 2
  .amdhsa_user_sgpr_kernarg_segment_ptr 1
  .amdhsa_system_sgpr_workgroup_id_x 1
.end_amdhsa_kernel
```
